```python
import torch

def _softmax(x, axis=-1):
    return torch.softmax(x, dim=axis)
def _gelu(x):
    return torch.nn.functional.gelu(x, approximate="tanh")
def _silu(x):
    return torch.nn.functional.silu(x)
def _sigmoid(x):
    return torch.sigmoid(x)
def _layernorm(x, axis=-1, eps=1e-5):
    m = x.mean(dim=axis, keepdim=True)
    v = x.var(dim=axis, keepdim=True, unbiased=False)
    return (x - m) / torch.sqrt(v + eps)
def _scatter_add(tgt, idx, src, axis=0):
    return tgt.clone().index_add_(axis, idx, src)
def _segment_sum(src, seg, n):
    out = torch.zeros((n,) + src.shape[1:], dtype=src.dtype)
    return out.index_add_(0, seg, src)
def _pad(x, pw):
    flat = tuple(v for pair in reversed(pw) for v in pair)
    return torch.nn.functional.pad(x, flat)

kernel_name = 'gated_mix__linear_attn_block__swiglu_ffn__prompt'

def setup_inputs():

    _w = (lambda a: (lambda t: t.to(torch.bfloat16) if t.is_floating_point() else t)(torch.as_tensor(a)))
    def _A_setup():
        B, S, D = 1, 2048, 576
        return {
            "x": _w((lambda *s: torch.randn(*s, dtype=torch.bfloat16) * 0.05)(B, S, D)),
            "wqkv": _w((lambda *s: torch.randn(*s, dtype=torch.bfloat16) * 0.8)(D, 3 * D)),
            "wo": _w((lambda *s: torch.randn(*s, dtype=torch.bfloat16) * 0.05)(D, D)),
        }
    _A_in = _A_setup()

    def _B_setup():
        B, S, D, F = 1, 2048, 576, 4608
        return {
            "x": _w((lambda *s: torch.randn(*s, dtype=torch.bfloat16) * 0.05)(B, S, D)),
            "w_gate": _w((lambda *s: torch.randn(*s, dtype=torch.bfloat16) * 0.05)(D, F)),
            "w_up": _w((lambda *s: torch.randn(*s, dtype=torch.bfloat16) * 0.05)(D, F)),
            "w_down": _w((lambda *s: torch.randn(*s, dtype=torch.bfloat16) * 0.05)(F, D)),
        }
    _B_in = _B_setup()

    return {
        "A_x": _A_in["x"],
        "A_wqkv": _A_in["wqkv"],
        "A_wo": _A_in["wo"],
        "B_x": _B_in["x"],
        "B_w_gate": _B_in["w_gate"],
        "B_w_up": _B_in["w_up"],
        "B_w_down": _B_in["w_down"],
        "gate_w": _w((lambda *s: torch.randn(*s, dtype=torch.bfloat16) * 0.05)(576) * 16.0),
    }

def reference(A_x, A_wqkv, A_wo, B_x, B_w_gate, B_w_up, B_w_down, gate_w):
    def _A_ref(x, wqkv, wo):
        B, S, D = x.shape
        H = 32; Dh = D // H
        qkv = (lambda x, *d: x.permute(*d))((x @ wqkv).reshape(B, S, 3, H, Dh), 2, 0, 3, 1, 4)
        q, k, v = qkv[0], qkv[1], qkv[2]
        phi = lambda t: torch.where(t > 0, t + 1, torch.exp(t)) + 1e-6
        pq, pk = phi(q), phi(k)
        kv = torch.einsum("bhsd,bhse->bhde", pk, v)
        z = torch.einsum("bhsd->bhd", pk)
        num = torch.einsum("bhqd,bhde->bhqe", pq, kv)
        den = torch.einsum("bhqd,bhd->bhq", pq, z)[..., None] + 1e-6
        o = num / den
        return (lambda x, *d: x.permute(*d))(o, 0, 2, 1, 3).reshape(B, S, D) @ wo

    def _B_ref(x, w_gate, w_up, w_down):
        g = _silu(x @ w_gate)
        u = x @ w_up
        return (g * u) @ w_down

    x = A_x
    g = _sigmoid((x * gate_w).sum(-1, keepdims=True))
    a = _A_ref(x, A_wqkv, A_wo)
    b = _B_ref(x, B_w_gate, B_w_up, B_w_down)
    return g * a + (1 - g) * b
```

```asm
; @launch grid=(256,1,1) block=(256,1,1) lds=163840
.amdgcn_target "amdgcn-amd-amdhsa--gfx950"
.text
.globl gated_mix__linear_attn_block__swiglu_ffn__prompt_kernel
.p2align 8
.type gated_mix__linear_attn_block__swiglu_ffn__prompt_kernel,@function
gated_mix__linear_attn_block__swiglu_ffn__prompt_kernel:
    s_cmp_ge_u32 s2, 256
    s_cbranch_scc1 k1_end
    s_mov_b32 s101, 0

    s_getpc_b64 s[30:31]
k1_pc:
    s_sub_u32 s30, s30, k1_pc-gated_mix__linear_attn_block__swiglu_ffn__prompt_kernel
    s_subb_u32 s31, s31, 0
    s_lshr_b32 s29, s2, 3
    s_lshl_b32 s29, s29, 12
    s_mov_b32 s28, m_code_end-gated_mix__linear_attn_block__swiglu_ffn__prompt_kernel-16
    v_lshlrev_b32 v25, 4, v0
    v_add_u32 v25, s29, v25
    v_min_u32 v25, s28, v25
    global_load_dwordx4 v[252:255], v25, s[30:31]

    s_load_dwordx2 s[4:5], s[0:1], 0
    s_load_dwordx2 s[6:7], s[0:1], 32
    s_load_dwordx2 s[8:9], s[0:1], 40
    s_load_dwordx2 s[10:11], s[0:1], 80
    s_load_dwordx2 s[88:89], s[0:1], 48
    s_load_dwordx2 s[90:91], s[0:1], 16
    s_load_dwordx4 s[80:83], s[0:1], 0
    s_load_dwordx4 s[84:87], s[0:1], 32
    s_load_dwordx2 s[96:97], s[0:1], 72

    s_and_b32 s21, s2, 7
    s_lshr_b32 s22, s2, 3
    s_and_b32 s23, s21, 1
    s_lshl_b32 s23, s23, 3
    s_and_b32 s24, s22, 7
    s_add_u32 s24, s24, s23
    s_lshr_b32 s25, s22, 3
    s_lshr_b32 s21, s21, 1
    s_mul_i32 s20, s21, 3
    s_add_u32 s20, s20, s25
    v_lshrrev_b32 v24, 6, v0
    v_and_b32 v0, 63, v0
    s_nop 0
    v_readfirstlane_b32 s26, v24

    s_waitcnt lgkmcnt(0)
    s_lshl_b32 s92, s2, 2
    s_add_u32 s92, s92, s26
    v_lshlrev_b32 v27, 4, v0
    v_lshrrev_b32 v28, 4, v0
    v_mul_u32_u24 v28, 768, v28
    v_and_b32 v29, 15, v0
    v_lshlrev_b32 v29, 4, v29
    v_add_u32 v28, v28, v29
    s_mov_b32 s19, 0x20000

    s_mov_b32 s16, s80
    s_mov_b32 s17, s81
    s_mov_b32 s18, 2359296
    s_mul_i32 s93, s92, 3072
    buffer_load_dwordx4 v[252:255], v27, s[16:19], s93 offen offset:0
    buffer_load_dwordx4 v[252:255], v27, s[16:19], s93 offen offset:1024
    buffer_load_dwordx4 v[252:255], v27, s[16:19], s93 offen offset:2048
    s_mov_b32 s16, s84
    s_mov_b32 s17, s85
    s_mov_b32 s18, 5308416
    s_lshl_b32 s93, s92, 1
    s_mul_hi_u32 s94, s93, 1431655766
    s_mul_i32 s95, s94, 3
    s_sub_u32 s95, s93, s95
    s_mul_i32 s94, s94, 9216
    s_mul_i32 s95, s95, 3072
    s_add_u32 s93, s94, s95
    buffer_load_dwordx4 v[252:255], v28, s[16:19], s93 offen
    s_lshl_b32 s93, s92, 1
    s_add_u32 s93, s93, 1
    s_mul_hi_u32 s94, s93, 1431655766
    s_mul_i32 s95, s94, 3
    s_sub_u32 s95, s93, s95
    s_mul_i32 s94, s94, 9216
    s_mul_i32 s95, s95, 3072
    s_add_u32 s93, s94, s95
    buffer_load_dwordx4 v[252:255], v28, s[16:19], s93 offen
    s_mov_b32 s16, s86
    s_mov_b32 s17, s87
    s_mov_b32 s18, 5308416
    s_lshl_b32 s93, s92, 1
    s_mul_hi_u32 s94, s93, 1431655766
    s_mul_i32 s95, s94, 3
    s_sub_u32 s95, s93, s95
    s_mul_i32 s94, s94, 9216
    s_mul_i32 s95, s95, 3072
    s_add_u32 s93, s94, s95
    buffer_load_dwordx4 v[252:255], v28, s[16:19], s93 offen
    s_lshl_b32 s93, s92, 1
    s_add_u32 s93, s93, 1
    s_mul_hi_u32 s94, s93, 1431655766
    s_mul_i32 s95, s94, 3
    s_sub_u32 s95, s93, s95
    s_mul_i32 s94, s94, 9216
    s_mul_i32 s95, s95, 3072
    s_add_u32 s93, s94, s95
    buffer_load_dwordx4 v[252:255], v28, s[16:19], s93 offen
    s_mov_b32 s16, s82
    s_mov_b32 s17, s83
    s_mov_b32 s18, 1990656
    s_mul_i32 s93, s92, 2048
    buffer_load_dwordx4 v[252:255], v27, s[16:19], s93 offen offset:0
    buffer_load_dwordx4 v[252:255], v27, s[16:19], s93 offen offset:1024
    s_cmp_eq_u32 s25, 3
    s_cbranch_scc1 k1_att

    s_waitcnt lgkmcnt(0)
    s_lshr_b32 s27, s26, 1
    s_and_b32 s28, s26, 1

    s_cmp_eq_u32 s27, 0
    s_cselect_b32 s36, s6, s8
    s_cselect_b32 s37, s7, s9
    s_mov_b32 s38, 5308416
    s_mov_b32 s39, 0x20000
    s_mov_b32 s40, s4
    s_mov_b32 s41, s5
    s_mov_b32 s42, 2359296
    s_mov_b32 s43, 0x20000
    s_mov_b32 s44, s10
    s_mov_b32 s45, s11
    s_mov_b32 s46, 21233664
    s_mov_b32 s47, 0x20000
    s_mov_b32 s60, 0xbfb8aa3b

    v_lshrrev_b32 v24, 3, v0
    v_and_b32 v25, 7, v0
    v_lshrrev_b32 v26, 1, v24
    s_lshl_b32 s29, s26, 5
    v_add_u32 v27, s29, v24
    v_mul_u32_u24 v27, 1152, v27

    v_add_u32 v28, 0, v26
    v_and_b32 v28, 7, v28
    v_xor_b32 v28, v28, v25
    v_lshlrev_b32 v28, 4, v28
    v_add_u32 v11, v27, v28
    v_add_u32 v28, 4, v26
    v_and_b32 v28, 7, v28
    v_xor_b32 v28, v28, v25
    v_lshlrev_b32 v28, 4, v28
    v_add_u32 v12, v27, v28
    v_add_u32 v12, 8192, v12
    v_add_u32 v28, 8, v26
    v_and_b32 v28, 7, v28
    v_xor_b32 v28, v28, v25
    v_lshlrev_b32 v28, 4, v28
    v_add_u32 v13, v27, v28
    v_add_u32 v13, 16384, v13
    v_add_u32 v28, 12, v26
    v_and_b32 v28, 7, v28
    v_xor_b32 v28, v28, v25
    v_lshlrev_b32 v28, 4, v28
    v_add_u32 v14, v27, v28
    v_add_u32 v14, 24576, v14
    v_and_b32 v28, 1, v26
    s_lshl_b32 s29, s27, 1
    v_or_b32 v28, s29, v28
    v_lshlrev_b32 v28, 1, v28
    v_xor_b32 v28, v28, v25
    v_lshlrev_b32 v28, 4, v28
    s_lshl_b32 s29, s28, 5
    v_add_u32 v27, s29, v24
    v_mul_u32_u24 v27, 9216, v27
    v_add_u32 v7, v27, v28

    v_add_u32 v8, 72704, v7
    v_add_u32 v9, 145408, v7
    v_add_u32 v10, 218112, v7
    s_mul_i32 s50, s24, 147456
    s_mul_i32 s51, s20, 768
    s_lshl_b32 s52, s26, 12

    s_mul_i32 s29, s24, 12
    s_add_u32 s29, s29, s20
    s_lshl_b32 s29, s29, 2
    s_add_u32 s29, s29, s26
    s_lshl_b32 s29, s29, 1
    s_add_u32 s12, s10, 67108864
    s_addc_u32 s13, s11, 0
    s_mov_b32 s15, 0x20000
    s_mov_b32 s19, 0x20000
    s_mov_b32 s55, s29

    s_add_u32 m0, s52, 0
    s_add_u32 s53, s50, 0
    buffer_load_dwordx4 v11, s[40:43], s53 offen offset:0  lds
    buffer_load_dwordx4 v12, s[40:43], s53 offen offset:1024  lds
    buffer_load_dwordx4 v13, s[40:43], s53 offen offset:2048  lds
    buffer_load_dwordx4 v14, s[40:43], s53 offen offset:3072  lds
    s_add_u32 m0, s52, 16384
    s_add_u32 s53, s51, 0
    buffer_load_dwordx4 v7, s[36:39], s53 offen offset:0  lds
    buffer_load_dwordx4 v8, s[36:39], s53 offen offset:1024  lds
    buffer_load_dwordx4 v9, s[36:39], s53 offen offset:2048  lds
    buffer_load_dwordx4 v10, s[36:39], s53 offen offset:3072  lds
    s_add_u32 m0, s52, 32768
    s_add_u32 s53, s50, 128
    buffer_load_dwordx4 v11, s[40:43], s53 offen offset:0  lds
    buffer_load_dwordx4 v12, s[40:43], s53 offen offset:1024  lds
    buffer_load_dwordx4 v13, s[40:43], s53 offen offset:2048  lds
    buffer_load_dwordx4 v14, s[40:43], s53 offen offset:3072  lds
    s_add_u32 m0, s52, 49152
    s_add_u32 s53, s51, 589824
    buffer_load_dwordx4 v7, s[36:39], s53 offen offset:0  lds
    buffer_load_dwordx4 v8, s[36:39], s53 offen offset:1024  lds
    buffer_load_dwordx4 v9, s[36:39], s53 offen offset:2048  lds
    buffer_load_dwordx4 v10, s[36:39], s53 offen offset:3072  lds
    s_mul_i32 s29, s24, 12
    s_add_u32 s29, s29, s20
    s_cmp_lt_u32 s29, 16
    s_cselect_b32 s66, 1, 0
    s_cmp_eq_u32 s26, 0
    s_cselect_b32 s66, s66, 0
    s_add_u32 s16, s10, 58720256
    s_addc_u32 s17, s11, 0
    s_mov_b32 s18, 38912
    s_mov_b32 s19, 0x20000
    s_cmp_eq_u32 s66, 0
    s_cbranch_scc1 k1_nozero
    s_mul_i32 s29, s29, 19
    v_add_u32 v29, s29, v0
    v_lshlrev_b32 v29, 7, v29
    v_mov_b32 v28, 0
    s_mov_b64 exec, 0x7ffff
    buffer_store_dword v28, v29, s[16:19], 0 offen sc1
    s_mov_b64 exec, -1

k1_nozero:
    v_bfe_u32 v24, v0, 4, 1
    v_lshrrev_b32 v25, 5, v0
    v_bfe_u32 v26, v0, 2, 2
    v_and_b32 v27, 3, v0
    v_lshrrev_b32 v28, 1, v26
    v_lshlrev_b32 v29, 1, v24
    v_or_b32 v28, v28, v29
    v_lshlrev_b32 v29, 3, v25
    v_add_u32 v29, v29, v26
    v_lshlrev_b32 v29, 7, v29
    v_lshlrev_b32 v30, 13, v24
    v_add_u32 v29, v29, v30
    v_lshlrev_b32 v27, 3, v27
    v_add_u32 v29, v29, v27
    s_lshl_b32 s29, s28, 1

    s_add_u32 s30, s29, 0
    v_xor_b32 v30, s30, v28
    v_lshlrev_b32 v30, 5, v30
    v_add_u32 v1, v29, v30
    v_add_u32 v2, 0x10000, v1
    v_add_u32 v3, 0x20000, v1
    s_add_u32 s30, s29, 1
    v_xor_b32 v30, s30, v28
    v_lshlrev_b32 v30, 5, v30
    v_add_u32 v4, v29, v30
    v_add_u32 v5, 0x10000, v4
    v_add_u32 v6, 0x20000, v4
    v_and_b32 v24, 31, v0
    v_bfe_u32 v26, v24, 1, 3
    s_lshl_b32 s29, s27, 6
    v_add_u32 v27, s29, v24
    v_lshlrev_b32 v27, 7, v27

    v_add_u32 v28, 0, v25
    v_xor_b32 v28, v28, v26
    v_lshlrev_b32 v28, 4, v28
    v_add_u32 v15, v27, v28
    v_add_u32 v28, 2, v25
    v_xor_b32 v28, v28, v26
    v_lshlrev_b32 v28, 4, v28
    v_add_u32 v16, v27, v28
    v_add_u32 v28, 4, v25
    v_xor_b32 v28, v28, v26
    v_lshlrev_b32 v28, 4, v28
    v_add_u32 v17, v27, v28
    v_add_u32 v28, 6, v25
    v_xor_b32 v28, v28, v26
    v_lshlrev_b32 v28, 4, v28
    v_add_u32 v18, v27, v28
    v_lshrrev_b32 v26, 4, v24
    v_lshlrev_b32 v26, 10, v26
    v_and_b32 v27, 15, v0
    v_lshlrev_b32 v27, 4, v27
    v_lshlrev_b32 v28, 8, v25
    v_add3_u32 v26, v26, v27, v28
    s_lshl_b32 s29, s27, 12
    s_lshl_b32 s30, s24, 13
    s_add_u32 s29, s29, s30
    s_lshl_b32 s30, s28, 17
    s_add_u32 s29, s29, s30
    v_add_u32 v23, s29, v26
    s_mul_i32 s48, s20, 1572864

    s_waitcnt vmcnt(8)
    s_barrier
    v_add_u32 v19, 0, v15
    ds_read_b128 a[0:3], v19 offset:0
    ds_read_b128 a[4:7], v19 offset:4096
    v_add_u32 v20, 0, v16
    ds_read_b128 a[8:11], v20 offset:0
    ds_read_b128 a[12:15], v20 offset:4096
    v_add_u32 v21, 0, v17
    ds_read_b128 a[16:19], v21 offset:0
    ds_read_b128 a[20:23], v21 offset:4096
    v_add_u32 v22, 0, v18
    ds_read_b128 a[24:27], v22 offset:0
    ds_read_b128 a[28:31], v22 offset:4096
    ds_read_b64_tr_b16 v[192:193], v1 offset:16384
    ds_read_b64_tr_b16 v[194:195], v1 offset:16896
    ds_read_b64_tr_b16 v[196:197], v4 offset:16384
    ds_read_b64_tr_b16 v[198:199], v4 offset:16896
    ds_read_b64_tr_b16 v[200:201], v1 offset:18432
    ds_read_b64_tr_b16 v[202:203], v1 offset:18944
    s_waitcnt vmcnt(0)
    s_waitcnt lgkmcnt(6)
    s_barrier
    s_waitcnt lgkmcnt(4)
    v_mfma_f32_32x32x16_bf16 v[64:79], v[192:195], a[0:3], 0
    ds_read_b64_tr_b16 v[204:205], v4 offset:18432
    v_add_u32 v19, 32768, v15
    s_add_u32 m0, s52, 65536
    s_add_u32 s53, s50, 256
    buffer_load_dwordx4 v11, s[40:43], s53 offen offset:0  lds
    v_mfma_f32_32x32x16_bf16 v[80:95], v[192:195], a[4:7], 0
    ds_read_b64_tr_b16 v[206:207], v4 offset:18944
    ds_read_b128 a[32:35], v19 offset:0
    buffer_load_dwordx4 v12, s[40:43], s53 offen offset:1024  lds
    s_waitcnt lgkmcnt(5)
    v_mfma_f32_32x32x16_bf16 v[96:111], v[196:199], a[0:3], 0
    ds_read_b64_tr_b16 v[192:193], v1 offset:20480
    ds_read_b128 a[36:39], v19 offset:4096
    buffer_load_dwordx4 v13, s[40:43], s53 offen offset:2048  lds
    v_mfma_f32_32x32x16_bf16 v[112:127], v[196:199], a[4:7], 0
    ds_read_b64_tr_b16 v[194:195], v1 offset:20992
    v_add_u32 v20, 32768, v16
    s_waitcnt lgkmcnt(6)
    v_mfma_f32_32x32x16_bf16 v[64:79], v[200:203], a[8:11], v[64:79]
    ds_read_b64_tr_b16 v[196:197], v4 offset:20480
    ds_read_b128 a[40:43], v20 offset:0
    buffer_load_dwordx4 v14, s[40:43], s53 offen offset:3072  lds
    v_mfma_f32_32x32x16_bf16 v[80:95], v[200:203], a[12:15], v[80:95]
    ds_read_b64_tr_b16 v[198:199], v4 offset:20992
    ds_read_b128 a[44:47], v20 offset:4096
    s_add_u32 m0, s52, 81920
    s_add_u32 s53, s51, 1179648
    buffer_load_dwordx4 v7, s[36:39], s53 offen offset:0  lds
    s_waitcnt lgkmcnt(8)
    v_mfma_f32_32x32x16_bf16 v[96:111], v[204:207], a[8:11], v[96:111]
    ds_read_b64_tr_b16 v[200:201], v1 offset:22528
    v_add_u32 v21, 32768, v17
    buffer_load_dwordx4 v8, s[36:39], s53 offen offset:1024  lds
    v_mfma_f32_32x32x16_bf16 v[112:127], v[204:207], a[12:15], v[112:127]
    ds_read_b64_tr_b16 v[202:203], v1 offset:23040
    ds_read_b128 a[48:51], v21 offset:0
    s_waitcnt lgkmcnt(7)
    v_mfma_f32_32x32x16_bf16 v[64:79], v[192:195], a[16:19], v[64:79]
    ds_read_b64_tr_b16 v[204:205], v4 offset:22528
    ds_read_b128 a[52:55], v21 offset:4096
    buffer_load_dwordx4 v9, s[36:39], s53 offen offset:2048  lds
    v_mfma_f32_32x32x16_bf16 v[80:95], v[192:195], a[20:23], v[80:95]
    ds_read_b64_tr_b16 v[206:207], v4 offset:23040
    v_add_u32 v22, 32768, v18
    buffer_load_dwordx4 v10, s[36:39], s53 offen offset:3072  lds
    s_waitcnt lgkmcnt(7)
    v_mfma_f32_32x32x16_bf16 v[96:111], v[196:199], a[16:19], v[96:111]
    ds_read_b64_tr_b16 v[192:193], v1 offset:49152
    ds_read_b128 a[56:59], v22 offset:0
    s_add_u32 m0, s52, 98304
    s_add_u32 s53, s50, 384
    buffer_load_dwordx4 v11, s[40:43], s53 offen offset:0  lds
    v_mfma_f32_32x32x16_bf16 v[112:127], v[196:199], a[20:23], v[112:127]
    ds_read_b64_tr_b16 v[194:195], v1 offset:49664
    ds_read_b128 a[60:63], v22 offset:4096
    s_waitcnt lgkmcnt(8)
    v_mfma_f32_32x32x16_bf16 v[64:79], v[200:203], a[24:27], v[64:79]
    ds_read_b64_tr_b16 v[196:197], v4 offset:49152
    buffer_load_dwordx4 v12, s[40:43], s53 offen offset:1024  lds
    v_mfma_f32_32x32x16_bf16 v[80:95], v[200:203], a[28:31], v[80:95]
    ds_read_b64_tr_b16 v[198:199], v4 offset:49664
    buffer_load_dwordx4 v13, s[40:43], s53 offen offset:2048  lds
    s_waitcnt lgkmcnt(6)
    v_mfma_f32_32x32x16_bf16 v[96:111], v[204:207], a[24:27], v[96:111]
    ds_read_b64_tr_b16 v[200:201], v1 offset:51200
    buffer_load_dwordx4 v14, s[40:43], s53 offen offset:3072  lds
    v_mfma_f32_32x32x16_bf16 v[112:127], v[204:207], a[28:31], v[112:127]
    ds_read_b64_tr_b16 v[202:203], v1 offset:51712
    s_waitcnt vmcnt(4)
    s_waitcnt lgkmcnt(4)
    s_barrier
    s_waitcnt lgkmcnt(5)
    v_mfma_f32_32x32x16_bf16 v[64:79], v[192:195], a[32:35], v[64:79]
    ds_read_b64_tr_b16 v[204:205], v4 offset:51200
    v_add_u32 v19, 65536, v15
    s_add_u32 m0, s52, 114688
    s_add_u32 s53, s51, 1769472
    buffer_load_dwordx4 v7, s[36:39], s53 offen offset:0  lds
    v_mfma_f32_32x32x16_bf16 v[80:95], v[192:195], a[36:39], v[80:95]
    ds_read_b64_tr_b16 v[206:207], v4 offset:51712
    ds_read_b128 a[64:67], v19 offset:0
    buffer_load_dwordx4 v8, s[36:39], s53 offen offset:1024  lds
    s_waitcnt lgkmcnt(5)
    v_mfma_f32_32x32x16_bf16 v[96:111], v[196:199], a[32:35], v[96:111]
    ds_read_b64_tr_b16 v[192:193], v1 offset:53248
    ds_read_b128 a[68:71], v19 offset:4096
    buffer_load_dwordx4 v9, s[36:39], s53 offen offset:2048  lds
    v_mfma_f32_32x32x16_bf16 v[112:127], v[196:199], a[36:39], v[112:127]
    ds_read_b64_tr_b16 v[194:195], v1 offset:53760
    v_add_u32 v20, 65536, v16
    s_waitcnt lgkmcnt(6)
    v_mfma_f32_32x32x16_bf16 v[64:79], v[200:203], a[40:43], v[64:79]
    ds_read_b64_tr_b16 v[196:197], v4 offset:53248
    ds_read_b128 a[72:75], v20 offset:0
    buffer_load_dwordx4 v10, s[36:39], s53 offen offset:3072  lds
    v_mfma_f32_32x32x16_bf16 v[80:95], v[200:203], a[44:47], v[80:95]
    ds_read_b64_tr_b16 v[198:199], v4 offset:53760
    ds_read_b128 a[76:79], v20 offset:4096
    s_add_u32 m0, s52, 131072
    s_add_u32 s53, s50, 512
    buffer_load_dwordx4 v11, s[40:43], s53 offen offset:0  lds
    s_waitcnt lgkmcnt(8)
    v_mfma_f32_32x32x16_bf16 v[96:111], v[204:207], a[40:43], v[96:111]
    ds_read_b64_tr_b16 v[200:201], v1 offset:55296
    v_add_u32 v21, 65536, v17
    buffer_load_dwordx4 v12, s[40:43], s53 offen offset:1024  lds
    v_mfma_f32_32x32x16_bf16 v[112:127], v[204:207], a[44:47], v[112:127]
    ds_read_b64_tr_b16 v[202:203], v1 offset:55808
    ds_read_b128 a[80:83], v21 offset:0
    s_waitcnt lgkmcnt(7)
    v_mfma_f32_32x32x16_bf16 v[64:79], v[192:195], a[48:51], v[64:79]
    ds_read_b64_tr_b16 v[204:205], v4 offset:55296
    ds_read_b128 a[84:87], v21 offset:4096
    buffer_load_dwordx4 v13, s[40:43], s53 offen offset:2048  lds
    v_mfma_f32_32x32x16_bf16 v[80:95], v[192:195], a[52:55], v[80:95]
    ds_read_b64_tr_b16 v[206:207], v4 offset:55808
    v_add_u32 v22, 65536, v18
    buffer_load_dwordx4 v14, s[40:43], s53 offen offset:3072  lds
    s_waitcnt lgkmcnt(7)
    v_mfma_f32_32x32x16_bf16 v[96:111], v[196:199], a[48:51], v[96:111]
    ds_read_b64_tr_b16 v[192:193], v2 offset:16384
    ds_read_b128 a[88:91], v22 offset:0
    s_add_u32 m0, s52, 0
    s_add_u32 s53, s51, 2359296
    buffer_load_dwordx4 v7, s[36:39], s53 offen offset:0  lds
    v_mfma_f32_32x32x16_bf16 v[112:127], v[196:199], a[52:55], v[112:127]
    ds_read_b64_tr_b16 v[194:195], v2 offset:16896
    ds_read_b128 a[92:95], v22 offset:4096
    s_waitcnt lgkmcnt(8)
    v_mfma_f32_32x32x16_bf16 v[64:79], v[200:203], a[56:59], v[64:79]
    ds_read_b64_tr_b16 v[196:197], v5 offset:16384
    buffer_load_dwordx4 v8, s[36:39], s53 offen offset:1024  lds
    v_mfma_f32_32x32x16_bf16 v[80:95], v[200:203], a[60:63], v[80:95]
    ds_read_b64_tr_b16 v[198:199], v5 offset:16896
    buffer_load_dwordx4 v9, s[36:39], s53 offen offset:2048  lds
    s_waitcnt lgkmcnt(6)
    v_mfma_f32_32x32x16_bf16 v[96:111], v[204:207], a[56:59], v[96:111]
    ds_read_b64_tr_b16 v[200:201], v2 offset:18432
    buffer_load_dwordx4 v10, s[36:39], s53 offen offset:3072  lds
    v_mfma_f32_32x32x16_bf16 v[112:127], v[204:207], a[60:63], v[112:127]
    ds_read_b64_tr_b16 v[202:203], v2 offset:18944
    s_waitcnt vmcnt(8)
    s_waitcnt lgkmcnt(4)
    s_barrier
    s_waitcnt lgkmcnt(5)
    v_mfma_f32_32x32x16_bf16 v[64:79], v[192:195], a[64:67], v[64:79]
    ds_read_b64_tr_b16 v[204:205], v5 offset:18432
    v_add_u32 v19, 98304, v15
    s_add_u32 m0, s52, 16384
    s_add_u32 s53, s50, 640
    buffer_load_dwordx4 v11, s[40:43], s53 offen offset:0  lds
    v_mfma_f32_32x32x16_bf16 v[80:95], v[192:195], a[68:71], v[80:95]
    ds_read_b64_tr_b16 v[206:207], v5 offset:18944
    ds_read_b128 a[96:99], v19 offset:0
    buffer_load_dwordx4 v12, s[40:43], s53 offen offset:1024  lds
    s_waitcnt lgkmcnt(5)
    v_mfma_f32_32x32x16_bf16 v[96:111], v[196:199], a[64:67], v[96:111]
    ds_read_b64_tr_b16 v[192:193], v2 offset:20480
    ds_read_b128 a[100:103], v19 offset:4096
    buffer_load_dwordx4 v13, s[40:43], s53 offen offset:2048  lds
    v_mfma_f32_32x32x16_bf16 v[112:127], v[196:199], a[68:71], v[112:127]
    ds_read_b64_tr_b16 v[194:195], v2 offset:20992
    v_add_u32 v20, 98304, v16
    s_waitcnt lgkmcnt(6)
    v_mfma_f32_32x32x16_bf16 v[64:79], v[200:203], a[72:75], v[64:79]
    ds_read_b64_tr_b16 v[196:197], v5 offset:20480
    ds_read_b128 a[104:107], v20 offset:0
    buffer_load_dwordx4 v14, s[40:43], s53 offen offset:3072  lds
    v_mfma_f32_32x32x16_bf16 v[80:95], v[200:203], a[76:79], v[80:95]
    ds_read_b64_tr_b16 v[198:199], v5 offset:20992
    ds_read_b128 a[108:111], v20 offset:4096
    s_add_u32 m0, s52, 32768
    s_add_u32 s53, s51, 2949120
    buffer_load_dwordx4 v7, s[36:39], s53 offen offset:0  lds
    s_waitcnt lgkmcnt(8)
    v_mfma_f32_32x32x16_bf16 v[96:111], v[204:207], a[72:75], v[96:111]
    ds_read_b64_tr_b16 v[200:201], v2 offset:22528
    v_add_u32 v21, 98304, v17
    buffer_load_dwordx4 v8, s[36:39], s53 offen offset:1024  lds
    v_mfma_f32_32x32x16_bf16 v[112:127], v[204:207], a[76:79], v[112:127]
    ds_read_b64_tr_b16 v[202:203], v2 offset:23040
    ds_read_b128 a[112:115], v21 offset:0
    s_waitcnt lgkmcnt(7)
    v_mfma_f32_32x32x16_bf16 v[64:79], v[192:195], a[80:83], v[64:79]
    ds_read_b64_tr_b16 v[204:205], v5 offset:22528
    ds_read_b128 a[116:119], v21 offset:4096
    buffer_load_dwordx4 v9, s[36:39], s53 offen offset:2048  lds
    v_mfma_f32_32x32x16_bf16 v[80:95], v[192:195], a[84:87], v[80:95]
    ds_read_b64_tr_b16 v[206:207], v5 offset:23040
    v_add_u32 v22, 98304, v18
    buffer_load_dwordx4 v10, s[36:39], s53 offen offset:3072  lds
    s_waitcnt lgkmcnt(7)
    v_mfma_f32_32x32x16_bf16 v[96:111], v[196:199], a[80:83], v[96:111]
    ds_read_b64_tr_b16 v[192:193], v2 offset:49152
    ds_read_b128 a[120:123], v22 offset:0
    s_add_u32 m0, s52, 49152
    s_add_u32 s53, s50, 768
    buffer_load_dwordx4 v11, s[40:43], s53 offen offset:0  lds
    v_mfma_f32_32x32x16_bf16 v[112:127], v[196:199], a[84:87], v[112:127]
    ds_read_b64_tr_b16 v[194:195], v2 offset:49664
    ds_read_b128 a[124:127], v22 offset:4096
    s_waitcnt lgkmcnt(8)
    v_mfma_f32_32x32x16_bf16 v[64:79], v[200:203], a[88:91], v[64:79]
    ds_read_b64_tr_b16 v[196:197], v5 offset:49152
    buffer_load_dwordx4 v12, s[40:43], s53 offen offset:1024  lds
    v_mfma_f32_32x32x16_bf16 v[80:95], v[200:203], a[92:95], v[80:95]
    ds_read_b64_tr_b16 v[198:199], v5 offset:49664
    buffer_load_dwordx4 v13, s[40:43], s53 offen offset:2048  lds
    s_waitcnt lgkmcnt(6)
    v_mfma_f32_32x32x16_bf16 v[96:111], v[204:207], a[88:91], v[96:111]
    ds_read_b64_tr_b16 v[200:201], v2 offset:51200
    buffer_load_dwordx4 v14, s[40:43], s53 offen offset:3072  lds
    v_mfma_f32_32x32x16_bf16 v[112:127], v[204:207], a[92:95], v[112:127]
    ds_read_b64_tr_b16 v[202:203], v2 offset:51712
    s_waitcnt vmcnt(12)
    s_waitcnt lgkmcnt(4)
    s_barrier
    s_waitcnt lgkmcnt(5)
    v_mfma_f32_32x32x16_bf16 v[64:79], v[192:195], a[96:99], v[64:79]
    ds_read_b64_tr_b16 v[204:205], v5 offset:51200
    v_add_u32 v19, 131072, v15
    s_add_u32 m0, s52, 65536
    s_add_u32 s53, s51, 3538944
    buffer_load_dwordx4 v7, s[36:39], s53 offen offset:0  lds
    v_mfma_f32_32x32x16_bf16 v[80:95], v[192:195], a[100:103], v[80:95]
    ds_read_b64_tr_b16 v[206:207], v5 offset:51712
    ds_read_b128 a[128:131], v19 offset:0
    buffer_load_dwordx4 v8, s[36:39], s53 offen offset:1024  lds
    s_waitcnt lgkmcnt(5)
    v_mfma_f32_32x32x16_bf16 v[96:111], v[196:199], a[96:99], v[96:111]
    ds_read_b64_tr_b16 v[192:193], v2 offset:53248
    ds_read_b128 a[132:135], v19 offset:4096
    buffer_load_dwordx4 v9, s[36:39], s53 offen offset:2048  lds
    v_mfma_f32_32x32x16_bf16 v[112:127], v[196:199], a[100:103], v[112:127]
    ds_read_b64_tr_b16 v[194:195], v2 offset:53760
    v_add_u32 v20, 131072, v16
    s_waitcnt lgkmcnt(6)
    v_mfma_f32_32x32x16_bf16 v[64:79], v[200:203], a[104:107], v[64:79]
    ds_read_b64_tr_b16 v[196:197], v5 offset:53248
    ds_read_b128 a[136:139], v20 offset:0
    buffer_load_dwordx4 v10, s[36:39], s53 offen offset:3072  lds
    v_mfma_f32_32x32x16_bf16 v[80:95], v[200:203], a[108:111], v[80:95]
    ds_read_b64_tr_b16 v[198:199], v5 offset:53760
    ds_read_b128 a[140:143], v20 offset:4096
    s_add_u32 m0, s52, 81920
    s_add_u32 s53, s50, 896
    buffer_load_dwordx4 v11, s[40:43], s53 offen offset:0  lds
    s_waitcnt lgkmcnt(8)
    v_mfma_f32_32x32x16_bf16 v[96:111], v[204:207], a[104:107], v[96:111]
    ds_read_b64_tr_b16 v[200:201], v2 offset:55296
    v_add_u32 v21, 131072, v17
    buffer_load_dwordx4 v12, s[40:43], s53 offen offset:1024  lds
    v_mfma_f32_32x32x16_bf16 v[112:127], v[204:207], a[108:111], v[112:127]
    ds_read_b64_tr_b16 v[202:203], v2 offset:55808
    ds_read_b128 a[144:147], v21 offset:0
    s_waitcnt lgkmcnt(7)
    v_mfma_f32_32x32x16_bf16 v[64:79], v[192:195], a[112:115], v[64:79]
    ds_read_b64_tr_b16 v[204:205], v5 offset:55296
    ds_read_b128 a[148:151], v21 offset:4096
    buffer_load_dwordx4 v13, s[40:43], s53 offen offset:2048  lds
    v_mfma_f32_32x32x16_bf16 v[80:95], v[192:195], a[116:119], v[80:95]
    ds_read_b64_tr_b16 v[206:207], v5 offset:55808
    v_add_u32 v22, 131072, v18
    buffer_load_dwordx4 v14, s[40:43], s53 offen offset:3072  lds
    s_waitcnt lgkmcnt(7)
    v_mfma_f32_32x32x16_bf16 v[96:111], v[196:199], a[112:115], v[96:111]
    ds_read_b64_tr_b16 v[192:193], v1 offset:0
    ds_read_b128 a[152:155], v22 offset:0
    s_add_u32 m0, s52, 98304
    s_add_u32 s53, s51, 4128768
    buffer_load_dwordx4 v7, s[36:39], s53 offen offset:0  lds
    v_mfma_f32_32x32x16_bf16 v[112:127], v[196:199], a[116:119], v[112:127]
    ds_read_b64_tr_b16 v[194:195], v1 offset:512
    ds_read_b128 a[156:159], v22 offset:4096
    s_waitcnt lgkmcnt(8)
    v_mfma_f32_32x32x16_bf16 v[64:79], v[200:203], a[120:123], v[64:79]
    ds_read_b64_tr_b16 v[196:197], v4 offset:0
    buffer_load_dwordx4 v8, s[36:39], s53 offen offset:1024  lds
    v_mfma_f32_32x32x16_bf16 v[80:95], v[200:203], a[124:127], v[80:95]
    ds_read_b64_tr_b16 v[198:199], v4 offset:512
    buffer_load_dwordx4 v9, s[36:39], s53 offen offset:2048  lds
    s_waitcnt lgkmcnt(6)
    v_mfma_f32_32x32x16_bf16 v[96:111], v[204:207], a[120:123], v[96:111]
    ds_read_b64_tr_b16 v[200:201], v1 offset:2048
    buffer_load_dwordx4 v10, s[36:39], s53 offen offset:3072  lds
    v_mfma_f32_32x32x16_bf16 v[112:127], v[204:207], a[124:127], v[112:127]
    ds_read_b64_tr_b16 v[202:203], v1 offset:2560
    s_waitcnt vmcnt(16)
    s_waitcnt lgkmcnt(4)
    s_barrier
    s_waitcnt lgkmcnt(5)
    v_mfma_f32_32x32x16_bf16 v[64:79], v[192:195], a[128:131], v[64:79]
    ds_read_b64_tr_b16 v[204:205], v4 offset:2048
    v_add_u32 v19, 16384, v15
    v_mfma_f32_32x32x16_bf16 v[80:95], v[192:195], a[132:135], v[80:95]
    ds_read_b64_tr_b16 v[206:207], v4 offset:2560
    ds_read_b128 a[160:163], v19 offset:0
    s_add_u32 m0, s52, 114688
    s_add_u32 s53, s50, 1024
    buffer_load_dwordx4 v11, s[40:43], s53 offen offset:0  lds
    s_waitcnt lgkmcnt(5)
    v_mfma_f32_32x32x16_bf16 v[96:111], v[196:199], a[128:131], v[96:111]
    ds_read_b64_tr_b16 v[192:193], v1 offset:4096
    ds_read_b128 a[164:167], v19 offset:4096
    v_mfma_f32_32x32x16_bf16 v[112:127], v[196:199], a[132:135], v[112:127]
    ds_read_b64_tr_b16 v[194:195], v1 offset:4608
    v_add_u32 v20, 16384, v16
    buffer_load_dwordx4 v12, s[40:43], s53 offen offset:1024  lds
    s_waitcnt lgkmcnt(6)
    v_mfma_f32_32x32x16_bf16 v[64:79], v[200:203], a[136:139], v[64:79]
    ds_read_b64_tr_b16 v[196:197], v4 offset:4096
    ds_read_b128 a[168:171], v20 offset:0
    v_mfma_f32_32x32x16_bf16 v[80:95], v[200:203], a[140:143], v[80:95]
    ds_read_b64_tr_b16 v[198:199], v4 offset:4608
    ds_read_b128 a[172:175], v20 offset:4096
    buffer_load_dwordx4 v13, s[40:43], s53 offen offset:2048  lds
    s_waitcnt lgkmcnt(8)
    v_mfma_f32_32x32x16_bf16 v[96:111], v[204:207], a[136:139], v[96:111]
    ds_read_b64_tr_b16 v[200:201], v1 offset:6144
    v_add_u32 v21, 16384, v17
    v_mfma_f32_32x32x16_bf16 v[112:127], v[204:207], a[140:143], v[112:127]
    ds_read_b64_tr_b16 v[202:203], v1 offset:6656
    ds_read_b128 a[176:179], v21 offset:0
    buffer_load_dwordx4 v14, s[40:43], s53 offen offset:3072  lds
    s_waitcnt lgkmcnt(7)
    v_mfma_f32_32x32x16_bf16 v[64:79], v[192:195], a[144:147], v[64:79]
    ds_read_b64_tr_b16 v[204:205], v4 offset:6144
    ds_read_b128 a[180:183], v21 offset:4096
    v_mfma_f32_32x32x16_bf16 v[80:95], v[192:195], a[148:151], v[80:95]
    ds_read_b64_tr_b16 v[206:207], v4 offset:6656
    v_add_u32 v22, 16384, v18
    s_add_u32 m0, s52, 131072
    s_add_u32 s53, s51, 4718592
    buffer_load_dwordx4 v7, s[36:39], s53 offen offset:0  lds
    s_waitcnt lgkmcnt(7)
    v_mfma_f32_32x32x16_bf16 v[96:111], v[196:199], a[144:147], v[96:111]
    ds_read_b64_tr_b16 v[192:193], v1 offset:32768
    ds_read_b128 a[184:187], v22 offset:0
    v_mfma_f32_32x32x16_bf16 v[112:127], v[196:199], a[148:151], v[112:127]
    ds_read_b64_tr_b16 v[194:195], v1 offset:33280
    ds_read_b128 a[188:191], v22 offset:4096
    buffer_load_dwordx4 v8, s[36:39], s53 offen offset:1024  lds
    s_waitcnt lgkmcnt(8)
    v_mfma_f32_32x32x16_bf16 v[64:79], v[200:203], a[152:155], v[64:79]
    ds_read_b64_tr_b16 v[196:197], v4 offset:32768
    v_mfma_f32_32x32x16_bf16 v[80:95], v[200:203], a[156:159], v[80:95]
    ds_read_b64_tr_b16 v[198:199], v4 offset:33280
    buffer_load_dwordx4 v9, s[36:39], s53 offen offset:2048  lds
    s_waitcnt lgkmcnt(6)
    v_mfma_f32_32x32x16_bf16 v[96:111], v[204:207], a[152:155], v[96:111]
    ds_read_b64_tr_b16 v[200:201], v1 offset:34816
    v_mfma_f32_32x32x16_bf16 v[112:127], v[204:207], a[156:159], v[112:127]
    ds_read_b64_tr_b16 v[202:203], v1 offset:35328
    buffer_load_dwordx4 v10, s[36:39], s53 offen offset:3072  lds
    s_waitcnt vmcnt(16)
    s_waitcnt lgkmcnt(4)
    s_barrier
    s_waitcnt lgkmcnt(5)
    v_mfma_f32_32x32x16_bf16 v[64:79], v[192:195], a[160:163], v[64:79]
    ds_read_b64_tr_b16 v[204:205], v4 offset:34816
    v_add_u32 v19, 49152, v15
    v_mfma_f32_32x32x16_bf16 v[80:95], v[192:195], a[164:167], v[80:95]
    ds_read_b64_tr_b16 v[206:207], v4 offset:35328
    ds_read_b128 a[192:195], v19 offset:0
    s_add_u32 m0, s52, 0
    s_add_u32 s53, s51, 128
    buffer_load_dwordx4 v7, s[36:39], s53 offen offset:0  lds
    s_waitcnt lgkmcnt(5)
    v_mfma_f32_32x32x16_bf16 v[96:111], v[196:199], a[160:163], v[96:111]
    ds_read_b64_tr_b16 v[192:193], v1 offset:36864
    ds_read_b128 a[196:199], v19 offset:4096
    v_mfma_f32_32x32x16_bf16 v[112:127], v[196:199], a[164:167], v[112:127]
    ds_read_b64_tr_b16 v[194:195], v1 offset:37376
    v_add_u32 v20, 49152, v16
    buffer_load_dwordx4 v8, s[36:39], s53 offen offset:1024  lds
    s_waitcnt lgkmcnt(6)
    v_mfma_f32_32x32x16_bf16 v[64:79], v[200:203], a[168:171], v[64:79]
    ds_read_b64_tr_b16 v[196:197], v4 offset:36864
    ds_read_b128 a[200:203], v20 offset:0
    v_mfma_f32_32x32x16_bf16 v[80:95], v[200:203], a[172:175], v[80:95]
    ds_read_b64_tr_b16 v[198:199], v4 offset:37376
    ds_read_b128 a[204:207], v20 offset:4096
    buffer_load_dwordx4 v9, s[36:39], s53 offen offset:2048  lds
    s_waitcnt lgkmcnt(8)
    v_mfma_f32_32x32x16_bf16 v[96:111], v[204:207], a[168:171], v[96:111]
    ds_read_b64_tr_b16 v[200:201], v1 offset:38912
    v_add_u32 v21, 49152, v17
    v_mfma_f32_32x32x16_bf16 v[112:127], v[204:207], a[172:175], v[112:127]
    ds_read_b64_tr_b16 v[202:203], v1 offset:39424
    ds_read_b128 a[208:211], v21 offset:0
    buffer_load_dwordx4 v10, s[36:39], s53 offen offset:3072  lds
    s_waitcnt lgkmcnt(7)
    v_mfma_f32_32x32x16_bf16 v[64:79], v[192:195], a[176:179], v[64:79]
    ds_read_b64_tr_b16 v[204:205], v4 offset:38912
    ds_read_b128 a[212:215], v21 offset:4096
    v_mfma_f32_32x32x16_bf16 v[80:95], v[192:195], a[180:183], v[80:95]
    ds_read_b64_tr_b16 v[206:207], v4 offset:39424
    v_add_u32 v22, 49152, v18
    s_add_u32 m0, s52, 16384
    s_add_u32 s53, s51, 589952
    buffer_load_dwordx4 v7, s[36:39], s53 offen offset:0  lds
    s_waitcnt lgkmcnt(7)
    v_mfma_f32_32x32x16_bf16 v[96:111], v[196:199], a[176:179], v[96:111]
    ds_read_b64_tr_b16 v[192:193], v2 offset:0
    ds_read_b128 a[216:219], v22 offset:0
    v_mfma_f32_32x32x16_bf16 v[112:127], v[196:199], a[180:183], v[112:127]
    ds_read_b64_tr_b16 v[194:195], v2 offset:512
    ds_read_b128 a[220:223], v22 offset:4096
    buffer_load_dwordx4 v8, s[36:39], s53 offen offset:1024  lds
    s_waitcnt lgkmcnt(8)
    v_mfma_f32_32x32x16_bf16 v[64:79], v[200:203], a[184:187], v[64:79]
    ds_read_b64_tr_b16 v[196:197], v5 offset:0
    v_mfma_f32_32x32x16_bf16 v[80:95], v[200:203], a[188:191], v[80:95]
    ds_read_b64_tr_b16 v[198:199], v5 offset:512
    buffer_load_dwordx4 v9, s[36:39], s53 offen offset:2048  lds
    s_waitcnt lgkmcnt(6)
    v_mfma_f32_32x32x16_bf16 v[96:111], v[204:207], a[184:187], v[96:111]
    ds_read_b64_tr_b16 v[200:201], v2 offset:2048
    v_mfma_f32_32x32x16_bf16 v[112:127], v[204:207], a[188:191], v[112:127]
    ds_read_b64_tr_b16 v[202:203], v2 offset:2560
    buffer_load_dwordx4 v10, s[36:39], s53 offen offset:3072  lds
    s_waitcnt vmcnt(16)
    s_waitcnt lgkmcnt(4)
    s_barrier
    s_waitcnt lgkmcnt(5)
    v_mfma_f32_32x32x16_bf16 v[64:79], v[192:195], a[192:195], v[64:79]
    ds_read_b64_tr_b16 v[204:205], v5 offset:2048
    v_add_u32 v19, 81920, v15
    v_mfma_f32_32x32x16_bf16 v[80:95], v[192:195], a[196:199], v[80:95]
    ds_read_b64_tr_b16 v[206:207], v5 offset:2560
    ds_read_b128 a[224:227], v19 offset:0
    s_add_u32 m0, s52, 32768
    s_add_u32 s53, s51, 1179776
    buffer_load_dwordx4 v7, s[36:39], s53 offen offset:0  lds
    s_waitcnt lgkmcnt(5)
    v_mfma_f32_32x32x16_bf16 v[96:111], v[196:199], a[192:195], v[96:111]
    ds_read_b64_tr_b16 v[192:193], v2 offset:4096
    ds_read_b128 a[228:231], v19 offset:4096
    v_mfma_f32_32x32x16_bf16 v[112:127], v[196:199], a[196:199], v[112:127]
    ds_read_b64_tr_b16 v[194:195], v2 offset:4608
    v_add_u32 v20, 81920, v16
    buffer_load_dwordx4 v8, s[36:39], s53 offen offset:1024  lds
    s_waitcnt lgkmcnt(6)
    v_mfma_f32_32x32x16_bf16 v[64:79], v[200:203], a[200:203], v[64:79]
    ds_read_b64_tr_b16 v[196:197], v5 offset:4096
    ds_read_b128 a[232:235], v20 offset:0
    v_mfma_f32_32x32x16_bf16 v[80:95], v[200:203], a[204:207], v[80:95]
    ds_read_b64_tr_b16 v[198:199], v5 offset:4608
    ds_read_b128 a[236:239], v20 offset:4096
    buffer_load_dwordx4 v9, s[36:39], s53 offen offset:2048  lds
    s_waitcnt lgkmcnt(8)
    v_mfma_f32_32x32x16_bf16 v[96:111], v[204:207], a[200:203], v[96:111]
    ds_read_b64_tr_b16 v[200:201], v2 offset:6144
    v_add_u32 v21, 81920, v17
    v_mfma_f32_32x32x16_bf16 v[112:127], v[204:207], a[204:207], v[112:127]
    ds_read_b64_tr_b16 v[202:203], v2 offset:6656
    ds_read_b128 a[240:243], v21 offset:0
    buffer_load_dwordx4 v10, s[36:39], s53 offen offset:3072  lds
    s_waitcnt lgkmcnt(7)
    v_mfma_f32_32x32x16_bf16 v[64:79], v[192:195], a[208:211], v[64:79]
    ds_read_b64_tr_b16 v[204:205], v5 offset:6144
    ds_read_b128 a[244:247], v21 offset:4096
    v_mfma_f32_32x32x16_bf16 v[80:95], v[192:195], a[212:215], v[80:95]
    ds_read_b64_tr_b16 v[206:207], v5 offset:6656
    v_add_u32 v22, 81920, v18
    s_add_u32 m0, s52, 49152
    s_add_u32 s53, s51, 1769600
    buffer_load_dwordx4 v7, s[36:39], s53 offen offset:0  lds
    s_waitcnt lgkmcnt(7)
    v_mfma_f32_32x32x16_bf16 v[96:111], v[196:199], a[208:211], v[96:111]
    ds_read_b64_tr_b16 v[192:193], v2 offset:32768
    ds_read_b128 a[248:251], v22 offset:0
    v_mfma_f32_32x32x16_bf16 v[112:127], v[196:199], a[212:215], v[112:127]
    ds_read_b64_tr_b16 v[194:195], v2 offset:33280
    ds_read_b128 a[252:255], v22 offset:4096
    buffer_load_dwordx4 v8, s[36:39], s53 offen offset:1024  lds
    s_waitcnt lgkmcnt(8)
    v_mfma_f32_32x32x16_bf16 v[64:79], v[200:203], a[216:219], v[64:79]
    ds_read_b64_tr_b16 v[196:197], v5 offset:32768
    v_mfma_f32_32x32x16_bf16 v[80:95], v[200:203], a[220:223], v[80:95]
    ds_read_b64_tr_b16 v[198:199], v5 offset:33280
    buffer_load_dwordx4 v9, s[36:39], s53 offen offset:2048  lds
    s_waitcnt lgkmcnt(6)
    v_mfma_f32_32x32x16_bf16 v[96:111], v[204:207], a[216:219], v[96:111]
    ds_read_b64_tr_b16 v[200:201], v2 offset:34816
    v_mfma_f32_32x32x16_bf16 v[112:127], v[204:207], a[220:223], v[112:127]
    ds_read_b64_tr_b16 v[202:203], v2 offset:35328
    buffer_load_dwordx4 v10, s[36:39], s53 offen offset:3072  lds
    s_waitcnt vmcnt(16)
    s_waitcnt lgkmcnt(4)
    s_barrier
    s_waitcnt lgkmcnt(5)
    v_mfma_f32_32x32x16_bf16 v[64:79], v[192:195], a[224:227], v[64:79]
    ds_read_b64_tr_b16 v[204:205], v5 offset:34816
    v_add_u32 v19, 114688, v15
    v_mfma_f32_32x32x16_bf16 v[80:95], v[192:195], a[228:231], v[80:95]
    ds_read_b64_tr_b16 v[206:207], v5 offset:35328
    ds_read_b128 v[32:35], v19 offset:0
    s_add_u32 m0, s52, 65536
    s_add_u32 s53, s51, 2359424
    buffer_load_dwordx4 v7, s[36:39], s53 offen offset:0  lds
    s_waitcnt lgkmcnt(5)
    v_mfma_f32_32x32x16_bf16 v[96:111], v[196:199], a[224:227], v[96:111]
    ds_read_b64_tr_b16 v[192:193], v2 offset:36864
    ds_read_b128 v[36:39], v19 offset:4096
    v_mfma_f32_32x32x16_bf16 v[112:127], v[196:199], a[228:231], v[112:127]
    ds_read_b64_tr_b16 v[194:195], v2 offset:37376
    v_add_u32 v20, 114688, v16
    buffer_load_dwordx4 v8, s[36:39], s53 offen offset:1024  lds
    s_waitcnt lgkmcnt(6)
    v_mfma_f32_32x32x16_bf16 v[64:79], v[200:203], a[232:235], v[64:79]
    ds_read_b64_tr_b16 v[196:197], v5 offset:36864
    ds_read_b128 v[40:43], v20 offset:0
    v_mfma_f32_32x32x16_bf16 v[80:95], v[200:203], a[236:239], v[80:95]
    ds_read_b64_tr_b16 v[198:199], v5 offset:37376
    ds_read_b128 v[44:47], v20 offset:4096
    buffer_load_dwordx4 v9, s[36:39], s53 offen offset:2048  lds
    s_waitcnt lgkmcnt(8)
    v_mfma_f32_32x32x16_bf16 v[96:111], v[204:207], a[232:235], v[96:111]
    ds_read_b64_tr_b16 v[200:201], v2 offset:38912
    v_add_u32 v21, 114688, v17
    v_mfma_f32_32x32x16_bf16 v[112:127], v[204:207], a[236:239], v[112:127]
    ds_read_b64_tr_b16 v[202:203], v2 offset:39424
    ds_read_b128 v[48:51], v21 offset:0
    buffer_load_dwordx4 v10, s[36:39], s53 offen offset:3072  lds
    s_waitcnt lgkmcnt(7)
    v_mfma_f32_32x32x16_bf16 v[64:79], v[192:195], a[240:243], v[64:79]
    ds_read_b64_tr_b16 v[204:205], v5 offset:38912
    ds_read_b128 v[52:55], v21 offset:4096
    v_mfma_f32_32x32x16_bf16 v[80:95], v[192:195], a[244:247], v[80:95]
    ds_read_b64_tr_b16 v[206:207], v5 offset:39424
    v_add_u32 v22, 114688, v18
    s_add_u32 m0, s52, 81920
    s_add_u32 s53, s51, 2949248
    buffer_load_dwordx4 v7, s[36:39], s53 offen offset:0  lds
    s_waitcnt lgkmcnt(7)
    v_mfma_f32_32x32x16_bf16 v[96:111], v[196:199], a[240:243], v[96:111]
    ds_read_b64_tr_b16 v[192:193], v3 offset:0
    ds_read_b128 v[56:59], v22 offset:0
    v_mfma_f32_32x32x16_bf16 v[112:127], v[196:199], a[244:247], v[112:127]
    ds_read_b64_tr_b16 v[194:195], v3 offset:512
    ds_read_b128 v[60:63], v22 offset:4096
    buffer_load_dwordx4 v8, s[36:39], s53 offen offset:1024  lds
    s_waitcnt lgkmcnt(8)
    v_mfma_f32_32x32x16_bf16 v[64:79], v[200:203], a[248:251], v[64:79]
    ds_read_b64_tr_b16 v[196:197], v6 offset:0
    v_mfma_f32_32x32x16_bf16 v[80:95], v[200:203], a[252:255], v[80:95]
    ds_read_b64_tr_b16 v[198:199], v6 offset:512
    buffer_load_dwordx4 v9, s[36:39], s53 offen offset:2048  lds
    s_waitcnt lgkmcnt(6)
    v_mfma_f32_32x32x16_bf16 v[96:111], v[204:207], a[248:251], v[96:111]
    ds_read_b64_tr_b16 v[200:201], v3 offset:2048
    v_mfma_f32_32x32x16_bf16 v[112:127], v[204:207], a[252:255], v[112:127]
    ds_read_b64_tr_b16 v[202:203], v3 offset:2560
    buffer_load_dwordx4 v10, s[36:39], s53 offen offset:3072  lds
    s_waitcnt vmcnt(20)
    s_waitcnt lgkmcnt(4)
    s_barrier
    s_waitcnt lgkmcnt(5)
    v_mfma_f32_32x32x16_bf16 v[64:79], v[192:195], v[32:35], v[64:79]
    ds_read_b64_tr_b16 v[204:205], v6 offset:2048
    v_mfma_f32_32x32x16_bf16 v[80:95], v[192:195], v[36:39], v[80:95]
    ds_read_b64_tr_b16 v[206:207], v6 offset:2560
    s_add_u32 m0, s52, 98304
    s_add_u32 s53, s51, 3539072
    buffer_load_dwordx4 v7, s[36:39], s53 offen offset:0  lds
    s_waitcnt lgkmcnt(4)
    v_mfma_f32_32x32x16_bf16 v[96:111], v[196:199], v[32:35], v[96:111]
    ds_read_b64_tr_b16 v[192:193], v3 offset:4096
    v_mfma_f32_32x32x16_bf16 v[112:127], v[196:199], v[36:39], v[112:127]
    ds_read_b64_tr_b16 v[194:195], v3 offset:4608
    buffer_load_dwordx4 v8, s[36:39], s53 offen offset:1024  lds
    s_waitcnt lgkmcnt(4)
    v_mfma_f32_32x32x16_bf16 v[64:79], v[200:203], v[40:43], v[64:79]
    ds_read_b64_tr_b16 v[196:197], v6 offset:4096
    v_mfma_f32_32x32x16_bf16 v[80:95], v[200:203], v[44:47], v[80:95]
    ds_read_b64_tr_b16 v[198:199], v6 offset:4608
    buffer_load_dwordx4 v9, s[36:39], s53 offen offset:2048  lds
    s_waitcnt lgkmcnt(4)
    v_mfma_f32_32x32x16_bf16 v[96:111], v[204:207], v[40:43], v[96:111]
    ds_read_b64_tr_b16 v[200:201], v3 offset:6144
    v_mfma_f32_32x32x16_bf16 v[112:127], v[204:207], v[44:47], v[112:127]
    ds_read_b64_tr_b16 v[202:203], v3 offset:6656
    buffer_load_dwordx4 v10, s[36:39], s53 offen offset:3072  lds
    s_waitcnt lgkmcnt(4)
    v_mfma_f32_32x32x16_bf16 v[64:79], v[192:195], v[48:51], v[64:79]
    ds_read_b64_tr_b16 v[204:205], v6 offset:6144
    v_mfma_f32_32x32x16_bf16 v[80:95], v[192:195], v[52:55], v[80:95]
    ds_read_b64_tr_b16 v[206:207], v6 offset:6656
    s_add_u32 m0, s52, 114688
    s_add_u32 s53, s51, 4128896
    buffer_load_dwordx4 v7, s[36:39], s53 offen offset:0  lds
    s_waitcnt lgkmcnt(4)
    v_mfma_f32_32x32x16_bf16 v[96:111], v[196:199], v[48:51], v[96:111]
    ds_read_b64_tr_b16 v[192:193], v1 offset:0
    v_mfma_f32_32x32x16_bf16 v[112:127], v[196:199], v[52:55], v[112:127]
    ds_read_b64_tr_b16 v[194:195], v1 offset:512
    buffer_load_dwordx4 v8, s[36:39], s53 offen offset:1024  lds
    s_waitcnt lgkmcnt(4)
    v_mfma_f32_32x32x16_bf16 v[64:79], v[200:203], v[56:59], v[64:79]
    ds_read_b64_tr_b16 v[196:197], v4 offset:0
    v_mfma_f32_32x32x16_bf16 v[80:95], v[200:203], v[60:63], v[80:95]
    ds_read_b64_tr_b16 v[198:199], v4 offset:512
    buffer_load_dwordx4 v9, s[36:39], s53 offen offset:2048  lds
    s_waitcnt lgkmcnt(4)
    v_mfma_f32_32x32x16_bf16 v[96:111], v[204:207], v[56:59], v[96:111]
    ds_read_b64_tr_b16 v[200:201], v1 offset:2048
    v_mfma_f32_32x32x16_bf16 v[112:127], v[204:207], v[60:63], v[112:127]
    ds_read_b64_tr_b16 v[202:203], v1 offset:2560
    buffer_load_dwordx4 v10, s[36:39], s53 offen offset:3072  lds
    s_waitcnt vmcnt(24)
    s_barrier
    s_waitcnt lgkmcnt(4)
    v_mfma_f32_32x32x16_bf16 v[128:143], v[192:195], a[0:3], 0
    ds_read_b64_tr_b16 v[204:205], v4 offset:2048
    v_mfma_f32_32x32x16_bf16 v[144:159], v[192:195], a[4:7], 0
    ds_read_b64_tr_b16 v[206:207], v4 offset:2560
    s_add_u32 m0, s52, 131072
    s_add_u32 s53, s51, 4718720
    buffer_load_dwordx4 v7, s[36:39], s53 offen offset:0  lds
    s_waitcnt lgkmcnt(4)
    v_mfma_f32_32x32x16_bf16 v[160:175], v[196:199], a[0:3], 0
    ds_read_b64_tr_b16 v[192:193], v1 offset:4096
    v_mfma_f32_32x32x16_bf16 v[176:191], v[196:199], a[4:7], 0
    ds_read_b64_tr_b16 v[194:195], v1 offset:4608
    s_waitcnt lgkmcnt(4)
    v_mfma_f32_32x32x16_bf16 v[128:143], v[200:203], a[8:11], v[128:143]
    ds_read_b64_tr_b16 v[196:197], v4 offset:4096
    buffer_load_dwordx4 v8, s[36:39], s53 offen offset:1024  lds
    v_lshrrev_b32 v24, 3, v0
    v_and_b32 v25, 7, v0
    v_mfma_f32_32x32x16_bf16 v[144:159], v[200:203], a[12:15], v[144:159]
    ds_read_b64_tr_b16 v[198:199], v4 offset:4608
    v_bfe_u32 v26, v0, 4, 2
    v_lshlrev_b32 v26, 1, v26
    v_xor_b32 v25, v25, v26
    s_waitcnt lgkmcnt(4)
    v_mfma_f32_32x32x16_bf16 v[160:175], v[204:207], a[8:11], v[160:175]
    ds_read_b64_tr_b16 v[200:201], v1 offset:6144
    v_lshlrev_b32 v25, 4, v25
    v_mul_u32_u24 v24, 1152, v24
    v_add_u32 v240, v24, v25
    v_add_u32 v241, 8192, v240
    v_mfma_f32_32x32x16_bf16 v[176:191], v[204:207], a[12:15], v[176:191]
    ds_read_b64_tr_b16 v[202:203], v1 offset:6656
    buffer_load_dwordx4 v9, s[36:39], s53 offen offset:2048  lds
    v_add_u32 v242, 16384, v240
    s_waitcnt lgkmcnt(4)
    v_mfma_f32_32x32x16_bf16 v[128:143], v[192:195], a[16:19], v[128:143]
    ds_read_b64_tr_b16 v[204:205], v4 offset:6144
    v_add_u32 v243, 24576, v240
    v_lshrrev_b32 v24, 4, v0
    v_and_b32 v25, 1, v24
    v_lshlrev_b32 v25, 2, v25
    v_mfma_f32_32x32x16_bf16 v[144:159], v[192:195], a[20:23], v[144:159]
    ds_read_b64_tr_b16 v[206:207], v4 offset:6656
    v_lshrrev_b32 v24, 1, v24
    v_lshlrev_b32 v24, 4, v24
    v_add_u32 v24, v24, v25
    s_waitcnt lgkmcnt(4)
    v_mfma_f32_32x32x16_bf16 v[160:175], v[196:199], a[16:19], v[160:175]
    ds_read_b64_tr_b16 v[192:193], v1 offset:16384
    buffer_load_dwordx4 v10, s[36:39], s53 offen offset:3072  lds
    v_bfe_u32 v25, v0, 2, 2
    v_add_u32 v24, v24, v25
    v_mfma_f32_32x32x16_bf16 v[176:191], v[196:199], a[20:23], v[176:191]
    ds_read_b64_tr_b16 v[194:195], v1 offset:16896
    v_bfe_u32 v25, v24, 1, 2
    v_lshlrev_b32 v24, 7, v24
    v_and_b32 v26, 3, v0
    s_waitcnt lgkmcnt(4)
    v_mfma_f32_32x32x16_bf16 v[128:143], v[200:203], a[24:27], v[128:143]
    ds_read_b64_tr_b16 v[196:197], v4 offset:16384
    v_lshlrev_b32 v26, 3, v26
    v_add_u32 v24, v24, v26
    s_add_u32 s49, s52, 147456
    v_add_u32 v24, s49, v24
    v_mfma_f32_32x32x16_bf16 v[144:159], v[200:203], a[28:31], v[144:159]
    ds_read_b64_tr_b16 v[198:199], v4 offset:16896
    s_mul_i32 s92, s24, 12
    s_add_u32 s92, s92, s20
    s_lshl_b32 s92, s92, 2
    s_add_u32 s92, s92, s26
    s_cmp_lt_u32 s92, 384
    s_cselect_b32 s16, s84, s86
    s_cselect_b32 s17, s85, s87
    s_cselect_b32 s93, 0, 384
    s_sub_u32 s92, s92, s93
    s_mul_hi_u32 s94, s92, 715827883
    s_mul_i32 s95, s94, 6
    s_sub_u32 s95, s92, s95
    s_mul_i32 s94, s94, 9216
    s_mul_i32 s95, s95, 1536
    s_add_u32 s92, s94, s95
    s_mov_b32 s19, 0x20000
    s_mov_b32 s18, 5308416
    v_lshrrev_b32 v28, 5, v0
    v_mul_u32_u24 v28, 768, v28
    v_and_b32 v29, 31, v0
    v_lshlrev_b32 v29, 4, v29
    v_add3_u32 v27, v28, v29, 0
    v_add_u32 v27, 256, v27
    buffer_load_dwordx4 v[252:255], v27, s[16:19], s92 offen
    s_add_u32 s92, s92, 589824
    s_waitcnt lgkmcnt(4)
    v_mfma_f32_32x32x16_bf16 v[160:175], v[204:207], a[24:27], v[160:175]
    ds_read_b64_tr_b16 v[200:201], v1 offset:18432
    v_xor_b32 v26, 0, v25
    v_lshlrev_b32 v26, 5, v26
    v_add_u32 v244, v24, v26
    v_xor_b32 v26, 1, v25
    v_mfma_f32_32x32x16_bf16 v[176:191], v[204:207], a[28:31], v[176:191]
    ds_read_b64_tr_b16 v[202:203], v1 offset:18944
    v_lshlrev_b32 v26, 5, v26
    v_add_u32 v245, v24, v26
    v_xor_b32 v26, 2, v25
    s_waitcnt vmcnt(25)
    s_barrier
    s_cmp_eq_u32 s66, 0
    s_cbranch_scc1 k1_sigZ
    v_mov_b32 v28, 64
    v_mov_b32 v29, 1
    s_mov_b64 exec, 1
    global_atomic_add v28, v29, s[96:97]
    s_mov_b64 exec, -1

k1_sigZ:
    s_waitcnt lgkmcnt(4)
    v_mfma_f32_32x32x16_bf16 v[128:143], v[192:195], a[32:35], v[128:143]
    ds_read_b64_tr_b16 v[204:205], v4 offset:18432
    v_lshlrev_b32 v26, 5, v26
    v_add_u32 v246, v24, v26
    v_xor_b32 v26, 3, v25
    v_lshlrev_b32 v26, 5, v26
    v_mfma_f32_32x32x16_bf16 v[144:159], v[192:195], a[36:39], v[144:159]
    ds_read_b64_tr_b16 v[206:207], v4 offset:18944
    s_add_u32 m0, s52, 0
    s_add_u32 s53, s51, 256
    buffer_load_dwordx4 v7, s[36:39], s53 offen offset:0  lds
    s_waitcnt lgkmcnt(4)
    v_mfma_f32_32x32x16_bf16 v[160:175], v[196:199], a[32:35], v[160:175]
    ds_read_b64_tr_b16 v[192:193], v1 offset:20480
    v_add_u32 v247, v24, v26
    v_lshlrev_b32 v248, 4, v0
    v_mul_f32 v208, s60, v64
    v_mul_f32 v209, s60, v65
    v_mfma_f32_32x32x16_bf16 v[176:191], v[196:199], a[36:39], v[176:191]
    ds_read_b64_tr_b16 v[194:195], v1 offset:20992
    buffer_load_dwordx4 v8, s[36:39], s53 offen offset:1024  lds
    s_waitcnt lgkmcnt(4)
    v_mfma_f32_32x32x16_bf16 v[128:143], v[200:203], a[40:43], v[128:143]
    ds_read_b64_tr_b16 v[196:197], v4 offset:20480
    v_exp_f32 v208, v208
    v_exp_f32 v209, v209
    v_mfma_f32_32x32x16_bf16 v[144:159], v[200:203], a[44:47], v[144:159]
    ds_read_b64_tr_b16 v[198:199], v4 offset:20992
    buffer_load_dwordx4 v9, s[36:39], s53 offen offset:2048  lds
    v_mul_f32 v210, v64, v72
    s_waitcnt lgkmcnt(4)
    v_mfma_f32_32x32x16_bf16 v[160:175], v[204:207], a[40:43], v[160:175]
    ds_read_b64_tr_b16 v[200:201], v1 offset:22528
    v_mul_f32 v211, v65, v73
    v_add_f32 v208, 1.0, v208
    v_add_f32 v209, 1.0, v209
    v_mfma_f32_32x32x16_bf16 v[176:191], v[204:207], a[44:47], v[176:191]
    ds_read_b64_tr_b16 v[202:203], v1 offset:23040
    buffer_load_dwordx4 v10, s[36:39], s53 offen offset:3072  lds
    s_waitcnt lgkmcnt(4)
    v_mfma_f32_32x32x16_bf16 v[128:143], v[192:195], a[48:51], v[128:143]
    ds_read_b64_tr_b16 v[204:205], v4 offset:22528
    v_rcp_f32 v208, v208
    v_rcp_f32 v209, v209
    v_mfma_f32_32x32x16_bf16 v[144:159], v[192:195], a[52:55], v[144:159]
    ds_read_b64_tr_b16 v[206:207], v4 offset:23040
    v_mul_f32 v212, s60, v66
    v_mul_f32 v213, s60, v67
    s_waitcnt lgkmcnt(4)
    v_mfma_f32_32x32x16_bf16 v[160:175], v[196:199], a[48:51], v[160:175]
    ds_read_b64_tr_b16 v[192:193], v1 offset:32768
    buffer_load_dwordx4 v[252:255], v27, s[16:19], s92 offen
    s_add_u32 s92, s92, 589824
    v_mfma_f32_32x32x16_bf16 v[176:191], v[196:199], a[52:55], v[176:191]
    ds_read_b64_tr_b16 v[194:195], v1 offset:33280
    v_exp_f32 v212, v212
    s_waitcnt lgkmcnt(4)
    v_mfma_f32_32x32x16_bf16 v[128:143], v[200:203], a[56:59], v[128:143]
    ds_read_b64_tr_b16 v[196:197], v4 offset:32768
    s_add_u32 s29, s55, 0
    s_mul_hi_u32 s30, s29, 477218589
    s_mul_i32 s31, s30, 9
    s_sub_u32 s31, s29, s31
    s_cmp_lt_u32 s30, 144
    s_cselect_b32 s56, s88, s90
    s_cselect_b32 s57, s89, s91
    s_mov_b32 s58, 663552
    s_cselect_b32 s58, 5308416, s58
    s_cselect_b32 s61, 0, 144
    s_mov_b32 s59, 0x20000
    s_sub_u32 s61, s30, s61
    s_mul_i32 s61, s61, 36864
    s_lshl_b32 s63, s31, 7
    s_add_u32 s61, s61, s63
    s_mul_i32 s62, s30, 36864
    s_lshl_b32 s63, s31, 12
    s_add_u32 s62, s62, s63
    s_cmp_lt_u32 s29, 1458
    s_cselect_b32 s14, 5971968, 0
    s_cselect_b32 s58, s58, 0
    s_add_u32 m0, s52, 147456
    s_nop 0
    buffer_load_dwordx4 v240, s[56:59], s61 offen offset:0  lds
    v_mfma_f32_32x32x16_bf16 v[144:159], v[200:203], a[60:63], v[144:159]
    ds_read_b64_tr_b16 v[198:199], v4 offset:33280
    v_exp_f32 v213, v213
    v_mul_f32 v214, v66, v74
    s_waitcnt lgkmcnt(4)
    v_mfma_f32_32x32x16_bf16 v[160:175], v[204:207], a[56:59], v[160:175]
    ds_read_b64_tr_b16 v[200:201], v1 offset:34816
    s_add_u32 m0, s52, 147456
    s_nop 0
    buffer_load_dwordx4 v241, s[56:59], s61 offen offset:1024  lds
    v_mfma_f32_32x32x16_bf16 v[176:191], v[204:207], a[60:63], v[176:191]
    ds_read_b64_tr_b16 v[202:203], v1 offset:35328
    v_mul_f32 v215, v67, v75
    v_mul_f32 v210, v210, v208
    v_mul_f32 v211, v211, v209
    s_waitcnt vmcnt(28)
    s_barrier
    s_waitcnt lgkmcnt(4)
    v_mfma_f32_32x32x16_bf16 v[128:143], v[192:195], a[64:67], v[128:143]
    ds_read_b64_tr_b16 v[204:205], v4 offset:34816
    v_cvt_pk_bf16_f32 v216, v210, v211
    v_add_f32 v212, 1.0, v212
    v_add_f32 v213, 1.0, v213
    v_mfma_f32_32x32x16_bf16 v[144:159], v[192:195], a[68:71], v[144:159]
    ds_read_b64_tr_b16 v[206:207], v4 offset:35328
    s_add_u32 m0, s52, 16384
    s_add_u32 s53, s51, 590080
    buffer_load_dwordx4 v7, s[36:39], s53 offen offset:0  lds
    s_waitcnt lgkmcnt(4)
    v_mfma_f32_32x32x16_bf16 v[160:175], v[196:199], a[64:67], v[160:175]
    ds_read_b64_tr_b16 v[192:193], v1 offset:36864
    v_rcp_f32 v212, v212
    v_rcp_f32 v213, v213
    v_mfma_f32_32x32x16_bf16 v[176:191], v[196:199], a[68:71], v[176:191]
    ds_read_b64_tr_b16 v[194:195], v1 offset:37376
    buffer_load_dwordx4 v8, s[36:39], s53 offen offset:1024  lds
    v_mul_f32 v208, s60, v68
    s_waitcnt lgkmcnt(4)
    v_mfma_f32_32x32x16_bf16 v[128:143], v[200:203], a[72:75], v[128:143]
    ds_read_b64_tr_b16 v[196:197], v4 offset:36864
    v_mul_f32 v209, s60, v69
    v_exp_f32 v208, v208
    v_mfma_f32_32x32x16_bf16 v[144:159], v[200:203], a[76:79], v[144:159]
    ds_read_b64_tr_b16 v[198:199], v4 offset:37376
    buffer_load_dwordx4 v9, s[36:39], s53 offen offset:2048  lds
    s_waitcnt lgkmcnt(4)
    v_mfma_f32_32x32x16_bf16 v[160:175], v[204:207], a[72:75], v[160:175]
    ds_read_b64_tr_b16 v[200:201], v1 offset:38912
    v_exp_f32 v209, v209
    v_mul_f32 v210, v68, v76
    v_mul_f32 v211, v69, v77
    v_mfma_f32_32x32x16_bf16 v[176:191], v[204:207], a[76:79], v[176:191]
    ds_read_b64_tr_b16 v[202:203], v1 offset:39424
    buffer_load_dwordx4 v10, s[36:39], s53 offen offset:3072  lds
    v_mul_f32 v214, v214, v212
    s_waitcnt lgkmcnt(4)
    v_mfma_f32_32x32x16_bf16 v[128:143], v[192:195], a[80:83], v[128:143]
    ds_read_b64_tr_b16 v[204:205], v4 offset:38912
    v_mul_f32 v215, v215, v213
    v_cvt_pk_bf16_f32 v217, v214, v215
    v_add_f32 v208, 1.0, v208
    v_add_f32 v209, 1.0, v209
    v_mfma_f32_32x32x16_bf16 v[144:159], v[192:195], a[84:87], v[144:159]
    ds_read_b64_tr_b16 v[206:207], v4 offset:39424
    v_rcp_f32 v208, v208
    s_waitcnt lgkmcnt(4)
    v_mfma_f32_32x32x16_bf16 v[160:175], v[196:199], a[80:83], v[160:175]
    ds_read_b64_tr_b16 v[192:193], v1 offset:49152
    buffer_load_dwordx4 v[252:255], v27, s[16:19], s92 offen
    s_add_u32 s92, s92, 589824
    v_mfma_f32_32x32x16_bf16 v[176:191], v[196:199], a[84:87], v[176:191]
    ds_read_b64_tr_b16 v[194:195], v1 offset:49664
    v_rcp_f32 v209, v209
    v_mul_f32 v212, s60, v70
    s_waitcnt lgkmcnt(4)
    v_mfma_f32_32x32x16_bf16 v[128:143], v[200:203], a[88:91], v[128:143]
    ds_read_b64_tr_b16 v[196:197], v4 offset:49152
    s_add_u32 m0, s52, 147456
    s_nop 0
    buffer_load_dwordx4 v242, s[56:59], s61 offen offset:2048  lds
    v_mfma_f32_32x32x16_bf16 v[144:159], v[200:203], a[92:95], v[144:159]
    ds_read_b64_tr_b16 v[198:199], v4 offset:49664
    v_mul_f32 v213, s60, v71
    v_exp_f32 v212, v212
    s_waitcnt lgkmcnt(4)
    v_mfma_f32_32x32x16_bf16 v[160:175], v[204:207], a[88:91], v[160:175]
    ds_read_b64_tr_b16 v[200:201], v1 offset:51200
    s_add_u32 m0, s52, 147456
    s_nop 0
    buffer_load_dwordx4 v243, s[56:59], s61 offen offset:3072  lds
    v_mfma_f32_32x32x16_bf16 v[176:191], v[204:207], a[92:95], v[176:191]
    ds_read_b64_tr_b16 v[202:203], v1 offset:51712
    v_exp_f32 v213, v213
    v_mul_f32 v214, v70, v78
    s_waitcnt vmcnt(31)
    s_barrier
    s_waitcnt lgkmcnt(4)
    v_mfma_f32_32x32x16_bf16 v[128:143], v[192:195], a[96:99], v[128:143]
    ds_read_b64_tr_b16 v[204:205], v4 offset:51200
    v_mul_f32 v215, v71, v79
    v_mul_f32 v210, v210, v208
    v_mul_f32 v211, v211, v209
    v_cvt_pk_bf16_f32 v218, v210, v211
    v_mfma_f32_32x32x16_bf16 v[144:159], v[192:195], a[100:103], v[144:159]
    ds_read_b64_tr_b16 v[206:207], v4 offset:51712
    s_add_u32 m0, s52, 32768
    s_add_u32 s53, s51, 1179904
    buffer_load_dwordx4 v7, s[36:39], s53 offen offset:0  lds
    s_waitcnt lgkmcnt(4)
    v_mfma_f32_32x32x16_bf16 v[160:175], v[196:199], a[96:99], v[160:175]
    ds_read_b64_tr_b16 v[192:193], v1 offset:53248
    v_add_f32 v212, 1.0, v212
    v_add_f32 v213, 1.0, v213
    v_rcp_f32 v212, v212
    v_mfma_f32_32x32x16_bf16 v[176:191], v[196:199], a[100:103], v[176:191]
    ds_read_b64_tr_b16 v[194:195], v1 offset:53760
    v_rcp_f32 v213, v213
    s_nop 1
    s_waitcnt lgkmcnt(4)
    v_mfma_f32_32x32x16_bf16 v[128:143], v[200:203], a[104:107], v[128:143]
    ds_read_b64_tr_b16 v[196:197], v4 offset:53248
    buffer_load_dwordx4 v8, s[36:39], s53 offen offset:1024  lds
    v_mul_f32 v214, v214, v212
    v_mul_f32 v215, v215, v213
    v_mfma_f32_32x32x16_bf16 v[144:159], v[200:203], a[108:111], v[144:159]
    ds_read_b64_tr_b16 v[198:199], v4 offset:53760
    v_cvt_pk_bf16_f32 v219, v214, v215
    buffer_store_dwordx4 v[216:219], v23, s[44:47], s48 offen offset:0 sc1
    s_waitcnt lgkmcnt(4)
    v_mfma_f32_32x32x16_bf16 v[160:175], v[204:207], a[104:107], v[160:175]
    ds_read_b64_tr_b16 v[200:201], v1 offset:55296
    v_mul_f32 v208, s60, v80
    v_mul_f32 v209, s60, v81
    v_exp_f32 v208, v208
    v_mfma_f32_32x32x16_bf16 v[176:191], v[204:207], a[108:111], v[176:191]
    ds_read_b64_tr_b16 v[202:203], v1 offset:55808
    buffer_load_dwordx4 v9, s[36:39], s53 offen offset:2048  lds
    s_waitcnt lgkmcnt(4)
    v_mfma_f32_32x32x16_bf16 v[128:143], v[192:195], a[112:115], v[128:143]
    ds_read_b64_tr_b16 v[204:205], v4 offset:55296
    v_exp_f32 v209, v209
    v_mul_f32 v210, v80, v88
    v_mul_f32 v211, v81, v89
    v_mfma_f32_32x32x16_bf16 v[144:159], v[192:195], a[116:119], v[144:159]
    ds_read_b64_tr_b16 v[206:207], v4 offset:55808
    v_add_f32 v208, 1.0, v208
    v_add_f32 v209, 1.0, v209
    s_waitcnt lgkmcnt(4)
    v_mfma_f32_32x32x16_bf16 v[160:175], v[196:199], a[112:115], v[160:175]
    ds_read_b64_tr_b16 v[192:193], v2 offset:0
    buffer_load_dwordx4 v10, s[36:39], s53 offen offset:3072  lds
    v_rcp_f32 v208, v208
    v_mfma_f32_32x32x16_bf16 v[176:191], v[196:199], a[116:119], v[176:191]
    ds_read_b64_tr_b16 v[194:195], v2 offset:512
    v_rcp_f32 v209, v209
    v_mul_f32 v212, s60, v82
    s_waitcnt lgkmcnt(4)
    v_mfma_f32_32x32x16_bf16 v[128:143], v[200:203], a[120:123], v[128:143]
    ds_read_b64_tr_b16 v[196:197], v5 offset:0
    v_mul_f32 v213, s60, v83
    v_exp_f32 v212, v212
    v_mfma_f32_32x32x16_bf16 v[144:159], v[200:203], a[124:127], v[144:159]
    ds_read_b64_tr_b16 v[198:199], v5 offset:512
    buffer_load_dwordx4 v[252:255], v27, s[16:19], s92 offen
    s_add_u32 s92, s92, 589824
    s_waitcnt lgkmcnt(4)
    v_mfma_f32_32x32x16_bf16 v[160:175], v[204:207], a[120:123], v[160:175]
    ds_read_b64_tr_b16 v[200:201], v2 offset:2048
    v_exp_f32 v213, v213
    v_mul_f32 v214, v82, v90
    v_mul_f32 v215, v83, v91
    v_mfma_f32_32x32x16_bf16 v[176:191], v[204:207], a[124:127], v[176:191]
    ds_read_b64_tr_b16 v[202:203], v2 offset:2560
    v_mul_f32 v210, v210, v208
    v_mul_f32 v211, v211, v209
    v_cvt_pk_bf16_f32 v220, v210, v211
    s_waitcnt vmcnt(33)
    s_barrier
    s_waitcnt lgkmcnt(4)
    v_mfma_f32_32x32x16_bf16 v[128:143], v[192:195], a[128:131], v[128:143]
    ds_read_b64_tr_b16 v[204:205], v5 offset:2048
    v_add_f32 v212, 1.0, v212
    v_add_f32 v213, 1.0, v213
    v_rcp_f32 v212, v212
    v_mfma_f32_32x32x16_bf16 v[144:159], v[192:195], a[132:135], v[144:159]
    ds_read_b64_tr_b16 v[206:207], v5 offset:2560
    s_add_u32 m0, s52, 49152
    s_add_u32 s53, s51, 1769728
    buffer_load_dwordx4 v7, s[36:39], s53 offen offset:0  lds
    s_waitcnt lgkmcnt(4)
    v_mfma_f32_32x32x16_bf16 v[160:175], v[196:199], a[128:131], v[160:175]
    ds_read_b64_tr_b16 v[192:193], v2 offset:4096
    v_rcp_f32 v213, v213
    v_mul_f32 v208, s60, v84
    v_mul_f32 v209, s60, v85
    v_mfma_f32_32x32x16_bf16 v[176:191], v[196:199], a[132:135], v[176:191]
    ds_read_b64_tr_b16 v[194:195], v2 offset:4608
    v_exp_f32 v208, v208
    s_waitcnt lgkmcnt(4)
    v_mfma_f32_32x32x16_bf16 v[128:143], v[200:203], a[136:139], v[128:143]
    ds_read_b64_tr_b16 v[196:197], v5 offset:4096
    buffer_load_dwordx4 v8, s[36:39], s53 offen offset:1024  lds
    v_exp_f32 v209, v209
    v_mfma_f32_32x32x16_bf16 v[144:159], v[200:203], a[140:143], v[144:159]
    ds_read_b64_tr_b16 v[198:199], v5 offset:4608
    v_mul_f32 v210, v84, v92
    v_mul_f32 v211, v85, v93
    v_mul_f32 v214, v214, v212
    s_waitcnt lgkmcnt(4)
    v_mfma_f32_32x32x16_bf16 v[160:175], v[204:207], a[136:139], v[160:175]
    ds_read_b64_tr_b16 v[200:201], v2 offset:6144
    v_mul_f32 v215, v215, v213
    v_cvt_pk_bf16_f32 v221, v214, v215
    v_add_f32 v208, 1.0, v208
    v_add_f32 v209, 1.0, v209
    v_mfma_f32_32x32x16_bf16 v[176:191], v[204:207], a[140:143], v[176:191]
    ds_read_b64_tr_b16 v[202:203], v2 offset:6656
    buffer_load_dwordx4 v9, s[36:39], s53 offen offset:2048  lds
    s_waitcnt lgkmcnt(4)
    v_mfma_f32_32x32x16_bf16 v[128:143], v[192:195], a[144:147], v[128:143]
    ds_read_b64_tr_b16 v[204:205], v5 offset:6144
    v_rcp_f32 v208, v208
    v_rcp_f32 v209, v209
    v_mfma_f32_32x32x16_bf16 v[144:159], v[192:195], a[148:151], v[144:159]
    ds_read_b64_tr_b16 v[206:207], v5 offset:6656
    v_mul_f32 v212, s60, v86
    v_mul_f32 v213, s60, v87
    s_waitcnt lgkmcnt(4)
    v_mfma_f32_32x32x16_bf16 v[160:175], v[196:199], a[144:147], v[160:175]
    ds_read_b64_tr_b16 v[192:193], v2 offset:16384
    buffer_load_dwordx4 v10, s[36:39], s53 offen offset:3072  lds
    v_exp_f32 v212, v212
    v_mfma_f32_32x32x16_bf16 v[176:191], v[196:199], a[148:151], v[176:191]
    ds_read_b64_tr_b16 v[194:195], v2 offset:16896
    v_exp_f32 v213, v213
    v_mul_f32 v214, v86, v94
    s_waitcnt lgkmcnt(4)
    v_mfma_f32_32x32x16_bf16 v[128:143], v[200:203], a[152:155], v[128:143]
    ds_read_b64_tr_b16 v[196:197], v5 offset:16384
    v_mul_f32 v215, v87, v95
    v_mul_f32 v210, v210, v208
    v_mul_f32 v211, v211, v209
    v_cvt_pk_bf16_f32 v222, v210, v211
    v_mfma_f32_32x32x16_bf16 v[144:159], v[200:203], a[156:159], v[144:159]
    ds_read_b64_tr_b16 v[198:199], v5 offset:16896
    buffer_load_dwordx4 v[252:255], v27, s[16:19], s92 offen
    s_add_u32 s92, s92, 589824
    s_waitcnt lgkmcnt(4)
    v_mfma_f32_32x32x16_bf16 v[160:175], v[204:207], a[152:155], v[160:175]
    ds_read_b64_tr_b16 v[200:201], v2 offset:18432
    v_add_f32 v212, 1.0, v212
    v_add_f32 v213, 1.0, v213
    v_rcp_f32 v212, v212
    v_mfma_f32_32x32x16_bf16 v[176:191], v[204:207], a[156:159], v[176:191]
    ds_read_b64_tr_b16 v[202:203], v2 offset:18944
    v_rcp_f32 v213, v213
    s_nop 1
    s_waitcnt vmcnt(34)
    s_barrier
    s_waitcnt lgkmcnt(4)
    v_mfma_f32_32x32x16_bf16 v[128:143], v[192:195], a[160:163], v[128:143]
    ds_read_b64_tr_b16 v[204:205], v5 offset:18432
    v_mul_f32 v214, v214, v212
    v_mul_f32 v215, v215, v213
    v_cvt_pk_bf16_f32 v223, v214, v215
    v_mfma_f32_32x32x16_bf16 v[144:159], v[192:195], a[164:167], v[144:159]
    ds_read_b64_tr_b16 v[206:207], v5 offset:18944
    s_add_u32 m0, s52, 65536
    s_add_u32 s53, s51, 2359552
    buffer_load_dwordx4 v7, s[36:39], s53 offen offset:0  lds
    s_waitcnt lgkmcnt(4)
    v_mfma_f32_32x32x16_bf16 v[160:175], v[196:199], a[160:163], v[160:175]
    ds_read_b64_tr_b16 v[192:193], v2 offset:20480
    buffer_store_dwordx4 v[220:223], v23, s[44:47], s48 offen offset:2048 sc1
    v_mul_f32 v208, s60, v96
    v_mul_f32 v209, s60, v97
    v_mfma_f32_32x32x16_bf16 v[176:191], v[196:199], a[164:167], v[176:191]
    ds_read_b64_tr_b16 v[194:195], v2 offset:20992
    v_exp_f32 v208, v208
    s_waitcnt lgkmcnt(4)
    v_mfma_f32_32x32x16_bf16 v[128:143], v[200:203], a[168:171], v[128:143]
    ds_read_b64_tr_b16 v[196:197], v5 offset:20480
    buffer_load_dwordx4 v8, s[36:39], s53 offen offset:1024  lds
    v_exp_f32 v209, v209
    v_mfma_f32_32x32x16_bf16 v[144:159], v[200:203], a[172:175], v[144:159]
    ds_read_b64_tr_b16 v[198:199], v5 offset:20992
    v_mul_f32 v210, v96, v104
    v_mul_f32 v211, v97, v105
    v_add_f32 v208, 1.0, v208
    s_waitcnt lgkmcnt(4)
    v_mfma_f32_32x32x16_bf16 v[160:175], v[204:207], a[168:171], v[160:175]
    ds_read_b64_tr_b16 v[200:201], v2 offset:22528
    v_add_f32 v209, 1.0, v209
    v_rcp_f32 v208, v208
    v_mfma_f32_32x32x16_bf16 v[176:191], v[204:207], a[172:175], v[176:191]
    ds_read_b64_tr_b16 v[202:203], v2 offset:23040
    buffer_load_dwordx4 v9, s[36:39], s53 offen offset:2048  lds
    s_waitcnt lgkmcnt(4)
    v_mfma_f32_32x32x16_bf16 v[128:143], v[192:195], a[176:179], v[128:143]
    ds_read_b64_tr_b16 v[204:205], v5 offset:22528
    v_rcp_f32 v209, v209
    v_mul_f32 v212, s60, v98
    v_mul_f32 v213, s60, v99
    v_mfma_f32_32x32x16_bf16 v[144:159], v[192:195], a[180:183], v[144:159]
    ds_read_b64_tr_b16 v[206:207], v5 offset:23040
    v_exp_f32 v212, v212
    s_waitcnt lgkmcnt(4)
    v_mfma_f32_32x32x16_bf16 v[160:175], v[196:199], a[176:179], v[160:175]
    ds_read_b64_tr_b16 v[192:193], v2 offset:32768
    buffer_load_dwordx4 v10, s[36:39], s53 offen offset:3072  lds
    v_exp_f32 v213, v213
    v_mfma_f32_32x32x16_bf16 v[176:191], v[196:199], a[180:183], v[176:191]
    ds_read_b64_tr_b16 v[194:195], v2 offset:33280
    v_mul_f32 v214, v98, v106
    v_mul_f32 v215, v99, v107
    v_mul_f32 v210, v210, v208
    s_waitcnt lgkmcnt(4)
    v_mfma_f32_32x32x16_bf16 v[128:143], v[200:203], a[184:187], v[128:143]
    ds_read_b64_tr_b16 v[196:197], v5 offset:32768
    v_mul_f32 v211, v211, v209
    v_cvt_pk_bf16_f32 v216, v210, v211
    v_add_f32 v212, 1.0, v212
    v_add_f32 v213, 1.0, v213
    v_mfma_f32_32x32x16_bf16 v[144:159], v[200:203], a[188:191], v[144:159]
    ds_read_b64_tr_b16 v[198:199], v5 offset:33280
    buffer_load_dwordx4 v[252:255], v27, s[16:19], s92 offen
    s_add_u32 s92, s92, 589824
    s_waitcnt lgkmcnt(4)
    v_mfma_f32_32x32x16_bf16 v[160:175], v[204:207], a[184:187], v[160:175]
    ds_read_b64_tr_b16 v[200:201], v2 offset:34816
    v_rcp_f32 v212, v212
    v_rcp_f32 v213, v213
    v_mfma_f32_32x32x16_bf16 v[176:191], v[204:207], a[188:191], v[176:191]
    ds_read_b64_tr_b16 v[202:203], v2 offset:35328
    v_mul_f32 v208, s60, v100
    v_mul_f32 v209, s60, v101
    s_waitcnt vmcnt(36)
    s_barrier
    s_waitcnt lgkmcnt(4)
    v_mfma_f32_32x32x16_bf16 v[128:143], v[192:195], a[192:195], v[128:143]
    ds_read_b64_tr_b16 v[204:205], v5 offset:34816
    v_exp_f32 v208, v208
    v_exp_f32 v209, v209
    v_mfma_f32_32x32x16_bf16 v[144:159], v[192:195], a[196:199], v[144:159]
    ds_read_b64_tr_b16 v[206:207], v5 offset:35328
    s_add_u32 m0, s52, 81920
    s_add_u32 s53, s51, 2949376
    buffer_load_dwordx4 v7, s[36:39], s53 offen offset:0  lds
    s_waitcnt lgkmcnt(4)
    v_mfma_f32_32x32x16_bf16 v[160:175], v[196:199], a[192:195], v[160:175]
    ds_read_b64_tr_b16 v[192:193], v2 offset:36864
    v_mul_f32 v210, v100, v108
    v_mul_f32 v211, v101, v109
    v_mul_f32 v214, v214, v212
    v_mul_f32 v215, v215, v213
    v_mfma_f32_32x32x16_bf16 v[176:191], v[196:199], a[196:199], v[176:191]
    ds_read_b64_tr_b16 v[194:195], v2 offset:37376
    v_cvt_pk_bf16_f32 v217, v214, v215
    v_add_f32 v208, 1.0, v208
    v_add_f32 v209, 1.0, v209
    s_waitcnt lgkmcnt(4)
    v_mfma_f32_32x32x16_bf16 v[128:143], v[200:203], a[200:203], v[128:143]
    ds_read_b64_tr_b16 v[196:197], v5 offset:36864
    buffer_load_dwordx4 v8, s[36:39], s53 offen offset:1024  lds
    v_rcp_f32 v208, v208
    v_mfma_f32_32x32x16_bf16 v[144:159], v[200:203], a[204:207], v[144:159]
    ds_read_b64_tr_b16 v[198:199], v5 offset:37376
    v_rcp_f32 v209, v209
    v_mul_f32 v212, s60, v102
    s_waitcnt lgkmcnt(4)
    v_mfma_f32_32x32x16_bf16 v[160:175], v[204:207], a[200:203], v[160:175]
    ds_read_b64_tr_b16 v[200:201], v2 offset:38912
    v_mul_f32 v213, s60, v103
    v_exp_f32 v212, v212
    v_mfma_f32_32x32x16_bf16 v[176:191], v[204:207], a[204:207], v[176:191]
    ds_read_b64_tr_b16 v[202:203], v2 offset:39424
    buffer_load_dwordx4 v9, s[36:39], s53 offen offset:2048  lds
    s_waitcnt lgkmcnt(4)
    v_mfma_f32_32x32x16_bf16 v[128:143], v[192:195], a[208:211], v[128:143]
    ds_read_b64_tr_b16 v[204:205], v5 offset:38912
    v_exp_f32 v213, v213
    v_mul_f32 v214, v102, v110
    v_mul_f32 v215, v103, v111
    v_mfma_f32_32x32x16_bf16 v[144:159], v[192:195], a[212:215], v[144:159]
    ds_read_b64_tr_b16 v[206:207], v5 offset:39424
    v_mul_f32 v210, v210, v208
    v_mul_f32 v211, v211, v209
    v_cvt_pk_bf16_f32 v218, v210, v211
    s_waitcnt lgkmcnt(4)
    v_mfma_f32_32x32x16_bf16 v[160:175], v[196:199], a[208:211], v[160:175]
    ds_read_b64_tr_b16 v[192:193], v2 offset:49152
    buffer_load_dwordx4 v10, s[36:39], s53 offen offset:3072  lds
    v_add_f32 v212, 1.0, v212
    v_add_f32 v213, 1.0, v213
    v_mfma_f32_32x32x16_bf16 v[176:191], v[196:199], a[212:215], v[176:191]
    ds_read_b64_tr_b16 v[194:195], v2 offset:49664
    v_rcp_f32 v212, v212
    s_waitcnt lgkmcnt(4)
    v_mfma_f32_32x32x16_bf16 v[128:143], v[200:203], a[216:219], v[128:143]
    ds_read_b64_tr_b16 v[196:197], v5 offset:49152
    v_rcp_f32 v213, v213
    s_nop 1
    v_mul_f32 v214, v214, v212
    v_mfma_f32_32x32x16_bf16 v[144:159], v[200:203], a[220:223], v[144:159]
    ds_read_b64_tr_b16 v[198:199], v5 offset:49664
    buffer_load_dwordx4 v[252:255], v27, s[16:19], s92 offen
    s_add_u32 s92, s92, 589824
    s_waitcnt lgkmcnt(4)
    v_mfma_f32_32x32x16_bf16 v[160:175], v[204:207], a[216:219], v[160:175]
    ds_read_b64_tr_b16 v[200:201], v2 offset:51200
    v_mul_f32 v215, v215, v213
    v_cvt_pk_bf16_f32 v219, v214, v215
    buffer_store_dwordx4 v[216:219], v23, s[44:47], s48 offen offset:512 sc1
    v_mfma_f32_32x32x16_bf16 v[176:191], v[204:207], a[220:223], v[176:191]
    ds_read_b64_tr_b16 v[202:203], v2 offset:51712
    v_mul_f32 v208, s60, v112
    v_mul_f32 v209, s60, v113
    s_waitcnt vmcnt(38)
    s_barrier
    s_waitcnt lgkmcnt(4)
    v_mfma_f32_32x32x16_bf16 v[128:143], v[192:195], a[224:227], v[128:143]
    ds_read_b64_tr_b16 v[204:205], v5 offset:51200
    v_exp_f32 v208, v208
    v_exp_f32 v209, v209
    v_mfma_f32_32x32x16_bf16 v[144:159], v[192:195], a[228:231], v[144:159]
    ds_read_b64_tr_b16 v[206:207], v5 offset:51712
    s_add_u32 m0, s52, 98304
    s_add_u32 s53, s51, 3539200
    buffer_load_dwordx4 v7, s[36:39], s53 offen offset:0  lds
    s_waitcnt lgkmcnt(4)
    v_mfma_f32_32x32x16_bf16 v[160:175], v[196:199], a[224:227], v[160:175]
    ds_read_b64_tr_b16 v[192:193], v2 offset:53248
    v_mul_f32 v210, v112, v120
    v_mul_f32 v211, v113, v121
    v_add_f32 v208, 1.0, v208
    v_add_f32 v209, 1.0, v209
    v_mfma_f32_32x32x16_bf16 v[176:191], v[196:199], a[228:231], v[176:191]
    ds_read_b64_tr_b16 v[194:195], v2 offset:53760
    v_rcp_f32 v208, v208
    s_waitcnt lgkmcnt(4)
    v_mfma_f32_32x32x16_bf16 v[128:143], v[200:203], a[232:235], v[128:143]
    ds_read_b64_tr_b16 v[196:197], v5 offset:53248
    buffer_load_dwordx4 v8, s[36:39], s53 offen offset:1024  lds
    v_rcp_f32 v209, v209
    v_mfma_f32_32x32x16_bf16 v[144:159], v[200:203], a[236:239], v[144:159]
    ds_read_b64_tr_b16 v[198:199], v5 offset:53760
    v_mul_f32 v212, s60, v114
    v_mul_f32 v213, s60, v115
    s_waitcnt lgkmcnt(4)
    v_mfma_f32_32x32x16_bf16 v[160:175], v[204:207], a[232:235], v[160:175]
    ds_read_b64_tr_b16 v[200:201], v2 offset:55296
    v_exp_f32 v212, v212
    v_exp_f32 v213, v213
    v_mfma_f32_32x32x16_bf16 v[176:191], v[204:207], a[236:239], v[176:191]
    ds_read_b64_tr_b16 v[202:203], v2 offset:55808
    buffer_load_dwordx4 v9, s[36:39], s53 offen offset:2048  lds
    v_mul_f32 v214, v114, v122
    s_waitcnt lgkmcnt(4)
    v_mfma_f32_32x32x16_bf16 v[128:143], v[192:195], a[240:243], v[128:143]
    ds_read_b64_tr_b16 v[204:205], v5 offset:55296
    v_mul_f32 v215, v115, v123
    v_mul_f32 v210, v210, v208
    v_mul_f32 v211, v211, v209
    v_cvt_pk_bf16_f32 v220, v210, v211
    v_mfma_f32_32x32x16_bf16 v[144:159], v[192:195], a[244:247], v[144:159]
    ds_read_b64_tr_b16 v[206:207], v5 offset:55808
    v_add_f32 v212, 1.0, v212
    v_add_f32 v213, 1.0, v213
    s_waitcnt lgkmcnt(4)
    v_mfma_f32_32x32x16_bf16 v[160:175], v[196:199], a[240:243], v[160:175]
    ds_read_b64_tr_b16 v[192:193], v3 offset:0
    buffer_load_dwordx4 v10, s[36:39], s53 offen offset:3072  lds
    v_rcp_f32 v212, v212
    v_mfma_f32_32x32x16_bf16 v[176:191], v[196:199], a[244:247], v[176:191]
    ds_read_b64_tr_b16 v[194:195], v3 offset:512
    v_rcp_f32 v213, v213
    v_mul_f32 v208, s60, v116
    s_waitcnt lgkmcnt(4)
    v_mfma_f32_32x32x16_bf16 v[128:143], v[200:203], a[248:251], v[128:143]
    ds_read_b64_tr_b16 v[196:197], v6 offset:0
    v_mul_f32 v209, s60, v117
    v_exp_f32 v208, v208
    v_mfma_f32_32x32x16_bf16 v[144:159], v[200:203], a[252:255], v[144:159]
    ds_read_b64_tr_b16 v[198:199], v6 offset:512
    buffer_load_dwordx4 v[252:255], v27, s[16:19], s92 offen
    s_add_u32 s92, s92, 589824
    s_waitcnt lgkmcnt(4)
    v_mfma_f32_32x32x16_bf16 v[160:175], v[204:207], a[248:251], v[160:175]
    ds_read_b64_tr_b16 v[200:201], v3 offset:2048
    v_exp_f32 v209, v209
    v_mul_f32 v210, v116, v124
    v_mul_f32 v211, v117, v125
    v_mfma_f32_32x32x16_bf16 v[176:191], v[204:207], a[252:255], v[176:191]
    ds_read_b64_tr_b16 v[202:203], v3 offset:2560
    v_mul_f32 v214, v214, v212
    v_mul_f32 v215, v215, v213
    v_cvt_pk_bf16_f32 v221, v214, v215
    s_waitcnt vmcnt(38)
    s_barrier
    s_waitcnt lgkmcnt(4)
    v_mfma_f32_32x32x16_bf16 v[128:143], v[192:195], v[32:35], v[128:143]
    ds_read_b64_tr_b16 v[204:205], v6 offset:2048
    v_add_f32 v208, 1.0, v208
    v_add_f32 v209, 1.0, v209
    v_rcp_f32 v208, v208
    v_mfma_f32_32x32x16_bf16 v[144:159], v[192:195], v[36:39], v[144:159]
    ds_read_b64_tr_b16 v[206:207], v6 offset:2560
    s_add_u32 m0, s52, 114688
    s_add_u32 s53, s51, 4129024
    buffer_load_dwordx4 v7, s[36:39], s53 offen offset:0  lds
    s_waitcnt lgkmcnt(4)
    v_mfma_f32_32x32x16_bf16 v[160:175], v[196:199], v[32:35], v[160:175]
    ds_read_b64_tr_b16 v[192:193], v3 offset:4096
    v_rcp_f32 v209, v209
    v_mul_f32 v212, s60, v118
    v_mul_f32 v213, s60, v119
    v_mfma_f32_32x32x16_bf16 v[176:191], v[196:199], v[36:39], v[176:191]
    ds_read_b64_tr_b16 v[194:195], v3 offset:4608
    v_exp_f32 v212, v212
    s_waitcnt lgkmcnt(4)
    v_mfma_f32_32x32x16_bf16 v[128:143], v[200:203], v[40:43], v[128:143]
    ds_read_b64_tr_b16 v[196:197], v6 offset:4096
    buffer_load_dwordx4 v8, s[36:39], s53 offen offset:1024  lds
    v_exp_f32 v213, v213
    v_mfma_f32_32x32x16_bf16 v[144:159], v[200:203], v[44:47], v[144:159]
    ds_read_b64_tr_b16 v[198:199], v6 offset:4608
    v_mul_f32 v214, v118, v126
    v_mul_f32 v215, v119, v127
    v_mul_f32 v210, v210, v208
    s_waitcnt lgkmcnt(4)
    v_mfma_f32_32x32x16_bf16 v[160:175], v[204:207], v[40:43], v[160:175]
    ds_read_b64_tr_b16 v[200:201], v3 offset:6144
    v_mul_f32 v211, v211, v209
    v_cvt_pk_bf16_f32 v222, v210, v211
    v_add_f32 v212, 1.0, v212
    v_add_f32 v213, 1.0, v213
    v_mfma_f32_32x32x16_bf16 v[176:191], v[204:207], v[44:47], v[176:191]
    ds_read_b64_tr_b16 v[202:203], v3 offset:6656
    buffer_load_dwordx4 v9, s[36:39], s53 offen offset:2048  lds
    s_waitcnt lgkmcnt(4)
    v_mfma_f32_32x32x16_bf16 v[128:143], v[192:195], v[48:51], v[128:143]
    ds_read_b64_tr_b16 v[204:205], v6 offset:6144
    v_rcp_f32 v212, v212
    v_rcp_f32 v213, v213
    v_mfma_f32_32x32x16_bf16 v[144:159], v[192:195], v[52:55], v[144:159]
    ds_read_b64_tr_b16 v[206:207], v6 offset:6656
    s_nop 1
    v_mul_f32 v214, v214, v212
    v_mul_f32 v215, v215, v213
    s_waitcnt lgkmcnt(4)
    v_mfma_f32_32x32x16_bf16 v[160:175], v[196:199], v[48:51], v[160:175]
    ds_read_b64_tr_b16 v[192:193], v1 offset:0
    buffer_load_dwordx4 v10, s[36:39], s53 offen offset:3072  lds
    v_cvt_pk_bf16_f32 v223, v214, v215
    v_mfma_f32_32x32x16_bf16 v[176:191], v[196:199], v[52:55], v[176:191]
    ds_read_b64_tr_b16 v[194:195], v1 offset:512
    buffer_store_dwordx4 v[220:223], v23, s[44:47], s48 offen offset:2560 sc1
    s_add_u32 s48, s48, 262144
    s_waitcnt lgkmcnt(4)
    v_mfma_f32_32x32x16_bf16 v[128:143], v[200:203], v[56:59], v[128:143]
    ds_read_b64_tr_b16 v[196:197], v4 offset:0
    v_mfma_f32_32x32x16_bf16 v[144:159], v[200:203], v[60:63], v[144:159]
    ds_read_b64_tr_b16 v[198:199], v4 offset:512
    buffer_load_dwordx4 v[252:255], v27, s[16:19], s92 offen
    s_add_u32 s92, s92, 589824
    s_waitcnt lgkmcnt(4)
    v_mfma_f32_32x32x16_bf16 v[160:175], v[204:207], v[56:59], v[160:175]
    ds_read_b64_tr_b16 v[200:201], v1 offset:2048
    v_mfma_f32_32x32x16_bf16 v[176:191], v[204:207], v[60:63], v[176:191]
    ds_read_b64_tr_b16 v[202:203], v1 offset:2560
    s_waitcnt vmcnt(37)
    s_barrier
    s_waitcnt lgkmcnt(4)
    v_mfma_f32_32x32x16_bf16 v[64:79], v[192:195], a[0:3], 0
    ds_read_b64_tr_b16 v[204:205], v4 offset:2048
    v_mfma_f32_32x32x16_bf16 v[80:95], v[192:195], a[4:7], 0
    ds_read_b64_tr_b16 v[206:207], v4 offset:2560
    s_add_u32 m0, s52, 131072
    s_add_u32 s53, s51, 4718848
    buffer_load_dwordx4 v7, s[36:39], s53 offen offset:0  lds
    s_waitcnt lgkmcnt(4)
    v_mfma_f32_32x32x16_bf16 v[96:111], v[196:199], a[0:3], 0
    ds_read_b64_tr_b16 v[192:193], v1 offset:4096
    v_mfma_f32_32x32x16_bf16 v[112:127], v[196:199], a[4:7], 0
    ds_read_b64_tr_b16 v[194:195], v1 offset:4608
    s_waitcnt lgkmcnt(4)
    v_mfma_f32_32x32x16_bf16 v[64:79], v[200:203], a[8:11], v[64:79]
    ds_read_b64_tr_b16 v[196:197], v4 offset:4096
    v_mul_f32 v208, s60, v128
    v_mul_f32 v209, s60, v129
    v_exp_f32 v208, v208
    v_mfma_f32_32x32x16_bf16 v[80:95], v[200:203], a[12:15], v[80:95]
    ds_read_b64_tr_b16 v[198:199], v4 offset:4608
    buffer_load_dwordx4 v8, s[36:39], s53 offen offset:1024  lds
    s_waitcnt lgkmcnt(4)
    v_mfma_f32_32x32x16_bf16 v[96:111], v[204:207], a[8:11], v[96:111]
    ds_read_b64_tr_b16 v[200:201], v1 offset:6144
    v_exp_f32 v209, v209
    v_mul_f32 v210, v128, v136
    v_mul_f32 v211, v129, v137
    v_mfma_f32_32x32x16_bf16 v[112:127], v[204:207], a[12:15], v[112:127]
    ds_read_b64_tr_b16 v[202:203], v1 offset:6656
    v_add_f32 v208, 1.0, v208
    v_add_f32 v209, 1.0, v209
    s_waitcnt lgkmcnt(4)
    v_mfma_f32_32x32x16_bf16 v[64:79], v[192:195], a[16:19], v[64:79]
    ds_read_b64_tr_b16 v[204:205], v4 offset:6144
    v_rcp_f32 v208, v208
    v_rcp_f32 v209, v209
    v_mfma_f32_32x32x16_bf16 v[80:95], v[192:195], a[20:23], v[80:95]
    ds_read_b64_tr_b16 v[206:207], v4 offset:6656
    buffer_load_dwordx4 v9, s[36:39], s53 offen offset:2048  lds
    v_mul_f32 v212, s60, v130
    s_waitcnt lgkmcnt(4)
    v_mfma_f32_32x32x16_bf16 v[96:111], v[196:199], a[16:19], v[96:111]
    ds_read_b64_tr_b16 v[192:193], v1 offset:16384
    v_mul_f32 v213, s60, v131
    v_exp_f32 v212, v212
    v_mfma_f32_32x32x16_bf16 v[112:127], v[196:199], a[20:23], v[112:127]
    ds_read_b64_tr_b16 v[194:195], v1 offset:16896
    v_exp_f32 v213, v213
    v_mul_f32 v214, v130, v138
    s_waitcnt lgkmcnt(4)
    v_mfma_f32_32x32x16_bf16 v[64:79], v[200:203], a[24:27], v[64:79]
    ds_read_b64_tr_b16 v[196:197], v4 offset:16384
    v_mul_f32 v215, v131, v139
    v_mul_f32 v210, v210, v208
    v_mul_f32 v211, v211, v209
    v_cvt_pk_bf16_f32 v216, v210, v211
    v_mfma_f32_32x32x16_bf16 v[80:95], v[200:203], a[28:31], v[80:95]
    ds_read_b64_tr_b16 v[198:199], v4 offset:16896
    buffer_load_dwordx4 v10, s[36:39], s53 offen offset:3072  lds
    v_add_f32 v212, 1.0, v212
    s_waitcnt lgkmcnt(4)
    v_mfma_f32_32x32x16_bf16 v[96:111], v[204:207], a[24:27], v[96:111]
    ds_read_b64_tr_b16 v[200:201], v1 offset:18432
    v_add_f32 v213, 1.0, v213
    v_rcp_f32 v212, v212
    v_mfma_f32_32x32x16_bf16 v[112:127], v[204:207], a[28:31], v[112:127]
    ds_read_b64_tr_b16 v[202:203], v1 offset:18944
    v_rcp_f32 v213, v213
    v_mul_f32 v208, s60, v132
    s_waitcnt vmcnt(33)
    s_barrier
    s_waitcnt lgkmcnt(4)
    v_mfma_f32_32x32x16_bf16 v[64:79], v[192:195], a[32:35], v[64:79]
    ds_read_b64_tr_b16 v[204:205], v4 offset:18432
    v_mul_f32 v209, s60, v133
    v_exp_f32 v208, v208
    v_mfma_f32_32x32x16_bf16 v[80:95], v[192:195], a[36:39], v[80:95]
    ds_read_b64_tr_b16 v[206:207], v4 offset:18944
    s_add_u32 m0, s52, 0
    s_add_u32 s53, s51, 384
    buffer_load_dwordx4 v7, s[36:39], s53 offen offset:0  lds
    s_waitcnt lgkmcnt(4)
    v_mfma_f32_32x32x16_bf16 v[96:111], v[196:199], a[32:35], v[96:111]
    ds_read_b64_tr_b16 v[192:193], v1 offset:20480
    s_mov_b32 s49, s62
    ds_read_b64_tr_b16 v[224:225], v244 offset:0
    ds_read_b64_tr_b16 v[226:227], v244 offset:1024
    ds_read_b64_tr_b16 v[228:229], v245 offset:0
    v_mfma_f32_32x32x16_bf16 v[112:127], v[196:199], a[36:39], v[112:127]
    ds_read_b64_tr_b16 v[194:195], v1 offset:20992
    ds_read_b64_tr_b16 v[230:231], v245 offset:1024
    ds_read_b64_tr_b16 v[232:233], v246 offset:0
    ds_read_b64_tr_b16 v[234:235], v246 offset:1024
    s_waitcnt lgkmcnt(10)
    v_mfma_f32_32x32x16_bf16 v[64:79], v[200:203], a[40:43], v[64:79]
    ds_read_b64_tr_b16 v[196:197], v4 offset:20480
    ds_read_b64_tr_b16 v[236:237], v247 offset:0
    ds_read_b64_tr_b16 v[238:239], v247 offset:1024
    s_waitcnt lgkmcnt(0)
    v_mfma_f32_32x32x16_bf16 v[80:95], v[200:203], a[44:47], v[80:95]
    ds_read_b64_tr_b16 v[198:199], v4 offset:20992
    buffer_load_dwordx4 v8, s[36:39], s53 offen offset:1024  lds
    s_waitcnt lgkmcnt(12)
    v_mfma_f32_32x32x16_bf16 v[96:111], v[204:207], a[40:43], v[96:111]
    ds_read_b64_tr_b16 v[200:201], v1 offset:22528
    v_exp_f32 v209, v209
    v_mul_f32 v210, v132, v140
    v_mul_f32 v211, v133, v141
    v_mfma_f32_32x32x16_bf16 v[112:127], v[204:207], a[44:47], v[112:127]
    ds_read_b64_tr_b16 v[202:203], v1 offset:23040
    v_mul_f32 v214, v214, v212
    v_mul_f32 v215, v215, v213
    v_cvt_pk_bf16_f32 v217, v214, v215
    s_waitcnt lgkmcnt(9)
    v_mfma_f32_32x32x16_bf16 v[64:79], v[192:195], a[48:51], v[64:79]
    ds_read_b64_tr_b16 v[204:205], v4 offset:22528
    v_add_f32 v208, 1.0, v208
    v_add_f32 v209, 1.0, v209
    v_rcp_f32 v208, v208
    v_mfma_f32_32x32x16_bf16 v[80:95], v[192:195], a[52:55], v[80:95]
    ds_read_b64_tr_b16 v[206:207], v4 offset:23040
    buffer_load_dwordx4 v9, s[36:39], s53 offen offset:2048  lds
    s_waitcnt lgkmcnt(4)
    v_mfma_f32_32x32x16_bf16 v[96:111], v[196:199], a[48:51], v[96:111]
    ds_read_b64_tr_b16 v[192:193], v1 offset:32768
    v_rcp_f32 v209, v209
    v_mul_f32 v212, s60, v134
    v_mul_f32 v213, s60, v135
    v_mfma_f32_32x32x16_bf16 v[112:127], v[196:199], a[52:55], v[112:127]
    ds_read_b64_tr_b16 v[194:195], v1 offset:33280
    v_exp_f32 v212, v212
    s_waitcnt lgkmcnt(4)
    v_mfma_f32_32x32x16_bf16 v[64:79], v[200:203], a[56:59], v[64:79]
    ds_read_b64_tr_b16 v[196:197], v4 offset:32768
    v_exp_f32 v213, v213
    v_mul_f32 v214, v134, v142
    v_mul_f32 v215, v135, v143
    v_mfma_f32_32x32x16_bf16 v[80:95], v[200:203], a[60:63], v[80:95]
    ds_read_b64_tr_b16 v[198:199], v4 offset:33280
    buffer_load_dwordx4 v10, s[36:39], s53 offen offset:3072  lds
    v_mul_f32 v210, v210, v208
    s_waitcnt lgkmcnt(4)
    v_mfma_f32_32x32x16_bf16 v[96:111], v[204:207], a[56:59], v[96:111]
    ds_read_b64_tr_b16 v[200:201], v1 offset:34816
    v_mul_f32 v211, v211, v209
    v_cvt_pk_bf16_f32 v218, v210, v211
    v_add_f32 v212, 1.0, v212
    v_add_f32 v213, 1.0, v213
    v_mfma_f32_32x32x16_bf16 v[112:127], v[204:207], a[60:63], v[112:127]
    ds_read_b64_tr_b16 v[202:203], v1 offset:35328
    buffer_store_dwordx4 v[224:227], v248, s[12:15], s49 offen offset:0 sc1
    s_waitcnt vmcnt(33)
    s_barrier
    s_load_dwordx2 s[8:9], s[0:1], 64
    s_waitcnt lgkmcnt(4)
    v_mfma_f32_32x32x16_bf16 v[64:79], v[192:195], a[64:67], v[64:79]
    ds_read_b64_tr_b16 v[204:205], v4 offset:34816
    v_rcp_f32 v212, v212
    v_rcp_f32 v213, v213
    v_mfma_f32_32x32x16_bf16 v[80:95], v[192:195], a[68:71], v[80:95]
    ds_read_b64_tr_b16 v[206:207], v4 offset:35328
    s_add_u32 m0, s52, 16384
    s_add_u32 s53, s51, 590208
    buffer_load_dwordx4 v7, s[36:39], s53 offen offset:0  lds
    s_waitcnt lgkmcnt(4)
    v_mfma_f32_32x32x16_bf16 v[96:111], v[196:199], a[64:67], v[96:111]
    ds_read_b64_tr_b16 v[192:193], v1 offset:36864
    s_nop 1
    v_mul_f32 v214, v214, v212
    v_mul_f32 v215, v215, v213
    v_cvt_pk_bf16_f32 v219, v214, v215
    v_mfma_f32_32x32x16_bf16 v[112:127], v[196:199], a[68:71], v[112:127]
    ds_read_b64_tr_b16 v[194:195], v1 offset:37376
    buffer_store_dwordx4 v[216:219], v23, s[44:47], s48 offen offset:0 sc1
    v_mul_f32 v208, s60, v144
    s_waitcnt lgkmcnt(4)
    v_mfma_f32_32x32x16_bf16 v[64:79], v[200:203], a[72:75], v[64:79]
    ds_read_b64_tr_b16 v[196:197], v4 offset:36864
    v_mul_f32 v209, s60, v145
    v_exp_f32 v208, v208
    v_mfma_f32_32x32x16_bf16 v[80:95], v[200:203], a[76:79], v[80:95]
    ds_read_b64_tr_b16 v[198:199], v4 offset:37376
    buffer_load_dwordx4 v8, s[36:39], s53 offen offset:1024  lds
    s_waitcnt lgkmcnt(4)
    v_mfma_f32_32x32x16_bf16 v[96:111], v[204:207], a[72:75], v[96:111]
    ds_read_b64_tr_b16 v[200:201], v1 offset:38912
    buffer_store_dwordx4 v[228:231], v248, s[12:15], s49 offen offset:1024 sc1
    v_exp_f32 v209, v209
    v_mfma_f32_32x32x16_bf16 v[112:127], v[204:207], a[76:79], v[112:127]
    ds_read_b64_tr_b16 v[202:203], v1 offset:39424
    v_mul_f32 v210, v144, v152
    v_mul_f32 v211, v145, v153
    v_add_f32 v208, 1.0, v208
    s_waitcnt lgkmcnt(4)
    v_mfma_f32_32x32x16_bf16 v[64:79], v[192:195], a[80:83], v[64:79]
    ds_read_b64_tr_b16 v[204:205], v4 offset:38912
    v_add_f32 v209, 1.0, v209
    v_rcp_f32 v208, v208
    v_mfma_f32_32x32x16_bf16 v[80:95], v[192:195], a[84:87], v[80:95]
    ds_read_b64_tr_b16 v[206:207], v4 offset:39424
    buffer_load_dwordx4 v9, s[36:39], s53 offen offset:2048  lds
    s_waitcnt lgkmcnt(4)
    v_mfma_f32_32x32x16_bf16 v[96:111], v[196:199], a[80:83], v[96:111]
    ds_read_b64_tr_b16 v[192:193], v1 offset:49152
    v_rcp_f32 v209, v209
    v_mul_f32 v212, s60, v146
    v_mul_f32 v213, s60, v147
    v_mfma_f32_32x32x16_bf16 v[112:127], v[196:199], a[84:87], v[112:127]
    ds_read_b64_tr_b16 v[194:195], v1 offset:49664
    v_exp_f32 v212, v212
    s_waitcnt lgkmcnt(4)
    v_mfma_f32_32x32x16_bf16 v[64:79], v[200:203], a[88:91], v[64:79]
    ds_read_b64_tr_b16 v[196:197], v4 offset:49152
    v_exp_f32 v213, v213
    v_mul_f32 v214, v146, v154
    v_mul_f32 v215, v147, v155
    v_mfma_f32_32x32x16_bf16 v[80:95], v[200:203], a[92:95], v[80:95]
    ds_read_b64_tr_b16 v[198:199], v4 offset:49664
    buffer_load_dwordx4 v10, s[36:39], s53 offen offset:3072  lds
    v_mul_f32 v210, v210, v208
    s_waitcnt lgkmcnt(4)
    v_mfma_f32_32x32x16_bf16 v[96:111], v[204:207], a[88:91], v[96:111]
    ds_read_b64_tr_b16 v[200:201], v1 offset:51200
    v_mul_f32 v211, v211, v209
    v_cvt_pk_bf16_f32 v220, v210, v211
    v_add_f32 v212, 1.0, v212
    v_add_f32 v213, 1.0, v213
    v_mfma_f32_32x32x16_bf16 v[112:127], v[204:207], a[92:95], v[112:127]
    ds_read_b64_tr_b16 v[202:203], v1 offset:51712
    v_rcp_f32 v212, v212
    s_waitcnt vmcnt(33)
    s_barrier
    s_waitcnt lgkmcnt(4)
    v_mfma_f32_32x32x16_bf16 v[64:79], v[192:195], a[96:99], v[64:79]
    ds_read_b64_tr_b16 v[204:205], v4 offset:51200
    v_rcp_f32 v213, v213
    v_mul_f32 v208, s60, v148
    v_mul_f32 v209, s60, v149
    v_mfma_f32_32x32x16_bf16 v[80:95], v[192:195], a[100:103], v[80:95]
    ds_read_b64_tr_b16 v[206:207], v4 offset:51712
    s_add_u32 m0, s52, 32768
    s_add_u32 s53, s51, 1180032
    buffer_load_dwordx4 v7, s[36:39], s53 offen offset:0  lds
    s_waitcnt lgkmcnt(4)
    v_mfma_f32_32x32x16_bf16 v[96:111], v[196:199], a[96:99], v[96:111]
    ds_read_b64_tr_b16 v[192:193], v1 offset:53248
    v_exp_f32 v208, v208
    v_exp_f32 v209, v209
    v_mfma_f32_32x32x16_bf16 v[112:127], v[196:199], a[100:103], v[112:127]
    ds_read_b64_tr_b16 v[194:195], v1 offset:53760
    buffer_load_dwordx4 v8, s[36:39], s53 offen offset:1024  lds
    v_mul_f32 v210, v148, v156
    s_waitcnt lgkmcnt(4)
    v_mfma_f32_32x32x16_bf16 v[64:79], v[200:203], a[104:107], v[64:79]
    ds_read_b64_tr_b16 v[196:197], v4 offset:53248
    v_mul_f32 v211, v149, v157
    v_mul_f32 v214, v214, v212
    v_mul_f32 v215, v215, v213
    v_cvt_pk_bf16_f32 v221, v214, v215
    v_mfma_f32_32x32x16_bf16 v[80:95], v[200:203], a[108:111], v[80:95]
    ds_read_b64_tr_b16 v[198:199], v4 offset:53760
    v_add_f32 v208, 1.0, v208
    v_add_f32 v209, 1.0, v209
    s_waitcnt lgkmcnt(4)
    v_mfma_f32_32x32x16_bf16 v[96:111], v[204:207], a[104:107], v[96:111]
    ds_read_b64_tr_b16 v[200:201], v1 offset:55296
    buffer_load_dwordx4 v9, s[36:39], s53 offen offset:2048  lds
    buffer_store_dwordx4 v[232:235], v248, s[12:15], s49 offen offset:2048 sc1
    v_mfma_f32_32x32x16_bf16 v[112:127], v[204:207], a[108:111], v[112:127]
    ds_read_b64_tr_b16 v[202:203], v1 offset:55808
    v_rcp_f32 v208, v208
    s_waitcnt lgkmcnt(4)
    v_mfma_f32_32x32x16_bf16 v[64:79], v[192:195], a[112:115], v[64:79]
    ds_read_b64_tr_b16 v[204:205], v4 offset:55296
    v_rcp_f32 v209, v209
    v_mul_f32 v212, s60, v150
    v_mul_f32 v213, s60, v151
    v_mfma_f32_32x32x16_bf16 v[80:95], v[192:195], a[116:119], v[80:95]
    ds_read_b64_tr_b16 v[206:207], v4 offset:55808
    buffer_load_dwordx4 v10, s[36:39], s53 offen offset:3072  lds
    s_waitcnt lgkmcnt(4)
    v_mfma_f32_32x32x16_bf16 v[96:111], v[196:199], a[112:115], v[96:111]
    ds_read_b64_tr_b16 v[192:193], v2 offset:0
    v_exp_f32 v212, v212
    v_exp_f32 v213, v213
    v_mfma_f32_32x32x16_bf16 v[112:127], v[196:199], a[116:119], v[112:127]
    ds_read_b64_tr_b16 v[194:195], v2 offset:512
    s_add_u32 s29, s55, 1
    s_mul_hi_u32 s30, s29, 477218589
    s_mul_i32 s31, s30, 9
    s_sub_u32 s31, s29, s31
    s_cmp_lt_u32 s30, 144
    s_cselect_b32 s56, s88, s90
    s_cselect_b32 s57, s89, s91
    s_mov_b32 s58, 663552
    s_cselect_b32 s58, 5308416, s58
    s_cselect_b32 s61, 0, 144
    s_mov_b32 s59, 0x20000
    s_sub_u32 s61, s30, s61
    s_mul_i32 s61, s61, 36864
    s_lshl_b32 s63, s31, 7
    s_add_u32 s61, s61, s63
    s_mul_i32 s62, s30, 36864
    s_lshl_b32 s63, s31, 12
    s_add_u32 s62, s62, s63
    s_cmp_lt_u32 s29, 1458
    s_cselect_b32 s14, 5971968, 0
    s_cselect_b32 s58, s58, 0
    s_add_u32 m0, s52, 147456
    s_nop 0
    buffer_load_dwordx4 v240, s[56:59], s61 offen offset:0  lds
    s_waitcnt lgkmcnt(4)
    v_mfma_f32_32x32x16_bf16 v[64:79], v[200:203], a[120:123], v[64:79]
    ds_read_b64_tr_b16 v[196:197], v5 offset:0
    v_mul_f32 v214, v150, v158
    v_mul_f32 v215, v151, v159
    v_mul_f32 v210, v210, v208
    v_mul_f32 v211, v211, v209
    v_mfma_f32_32x32x16_bf16 v[80:95], v[200:203], a[124:127], v[80:95]
    ds_read_b64_tr_b16 v[198:199], v5 offset:512
    v_cvt_pk_bf16_f32 v222, v210, v211
    v_add_f32 v212, 1.0, v212
    v_add_f32 v213, 1.0, v213
    s_waitcnt lgkmcnt(4)
    v_mfma_f32_32x32x16_bf16 v[96:111], v[204:207], a[120:123], v[96:111]
    ds_read_b64_tr_b16 v[200:201], v2 offset:2048
    s_add_u32 m0, s52, 147456
    s_nop 0
    buffer_load_dwordx4 v241, s[56:59], s61 offen offset:1024  lds
    v_mfma_f32_32x32x16_bf16 v[112:127], v[204:207], a[124:127], v[112:127]
    ds_read_b64_tr_b16 v[202:203], v2 offset:2560
    v_rcp_f32 v212, v212
    s_waitcnt vmcnt(35)
    s_barrier
    s_waitcnt lgkmcnt(4)
    v_mfma_f32_32x32x16_bf16 v[64:79], v[192:195], a[128:131], v[64:79]
    ds_read_b64_tr_b16 v[204:205], v5 offset:2048
    v_rcp_f32 v213, v213
    s_nop 1
    v_mul_f32 v214, v214, v212
    v_mfma_f32_32x32x16_bf16 v[80:95], v[192:195], a[132:135], v[80:95]
    ds_read_b64_tr_b16 v[206:207], v5 offset:2560
    s_add_u32 m0, s52, 49152
    s_add_u32 s53, s51, 1769856
    buffer_load_dwordx4 v7, s[36:39], s53 offen offset:0  lds
    s_waitcnt lgkmcnt(4)
    v_mfma_f32_32x32x16_bf16 v[96:111], v[196:199], a[128:131], v[96:111]
    ds_read_b64_tr_b16 v[192:193], v2 offset:4096
    v_mul_f32 v215, v215, v213
    v_cvt_pk_bf16_f32 v223, v214, v215
    buffer_store_dwordx4 v[220:223], v23, s[44:47], s48 offen offset:2048 sc1
    v_mfma_f32_32x32x16_bf16 v[112:127], v[196:199], a[132:135], v[112:127]
    ds_read_b64_tr_b16 v[194:195], v2 offset:4608
    buffer_load_dwordx4 v8, s[36:39], s53 offen offset:1024  lds
    v_mul_f32 v208, s60, v160
    s_waitcnt lgkmcnt(4)
    v_mfma_f32_32x32x16_bf16 v[64:79], v[200:203], a[136:139], v[64:79]
    ds_read_b64_tr_b16 v[196:197], v5 offset:4096
    v_mul_f32 v209, s60, v161
    v_exp_f32 v208, v208
    v_mfma_f32_32x32x16_bf16 v[80:95], v[200:203], a[140:143], v[80:95]
    ds_read_b64_tr_b16 v[198:199], v5 offset:4608
    v_exp_f32 v209, v209
    v_mul_f32 v210, v160, v168
    s_waitcnt lgkmcnt(4)
    v_mfma_f32_32x32x16_bf16 v[96:111], v[204:207], a[136:139], v[96:111]
    ds_read_b64_tr_b16 v[200:201], v2 offset:6144
    buffer_load_dwordx4 v9, s[36:39], s53 offen offset:2048  lds
    buffer_store_dwordx4 v[236:239], v248, s[12:15], s49 offen offset:3072 sc1
    v_mfma_f32_32x32x16_bf16 v[112:127], v[204:207], a[140:143], v[112:127]
    ds_read_b64_tr_b16 v[202:203], v2 offset:6656
    v_mul_f32 v211, v161, v169
    v_add_f32 v208, 1.0, v208
    v_add_f32 v209, 1.0, v209
    s_waitcnt lgkmcnt(4)
    v_mfma_f32_32x32x16_bf16 v[64:79], v[192:195], a[144:147], v[64:79]
    ds_read_b64_tr_b16 v[204:205], v5 offset:6144
    v_rcp_f32 v208, v208
    v_rcp_f32 v209, v209
    v_mfma_f32_32x32x16_bf16 v[80:95], v[192:195], a[148:151], v[80:95]
    ds_read_b64_tr_b16 v[206:207], v5 offset:6656
    buffer_load_dwordx4 v10, s[36:39], s53 offen offset:3072  lds
    v_mul_f32 v212, s60, v162
    s_waitcnt lgkmcnt(4)
    v_mfma_f32_32x32x16_bf16 v[96:111], v[196:199], a[144:147], v[96:111]
    ds_read_b64_tr_b16 v[192:193], v2 offset:16384
    v_mul_f32 v213, s60, v163
    v_exp_f32 v212, v212
    v_mfma_f32_32x32x16_bf16 v[112:127], v[196:199], a[148:151], v[112:127]
    ds_read_b64_tr_b16 v[194:195], v2 offset:16896
    s_add_u32 m0, s52, 147456
    s_nop 0
    buffer_load_dwordx4 v242, s[56:59], s61 offen offset:2048  lds
    s_waitcnt lgkmcnt(4)
    v_mfma_f32_32x32x16_bf16 v[64:79], v[200:203], a[152:155], v[64:79]
    ds_read_b64_tr_b16 v[196:197], v5 offset:16384
    v_exp_f32 v213, v213
    v_mul_f32 v214, v162, v170
    v_mul_f32 v215, v163, v171
    v_mfma_f32_32x32x16_bf16 v[80:95], v[200:203], a[156:159], v[80:95]
    ds_read_b64_tr_b16 v[198:199], v5 offset:16896
    v_mul_f32 v210, v210, v208
    v_mul_f32 v211, v211, v209
    v_cvt_pk_bf16_f32 v216, v210, v211
    s_waitcnt lgkmcnt(4)
    v_mfma_f32_32x32x16_bf16 v[96:111], v[204:207], a[152:155], v[96:111]
    ds_read_b64_tr_b16 v[200:201], v2 offset:18432
    s_add_u32 m0, s52, 147456
    s_nop 0
    buffer_load_dwordx4 v243, s[56:59], s61 offen offset:3072  lds
    v_mfma_f32_32x32x16_bf16 v[112:127], v[204:207], a[156:159], v[112:127]
    ds_read_b64_tr_b16 v[202:203], v2 offset:18944
    v_add_f32 v212, 1.0, v212
    v_add_f32 v213, 1.0, v213
    s_waitcnt vmcnt(37)
    s_barrier
    s_waitcnt lgkmcnt(4)
    v_mfma_f32_32x32x16_bf16 v[64:79], v[192:195], a[160:163], v[64:79]
    ds_read_b64_tr_b16 v[204:205], v5 offset:18432
    v_rcp_f32 v212, v212
    v_rcp_f32 v213, v213
    v_mfma_f32_32x32x16_bf16 v[80:95], v[192:195], a[164:167], v[80:95]
    ds_read_b64_tr_b16 v[206:207], v5 offset:18944
    s_add_u32 m0, s52, 65536
    s_add_u32 s53, s51, 2359680
    buffer_load_dwordx4 v7, s[36:39], s53 offen offset:0  lds
    s_waitcnt lgkmcnt(4)
    v_mfma_f32_32x32x16_bf16 v[96:111], v[196:199], a[160:163], v[96:111]
    ds_read_b64_tr_b16 v[192:193], v2 offset:20480
    v_mul_f32 v208, s60, v164
    v_mul_f32 v209, s60, v165
    v_exp_f32 v208, v208
    v_mfma_f32_32x32x16_bf16 v[112:127], v[196:199], a[164:167], v[112:127]
    ds_read_b64_tr_b16 v[194:195], v2 offset:20992
    v_exp_f32 v209, v209
    v_mul_f32 v210, v164, v172
    s_waitcnt lgkmcnt(4)
    v_mfma_f32_32x32x16_bf16 v[64:79], v[200:203], a[168:171], v[64:79]
    ds_read_b64_tr_b16 v[196:197], v5 offset:20480
    v_mul_f32 v211, v165, v173
    v_mul_f32 v214, v214, v212
    v_mul_f32 v215, v215, v213
    v_cvt_pk_bf16_f32 v217, v214, v215
    v_mfma_f32_32x32x16_bf16 v[80:95], v[200:203], a[172:175], v[80:95]
    ds_read_b64_tr_b16 v[198:199], v5 offset:20992
    buffer_load_dwordx4 v8, s[36:39], s53 offen offset:1024  lds
    v_add_f32 v208, 1.0, v208
    s_waitcnt lgkmcnt(4)
    v_mfma_f32_32x32x16_bf16 v[96:111], v[204:207], a[168:171], v[96:111]
    ds_read_b64_tr_b16 v[200:201], v2 offset:22528
    v_add_f32 v209, 1.0, v209
    v_rcp_f32 v208, v208
    v_mfma_f32_32x32x16_bf16 v[112:127], v[204:207], a[172:175], v[112:127]
    ds_read_b64_tr_b16 v[202:203], v2 offset:23040
    v_rcp_f32 v209, v209
    v_mul_f32 v212, s60, v166
    s_waitcnt lgkmcnt(4)
    v_mfma_f32_32x32x16_bf16 v[64:79], v[192:195], a[176:179], v[64:79]
    ds_read_b64_tr_b16 v[204:205], v5 offset:22528
    v_mul_f32 v213, s60, v167
    v_exp_f32 v212, v212
    v_mfma_f32_32x32x16_bf16 v[80:95], v[192:195], a[180:183], v[80:95]
    ds_read_b64_tr_b16 v[206:207], v5 offset:23040
    buffer_load_dwordx4 v9, s[36:39], s53 offen offset:2048  lds
    s_waitcnt lgkmcnt(4)
    v_mfma_f32_32x32x16_bf16 v[96:111], v[196:199], a[176:179], v[96:111]
    ds_read_b64_tr_b16 v[192:193], v2 offset:32768
    v_exp_f32 v213, v213
    v_mul_f32 v214, v166, v174
    v_mul_f32 v215, v167, v175
    v_mfma_f32_32x32x16_bf16 v[112:127], v[196:199], a[180:183], v[112:127]
    ds_read_b64_tr_b16 v[194:195], v2 offset:33280
    v_mul_f32 v210, v210, v208
    v_mul_f32 v211, v211, v209
    v_cvt_pk_bf16_f32 v218, v210, v211
    s_waitcnt lgkmcnt(4)
    v_mfma_f32_32x32x16_bf16 v[64:79], v[200:203], a[184:187], v[64:79]
    ds_read_b64_tr_b16 v[196:197], v5 offset:32768
    v_add_f32 v212, 1.0, v212
    v_add_f32 v213, 1.0, v213
    v_rcp_f32 v212, v212
    v_mfma_f32_32x32x16_bf16 v[80:95], v[200:203], a[188:191], v[80:95]
    ds_read_b64_tr_b16 v[198:199], v5 offset:33280
    buffer_load_dwordx4 v10, s[36:39], s53 offen offset:3072  lds
    s_waitcnt lgkmcnt(4)
    v_mfma_f32_32x32x16_bf16 v[96:111], v[204:207], a[184:187], v[96:111]
    ds_read_b64_tr_b16 v[200:201], v2 offset:34816
    v_rcp_f32 v213, v213
    s_nop 1
    v_mul_f32 v214, v214, v212
    v_mfma_f32_32x32x16_bf16 v[112:127], v[204:207], a[188:191], v[112:127]
    ds_read_b64_tr_b16 v[202:203], v2 offset:35328
    v_mul_f32 v215, v215, v213
    v_cvt_pk_bf16_f32 v219, v214, v215
    s_waitcnt vmcnt(36)
    s_barrier
    s_waitcnt lgkmcnt(4)
    v_mfma_f32_32x32x16_bf16 v[64:79], v[192:195], a[192:195], v[64:79]
    ds_read_b64_tr_b16 v[204:205], v5 offset:34816
    buffer_store_dwordx4 v[216:219], v23, s[44:47], s48 offen offset:512 sc1
    v_mul_f32 v208, s60, v176
    v_mul_f32 v209, s60, v177
    v_mfma_f32_32x32x16_bf16 v[80:95], v[192:195], a[196:199], v[80:95]
    ds_read_b64_tr_b16 v[206:207], v5 offset:35328
    s_add_u32 m0, s52, 81920
    s_add_u32 s53, s51, 2949504
    buffer_load_dwordx4 v7, s[36:39], s53 offen offset:0  lds
    s_waitcnt lgkmcnt(4)
    v_mfma_f32_32x32x16_bf16 v[96:111], v[196:199], a[192:195], v[96:111]
    ds_read_b64_tr_b16 v[192:193], v2 offset:36864
    v_exp_f32 v208, v208
    v_exp_f32 v209, v209
    v_mfma_f32_32x32x16_bf16 v[112:127], v[196:199], a[196:199], v[112:127]
    ds_read_b64_tr_b16 v[194:195], v2 offset:37376
    v_mul_f32 v210, v176, v184
    v_mul_f32 v211, v177, v185
    v_add_f32 v208, 1.0, v208
    s_waitcnt lgkmcnt(4)
    v_mfma_f32_32x32x16_bf16 v[64:79], v[200:203], a[200:203], v[64:79]
    ds_read_b64_tr_b16 v[196:197], v5 offset:36864
    v_add_f32 v209, 1.0, v209
    v_rcp_f32 v208, v208
    v_mfma_f32_32x32x16_bf16 v[80:95], v[200:203], a[204:207], v[80:95]
    ds_read_b64_tr_b16 v[198:199], v5 offset:37376
    buffer_load_dwordx4 v8, s[36:39], s53 offen offset:1024  lds
    s_waitcnt lgkmcnt(4)
    v_mfma_f32_32x32x16_bf16 v[96:111], v[204:207], a[200:203], v[96:111]
    ds_read_b64_tr_b16 v[200:201], v2 offset:38912
    v_rcp_f32 v209, v209
    v_mul_f32 v212, s60, v178
    v_mul_f32 v213, s60, v179
    v_mfma_f32_32x32x16_bf16 v[112:127], v[204:207], a[204:207], v[112:127]
    ds_read_b64_tr_b16 v[202:203], v2 offset:39424
    v_exp_f32 v212, v212
    s_waitcnt lgkmcnt(4)
    v_mfma_f32_32x32x16_bf16 v[64:79], v[192:195], a[208:211], v[64:79]
    ds_read_b64_tr_b16 v[204:205], v5 offset:38912
    v_exp_f32 v213, v213
    v_mul_f32 v214, v178, v186
    v_mul_f32 v215, v179, v187
    v_mfma_f32_32x32x16_bf16 v[80:95], v[192:195], a[212:215], v[80:95]
    ds_read_b64_tr_b16 v[206:207], v5 offset:39424
    buffer_load_dwordx4 v9, s[36:39], s53 offen offset:2048  lds
    v_mul_f32 v210, v210, v208
    s_waitcnt lgkmcnt(4)
    v_mfma_f32_32x32x16_bf16 v[96:111], v[196:199], a[208:211], v[96:111]
    ds_read_b64_tr_b16 v[192:193], v2 offset:49152
    v_mul_f32 v211, v211, v209
    v_cvt_pk_bf16_f32 v220, v210, v211
    v_add_f32 v212, 1.0, v212
    v_add_f32 v213, 1.0, v213
    v_mfma_f32_32x32x16_bf16 v[112:127], v[196:199], a[212:215], v[112:127]
    ds_read_b64_tr_b16 v[194:195], v2 offset:49664
    v_rcp_f32 v212, v212
    s_waitcnt lgkmcnt(4)
    v_mfma_f32_32x32x16_bf16 v[64:79], v[200:203], a[216:219], v[64:79]
    ds_read_b64_tr_b16 v[196:197], v5 offset:49152
    v_rcp_f32 v213, v213
    v_mul_f32 v208, s60, v180
    v_mul_f32 v209, s60, v181
    v_mfma_f32_32x32x16_bf16 v[80:95], v[200:203], a[220:223], v[80:95]
    ds_read_b64_tr_b16 v[198:199], v5 offset:49664
    buffer_load_dwordx4 v10, s[36:39], s53 offen offset:3072  lds
    s_waitcnt lgkmcnt(4)
    v_mfma_f32_32x32x16_bf16 v[96:111], v[204:207], a[216:219], v[96:111]
    ds_read_b64_tr_b16 v[200:201], v2 offset:51200
    v_exp_f32 v208, v208
    v_exp_f32 v209, v209
    v_mfma_f32_32x32x16_bf16 v[112:127], v[204:207], a[220:223], v[112:127]
    ds_read_b64_tr_b16 v[202:203], v2 offset:51712
    v_mul_f32 v210, v180, v188
    v_mul_f32 v211, v181, v189
    v_mul_f32 v214, v214, v212
    s_waitcnt vmcnt(35)
    s_barrier
    s_waitcnt lgkmcnt(4)
    v_mfma_f32_32x32x16_bf16 v[64:79], v[192:195], a[224:227], v[64:79]
    ds_read_b64_tr_b16 v[204:205], v5 offset:51200
    v_mul_f32 v215, v215, v213
    v_cvt_pk_bf16_f32 v221, v214, v215
    v_add_f32 v208, 1.0, v208
    v_add_f32 v209, 1.0, v209
    v_mfma_f32_32x32x16_bf16 v[80:95], v[192:195], a[228:231], v[80:95]
    ds_read_b64_tr_b16 v[206:207], v5 offset:51712
    s_add_u32 m0, s52, 98304
    s_add_u32 s53, s51, 3539328
    buffer_load_dwordx4 v7, s[36:39], s53 offen offset:0  lds
    s_waitcnt lgkmcnt(4)
    v_mfma_f32_32x32x16_bf16 v[96:111], v[196:199], a[224:227], v[96:111]
    ds_read_b64_tr_b16 v[192:193], v2 offset:53248
    v_rcp_f32 v208, v208
    v_rcp_f32 v209, v209
    v_mfma_f32_32x32x16_bf16 v[112:127], v[196:199], a[228:231], v[112:127]
    ds_read_b64_tr_b16 v[194:195], v2 offset:53760
    v_mul_f32 v212, s60, v182
    v_mul_f32 v213, s60, v183
    s_waitcnt lgkmcnt(4)
    v_mfma_f32_32x32x16_bf16 v[64:79], v[200:203], a[232:235], v[64:79]
    ds_read_b64_tr_b16 v[196:197], v5 offset:53248
    v_exp_f32 v212, v212
    v_exp_f32 v213, v213
    v_mfma_f32_32x32x16_bf16 v[80:95], v[200:203], a[236:239], v[80:95]
    ds_read_b64_tr_b16 v[198:199], v5 offset:53760
    buffer_load_dwordx4 v8, s[36:39], s53 offen offset:1024  lds
    v_mul_f32 v214, v182, v190
    s_waitcnt lgkmcnt(4)
    v_mfma_f32_32x32x16_bf16 v[96:111], v[204:207], a[232:235], v[96:111]
    ds_read_b64_tr_b16 v[200:201], v2 offset:55296
    v_mul_f32 v215, v183, v191
    v_mul_f32 v210, v210, v208
    v_mul_f32 v211, v211, v209
    v_cvt_pk_bf16_f32 v222, v210, v211
    v_mfma_f32_32x32x16_bf16 v[112:127], v[204:207], a[236:239], v[112:127]
    ds_read_b64_tr_b16 v[202:203], v2 offset:55808
    v_add_f32 v212, 1.0, v212
    v_add_f32 v213, 1.0, v213
    s_waitcnt lgkmcnt(4)
    v_mfma_f32_32x32x16_bf16 v[64:79], v[192:195], a[240:243], v[64:79]
    ds_read_b64_tr_b16 v[204:205], v5 offset:55296
    v_rcp_f32 v212, v212
    v_rcp_f32 v213, v213
    v_mfma_f32_32x32x16_bf16 v[80:95], v[192:195], a[244:247], v[80:95]
    ds_read_b64_tr_b16 v[206:207], v5 offset:55808
    buffer_load_dwordx4 v9, s[36:39], s53 offen offset:2048  lds
    s_nop 1
    s_waitcnt lgkmcnt(4)
    v_mfma_f32_32x32x16_bf16 v[96:111], v[196:199], a[240:243], v[96:111]
    ds_read_b64_tr_b16 v[192:193], v3 offset:0
    v_mul_f32 v214, v214, v212
    v_mul_f32 v215, v215, v213
    v_cvt_pk_bf16_f32 v223, v214, v215
    v_mfma_f32_32x32x16_bf16 v[112:127], v[196:199], a[244:247], v[112:127]
    ds_read_b64_tr_b16 v[194:195], v3 offset:512
    buffer_store_dwordx4 v[220:223], v23, s[44:47], s48 offen offset:2560 sc1
    s_add_u32 s48, s48, 262144
    s_waitcnt lgkmcnt(4)
    v_mfma_f32_32x32x16_bf16 v[64:79], v[200:203], a[248:251], v[64:79]
    ds_read_b64_tr_b16 v[196:197], v6 offset:0
    v_mfma_f32_32x32x16_bf16 v[80:95], v[200:203], a[252:255], v[80:95]
    ds_read_b64_tr_b16 v[198:199], v6 offset:512
    buffer_load_dwordx4 v10, s[36:39], s53 offen offset:3072  lds
    s_waitcnt lgkmcnt(4)
    v_mfma_f32_32x32x16_bf16 v[96:111], v[204:207], a[248:251], v[96:111]
    ds_read_b64_tr_b16 v[200:201], v3 offset:2048
    v_mfma_f32_32x32x16_bf16 v[112:127], v[204:207], a[252:255], v[112:127]
    ds_read_b64_tr_b16 v[202:203], v3 offset:2560
    s_waitcnt vmcnt(36)
    s_barrier
    s_waitcnt lgkmcnt(4)
    v_mfma_f32_32x32x16_bf16 v[64:79], v[192:195], v[32:35], v[64:79]
    ds_read_b64_tr_b16 v[204:205], v6 offset:2048
    v_mfma_f32_32x32x16_bf16 v[80:95], v[192:195], v[36:39], v[80:95]
    ds_read_b64_tr_b16 v[206:207], v6 offset:2560
    s_add_u32 m0, s52, 114688
    s_add_u32 s53, s51, 4129152
    buffer_load_dwordx4 v7, s[36:39], s53 offen offset:0  lds
    s_waitcnt lgkmcnt(4)
    v_mfma_f32_32x32x16_bf16 v[96:111], v[196:199], v[32:35], v[96:111]
    ds_read_b64_tr_b16 v[192:193], v3 offset:4096
    v_mfma_f32_32x32x16_bf16 v[112:127], v[196:199], v[36:39], v[112:127]
    ds_read_b64_tr_b16 v[194:195], v3 offset:4608
    s_waitcnt lgkmcnt(4)
    v_mfma_f32_32x32x16_bf16 v[64:79], v[200:203], v[40:43], v[64:79]
    ds_read_b64_tr_b16 v[196:197], v6 offset:4096
    v_mfma_f32_32x32x16_bf16 v[80:95], v[200:203], v[44:47], v[80:95]
    ds_read_b64_tr_b16 v[198:199], v6 offset:4608
    buffer_load_dwordx4 v8, s[36:39], s53 offen offset:1024  lds
    s_waitcnt lgkmcnt(4)
    v_mfma_f32_32x32x16_bf16 v[96:111], v[204:207], v[40:43], v[96:111]
    ds_read_b64_tr_b16 v[200:201], v3 offset:6144
    v_mfma_f32_32x32x16_bf16 v[112:127], v[204:207], v[44:47], v[112:127]
    ds_read_b64_tr_b16 v[202:203], v3 offset:6656
    s_waitcnt lgkmcnt(4)
    v_mfma_f32_32x32x16_bf16 v[64:79], v[192:195], v[48:51], v[64:79]
    ds_read_b64_tr_b16 v[204:205], v6 offset:6144
    v_mfma_f32_32x32x16_bf16 v[80:95], v[192:195], v[52:55], v[80:95]
    ds_read_b64_tr_b16 v[206:207], v6 offset:6656
    buffer_load_dwordx4 v9, s[36:39], s53 offen offset:2048  lds
    s_waitcnt lgkmcnt(4)
    v_mfma_f32_32x32x16_bf16 v[96:111], v[196:199], v[48:51], v[96:111]
    ds_read_b64_tr_b16 v[192:193], v1 offset:0
    v_mfma_f32_32x32x16_bf16 v[112:127], v[196:199], v[52:55], v[112:127]
    ds_read_b64_tr_b16 v[194:195], v1 offset:512
    s_waitcnt lgkmcnt(4)
    v_mfma_f32_32x32x16_bf16 v[64:79], v[200:203], v[56:59], v[64:79]
    ds_read_b64_tr_b16 v[196:197], v4 offset:0
    v_mfma_f32_32x32x16_bf16 v[80:95], v[200:203], v[60:63], v[80:95]
    ds_read_b64_tr_b16 v[198:199], v4 offset:512
    buffer_load_dwordx4 v10, s[36:39], s53 offen offset:3072  lds
    s_waitcnt lgkmcnt(4)
    v_mfma_f32_32x32x16_bf16 v[96:111], v[204:207], v[56:59], v[96:111]
    ds_read_b64_tr_b16 v[200:201], v1 offset:2048
    v_mfma_f32_32x32x16_bf16 v[112:127], v[204:207], v[60:63], v[112:127]
    ds_read_b64_tr_b16 v[202:203], v1 offset:2560
    s_waitcnt vmcnt(33)
    s_barrier
    s_waitcnt lgkmcnt(4)
    v_mfma_f32_32x32x16_bf16 v[128:143], v[192:195], a[0:3], 0
    ds_read_b64_tr_b16 v[204:205], v4 offset:2048
    v_mfma_f32_32x32x16_bf16 v[144:159], v[192:195], a[4:7], 0
    ds_read_b64_tr_b16 v[206:207], v4 offset:2560
    s_add_u32 m0, s52, 131072
    s_add_u32 s53, s51, 4718976
    buffer_load_dwordx4 v7, s[36:39], s53 offen offset:0  lds
    s_waitcnt lgkmcnt(4)
    v_mfma_f32_32x32x16_bf16 v[160:175], v[196:199], a[0:3], 0
    ds_read_b64_tr_b16 v[192:193], v1 offset:4096
    v_mfma_f32_32x32x16_bf16 v[176:191], v[196:199], a[4:7], 0
    ds_read_b64_tr_b16 v[194:195], v1 offset:4608
    s_waitcnt lgkmcnt(4)
    v_mfma_f32_32x32x16_bf16 v[128:143], v[200:203], a[8:11], v[128:143]
    ds_read_b64_tr_b16 v[196:197], v4 offset:4096
    v_mul_f32 v208, s60, v64
    v_mul_f32 v209, s60, v65
    v_exp_f32 v208, v208
    v_mfma_f32_32x32x16_bf16 v[144:159], v[200:203], a[12:15], v[144:159]
    ds_read_b64_tr_b16 v[198:199], v4 offset:4608
    buffer_load_dwordx4 v8, s[36:39], s53 offen offset:1024  lds
    s_waitcnt lgkmcnt(4)
    v_mfma_f32_32x32x16_bf16 v[160:175], v[204:207], a[8:11], v[160:175]
    ds_read_b64_tr_b16 v[200:201], v1 offset:6144
    v_exp_f32 v209, v209
    v_mul_f32 v210, v64, v72
    v_mul_f32 v211, v65, v73
    v_mfma_f32_32x32x16_bf16 v[176:191], v[204:207], a[12:15], v[176:191]
    ds_read_b64_tr_b16 v[202:203], v1 offset:6656
    v_add_f32 v208, 1.0, v208
    v_add_f32 v209, 1.0, v209
    s_waitcnt lgkmcnt(4)
    v_mfma_f32_32x32x16_bf16 v[128:143], v[192:195], a[16:19], v[128:143]
    ds_read_b64_tr_b16 v[204:205], v4 offset:6144
    v_rcp_f32 v208, v208
    v_rcp_f32 v209, v209
    v_mfma_f32_32x32x16_bf16 v[144:159], v[192:195], a[20:23], v[144:159]
    ds_read_b64_tr_b16 v[206:207], v4 offset:6656
    buffer_load_dwordx4 v9, s[36:39], s53 offen offset:2048  lds
    v_mul_f32 v212, s60, v66
    s_waitcnt lgkmcnt(4)
    v_mfma_f32_32x32x16_bf16 v[160:175], v[196:199], a[16:19], v[160:175]
    ds_read_b64_tr_b16 v[192:193], v1 offset:16384
    v_mul_f32 v213, s60, v67
    v_exp_f32 v212, v212
    v_mfma_f32_32x32x16_bf16 v[176:191], v[196:199], a[20:23], v[176:191]
    ds_read_b64_tr_b16 v[194:195], v1 offset:16896
    v_exp_f32 v213, v213
    v_mul_f32 v214, v66, v74
    s_waitcnt lgkmcnt(4)
    v_mfma_f32_32x32x16_bf16 v[128:143], v[200:203], a[24:27], v[128:143]
    ds_read_b64_tr_b16 v[196:197], v4 offset:16384
    v_mul_f32 v215, v67, v75
    v_mul_f32 v210, v210, v208
    v_mul_f32 v211, v211, v209
    v_cvt_pk_bf16_f32 v216, v210, v211
    v_mfma_f32_32x32x16_bf16 v[144:159], v[200:203], a[28:31], v[144:159]
    ds_read_b64_tr_b16 v[198:199], v4 offset:16896
    buffer_load_dwordx4 v10, s[36:39], s53 offen offset:3072  lds
    v_add_f32 v212, 1.0, v212
    s_waitcnt lgkmcnt(4)
    v_mfma_f32_32x32x16_bf16 v[160:175], v[204:207], a[24:27], v[160:175]
    ds_read_b64_tr_b16 v[200:201], v1 offset:18432
    v_add_f32 v213, 1.0, v213
    v_rcp_f32 v212, v212
    v_mfma_f32_32x32x16_bf16 v[176:191], v[204:207], a[28:31], v[176:191]
    ds_read_b64_tr_b16 v[202:203], v1 offset:18944
    v_rcp_f32 v213, v213
    v_mul_f32 v208, s60, v68
    s_waitcnt vmcnt(32)
    s_barrier
    s_add_u32 s98, s10, 58720256
    s_addc_u32 s99, s11, 0
    v_mov_b32 v24, 64
    s_cmp_lg_u32 s26, 0
    s_cbranch_scc1 k1_npZ
    global_load_dword v25, v24, s[96:97] sc1

k1_npZ:
    s_waitcnt lgkmcnt(4)
    v_mfma_f32_32x32x16_bf16 v[128:143], v[192:195], a[32:35], v[128:143]
    ds_read_b64_tr_b16 v[204:205], v4 offset:18432
    v_mul_f32 v209, s60, v69
    v_exp_f32 v208, v208
    v_mfma_f32_32x32x16_bf16 v[144:159], v[192:195], a[36:39], v[144:159]
    ds_read_b64_tr_b16 v[206:207], v4 offset:18944
    s_add_u32 m0, s52, 0
    s_add_u32 s53, s51, 512
    buffer_load_dwordx4 v7, s[36:39], s53 offen offset:0  lds
    s_waitcnt lgkmcnt(4)
    v_mfma_f32_32x32x16_bf16 v[160:175], v[196:199], a[32:35], v[160:175]
    ds_read_b64_tr_b16 v[192:193], v1 offset:20480
    v_exp_f32 v209, v209
    v_mul_f32 v210, v68, v76
    v_mul_f32 v211, v69, v77
    v_mfma_f32_32x32x16_bf16 v[176:191], v[196:199], a[36:39], v[176:191]
    ds_read_b64_tr_b16 v[194:195], v1 offset:20992
    v_mul_f32 v214, v214, v212
    v_mul_f32 v215, v215, v213
    v_cvt_pk_bf16_f32 v217, v214, v215
    s_waitcnt lgkmcnt(4)
    v_mfma_f32_32x32x16_bf16 v[128:143], v[200:203], a[40:43], v[128:143]
    ds_read_b64_tr_b16 v[196:197], v4 offset:20480
    v_add_f32 v208, 1.0, v208
    v_add_f32 v209, 1.0, v209
    v_rcp_f32 v208, v208
    v_mfma_f32_32x32x16_bf16 v[144:159], v[200:203], a[44:47], v[144:159]
    ds_read_b64_tr_b16 v[198:199], v4 offset:20992
    buffer_load_dwordx4 v8, s[36:39], s53 offen offset:1024  lds
    s_waitcnt lgkmcnt(4)
    v_mfma_f32_32x32x16_bf16 v[160:175], v[204:207], a[40:43], v[160:175]
    ds_read_b64_tr_b16 v[200:201], v1 offset:22528
    v_rcp_f32 v209, v209
    v_mul_f32 v212, s60, v70
    v_mul_f32 v213, s60, v71
    v_mfma_f32_32x32x16_bf16 v[176:191], v[204:207], a[44:47], v[176:191]
    ds_read_b64_tr_b16 v[202:203], v1 offset:23040
    v_exp_f32 v212, v212
    s_waitcnt lgkmcnt(4)
    v_mfma_f32_32x32x16_bf16 v[128:143], v[192:195], a[48:51], v[128:143]
    ds_read_b64_tr_b16 v[204:205], v4 offset:22528
    v_exp_f32 v213, v213
    v_mul_f32 v214, v70, v78
    v_mul_f32 v215, v71, v79
    v_mfma_f32_32x32x16_bf16 v[144:159], v[192:195], a[52:55], v[144:159]
    ds_read_b64_tr_b16 v[206:207], v4 offset:23040
    buffer_load_dwordx4 v9, s[36:39], s53 offen offset:2048  lds
    v_mul_f32 v210, v210, v208
    s_waitcnt lgkmcnt(4)
    v_mfma_f32_32x32x16_bf16 v[160:175], v[196:199], a[48:51], v[160:175]
    ds_read_b64_tr_b16 v[192:193], v1 offset:32768
    v_mul_f32 v211, v211, v209
    v_cvt_pk_bf16_f32 v218, v210, v211
    v_add_f32 v212, 1.0, v212
    v_add_f32 v213, 1.0, v213
    v_mfma_f32_32x32x16_bf16 v[176:191], v[196:199], a[52:55], v[176:191]
    ds_read_b64_tr_b16 v[194:195], v1 offset:33280
    v_rcp_f32 v212, v212
    s_waitcnt lgkmcnt(4)
    v_mfma_f32_32x32x16_bf16 v[128:143], v[200:203], a[56:59], v[128:143]
    ds_read_b64_tr_b16 v[196:197], v4 offset:32768
    v_rcp_f32 v213, v213
    s_nop 1
    v_mul_f32 v214, v214, v212
    v_mfma_f32_32x32x16_bf16 v[144:159], v[200:203], a[60:63], v[144:159]
    ds_read_b64_tr_b16 v[198:199], v4 offset:33280
    buffer_load_dwordx4 v10, s[36:39], s53 offen offset:3072  lds
    v_mul_f32 v215, v215, v213
    s_waitcnt lgkmcnt(4)
    v_mfma_f32_32x32x16_bf16 v[160:175], v[204:207], a[56:59], v[160:175]
    ds_read_b64_tr_b16 v[200:201], v1 offset:34816
    v_cvt_pk_bf16_f32 v219, v214, v215
    buffer_store_dwordx4 v[216:219], v23, s[44:47], s48 offen offset:0 sc1
    v_mul_f32 v208, s60, v80
    v_mfma_f32_32x32x16_bf16 v[176:191], v[204:207], a[60:63], v[176:191]
    ds_read_b64_tr_b16 v[202:203], v1 offset:35328
    v_mul_f32 v209, s60, v81
    v_exp_f32 v208, v208
    s_waitcnt vmcnt(29)
    s_barrier
    s_waitcnt lgkmcnt(4)
    v_mfma_f32_32x32x16_bf16 v[128:143], v[192:195], a[64:67], v[128:143]
    ds_read_b64_tr_b16 v[204:205], v4 offset:34816
    v_exp_f32 v209, v209
    v_mul_f32 v210, v80, v88
    v_mul_f32 v211, v81, v89
    v_mfma_f32_32x32x16_bf16 v[144:159], v[192:195], a[68:71], v[144:159]
    ds_read_b64_tr_b16 v[206:207], v4 offset:35328
    s_add_u32 m0, s52, 16384
    s_add_u32 s53, s51, 590336
    buffer_load_dwordx4 v7, s[36:39], s53 offen offset:0  lds
    s_waitcnt lgkmcnt(4)
    v_mfma_f32_32x32x16_bf16 v[160:175], v[196:199], a[64:67], v[160:175]
    ds_read_b64_tr_b16 v[192:193], v1 offset:36864
    v_add_f32 v208, 1.0, v208
    v_add_f32 v209, 1.0, v209
    v_rcp_f32 v208, v208
    v_mfma_f32_32x32x16_bf16 v[176:191], v[196:199], a[68:71], v[176:191]
    ds_read_b64_tr_b16 v[194:195], v1 offset:37376
    v_rcp_f32 v209, v209
    v_mul_f32 v212, s60, v82
    s_waitcnt lgkmcnt(4)
    v_mfma_f32_32x32x16_bf16 v[128:143], v[200:203], a[72:75], v[128:143]
    ds_read_b64_tr_b16 v[196:197], v4 offset:36864
    v_mul_f32 v213, s60, v83
    v_exp_f32 v212, v212
    v_mfma_f32_32x32x16_bf16 v[144:159], v[200:203], a[76:79], v[144:159]
    ds_read_b64_tr_b16 v[198:199], v4 offset:37376
    buffer_load_dwordx4 v8, s[36:39], s53 offen offset:1024  lds
    s_waitcnt lgkmcnt(4)
    v_mfma_f32_32x32x16_bf16 v[160:175], v[204:207], a[72:75], v[160:175]
    ds_read_b64_tr_b16 v[200:201], v1 offset:38912
    v_exp_f32 v213, v213
    v_mul_f32 v214, v82, v90
    v_mul_f32 v215, v83, v91
    v_mfma_f32_32x32x16_bf16 v[176:191], v[204:207], a[76:79], v[176:191]
    ds_read_b64_tr_b16 v[202:203], v1 offset:39424
    v_mul_f32 v210, v210, v208
    v_mul_f32 v211, v211, v209
    v_cvt_pk_bf16_f32 v220, v210, v211
    s_waitcnt lgkmcnt(4)
    v_mfma_f32_32x32x16_bf16 v[128:143], v[192:195], a[80:83], v[128:143]
    ds_read_b64_tr_b16 v[204:205], v4 offset:38912
    v_add_f32 v212, 1.0, v212
    v_add_f32 v213, 1.0, v213
    v_rcp_f32 v212, v212
    v_mfma_f32_32x32x16_bf16 v[144:159], v[192:195], a[84:87], v[144:159]
    ds_read_b64_tr_b16 v[206:207], v4 offset:39424
    buffer_load_dwordx4 v9, s[36:39], s53 offen offset:2048  lds
    s_waitcnt lgkmcnt(4)
    v_mfma_f32_32x32x16_bf16 v[160:175], v[196:199], a[80:83], v[160:175]
    ds_read_b64_tr_b16 v[192:193], v1 offset:49152
    v_rcp_f32 v213, v213
    v_mul_f32 v208, s60, v84
    v_mul_f32 v209, s60, v85
    v_mfma_f32_32x32x16_bf16 v[176:191], v[196:199], a[84:87], v[176:191]
    ds_read_b64_tr_b16 v[194:195], v1 offset:49664
    v_exp_f32 v208, v208
    s_waitcnt lgkmcnt(4)
    v_mfma_f32_32x32x16_bf16 v[128:143], v[200:203], a[88:91], v[128:143]
    ds_read_b64_tr_b16 v[196:197], v4 offset:49152
    v_exp_f32 v209, v209
    v_mul_f32 v210, v84, v92
    v_mul_f32 v211, v85, v93
    v_mfma_f32_32x32x16_bf16 v[144:159], v[200:203], a[92:95], v[144:159]
    ds_read_b64_tr_b16 v[198:199], v4 offset:49664
    buffer_load_dwordx4 v10, s[36:39], s53 offen offset:3072  lds
    v_mul_f32 v214, v214, v212
    s_waitcnt lgkmcnt(4)
    v_mfma_f32_32x32x16_bf16 v[160:175], v[204:207], a[88:91], v[160:175]
    ds_read_b64_tr_b16 v[200:201], v1 offset:51200
    v_mul_f32 v215, v215, v213
    v_cvt_pk_bf16_f32 v221, v214, v215
    v_add_f32 v208, 1.0, v208
    v_add_f32 v209, 1.0, v209
    v_mfma_f32_32x32x16_bf16 v[176:191], v[204:207], a[92:95], v[176:191]
    ds_read_b64_tr_b16 v[202:203], v1 offset:51712
    v_rcp_f32 v208, v208
    s_waitcnt vmcnt(27)
    s_barrier
    s_waitcnt lgkmcnt(4)
    v_mfma_f32_32x32x16_bf16 v[128:143], v[192:195], a[96:99], v[128:143]
    ds_read_b64_tr_b16 v[204:205], v4 offset:51200
    v_rcp_f32 v209, v209
    v_mul_f32 v212, s60, v86
    v_mul_f32 v213, s60, v87
    v_mfma_f32_32x32x16_bf16 v[144:159], v[192:195], a[100:103], v[144:159]
    ds_read_b64_tr_b16 v[206:207], v4 offset:51712
    s_add_u32 m0, s52, 32768
    s_add_u32 s53, s51, 1180160
    buffer_load_dwordx4 v7, s[36:39], s53 offen offset:0  lds
    s_waitcnt lgkmcnt(4)
    v_mfma_f32_32x32x16_bf16 v[160:175], v[196:199], a[96:99], v[160:175]
    ds_read_b64_tr_b16 v[192:193], v1 offset:53248
    s_mov_b32 s49, s62
    ds_read_b64_tr_b16 v[224:225], v244 offset:0
    ds_read_b64_tr_b16 v[226:227], v244 offset:1024
    ds_read_b64_tr_b16 v[228:229], v245 offset:0
    v_mfma_f32_32x32x16_bf16 v[176:191], v[196:199], a[100:103], v[176:191]
    ds_read_b64_tr_b16 v[194:195], v1 offset:53760
    ds_read_b64_tr_b16 v[230:231], v245 offset:1024
    ds_read_b64_tr_b16 v[232:233], v246 offset:0
    ds_read_b64_tr_b16 v[234:235], v246 offset:1024
    s_waitcnt lgkmcnt(10)
    v_mfma_f32_32x32x16_bf16 v[128:143], v[200:203], a[104:107], v[128:143]
    ds_read_b64_tr_b16 v[196:197], v4 offset:53248
    ds_read_b64_tr_b16 v[236:237], v247 offset:0
    ds_read_b64_tr_b16 v[238:239], v247 offset:1024
    s_waitcnt lgkmcnt(0)
    v_mfma_f32_32x32x16_bf16 v[144:159], v[200:203], a[108:111], v[144:159]
    ds_read_b64_tr_b16 v[198:199], v4 offset:53760
    buffer_load_dwordx4 v8, s[36:39], s53 offen offset:1024  lds
    s_waitcnt lgkmcnt(12)
    v_mfma_f32_32x32x16_bf16 v[160:175], v[204:207], a[104:107], v[160:175]
    ds_read_b64_tr_b16 v[200:201], v1 offset:55296
    v_exp_f32 v212, v212
    v_exp_f32 v213, v213
    v_mfma_f32_32x32x16_bf16 v[176:191], v[204:207], a[108:111], v[176:191]
    ds_read_b64_tr_b16 v[202:203], v1 offset:55808
    v_mul_f32 v214, v86, v94
    v_mul_f32 v215, v87, v95
    v_mul_f32 v210, v210, v208
    s_waitcnt lgkmcnt(9)
    v_mfma_f32_32x32x16_bf16 v[128:143], v[192:195], a[112:115], v[128:143]
    ds_read_b64_tr_b16 v[204:205], v4 offset:55296
    v_mul_f32 v211, v211, v209
    v_cvt_pk_bf16_f32 v222, v210, v211
    v_add_f32 v212, 1.0, v212
    v_add_f32 v213, 1.0, v213
    v_mfma_f32_32x32x16_bf16 v[144:159], v[192:195], a[116:119], v[144:159]
    ds_read_b64_tr_b16 v[206:207], v4 offset:55808
    buffer_load_dwordx4 v9, s[36:39], s53 offen offset:2048  lds
    s_waitcnt lgkmcnt(4)
    v_mfma_f32_32x32x16_bf16 v[160:175], v[196:199], a[112:115], v[160:175]
    ds_read_b64_tr_b16 v[192:193], v2 offset:0
    v_rcp_f32 v212, v212
    v_rcp_f32 v213, v213
    v_mfma_f32_32x32x16_bf16 v[176:191], v[196:199], a[116:119], v[176:191]
    ds_read_b64_tr_b16 v[194:195], v2 offset:512
    s_nop 1
    v_mul_f32 v214, v214, v212
    v_mul_f32 v215, v215, v213
    s_waitcnt lgkmcnt(4)
    v_mfma_f32_32x32x16_bf16 v[128:143], v[200:203], a[120:123], v[128:143]
    ds_read_b64_tr_b16 v[196:197], v5 offset:0
    v_cvt_pk_bf16_f32 v223, v214, v215
    buffer_store_dwordx4 v[220:223], v23, s[44:47], s48 offen offset:2048 sc1
    v_mul_f32 v208, s60, v96
    v_mfma_f32_32x32x16_bf16 v[144:159], v[200:203], a[124:127], v[144:159]
    ds_read_b64_tr_b16 v[198:199], v5 offset:512
    buffer_load_dwordx4 v10, s[36:39], s53 offen offset:3072  lds
    v_mul_f32 v209, s60, v97
    s_waitcnt lgkmcnt(4)
    v_mfma_f32_32x32x16_bf16 v[160:175], v[204:207], a[120:123], v[160:175]
    ds_read_b64_tr_b16 v[200:201], v2 offset:2048
    v_exp_f32 v208, v208
    v_exp_f32 v209, v209
    v_mfma_f32_32x32x16_bf16 v[176:191], v[204:207], a[124:127], v[176:191]
    ds_read_b64_tr_b16 v[202:203], v2 offset:2560
    buffer_store_dwordx4 v[224:227], v248, s[12:15], s49 offen offset:0 sc1
    v_mul_f32 v210, v96, v104
    s_waitcnt vmcnt(28)
    s_barrier
    s_waitcnt lgkmcnt(4)
    v_mfma_f32_32x32x16_bf16 v[128:143], v[192:195], a[128:131], v[128:143]
    ds_read_b64_tr_b16 v[204:205], v5 offset:2048
    v_mul_f32 v211, v97, v105
    v_add_f32 v208, 1.0, v208
    v_add_f32 v209, 1.0, v209
    v_mfma_f32_32x32x16_bf16 v[144:159], v[192:195], a[132:135], v[144:159]
    ds_read_b64_tr_b16 v[206:207], v5 offset:2560
    s_add_u32 m0, s52, 49152
    s_add_u32 s53, s51, 1769984
    buffer_load_dwordx4 v7, s[36:39], s53 offen offset:0  lds
    s_waitcnt lgkmcnt(4)
    v_mfma_f32_32x32x16_bf16 v[160:175], v[196:199], a[128:131], v[160:175]
    ds_read_b64_tr_b16 v[192:193], v2 offset:4096
    v_rcp_f32 v208, v208
    v_rcp_f32 v209, v209
    v_mfma_f32_32x32x16_bf16 v[176:191], v[196:199], a[132:135], v[176:191]
    ds_read_b64_tr_b16 v[194:195], v2 offset:4608
    v_mul_f32 v212, s60, v98
    v_mul_f32 v213, s60, v99
    s_waitcnt lgkmcnt(4)
    v_mfma_f32_32x32x16_bf16 v[128:143], v[200:203], a[136:139], v[128:143]
    ds_read_b64_tr_b16 v[196:197], v5 offset:4096
    v_exp_f32 v212, v212
    v_exp_f32 v213, v213
    v_mfma_f32_32x32x16_bf16 v[144:159], v[200:203], a[140:143], v[144:159]
    ds_read_b64_tr_b16 v[198:199], v5 offset:4608
    buffer_load_dwordx4 v8, s[36:39], s53 offen offset:1024  lds
    v_mul_f32 v214, v98, v106
    s_waitcnt lgkmcnt(4)
    v_mfma_f32_32x32x16_bf16 v[160:175], v[204:207], a[136:139], v[160:175]
    ds_read_b64_tr_b16 v[200:201], v2 offset:6144
    buffer_store_dwordx4 v[228:231], v248, s[12:15], s49 offen offset:1024 sc1
    v_mul_f32 v215, v99, v107
    v_mul_f32 v210, v210, v208
    v_mfma_f32_32x32x16_bf16 v[176:191], v[204:207], a[140:143], v[176:191]
    ds_read_b64_tr_b16 v[202:203], v2 offset:6656
    v_mul_f32 v211, v211, v209
    v_cvt_pk_bf16_f32 v216, v210, v211
    v_add_f32 v212, 1.0, v212
    s_waitcnt lgkmcnt(4)
    v_mfma_f32_32x32x16_bf16 v[128:143], v[192:195], a[144:147], v[128:143]
    ds_read_b64_tr_b16 v[204:205], v5 offset:6144
    v_add_f32 v213, 1.0, v213
    v_rcp_f32 v212, v212
    v_mfma_f32_32x32x16_bf16 v[144:159], v[192:195], a[148:151], v[144:159]
    ds_read_b64_tr_b16 v[206:207], v5 offset:6656
    buffer_load_dwordx4 v9, s[36:39], s53 offen offset:2048  lds
    s_waitcnt lgkmcnt(4)
    v_mfma_f32_32x32x16_bf16 v[160:175], v[196:199], a[144:147], v[160:175]
    ds_read_b64_tr_b16 v[192:193], v2 offset:16384
    v_rcp_f32 v213, v213
    v_mul_f32 v208, s60, v100
    v_mul_f32 v209, s60, v101
    v_mfma_f32_32x32x16_bf16 v[176:191], v[196:199], a[148:151], v[176:191]
    ds_read_b64_tr_b16 v[194:195], v2 offset:16896
    v_exp_f32 v208, v208
    s_waitcnt lgkmcnt(4)
    v_mfma_f32_32x32x16_bf16 v[128:143], v[200:203], a[152:155], v[128:143]
    ds_read_b64_tr_b16 v[196:197], v5 offset:16384
    v_exp_f32 v209, v209
    v_mul_f32 v210, v100, v108
    v_mul_f32 v211, v101, v109
    v_mfma_f32_32x32x16_bf16 v[144:159], v[200:203], a[156:159], v[144:159]
    ds_read_b64_tr_b16 v[198:199], v5 offset:16896
    buffer_load_dwordx4 v10, s[36:39], s53 offen offset:3072  lds
    v_mul_f32 v214, v214, v212
    s_waitcnt lgkmcnt(4)
    v_mfma_f32_32x32x16_bf16 v[160:175], v[204:207], a[152:155], v[160:175]
    ds_read_b64_tr_b16 v[200:201], v2 offset:18432
    v_mul_f32 v215, v215, v213
    v_cvt_pk_bf16_f32 v217, v214, v215
    v_add_f32 v208, 1.0, v208
    v_add_f32 v209, 1.0, v209
    v_mfma_f32_32x32x16_bf16 v[176:191], v[204:207], a[156:159], v[176:191]
    ds_read_b64_tr_b16 v[202:203], v2 offset:18944
    v_rcp_f32 v208, v208
    s_waitcnt vmcnt(28)
    s_barrier
    s_waitcnt lgkmcnt(4)
    v_mfma_f32_32x32x16_bf16 v[128:143], v[192:195], a[160:163], v[128:143]
    ds_read_b64_tr_b16 v[204:205], v5 offset:18432
    v_rcp_f32 v209, v209
    v_mul_f32 v212, s60, v102
    v_mul_f32 v213, s60, v103
    v_mfma_f32_32x32x16_bf16 v[144:159], v[192:195], a[164:167], v[144:159]
    ds_read_b64_tr_b16 v[206:207], v5 offset:18944
    s_add_u32 m0, s52, 65536
    s_add_u32 s53, s51, 2359808
    buffer_load_dwordx4 v7, s[36:39], s53 offen offset:0  lds
    s_waitcnt lgkmcnt(4)
    v_mfma_f32_32x32x16_bf16 v[160:175], v[196:199], a[160:163], v[160:175]
    ds_read_b64_tr_b16 v[192:193], v2 offset:20480
    v_exp_f32 v212, v212
    v_exp_f32 v213, v213
    v_mfma_f32_32x32x16_bf16 v[176:191], v[196:199], a[164:167], v[176:191]
    ds_read_b64_tr_b16 v[194:195], v2 offset:20992
    v_mul_f32 v214, v102, v110
    v_mul_f32 v215, v103, v111
    v_mul_f32 v210, v210, v208
    s_waitcnt lgkmcnt(4)
    v_mfma_f32_32x32x16_bf16 v[128:143], v[200:203], a[168:171], v[128:143]
    ds_read_b64_tr_b16 v[196:197], v5 offset:20480
    v_mul_f32 v211, v211, v209
    v_cvt_pk_bf16_f32 v218, v210, v211
    v_add_f32 v212, 1.0, v212
    v_add_f32 v213, 1.0, v213
    v_mfma_f32_32x32x16_bf16 v[144:159], v[200:203], a[172:175], v[144:159]
    ds_read_b64_tr_b16 v[198:199], v5 offset:20992
    buffer_load_dwordx4 v8, s[36:39], s53 offen offset:1024  lds
    s_waitcnt lgkmcnt(4)
    v_mfma_f32_32x32x16_bf16 v[160:175], v[204:207], a[168:171], v[160:175]
    ds_read_b64_tr_b16 v[200:201], v2 offset:22528
    buffer_store_dwordx4 v[232:235], v248, s[12:15], s49 offen offset:2048 sc1
    v_rcp_f32 v212, v212
    v_mfma_f32_32x32x16_bf16 v[176:191], v[204:207], a[172:175], v[176:191]
    ds_read_b64_tr_b16 v[202:203], v2 offset:23040
    v_rcp_f32 v213, v213
    s_nop 1
    s_waitcnt lgkmcnt(4)
    v_mfma_f32_32x32x16_bf16 v[128:143], v[192:195], a[176:179], v[128:143]
    ds_read_b64_tr_b16 v[204:205], v5 offset:22528
    v_mul_f32 v214, v214, v212
    v_mul_f32 v215, v215, v213
    v_cvt_pk_bf16_f32 v219, v214, v215
    v_mfma_f32_32x32x16_bf16 v[144:159], v[192:195], a[180:183], v[144:159]
    ds_read_b64_tr_b16 v[206:207], v5 offset:23040
    buffer_load_dwordx4 v9, s[36:39], s53 offen offset:2048  lds
    s_waitcnt lgkmcnt(4)
    v_mfma_f32_32x32x16_bf16 v[160:175], v[196:199], a[176:179], v[160:175]
    ds_read_b64_tr_b16 v[192:193], v2 offset:32768
    buffer_store_dwordx4 v[216:219], v23, s[44:47], s48 offen offset:512 sc1
    v_mul_f32 v208, s60, v112
    v_mul_f32 v209, s60, v113
    v_mfma_f32_32x32x16_bf16 v[176:191], v[196:199], a[180:183], v[176:191]
    ds_read_b64_tr_b16 v[194:195], v2 offset:33280
    v_exp_f32 v208, v208
    s_waitcnt lgkmcnt(4)
    v_mfma_f32_32x32x16_bf16 v[128:143], v[200:203], a[184:187], v[128:143]
    ds_read_b64_tr_b16 v[196:197], v5 offset:32768
    v_exp_f32 v209, v209
    v_mul_f32 v210, v112, v120
    v_mul_f32 v211, v113, v121
    v_mfma_f32_32x32x16_bf16 v[144:159], v[200:203], a[188:191], v[144:159]
    ds_read_b64_tr_b16 v[198:199], v5 offset:33280
    buffer_load_dwordx4 v10, s[36:39], s53 offen offset:3072  lds
    v_add_f32 v208, 1.0, v208
    s_waitcnt lgkmcnt(4)
    v_mfma_f32_32x32x16_bf16 v[160:175], v[204:207], a[184:187], v[160:175]
    ds_read_b64_tr_b16 v[200:201], v2 offset:34816
    v_add_f32 v209, 1.0, v209
    v_rcp_f32 v208, v208
    v_mfma_f32_32x32x16_bf16 v[176:191], v[204:207], a[188:191], v[176:191]
    ds_read_b64_tr_b16 v[202:203], v2 offset:35328
    v_rcp_f32 v209, v209
    v_mul_f32 v212, s60, v114
    s_waitcnt vmcnt(30)
    s_barrier
    s_waitcnt lgkmcnt(4)
    v_mfma_f32_32x32x16_bf16 v[128:143], v[192:195], a[192:195], v[128:143]
    ds_read_b64_tr_b16 v[204:205], v5 offset:34816
    v_mul_f32 v213, s60, v115
    v_exp_f32 v212, v212
    v_mfma_f32_32x32x16_bf16 v[144:159], v[192:195], a[196:199], v[144:159]
    ds_read_b64_tr_b16 v[206:207], v5 offset:35328
    s_add_u32 m0, s52, 81920
    s_add_u32 s53, s51, 2949632
    buffer_load_dwordx4 v7, s[36:39], s53 offen offset:0  lds
    s_waitcnt lgkmcnt(4)
    v_mfma_f32_32x32x16_bf16 v[160:175], v[196:199], a[192:195], v[160:175]
    ds_read_b64_tr_b16 v[192:193], v2 offset:36864
    v_exp_f32 v213, v213
    v_mul_f32 v214, v114, v122
    v_mul_f32 v215, v115, v123
    v_mfma_f32_32x32x16_bf16 v[176:191], v[196:199], a[196:199], v[176:191]
    ds_read_b64_tr_b16 v[194:195], v2 offset:37376
    v_mul_f32 v210, v210, v208
    v_mul_f32 v211, v211, v209
    v_cvt_pk_bf16_f32 v220, v210, v211
    s_waitcnt lgkmcnt(4)
    v_mfma_f32_32x32x16_bf16 v[128:143], v[200:203], a[200:203], v[128:143]
    ds_read_b64_tr_b16 v[196:197], v5 offset:36864
    v_add_f32 v212, 1.0, v212
    v_add_f32 v213, 1.0, v213
    v_rcp_f32 v212, v212
    v_mfma_f32_32x32x16_bf16 v[144:159], v[200:203], a[204:207], v[144:159]
    ds_read_b64_tr_b16 v[198:199], v5 offset:37376
    buffer_load_dwordx4 v8, s[36:39], s53 offen offset:1024  lds
    s_waitcnt lgkmcnt(4)
    v_mfma_f32_32x32x16_bf16 v[160:175], v[204:207], a[200:203], v[160:175]
    ds_read_b64_tr_b16 v[200:201], v2 offset:38912
    buffer_store_dwordx4 v[236:239], v248, s[12:15], s49 offen offset:3072 sc1
    v_rcp_f32 v213, v213
    v_mfma_f32_32x32x16_bf16 v[176:191], v[204:207], a[204:207], v[176:191]
    ds_read_b64_tr_b16 v[202:203], v2 offset:39424
    v_mul_f32 v208, s60, v116
    v_mul_f32 v209, s60, v117
    s_waitcnt lgkmcnt(4)
    v_mfma_f32_32x32x16_bf16 v[128:143], v[192:195], a[208:211], v[128:143]
    ds_read_b64_tr_b16 v[204:205], v5 offset:38912
    v_exp_f32 v208, v208
    v_exp_f32 v209, v209
    v_mfma_f32_32x32x16_bf16 v[144:159], v[192:195], a[212:215], v[144:159]
    ds_read_b64_tr_b16 v[206:207], v5 offset:39424
    buffer_load_dwordx4 v9, s[36:39], s53 offen offset:2048  lds
    v_mul_f32 v210, v116, v124
    s_waitcnt lgkmcnt(4)
    v_mfma_f32_32x32x16_bf16 v[160:175], v[196:199], a[208:211], v[160:175]
    ds_read_b64_tr_b16 v[192:193], v2 offset:49152
    v_mul_f32 v211, v117, v125
    v_mul_f32 v214, v214, v212
    v_mul_f32 v215, v215, v213
    v_cvt_pk_bf16_f32 v221, v214, v215
    v_mfma_f32_32x32x16_bf16 v[176:191], v[196:199], a[212:215], v[176:191]
    ds_read_b64_tr_b16 v[194:195], v2 offset:49664
    v_add_f32 v208, 1.0, v208
    v_add_f32 v209, 1.0, v209
    s_waitcnt lgkmcnt(4)
    v_mfma_f32_32x32x16_bf16 v[128:143], v[200:203], a[216:219], v[128:143]
    ds_read_b64_tr_b16 v[196:197], v5 offset:49152
    v_rcp_f32 v208, v208
    v_rcp_f32 v209, v209
    v_mfma_f32_32x32x16_bf16 v[144:159], v[200:203], a[220:223], v[144:159]
    ds_read_b64_tr_b16 v[198:199], v5 offset:49664
    buffer_load_dwordx4 v10, s[36:39], s53 offen offset:3072  lds
    v_mul_f32 v212, s60, v118
    s_waitcnt lgkmcnt(4)
    v_mfma_f32_32x32x16_bf16 v[160:175], v[204:207], a[216:219], v[160:175]
    ds_read_b64_tr_b16 v[200:201], v2 offset:51200
    v_mul_f32 v213, s60, v119
    v_exp_f32 v212, v212
    v_mfma_f32_32x32x16_bf16 v[176:191], v[204:207], a[220:223], v[176:191]
    ds_read_b64_tr_b16 v[202:203], v2 offset:51712
    v_exp_f32 v213, v213
    v_mul_f32 v214, v118, v126
    s_waitcnt vmcnt(31)
    s_barrier
    s_waitcnt lgkmcnt(4)
    v_mfma_f32_32x32x16_bf16 v[128:143], v[192:195], a[224:227], v[128:143]
    ds_read_b64_tr_b16 v[204:205], v5 offset:51200
    v_mul_f32 v215, v119, v127
    v_mul_f32 v210, v210, v208
    v_mul_f32 v211, v211, v209
    v_cvt_pk_bf16_f32 v222, v210, v211
    v_mfma_f32_32x32x16_bf16 v[144:159], v[192:195], a[228:231], v[144:159]
    ds_read_b64_tr_b16 v[206:207], v5 offset:51712
    s_add_u32 m0, s52, 98304
    s_add_u32 s53, s51, 3539456
    buffer_load_dwordx4 v7, s[36:39], s53 offen offset:0  lds
    s_waitcnt lgkmcnt(4)
    v_mfma_f32_32x32x16_bf16 v[160:175], v[196:199], a[224:227], v[160:175]
    ds_read_b64_tr_b16 v[192:193], v2 offset:53248
    v_add_f32 v212, 1.0, v212
    v_add_f32 v213, 1.0, v213
    v_rcp_f32 v212, v212
    v_mfma_f32_32x32x16_bf16 v[176:191], v[196:199], a[228:231], v[176:191]
    ds_read_b64_tr_b16 v[194:195], v2 offset:53760
    v_rcp_f32 v213, v213
    s_nop 1
    s_waitcnt lgkmcnt(4)
    v_mfma_f32_32x32x16_bf16 v[128:143], v[200:203], a[232:235], v[128:143]
    ds_read_b64_tr_b16 v[196:197], v5 offset:53248
    v_mul_f32 v214, v214, v212
    v_mul_f32 v215, v215, v213
    v_cvt_pk_bf16_f32 v223, v214, v215
    v_mfma_f32_32x32x16_bf16 v[144:159], v[200:203], a[236:239], v[144:159]
    ds_read_b64_tr_b16 v[198:199], v5 offset:53760
    buffer_load_dwordx4 v8, s[36:39], s53 offen offset:1024  lds
    s_waitcnt lgkmcnt(4)
    v_mfma_f32_32x32x16_bf16 v[160:175], v[204:207], a[232:235], v[160:175]
    ds_read_b64_tr_b16 v[200:201], v2 offset:55296
    buffer_store_dwordx4 v[220:223], v23, s[44:47], s48 offen offset:2560 sc1
    s_add_u32 s48, s48, 262144
    v_mfma_f32_32x32x16_bf16 v[176:191], v[204:207], a[236:239], v[176:191]
    ds_read_b64_tr_b16 v[202:203], v2 offset:55808
    s_waitcnt lgkmcnt(4)
    v_mfma_f32_32x32x16_bf16 v[128:143], v[192:195], a[240:243], v[128:143]
    ds_read_b64_tr_b16 v[204:205], v5 offset:55296
    v_mfma_f32_32x32x16_bf16 v[144:159], v[192:195], a[244:247], v[144:159]
    ds_read_b64_tr_b16 v[206:207], v5 offset:55808
    buffer_load_dwordx4 v9, s[36:39], s53 offen offset:2048  lds
    s_waitcnt lgkmcnt(4)
    v_mfma_f32_32x32x16_bf16 v[160:175], v[196:199], a[240:243], v[160:175]
    ds_read_b64_tr_b16 v[192:193], v3 offset:0
    v_mfma_f32_32x32x16_bf16 v[176:191], v[196:199], a[244:247], v[176:191]
    ds_read_b64_tr_b16 v[194:195], v3 offset:512
    s_waitcnt lgkmcnt(4)
    v_mfma_f32_32x32x16_bf16 v[128:143], v[200:203], a[248:251], v[128:143]
    ds_read_b64_tr_b16 v[196:197], v6 offset:0
    v_mfma_f32_32x32x16_bf16 v[144:159], v[200:203], a[252:255], v[144:159]
    ds_read_b64_tr_b16 v[198:199], v6 offset:512
    buffer_load_dwordx4 v10, s[36:39], s53 offen offset:3072  lds
    s_waitcnt lgkmcnt(4)
    v_mfma_f32_32x32x16_bf16 v[160:175], v[204:207], a[248:251], v[160:175]
    ds_read_b64_tr_b16 v[200:201], v3 offset:2048
    v_mfma_f32_32x32x16_bf16 v[176:191], v[204:207], a[252:255], v[176:191]
    ds_read_b64_tr_b16 v[202:203], v3 offset:2560
    s_waitcnt vmcnt(32)
    s_barrier
    s_waitcnt lgkmcnt(4)
    v_mfma_f32_32x32x16_bf16 v[128:143], v[192:195], v[32:35], v[128:143]
    ds_read_b64_tr_b16 v[204:205], v6 offset:2048
    v_mfma_f32_32x32x16_bf16 v[144:159], v[192:195], v[36:39], v[144:159]
    ds_read_b64_tr_b16 v[206:207], v6 offset:2560
    s_add_u32 m0, s52, 114688
    s_add_u32 s53, s51, 4129280
    buffer_load_dwordx4 v7, s[36:39], s53 offen offset:0  lds
    s_waitcnt lgkmcnt(4)
    v_mfma_f32_32x32x16_bf16 v[160:175], v[196:199], v[32:35], v[160:175]
    ds_read_b64_tr_b16 v[192:193], v3 offset:4096
    v_mfma_f32_32x32x16_bf16 v[176:191], v[196:199], v[36:39], v[176:191]
    ds_read_b64_tr_b16 v[194:195], v3 offset:4608
    s_waitcnt lgkmcnt(4)
    v_mfma_f32_32x32x16_bf16 v[128:143], v[200:203], v[40:43], v[128:143]
    ds_read_b64_tr_b16 v[196:197], v6 offset:4096
    v_mfma_f32_32x32x16_bf16 v[144:159], v[200:203], v[44:47], v[144:159]
    ds_read_b64_tr_b16 v[198:199], v6 offset:4608
    buffer_load_dwordx4 v8, s[36:39], s53 offen offset:1024  lds
    s_waitcnt lgkmcnt(4)
    v_mfma_f32_32x32x16_bf16 v[160:175], v[204:207], v[40:43], v[160:175]
    ds_read_b64_tr_b16 v[200:201], v3 offset:6144
    v_mfma_f32_32x32x16_bf16 v[176:191], v[204:207], v[44:47], v[176:191]
    ds_read_b64_tr_b16 v[202:203], v3 offset:6656
    s_waitcnt lgkmcnt(4)
    v_mfma_f32_32x32x16_bf16 v[128:143], v[192:195], v[48:51], v[128:143]
    ds_read_b64_tr_b16 v[204:205], v6 offset:6144
    v_mfma_f32_32x32x16_bf16 v[144:159], v[192:195], v[52:55], v[144:159]
    ds_read_b64_tr_b16 v[206:207], v6 offset:6656
    buffer_load_dwordx4 v9, s[36:39], s53 offen offset:2048  lds
    s_waitcnt lgkmcnt(4)
    v_mfma_f32_32x32x16_bf16 v[160:175], v[196:199], v[48:51], v[160:175]
    ds_read_b64_tr_b16 v[192:193], v1 offset:0
    v_mfma_f32_32x32x16_bf16 v[176:191], v[196:199], v[52:55], v[176:191]
    ds_read_b64_tr_b16 v[194:195], v1 offset:512
    s_waitcnt lgkmcnt(4)
    v_mfma_f32_32x32x16_bf16 v[128:143], v[200:203], v[56:59], v[128:143]
    ds_read_b64_tr_b16 v[196:197], v4 offset:0
    v_mfma_f32_32x32x16_bf16 v[144:159], v[200:203], v[60:63], v[144:159]
    ds_read_b64_tr_b16 v[198:199], v4 offset:512
    buffer_load_dwordx4 v10, s[36:39], s53 offen offset:3072  lds
    s_waitcnt lgkmcnt(4)
    v_mfma_f32_32x32x16_bf16 v[160:175], v[204:207], v[56:59], v[160:175]
    ds_read_b64_tr_b16 v[200:201], v1 offset:2048
    v_mfma_f32_32x32x16_bf16 v[176:191], v[204:207], v[60:63], v[176:191]
    ds_read_b64_tr_b16 v[202:203], v1 offset:2560
    s_waitcnt vmcnt(31)
    s_barrier
    s_cmp_lg_u32 s26, 0
    s_cbranch_scc1 k1_pZx

k1_pZ:
    v_cmp_gt_u32 vcc, 16, v25
    s_nop 1
    s_cmp_eq_u64 vcc, 0
    s_cbranch_scc1 k1_pZx
    s_sleep 8
    s_add_u32 s101, s101, 1
    s_cmp_ge_u32 s101, 4194304
    s_cbranch_scc1 k1_pZx
    global_load_dword v25, v24, s[96:97] sc1
    s_waitcnt vmcnt(0)
    s_branch k1_pZ

k1_pZx:
    s_waitcnt lgkmcnt(4)
    v_mfma_f32_32x32x16_bf16 v[64:79], v[192:195], a[0:3], 0
    ds_read_b64_tr_b16 v[204:205], v4 offset:2048
    v_mfma_f32_32x32x16_bf16 v[80:95], v[192:195], a[4:7], 0
    ds_read_b64_tr_b16 v[206:207], v4 offset:2560
    s_add_u32 m0, s52, 131072
    s_add_u32 s53, s51, 4719104
    buffer_load_dwordx4 v7, s[36:39], s53 offen offset:0  lds
    s_waitcnt lgkmcnt(4)
    v_mfma_f32_32x32x16_bf16 v[96:111], v[196:199], a[0:3], 0
    ds_read_b64_tr_b16 v[192:193], v1 offset:4096
    v_mfma_f32_32x32x16_bf16 v[112:127], v[196:199], a[4:7], 0
    ds_read_b64_tr_b16 v[194:195], v1 offset:4608
    s_waitcnt lgkmcnt(4)
    v_mfma_f32_32x32x16_bf16 v[64:79], v[200:203], a[8:11], v[64:79]
    ds_read_b64_tr_b16 v[196:197], v4 offset:4096
    v_mul_f32 v208, s60, v128
    v_mul_f32 v209, s60, v129
    v_exp_f32 v208, v208
    v_mfma_f32_32x32x16_bf16 v[80:95], v[200:203], a[12:15], v[80:95]
    ds_read_b64_tr_b16 v[198:199], v4 offset:4608
    buffer_load_dwordx4 v8, s[36:39], s53 offen offset:1024  lds
    v_exp_f32 v209, v209
    s_waitcnt lgkmcnt(4)
    v_mfma_f32_32x32x16_bf16 v[96:111], v[204:207], a[8:11], v[96:111]
    ds_read_b64_tr_b16 v[200:201], v1 offset:6144
    v_mul_f32 v210, v128, v136
    v_mul_f32 v211, v129, v137
    v_add_f32 v208, 1.0, v208
    v_add_f32 v209, 1.0, v209
    v_mfma_f32_32x32x16_bf16 v[112:127], v[204:207], a[12:15], v[112:127]
    ds_read_b64_tr_b16 v[202:203], v1 offset:6656
    v_rcp_f32 v208, v208
    v_rcp_f32 v209, v209
    s_waitcnt lgkmcnt(4)
    v_mfma_f32_32x32x16_bf16 v[64:79], v[192:195], a[16:19], v[64:79]
    ds_read_b64_tr_b16 v[204:205], v4 offset:6144
    v_mul_f32 v212, s60, v130
    v_mul_f32 v213, s60, v131
    v_exp_f32 v212, v212
    v_mfma_f32_32x32x16_bf16 v[80:95], v[192:195], a[20:23], v[80:95]
    ds_read_b64_tr_b16 v[206:207], v4 offset:6656
    buffer_load_dwordx4 v9, s[36:39], s53 offen offset:2048  lds
    v_exp_f32 v213, v213
    s_waitcnt lgkmcnt(4)
    v_mfma_f32_32x32x16_bf16 v[96:111], v[196:199], a[16:19], v[96:111]
    ds_read_b64_tr_b16 v[192:193], v1 offset:16384
    v_mul_f32 v214, v130, v138
    v_mul_f32 v215, v131, v139
    v_mul_f32 v210, v210, v208
    v_mul_f32 v211, v211, v209
    v_cvt_pk_bf16_f32 v216, v210, v211
    v_mfma_f32_32x32x16_bf16 v[112:127], v[196:199], a[20:23], v[112:127]
    ds_read_b64_tr_b16 v[194:195], v1 offset:16896
    v_add_f32 v212, 1.0, v212
    v_add_f32 v213, 1.0, v213
    v_rcp_f32 v212, v212
    s_waitcnt lgkmcnt(4)
    v_mfma_f32_32x32x16_bf16 v[64:79], v[200:203], a[24:27], v[64:79]
    ds_read_b64_tr_b16 v[196:197], v4 offset:16384
    v_rcp_f32 v213, v213
    v_mul_f32 v208, s60, v132
    v_mul_f32 v209, s60, v133
    v_mfma_f32_32x32x16_bf16 v[80:95], v[200:203], a[28:31], v[80:95]
    ds_read_b64_tr_b16 v[198:199], v4 offset:16896
    buffer_load_dwordx4 v10, s[36:39], s53 offen offset:3072  lds
    v_exp_f32 v208, v208
    s_waitcnt lgkmcnt(4)
    v_mfma_f32_32x32x16_bf16 v[96:111], v[204:207], a[24:27], v[96:111]
    ds_read_b64_tr_b16 v[200:201], v1 offset:18432
    v_exp_f32 v209, v209
    v_mul_f32 v210, v132, v140
    v_mul_f32 v211, v133, v141
    v_mul_f32 v214, v214, v212
    v_mfma_f32_32x32x16_bf16 v[112:127], v[204:207], a[28:31], v[112:127]
    ds_read_b64_tr_b16 v[202:203], v1 offset:18944
    v_mul_f32 v215, v215, v213
    v_cvt_pk_bf16_f32 v217, v214, v215
    v_add_f32 v208, 1.0, v208
    v_add_f32 v209, 1.0, v209
    s_waitcnt vmcnt(30)
    s_barrier
    s_cmp_lg_u32 s26, 0
    s_cbranch_scc1 k1_sigA1
    s_lshl_b32 s31, s24, 2
    s_add_u32 s31, s31, s21
    s_lshl_b32 s31, s31, 7
    s_add_u32 s31, s31, 28672
    v_mov_b32 v24, s31
    v_mov_b32 v25, 1
    s_mov_b64 exec, 1
    global_atomic_add v24, v25, s[98:99]
    s_mov_b64 exec, -1

k1_sigA1:
    s_waitcnt lgkmcnt(4)
    v_mfma_f32_32x32x16_bf16 v[64:79], v[192:195], a[32:35], v[64:79]
    ds_read_b64_tr_b16 v[204:205], v4 offset:18432
    v_rcp_f32 v208, v208
    v_rcp_f32 v209, v209
    v_mul_f32 v212, s60, v134
    v_mfma_f32_32x32x16_bf16 v[80:95], v[192:195], a[36:39], v[80:95]
    ds_read_b64_tr_b16 v[206:207], v4 offset:18944
    s_add_u32 m0, s52, 0
    s_add_u32 s53, s51, 640
    buffer_load_dwordx4 v7, s[36:39], s53 offen offset:0  lds
    s_waitcnt lgkmcnt(4)
    v_mfma_f32_32x32x16_bf16 v[96:111], v[196:199], a[32:35], v[96:111]
    ds_read_b64_tr_b16 v[192:193], v1 offset:20480
    v_mul_f32 v213, s60, v135
    v_exp_f32 v212, v212
    v_exp_f32 v213, v213
    v_mfma_f32_32x32x16_bf16 v[112:127], v[196:199], a[36:39], v[112:127]
    ds_read_b64_tr_b16 v[194:195], v1 offset:20992
    v_mul_f32 v214, v134, v142
    v_mul_f32 v215, v135, v143
    v_mul_f32 v210, v210, v208
    v_mul_f32 v211, v211, v209
    s_waitcnt lgkmcnt(4)
    v_mfma_f32_32x32x16_bf16 v[64:79], v[200:203], a[40:43], v[64:79]
    ds_read_b64_tr_b16 v[196:197], v4 offset:20480
    v_cvt_pk_bf16_f32 v218, v210, v211
    v_add_f32 v212, 1.0, v212
    v_add_f32 v213, 1.0, v213
    v_rcp_f32 v212, v212
    v_mfma_f32_32x32x16_bf16 v[80:95], v[200:203], a[44:47], v[80:95]
    ds_read_b64_tr_b16 v[198:199], v4 offset:20992
    buffer_load_dwordx4 v8, s[36:39], s53 offen offset:1024  lds
    v_rcp_f32 v213, v213
    s_waitcnt lgkmcnt(4)
    v_mfma_f32_32x32x16_bf16 v[96:111], v[204:207], a[40:43], v[96:111]
    ds_read_b64_tr_b16 v[200:201], v1 offset:22528
    s_nop 1
    v_mul_f32 v214, v214, v212
    v_mul_f32 v215, v215, v213
    v_cvt_pk_bf16_f32 v219, v214, v215
    v_mfma_f32_32x32x16_bf16 v[112:127], v[204:207], a[44:47], v[112:127]
    ds_read_b64_tr_b16 v[202:203], v1 offset:23040
    buffer_store_dwordx4 v[216:219], v23, s[44:47], s48 offen offset:0 sc1
    v_mul_f32 v208, s60, v144
    v_mul_f32 v209, s60, v145
    s_waitcnt lgkmcnt(4)
    v_mfma_f32_32x32x16_bf16 v[64:79], v[192:195], a[48:51], v[64:79]
    ds_read_b64_tr_b16 v[204:205], v4 offset:22528
    v_exp_f32 v208, v208
    v_exp_f32 v209, v209
    v_mul_f32 v210, v144, v152
    v_mfma_f32_32x32x16_bf16 v[80:95], v[192:195], a[52:55], v[80:95]
    ds_read_b64_tr_b16 v[206:207], v4 offset:23040
    buffer_load_dwordx4 v9, s[36:39], s53 offen offset:2048  lds
    v_mul_f32 v211, v145, v153
    v_add_f32 v208, 1.0, v208
    s_waitcnt lgkmcnt(4)
    v_mfma_f32_32x32x16_bf16 v[96:111], v[196:199], a[48:51], v[96:111]
    ds_read_b64_tr_b16 v[192:193], v1 offset:32768
    v_add_f32 v209, 1.0, v209
    v_rcp_f32 v208, v208
    v_rcp_f32 v209, v209
    v_mfma_f32_32x32x16_bf16 v[112:127], v[196:199], a[52:55], v[112:127]
    ds_read_b64_tr_b16 v[194:195], v1 offset:33280
    v_mul_f32 v212, s60, v146
    v_mul_f32 v213, s60, v147
    v_exp_f32 v212, v212
    s_waitcnt lgkmcnt(4)
    v_mfma_f32_32x32x16_bf16 v[64:79], v[200:203], a[56:59], v[64:79]
    ds_read_b64_tr_b16 v[196:197], v4 offset:32768
    v_exp_f32 v213, v213
    v_mul_f32 v214, v146, v154
    v_mul_f32 v215, v147, v155
    v_mul_f32 v210, v210, v208
    v_mfma_f32_32x32x16_bf16 v[80:95], v[200:203], a[60:63], v[80:95]
    ds_read_b64_tr_b16 v[198:199], v4 offset:33280
    buffer_load_dwordx4 v10, s[36:39], s53 offen offset:3072  lds
    v_mul_f32 v211, v211, v209
    v_cvt_pk_bf16_f32 v220, v210, v211
    s_waitcnt lgkmcnt(4)
    v_mfma_f32_32x32x16_bf16 v[96:111], v[204:207], a[56:59], v[96:111]
    ds_read_b64_tr_b16 v[200:201], v1 offset:34816
    v_add_f32 v212, 1.0, v212
    v_add_f32 v213, 1.0, v213
    v_rcp_f32 v212, v212
    v_mfma_f32_32x32x16_bf16 v[112:127], v[204:207], a[60:63], v[112:127]
    ds_read_b64_tr_b16 v[202:203], v1 offset:35328
    v_rcp_f32 v213, v213
    v_mul_f32 v208, s60, v148
    v_mul_f32 v209, s60, v149
    s_waitcnt vmcnt(20)
    s_barrier
    s_cmp_lg_u32 s26, 0
    s_cbranch_scc1 k1_sigF
    s_and_b32 s31, s2, 15
    s_lshl_b32 s31, s31, 7
    s_add_u32 s31, s31, 26624
    v_mov_b32 v24, s31
    v_mov_b32 v25, 1
    s_mov_b64 exec, 1
    global_atomic_add v24, v25, s[98:99]
    s_mov_b64 exec, -1

k1_sigF:
    s_waitcnt lgkmcnt(4)
    v_mfma_f32_32x32x16_bf16 v[64:79], v[192:195], a[64:67], v[64:79]
    ds_read_b64_tr_b16 v[204:205], v4 offset:34816
    v_exp_f32 v208, v208
    v_exp_f32 v209, v209
    v_mul_f32 v210, v148, v156
    v_mfma_f32_32x32x16_bf16 v[80:95], v[192:195], a[68:71], v[80:95]
    ds_read_b64_tr_b16 v[206:207], v4 offset:35328
    s_add_u32 m0, s52, 16384
    s_add_u32 s53, s51, 590464
    buffer_load_dwordx4 v7, s[36:39], s53 offen offset:0  lds
    s_waitcnt lgkmcnt(4)
    v_mfma_f32_32x32x16_bf16 v[96:111], v[196:199], a[64:67], v[96:111]
    ds_read_b64_tr_b16 v[192:193], v1 offset:36864
    v_mul_f32 v211, v149, v157
    v_mul_f32 v214, v214, v212
    v_mul_f32 v215, v215, v213
    v_cvt_pk_bf16_f32 v221, v214, v215
    v_add_f32 v208, 1.0, v208
    v_mfma_f32_32x32x16_bf16 v[112:127], v[196:199], a[68:71], v[112:127]
    ds_read_b64_tr_b16 v[194:195], v1 offset:37376
    v_add_f32 v209, 1.0, v209
    v_rcp_f32 v208, v208
    s_waitcnt lgkmcnt(4)
    v_mfma_f32_32x32x16_bf16 v[64:79], v[200:203], a[72:75], v[64:79]
    ds_read_b64_tr_b16 v[196:197], v4 offset:36864
    v_rcp_f32 v209, v209
    v_mul_f32 v212, s60, v150
    v_mul_f32 v213, s60, v151
    v_mfma_f32_32x32x16_bf16 v[80:95], v[200:203], a[76:79], v[80:95]
    ds_read_b64_tr_b16 v[198:199], v4 offset:37376
    buffer_load_dwordx4 v8, s[36:39], s53 offen offset:1024  lds
    v_exp_f32 v212, v212
    s_waitcnt lgkmcnt(4)
    v_mfma_f32_32x32x16_bf16 v[96:111], v[204:207], a[72:75], v[96:111]
    ds_read_b64_tr_b16 v[200:201], v1 offset:38912
    v_exp_f32 v213, v213
    v_mul_f32 v214, v150, v158
    v_mul_f32 v215, v151, v159
    v_mul_f32 v210, v210, v208
    v_mfma_f32_32x32x16_bf16 v[112:127], v[204:207], a[76:79], v[112:127]
    ds_read_b64_tr_b16 v[202:203], v1 offset:39424
    v_mul_f32 v211, v211, v209
    v_cvt_pk_bf16_f32 v222, v210, v211
    v_add_f32 v212, 1.0, v212
    v_add_f32 v213, 1.0, v213
    s_waitcnt lgkmcnt(4)
    v_mfma_f32_32x32x16_bf16 v[64:79], v[192:195], a[80:83], v[64:79]
    ds_read_b64_tr_b16 v[204:205], v4 offset:38912
    v_rcp_f32 v212, v212
    v_rcp_f32 v213, v213
    s_nop 1
    v_mfma_f32_32x32x16_bf16 v[80:95], v[192:195], a[84:87], v[80:95]
    ds_read_b64_tr_b16 v[206:207], v4 offset:39424
    buffer_load_dwordx4 v9, s[36:39], s53 offen offset:2048  lds
    v_mul_f32 v214, v214, v212
    v_mul_f32 v215, v215, v213
    s_waitcnt lgkmcnt(4)
    v_mfma_f32_32x32x16_bf16 v[96:111], v[196:199], a[80:83], v[96:111]
    ds_read_b64_tr_b16 v[192:193], v1 offset:49152
    v_cvt_pk_bf16_f32 v223, v214, v215
    buffer_store_dwordx4 v[220:223], v23, s[44:47], s48 offen offset:2048 sc1
    v_mul_f32 v208, s60, v160
    v_mul_f32 v209, s60, v161
    v_mfma_f32_32x32x16_bf16 v[112:127], v[196:199], a[84:87], v[112:127]
    ds_read_b64_tr_b16 v[194:195], v1 offset:49664
    v_exp_f32 v208, v208
    v_exp_f32 v209, v209
    s_waitcnt lgkmcnt(4)
    v_mfma_f32_32x32x16_bf16 v[64:79], v[200:203], a[88:91], v[64:79]
    ds_read_b64_tr_b16 v[196:197], v4 offset:49152
    v_mul_f32 v210, v160, v168
    v_mul_f32 v211, v161, v169
    v_add_f32 v208, 1.0, v208
    v_add_f32 v209, 1.0, v209
    v_mfma_f32_32x32x16_bf16 v[80:95], v[200:203], a[92:95], v[80:95]
    ds_read_b64_tr_b16 v[198:199], v4 offset:49664
    buffer_load_dwordx4 v10, s[36:39], s53 offen offset:3072  lds
    v_rcp_f32 v208, v208
    s_waitcnt lgkmcnt(4)
    v_mfma_f32_32x32x16_bf16 v[96:111], v[204:207], a[88:91], v[96:111]
    ds_read_b64_tr_b16 v[200:201], v1 offset:51200
    v_rcp_f32 v209, v209
    v_mul_f32 v212, s60, v162
    v_mul_f32 v213, s60, v163
    v_mfma_f32_32x32x16_bf16 v[112:127], v[204:207], a[92:95], v[112:127]
    ds_read_b64_tr_b16 v[202:203], v1 offset:51712
    v_exp_f32 v212, v212
    v_exp_f32 v213, v213
    s_waitcnt vmcnt(28)
    s_barrier
    s_waitcnt lgkmcnt(4)
    v_mfma_f32_32x32x16_bf16 v[64:79], v[192:195], a[96:99], v[64:79]
    ds_read_b64_tr_b16 v[204:205], v4 offset:51200
    v_mul_f32 v214, v162, v170
    v_mul_f32 v215, v163, v171
    v_mul_f32 v210, v210, v208
    v_mul_f32 v211, v211, v209
    v_cvt_pk_bf16_f32 v216, v210, v211
    v_mfma_f32_32x32x16_bf16 v[80:95], v[192:195], a[100:103], v[80:95]
    ds_read_b64_tr_b16 v[206:207], v4 offset:51712
    s_add_u32 m0, s52, 32768
    s_add_u32 s53, s51, 1180288
    buffer_load_dwordx4 v7, s[36:39], s53 offen offset:0  lds
    s_waitcnt lgkmcnt(4)
    v_mfma_f32_32x32x16_bf16 v[96:111], v[196:199], a[96:99], v[96:111]
    ds_read_b64_tr_b16 v[192:193], v1 offset:53248
    v_add_f32 v212, 1.0, v212
    v_add_f32 v213, 1.0, v213
    v_rcp_f32 v212, v212
    v_mfma_f32_32x32x16_bf16 v[112:127], v[196:199], a[100:103], v[112:127]
    ds_read_b64_tr_b16 v[194:195], v1 offset:53760
    v_rcp_f32 v213, v213
    v_mul_f32 v208, s60, v164
    v_mul_f32 v209, s60, v165
    s_waitcnt lgkmcnt(4)
    v_mfma_f32_32x32x16_bf16 v[64:79], v[200:203], a[104:107], v[64:79]
    ds_read_b64_tr_b16 v[196:197], v4 offset:53248
    v_exp_f32 v208, v208
    v_exp_f32 v209, v209
    v_mul_f32 v210, v164, v172
    v_mfma_f32_32x32x16_bf16 v[80:95], v[200:203], a[108:111], v[80:95]
    ds_read_b64_tr_b16 v[198:199], v4 offset:53760
    buffer_load_dwordx4 v8, s[36:39], s53 offen offset:1024  lds
    v_mul_f32 v211, v165, v173
    v_mul_f32 v214, v214, v212
    s_waitcnt lgkmcnt(4)
    v_mfma_f32_32x32x16_bf16 v[96:111], v[204:207], a[104:107], v[96:111]
    ds_read_b64_tr_b16 v[200:201], v1 offset:55296
    v_mul_f32 v215, v215, v213
    v_cvt_pk_bf16_f32 v217, v214, v215
    v_add_f32 v208, 1.0, v208
    v_add_f32 v209, 1.0, v209
    v_mfma_f32_32x32x16_bf16 v[112:127], v[204:207], a[108:111], v[112:127]
    ds_read_b64_tr_b16 v[202:203], v1 offset:55808
    v_rcp_f32 v208, v208
    v_rcp_f32 v209, v209
    s_waitcnt lgkmcnt(4)
    v_mfma_f32_32x32x16_bf16 v[64:79], v[192:195], a[112:115], v[64:79]
    ds_read_b64_tr_b16 v[204:205], v4 offset:55296
    v_mul_f32 v212, s60, v166
    v_mul_f32 v213, s60, v167
    v_exp_f32 v212, v212
    v_mfma_f32_32x32x16_bf16 v[80:95], v[192:195], a[116:119], v[80:95]
    ds_read_b64_tr_b16 v[206:207], v4 offset:55808
    buffer_load_dwordx4 v9, s[36:39], s53 offen offset:2048  lds
    v_exp_f32 v213, v213
    s_waitcnt lgkmcnt(4)
    v_mfma_f32_32x32x16_bf16 v[96:111], v[196:199], a[112:115], v[96:111]
    ds_read_b64_tr_b16 v[192:193], v2 offset:0
    v_mul_f32 v214, v166, v174
    v_mul_f32 v215, v167, v175
    v_mul_f32 v210, v210, v208
    v_mul_f32 v211, v211, v209
    v_cvt_pk_bf16_f32 v218, v210, v211
    v_mfma_f32_32x32x16_bf16 v[112:127], v[196:199], a[116:119], v[112:127]
    ds_read_b64_tr_b16 v[194:195], v2 offset:512
    v_add_f32 v212, 1.0, v212
    v_add_f32 v213, 1.0, v213
    v_rcp_f32 v212, v212
    s_waitcnt lgkmcnt(4)
    v_mfma_f32_32x32x16_bf16 v[64:79], v[200:203], a[120:123], v[64:79]
    ds_read_b64_tr_b16 v[196:197], v5 offset:0
    v_rcp_f32 v213, v213
    s_nop 1
    v_mul_f32 v214, v214, v212
    v_mul_f32 v215, v215, v213
    v_mfma_f32_32x32x16_bf16 v[80:95], v[200:203], a[124:127], v[80:95]
    ds_read_b64_tr_b16 v[198:199], v5 offset:512
    buffer_load_dwordx4 v10, s[36:39], s53 offen offset:3072  lds
    v_cvt_pk_bf16_f32 v219, v214, v215
    s_waitcnt lgkmcnt(4)
    v_mfma_f32_32x32x16_bf16 v[96:111], v[204:207], a[120:123], v[96:111]
    ds_read_b64_tr_b16 v[200:201], v2 offset:2048
    buffer_store_dwordx4 v[216:219], v23, s[44:47], s48 offen offset:512 sc1
    v_mul_f32 v208, s60, v176
    v_mul_f32 v209, s60, v177
    v_mfma_f32_32x32x16_bf16 v[112:127], v[204:207], a[124:127], v[112:127]
    ds_read_b64_tr_b16 v[202:203], v2 offset:2560
    v_exp_f32 v208, v208
    v_exp_f32 v209, v209
    s_waitcnt vmcnt(28)
    s_barrier
    s_waitcnt lgkmcnt(4)
    v_mfma_f32_32x32x16_bf16 v[64:79], v[192:195], a[128:131], v[64:79]
    ds_read_b64_tr_b16 v[204:205], v5 offset:2048
    v_mul_f32 v210, v176, v184
    v_mul_f32 v211, v177, v185
    v_add_f32 v208, 1.0, v208
    v_add_f32 v209, 1.0, v209
    v_mfma_f32_32x32x16_bf16 v[80:95], v[192:195], a[132:135], v[80:95]
    ds_read_b64_tr_b16 v[206:207], v5 offset:2560
    s_add_u32 m0, s52, 49152
    s_add_u32 s53, s51, 1770112
    buffer_load_dwordx4 v7, s[36:39], s53 offen offset:0  lds
    s_waitcnt lgkmcnt(4)
    v_mfma_f32_32x32x16_bf16 v[96:111], v[196:199], a[128:131], v[96:111]
    ds_read_b64_tr_b16 v[192:193], v2 offset:4096
    v_rcp_f32 v208, v208
    v_rcp_f32 v209, v209
    v_mul_f32 v212, s60, v178
    v_mfma_f32_32x32x16_bf16 v[112:127], v[196:199], a[132:135], v[112:127]
    ds_read_b64_tr_b16 v[194:195], v2 offset:4608
    v_mul_f32 v213, s60, v179
    v_exp_f32 v212, v212
    s_waitcnt lgkmcnt(4)
    v_mfma_f32_32x32x16_bf16 v[64:79], v[200:203], a[136:139], v[64:79]
    ds_read_b64_tr_b16 v[196:197], v5 offset:4096
    v_exp_f32 v213, v213
    v_mul_f32 v214, v178, v186
    v_mul_f32 v215, v179, v187
    v_mul_f32 v210, v210, v208
    v_mfma_f32_32x32x16_bf16 v[80:95], v[200:203], a[140:143], v[80:95]
    ds_read_b64_tr_b16 v[198:199], v5 offset:4608
    buffer_load_dwordx4 v8, s[36:39], s53 offen offset:1024  lds
    v_mul_f32 v211, v211, v209
    v_cvt_pk_bf16_f32 v220, v210, v211
    s_waitcnt lgkmcnt(4)
    v_mfma_f32_32x32x16_bf16 v[96:111], v[204:207], a[136:139], v[96:111]
    ds_read_b64_tr_b16 v[200:201], v2 offset:6144
    v_add_f32 v212, 1.0, v212
    v_add_f32 v213, 1.0, v213
    v_rcp_f32 v212, v212
    v_mfma_f32_32x32x16_bf16 v[112:127], v[204:207], a[140:143], v[112:127]
    ds_read_b64_tr_b16 v[202:203], v2 offset:6656
    v_rcp_f32 v213, v213
    v_mul_f32 v208, s60, v180
    v_mul_f32 v209, s60, v181
    s_waitcnt lgkmcnt(4)
    v_mfma_f32_32x32x16_bf16 v[64:79], v[192:195], a[144:147], v[64:79]
    ds_read_b64_tr_b16 v[204:205], v5 offset:6144
    v_exp_f32 v208, v208
    v_exp_f32 v209, v209
    v_mul_f32 v210, v180, v188
    v_mfma_f32_32x32x16_bf16 v[80:95], v[192:195], a[148:151], v[80:95]
    ds_read_b64_tr_b16 v[206:207], v5 offset:6656
    buffer_load_dwordx4 v9, s[36:39], s53 offen offset:2048  lds
    v_mul_f32 v211, v181, v189
    v_mul_f32 v214, v214, v212
    s_waitcnt lgkmcnt(4)
    v_mfma_f32_32x32x16_bf16 v[96:111], v[196:199], a[144:147], v[96:111]
    ds_read_b64_tr_b16 v[192:193], v2 offset:16384
    v_mul_f32 v215, v215, v213
    v_cvt_pk_bf16_f32 v221, v214, v215
    v_add_f32 v208, 1.0, v208
    v_add_f32 v209, 1.0, v209
    v_mfma_f32_32x32x16_bf16 v[112:127], v[196:199], a[148:151], v[112:127]
    ds_read_b64_tr_b16 v[194:195], v2 offset:16896
    v_rcp_f32 v208, v208
    v_rcp_f32 v209, v209
    s_waitcnt lgkmcnt(4)
    v_mfma_f32_32x32x16_bf16 v[64:79], v[200:203], a[152:155], v[64:79]
    ds_read_b64_tr_b16 v[196:197], v5 offset:16384
    v_mul_f32 v212, s60, v182
    v_mul_f32 v213, s60, v183
    v_exp_f32 v212, v212
    v_mfma_f32_32x32x16_bf16 v[80:95], v[200:203], a[156:159], v[80:95]
    ds_read_b64_tr_b16 v[198:199], v5 offset:16896
    buffer_load_dwordx4 v10, s[36:39], s53 offen offset:3072  lds
    v_exp_f32 v213, v213
    s_waitcnt lgkmcnt(4)
    v_mfma_f32_32x32x16_bf16 v[96:111], v[204:207], a[152:155], v[96:111]
    ds_read_b64_tr_b16 v[200:201], v2 offset:18432
    v_mul_f32 v214, v182, v190
    v_mul_f32 v215, v183, v191
    v_mul_f32 v210, v210, v208
    v_mul_f32 v211, v211, v209
    v_cvt_pk_bf16_f32 v222, v210, v211
    v_mfma_f32_32x32x16_bf16 v[112:127], v[204:207], a[156:159], v[112:127]
    ds_read_b64_tr_b16 v[202:203], v2 offset:18944
    v_add_f32 v212, 1.0, v212
    v_add_f32 v213, 1.0, v213
    v_rcp_f32 v212, v212
    s_waitcnt vmcnt(27)
    s_barrier
    s_waitcnt lgkmcnt(4)
    v_mfma_f32_32x32x16_bf16 v[64:79], v[192:195], a[160:163], v[64:79]
    ds_read_b64_tr_b16 v[204:205], v5 offset:18432
    v_rcp_f32 v213, v213
    s_nop 1
    v_mul_f32 v214, v214, v212
    v_mul_f32 v215, v215, v213
    v_mfma_f32_32x32x16_bf16 v[80:95], v[192:195], a[164:167], v[80:95]
    ds_read_b64_tr_b16 v[206:207], v5 offset:18944
    s_add_u32 m0, s52, 65536
    s_add_u32 s53, s51, 2359936
    buffer_load_dwordx4 v7, s[36:39], s53 offen offset:0  lds
    s_waitcnt lgkmcnt(4)
    v_mfma_f32_32x32x16_bf16 v[96:111], v[196:199], a[160:163], v[96:111]
    ds_read_b64_tr_b16 v[192:193], v2 offset:20480
    v_cvt_pk_bf16_f32 v223, v214, v215
    buffer_store_dwordx4 v[220:223], v23, s[44:47], s48 offen offset:2560 sc1
    s_add_u32 s48, s48, 262144
    s_and_b32 s27, s2, 7
    v_mfma_f32_32x32x16_bf16 v[112:127], v[196:199], a[164:167], v[112:127]
    ds_read_b64_tr_b16 v[194:195], v2 offset:20992
    s_lshr_b32 s70, s27, 1
    s_and_b32 s27, s27, 1
    s_lshl_b32 s27, s27, 3
    s_bfe_u32 s71, s2, 0x30003
    s_waitcnt lgkmcnt(4)
    v_mfma_f32_32x32x16_bf16 v[64:79], v[200:203], a[168:171], v[64:79]
    ds_read_b64_tr_b16 v[196:197], v5 offset:20480
    s_add_u32 s71, s71, s27
    s_lshr_b32 s72, s2, 6
    s_lshl_b32 s81, s71, 2
    s_add_u32 s81, s81, s70
    v_lshlrev_b32 v11, 4, v0
    v_mfma_f32_32x32x16_bf16 v[80:95], v[200:203], a[172:175], v[80:95]
    ds_read_b64_tr_b16 v[198:199], v5 offset:20992
    buffer_load_dwordx4 v8, s[36:39], s53 offen offset:1024  lds
    v_add_u32 v12, 4096, v11
    v_add_u32 v13, 8192, v11
    s_waitcnt lgkmcnt(4)
    v_mfma_f32_32x32x16_bf16 v[96:111], v[204:207], a[168:171], v[96:111]
    ds_read_b64_tr_b16 v[200:201], v2 offset:22528
    s_lshl_b32 s27, s71, 13
    s_lshl_b32 s28, s26, 11
    s_add_u32 s27, s27, s28
    v_add_u32 v18, s27, v11
    s_mul_i32 s73, s26, 9216
    v_mfma_f32_32x32x16_bf16 v[112:127], v[204:207], a[172:175], v[112:127]
    ds_read_b64_tr_b16 v[202:203], v2 offset:23040
    s_mov_b32 s12, s10
    s_mov_b32 s13, s11
    s_mov_b32 s14, 21233664
    s_mov_b32 s15, 0x20000
    s_waitcnt lgkmcnt(4)
    v_mfma_f32_32x32x16_bf16 v[64:79], v[192:195], a[176:179], v[64:79]
    ds_read_b64_tr_b16 v[204:205], v5 offset:22528
    s_mul_i32 s27, s72, 9216
    s_sub_u32 s18, 5971968, s27
    s_add_u32 s27, s27, 67108864
    s_add_u32 s16, s10, s27
    s_addc_u32 s17, s11, 0
    v_mfma_f32_32x32x16_bf16 v[80:95], v[192:195], a[180:183], v[80:95]
    ds_read_b64_tr_b16 v[206:207], v5 offset:23040
    buffer_load_dwordx4 v9, s[36:39], s53 offen offset:2048  lds
    s_mov_b32 s19, 0x20000
    s_mul_i32 s75, s70, 4718592
    s_waitcnt lgkmcnt(4)
    v_mfma_f32_32x32x16_bf16 v[96:111], v[196:199], a[176:179], v[96:111]
    ds_read_b64_tr_b16 v[192:193], v2 offset:32768
    s_mul_i32 s76, s70, 1327104
    s_mul_i32 s77, s70, 5
    s_lshl_b32 s78, s70, 2
    s_add_u32 s78, s78, 2
    s_min_u32 s77, s77, s78
    v_mfma_f32_32x32x16_bf16 v[112:127], v[196:199], a[180:183], v[112:127]
    ds_read_b64_tr_b16 v[194:195], v2 offset:33280
    s_cmp_lt_u32 s70, 2
    s_cselect_b32 s78, 5, 4
    s_add_u32 s27, s26, 0
    s_mul_i32 s28, s27, 43
    s_waitcnt lgkmcnt(4)
    v_mfma_f32_32x32x16_bf16 v[64:79], v[200:203], a[184:187], v[64:79]
    ds_read_b64_tr_b16 v[196:197], v5 offset:32768
    s_lshr_b32 s28, s28, 8
    s_mul_i32 s29, s28, 6
    s_sub_u32 s27, s27, s29
    s_lshl_b32 s28, s28, 1
    s_and_b32 s29, s27, 1
    v_mfma_f32_32x32x16_bf16 v[80:95], v[200:203], a[188:191], v[80:95]
    ds_read_b64_tr_b16 v[198:199], v5 offset:33280
    buffer_load_dwordx4 v10, s[36:39], s53 offen offset:3072  lds
    s_add_u32 s28, s28, s29
    s_lshr_b32 s27, s27, 1
    s_waitcnt lgkmcnt(4)
    v_mfma_f32_32x32x16_bf16 v[96:111], v[204:207], a[184:187], v[96:111]
    ds_read_b64_tr_b16 v[200:201], v2 offset:34816
    s_mul_i32 s27, s27, 12
    s_add_u32 s27, s27, s28
    s_mul_i32 s27, s27, 36864
    s_add_u32 s82, s27, s76
    s_add_u32 s27, s26, 4
    v_mfma_f32_32x32x16_bf16 v[112:127], v[204:207], a[188:191], v[112:127]
    ds_read_b64_tr_b16 v[202:203], v2 offset:35328
    s_mul_i32 s28, s27, 43
    s_lshr_b32 s28, s28, 8
    s_mul_i32 s29, s28, 6
    s_sub_u32 s27, s27, s29
    s_waitcnt vmcnt(28)
    s_barrier
    s_waitcnt lgkmcnt(4)
    v_mfma_f32_32x32x16_bf16 v[64:79], v[192:195], a[192:195], v[64:79]
    ds_read_b64_tr_b16 v[204:205], v5 offset:34816
    s_lshl_b32 s28, s28, 1
    s_and_b32 s29, s27, 1
    s_add_u32 s28, s28, s29
    s_lshr_b32 s27, s27, 1
    s_mul_i32 s27, s27, 12
    v_mfma_f32_32x32x16_bf16 v[80:95], v[192:195], a[196:199], v[80:95]
    ds_read_b64_tr_b16 v[206:207], v5 offset:35328
    s_add_u32 m0, s52, 81920
    s_add_u32 s53, s51, 2949760
    buffer_load_dwordx4 v7, s[36:39], s53 offen offset:0  lds
    s_waitcnt lgkmcnt(4)
    v_mfma_f32_32x32x16_bf16 v[96:111], v[196:199], a[192:195], v[96:111]
    ds_read_b64_tr_b16 v[192:193], v2 offset:36864
    s_add_u32 s27, s27, s28
    s_mul_i32 s27, s27, 36864
    s_add_u32 s83, s27, s76
    s_add_u32 s27, s26, 8
    s_mul_i32 s28, s27, 43
    v_mfma_f32_32x32x16_bf16 v[112:127], v[196:199], a[196:199], v[112:127]
    ds_read_b64_tr_b16 v[194:195], v2 offset:37376
    s_lshr_b32 s28, s28, 8
    s_mul_i32 s29, s28, 6
    s_sub_u32 s27, s27, s29
    s_lshl_b32 s28, s28, 1
    s_waitcnt lgkmcnt(4)
    v_mfma_f32_32x32x16_bf16 v[64:79], v[200:203], a[200:203], v[64:79]
    ds_read_b64_tr_b16 v[196:197], v5 offset:36864
    s_and_b32 s29, s27, 1
    s_add_u32 s28, s28, s29
    s_lshr_b32 s27, s27, 1
    s_mul_i32 s27, s27, 12
    s_add_u32 s27, s27, s28
    v_mfma_f32_32x32x16_bf16 v[80:95], v[200:203], a[204:207], v[80:95]
    ds_read_b64_tr_b16 v[198:199], v5 offset:37376
    buffer_load_dwordx4 v8, s[36:39], s53 offen offset:1024  lds
    s_mul_i32 s27, s27, 36864
    s_add_u32 s84, s27, s76
    s_waitcnt lgkmcnt(4)
    v_mfma_f32_32x32x16_bf16 v[96:111], v[204:207], a[200:203], v[96:111]
    ds_read_b64_tr_b16 v[200:201], v2 offset:38912
    s_add_u32 s27, s26, 12
    s_mul_i32 s28, s27, 43
    s_lshr_b32 s28, s28, 8
    s_mul_i32 s29, s28, 6
    s_sub_u32 s27, s27, s29
    v_mfma_f32_32x32x16_bf16 v[112:127], v[204:207], a[204:207], v[112:127]
    ds_read_b64_tr_b16 v[202:203], v2 offset:39424
    s_lshl_b32 s28, s28, 1
    s_and_b32 s29, s27, 1
    s_add_u32 s28, s28, s29
    s_lshr_b32 s27, s27, 1
    s_waitcnt lgkmcnt(4)
    v_mfma_f32_32x32x16_bf16 v[64:79], v[192:195], a[208:211], v[64:79]
    ds_read_b64_tr_b16 v[204:205], v5 offset:38912
    s_mul_i32 s27, s27, 12
    s_add_u32 s27, s27, s28
    s_mul_i32 s27, s27, 36864
    s_add_u32 s85, s27, s76
    s_add_u32 s27, s26, 16
    v_mfma_f32_32x32x16_bf16 v[80:95], v[192:195], a[212:215], v[80:95]
    ds_read_b64_tr_b16 v[206:207], v5 offset:39424
    buffer_load_dwordx4 v9, s[36:39], s53 offen offset:2048  lds
    s_mul_i32 s28, s27, 43
    s_lshr_b32 s28, s28, 8
    s_waitcnt lgkmcnt(4)
    v_mfma_f32_32x32x16_bf16 v[96:111], v[196:199], a[208:211], v[96:111]
    ds_read_b64_tr_b16 v[192:193], v2 offset:49152
    s_mul_i32 s29, s28, 6
    s_sub_u32 s27, s27, s29
    s_lshl_b32 s28, s28, 1
    s_and_b32 s29, s27, 1
    s_add_u32 s28, s28, s29
    v_mfma_f32_32x32x16_bf16 v[112:127], v[196:199], a[212:215], v[112:127]
    ds_read_b64_tr_b16 v[194:195], v2 offset:49664
    s_lshr_b32 s27, s27, 1
    s_mul_i32 s27, s27, 12
    s_add_u32 s27, s27, s28
    s_mul_i32 s27, s27, 36864
    s_waitcnt lgkmcnt(4)
    v_mfma_f32_32x32x16_bf16 v[64:79], v[200:203], a[216:219], v[64:79]
    ds_read_b64_tr_b16 v[196:197], v5 offset:49152
    s_add_u32 s86, s27, s76
    s_add_u32 s27, s26, 20
    s_mul_i32 s28, s27, 43
    s_lshr_b32 s28, s28, 8
    s_mul_i32 s29, s28, 6
    v_mfma_f32_32x32x16_bf16 v[80:95], v[200:203], a[220:223], v[80:95]
    ds_read_b64_tr_b16 v[198:199], v5 offset:49664
    buffer_load_dwordx4 v10, s[36:39], s53 offen offset:3072  lds
    s_sub_u32 s27, s27, s29
    s_lshl_b32 s28, s28, 1
    s_waitcnt lgkmcnt(4)
    v_mfma_f32_32x32x16_bf16 v[96:111], v[204:207], a[216:219], v[96:111]
    ds_read_b64_tr_b16 v[200:201], v2 offset:51200
    s_and_b32 s29, s27, 1
    s_add_u32 s28, s28, s29
    s_lshr_b32 s27, s27, 1
    s_mul_i32 s27, s27, 12
    s_add_u32 s27, s27, s28
    v_mfma_f32_32x32x16_bf16 v[112:127], v[204:207], a[220:223], v[112:127]
    ds_read_b64_tr_b16 v[202:203], v2 offset:51712
    s_mul_i32 s27, s27, 36864
    s_add_u32 s87, s27, s76
    s_add_u32 s27, s26, 24
    s_mul_i32 s28, s27, 43
    s_waitcnt vmcnt(28)
    s_barrier
    s_waitcnt lgkmcnt(4)
    v_mfma_f32_32x32x16_bf16 v[64:79], v[192:195], a[224:227], v[64:79]
    ds_read_b64_tr_b16 v[204:205], v5 offset:51200
    s_lshr_b32 s28, s28, 8
    s_mul_i32 s29, s28, 6
    s_sub_u32 s27, s27, s29
    s_lshl_b32 s28, s28, 1
    s_and_b32 s29, s27, 1
    v_mfma_f32_32x32x16_bf16 v[80:95], v[192:195], a[228:231], v[80:95]
    ds_read_b64_tr_b16 v[206:207], v5 offset:51712
    s_add_u32 m0, s52, 98304
    s_add_u32 s53, s51, 3539584
    buffer_load_dwordx4 v7, s[36:39], s53 offen offset:0  lds
    s_waitcnt lgkmcnt(4)
    v_mfma_f32_32x32x16_bf16 v[96:111], v[196:199], a[224:227], v[96:111]
    ds_read_b64_tr_b16 v[192:193], v2 offset:53248
    s_add_u32 s28, s28, s29
    s_lshr_b32 s27, s27, 1
    s_mul_i32 s27, s27, 12
    s_add_u32 s27, s27, s28
    s_mul_i32 s27, s27, 36864
    v_mfma_f32_32x32x16_bf16 v[112:127], v[196:199], a[228:231], v[112:127]
    ds_read_b64_tr_b16 v[194:195], v2 offset:53760
    s_add_u32 s88, s27, s76
    s_add_u32 s27, s26, 28
    s_mul_i32 s28, s27, 43
    s_lshr_b32 s28, s28, 8
    s_waitcnt lgkmcnt(4)
    v_mfma_f32_32x32x16_bf16 v[64:79], v[200:203], a[232:235], v[64:79]
    ds_read_b64_tr_b16 v[196:197], v5 offset:53248
    s_mul_i32 s29, s28, 6
    s_sub_u32 s27, s27, s29
    s_lshl_b32 s28, s28, 1
    s_and_b32 s29, s27, 1
    s_add_u32 s28, s28, s29
    v_mfma_f32_32x32x16_bf16 v[80:95], v[200:203], a[236:239], v[80:95]
    ds_read_b64_tr_b16 v[198:199], v5 offset:53760
    buffer_load_dwordx4 v8, s[36:39], s53 offen offset:1024  lds
    s_lshr_b32 s27, s27, 1
    s_mul_i32 s27, s27, 12
    s_waitcnt lgkmcnt(4)
    v_mfma_f32_32x32x16_bf16 v[96:111], v[204:207], a[232:235], v[96:111]
    ds_read_b64_tr_b16 v[200:201], v2 offset:55296
    s_add_u32 s27, s27, s28
    s_mul_i32 s27, s27, 36864
    s_add_u32 s89, s27, s76
    s_add_u32 s27, s26, 32
    s_mul_i32 s28, s27, 43
    v_mfma_f32_32x32x16_bf16 v[112:127], v[204:207], a[236:239], v[112:127]
    ds_read_b64_tr_b16 v[202:203], v2 offset:55808
    s_lshr_b32 s28, s28, 8
    s_mul_i32 s29, s28, 6
    s_sub_u32 s27, s27, s29
    s_lshl_b32 s28, s28, 1
    s_waitcnt lgkmcnt(4)
    v_mfma_f32_32x32x16_bf16 v[64:79], v[192:195], a[240:243], v[64:79]
    ds_read_b64_tr_b16 v[204:205], v5 offset:55296
    s_and_b32 s29, s27, 1
    s_add_u32 s28, s28, s29
    s_lshr_b32 s27, s27, 1
    s_mul_i32 s27, s27, 12
    s_add_u32 s27, s27, s28
    v_mfma_f32_32x32x16_bf16 v[80:95], v[192:195], a[244:247], v[80:95]
    ds_read_b64_tr_b16 v[206:207], v5 offset:55808
    buffer_load_dwordx4 v9, s[36:39], s53 offen offset:2048  lds
    s_mul_i32 s27, s27, 36864
    s_add_u32 s90, s27, s76
    s_waitcnt lgkmcnt(4)
    v_mfma_f32_32x32x16_bf16 v[96:111], v[196:199], a[240:243], v[96:111]
    ds_read_b64_tr_b16 v[192:193], v3 offset:0
    v_mfma_f32_32x32x16_bf16 v[112:127], v[196:199], a[244:247], v[112:127]
    ds_read_b64_tr_b16 v[194:195], v3 offset:512
    s_waitcnt lgkmcnt(4)
    v_mfma_f32_32x32x16_bf16 v[64:79], v[200:203], a[248:251], v[64:79]
    ds_read_b64_tr_b16 v[196:197], v6 offset:0
    v_mfma_f32_32x32x16_bf16 v[80:95], v[200:203], a[252:255], v[80:95]
    ds_read_b64_tr_b16 v[198:199], v6 offset:512
    buffer_load_dwordx4 v10, s[36:39], s53 offen offset:3072  lds
    s_waitcnt lgkmcnt(4)
    v_mfma_f32_32x32x16_bf16 v[96:111], v[204:207], a[248:251], v[96:111]
    ds_read_b64_tr_b16 v[200:201], v3 offset:2048
    v_mfma_f32_32x32x16_bf16 v[112:127], v[204:207], a[252:255], v[112:127]
    ds_read_b64_tr_b16 v[202:203], v3 offset:2560
    s_waitcnt vmcnt(27)
    s_barrier
    s_lshl_b32 s31, s24, 2
    s_add_u32 s31, s31, s21
    s_lshl_b32 s31, s31, 7
    s_add_u32 s31, s31, 28672
    v_mov_b32 v30, s31
    s_cmp_lg_u32 s26, 0
    s_cbranch_scc1 k1_npA1
    global_load_dword v29, v30, s[98:99] sc1

k1_npA1:
    v_and_b32 v24, 15, v0
    v_lshlrev_b32 v24, 7, v24
    v_add_u32 v24, 26624, v24
    s_cmp_lg_u32 s26, 0
    s_cbranch_scc1 k1_npF
    global_load_dword v25, v24, s[98:99] sc1

k1_npF:
    s_waitcnt lgkmcnt(4)
    v_mfma_f32_32x32x16_bf16 v[64:79], v[192:195], v[32:35], v[64:79]
    ds_read_b64_tr_b16 v[204:205], v6 offset:2048
    v_mfma_f32_32x32x16_bf16 v[80:95], v[192:195], v[36:39], v[80:95]
    ds_read_b64_tr_b16 v[206:207], v6 offset:2560
    s_add_u32 m0, s52, 114688
    s_add_u32 s53, s51, 4129408
    buffer_load_dwordx4 v7, s[36:39], s53 offen offset:0  lds
    s_waitcnt lgkmcnt(4)
    v_mfma_f32_32x32x16_bf16 v[96:111], v[196:199], v[32:35], v[96:111]
    ds_read_b64_tr_b16 v[192:193], v3 offset:4096
    v_mfma_f32_32x32x16_bf16 v[112:127], v[196:199], v[36:39], v[112:127]
    ds_read_b64_tr_b16 v[194:195], v3 offset:4608
    s_waitcnt lgkmcnt(4)
    v_mfma_f32_32x32x16_bf16 v[64:79], v[200:203], v[40:43], v[64:79]
    ds_read_b64_tr_b16 v[196:197], v6 offset:4096
    v_mfma_f32_32x32x16_bf16 v[80:95], v[200:203], v[44:47], v[80:95]
    ds_read_b64_tr_b16 v[198:199], v6 offset:4608
    buffer_load_dwordx4 v8, s[36:39], s53 offen offset:1024  lds
    s_waitcnt lgkmcnt(4)
    v_mfma_f32_32x32x16_bf16 v[96:111], v[204:207], v[40:43], v[96:111]
    ds_read_b64_tr_b16 v[200:201], v3 offset:6144
    v_mfma_f32_32x32x16_bf16 v[112:127], v[204:207], v[44:47], v[112:127]
    ds_read_b64_tr_b16 v[202:203], v3 offset:6656
    s_waitcnt lgkmcnt(4)
    v_mfma_f32_32x32x16_bf16 v[64:79], v[192:195], v[48:51], v[64:79]
    ds_read_b64_tr_b16 v[204:205], v6 offset:6144
    v_mfma_f32_32x32x16_bf16 v[80:95], v[192:195], v[52:55], v[80:95]
    ds_read_b64_tr_b16 v[206:207], v6 offset:6656
    buffer_load_dwordx4 v9, s[36:39], s53 offen offset:2048  lds
    s_waitcnt lgkmcnt(4)
    v_mfma_f32_32x32x16_bf16 v[96:111], v[196:199], v[48:51], v[96:111]
    ds_read_b64_tr_b16 v[192:193], v1 offset:0
    v_mfma_f32_32x32x16_bf16 v[112:127], v[196:199], v[52:55], v[112:127]
    ds_read_b64_tr_b16 v[194:195], v1 offset:512
    s_waitcnt lgkmcnt(4)
    v_mfma_f32_32x32x16_bf16 v[64:79], v[200:203], v[56:59], v[64:79]
    ds_read_b64_tr_b16 v[196:197], v4 offset:0
    v_mfma_f32_32x32x16_bf16 v[80:95], v[200:203], v[60:63], v[80:95]
    ds_read_b64_tr_b16 v[198:199], v4 offset:512
    buffer_load_dwordx4 v10, s[36:39], s53 offen offset:3072  lds
    s_waitcnt lgkmcnt(4)
    v_mfma_f32_32x32x16_bf16 v[96:111], v[204:207], v[56:59], v[96:111]
    ds_read_b64_tr_b16 v[200:201], v1 offset:2048
    v_mfma_f32_32x32x16_bf16 v[112:127], v[204:207], v[60:63], v[112:127]
    ds_read_b64_tr_b16 v[202:203], v1 offset:2560
    s_waitcnt vmcnt(26)
    s_barrier
    s_waitcnt lgkmcnt(4)
    v_mfma_f32_32x32x16_bf16 v[128:143], v[192:195], a[0:3], 0
    ds_read_b64_tr_b16 v[204:205], v4 offset:2048
    v_mfma_f32_32x32x16_bf16 v[144:159], v[192:195], a[4:7], 0
    ds_read_b64_tr_b16 v[206:207], v4 offset:2560
    s_add_u32 m0, s52, 131072
    s_add_u32 s53, s51, 4719232
    buffer_load_dwordx4 v7, s[36:39], s53 offen offset:0  lds
    s_waitcnt lgkmcnt(4)
    v_mfma_f32_32x32x16_bf16 v[160:175], v[196:199], a[0:3], 0
    ds_read_b64_tr_b16 v[192:193], v1 offset:4096
    v_mfma_f32_32x32x16_bf16 v[176:191], v[196:199], a[4:7], 0
    ds_read_b64_tr_b16 v[194:195], v1 offset:4608
    s_waitcnt lgkmcnt(4)
    v_mfma_f32_32x32x16_bf16 v[128:143], v[200:203], a[8:11], v[128:143]
    ds_read_b64_tr_b16 v[196:197], v4 offset:4096
    v_mul_f32 v208, s60, v64
    v_mul_f32 v209, s60, v65
    v_exp_f32 v208, v208
    v_mfma_f32_32x32x16_bf16 v[144:159], v[200:203], a[12:15], v[144:159]
    ds_read_b64_tr_b16 v[198:199], v4 offset:4608
    buffer_load_dwordx4 v8, s[36:39], s53 offen offset:1024  lds
    v_exp_f32 v209, v209
    s_waitcnt lgkmcnt(4)
    v_mfma_f32_32x32x16_bf16 v[160:175], v[204:207], a[8:11], v[160:175]
    ds_read_b64_tr_b16 v[200:201], v1 offset:6144
    v_mul_f32 v210, v64, v72
    v_mul_f32 v211, v65, v73
    v_add_f32 v208, 1.0, v208
    v_add_f32 v209, 1.0, v209
    v_mfma_f32_32x32x16_bf16 v[176:191], v[204:207], a[12:15], v[176:191]
    ds_read_b64_tr_b16 v[202:203], v1 offset:6656
    v_rcp_f32 v208, v208
    v_rcp_f32 v209, v209
    s_waitcnt lgkmcnt(4)
    v_mfma_f32_32x32x16_bf16 v[128:143], v[192:195], a[16:19], v[128:143]
    ds_read_b64_tr_b16 v[204:205], v4 offset:6144
    v_mul_f32 v212, s60, v66
    v_mul_f32 v213, s60, v67
    v_exp_f32 v212, v212
    v_mfma_f32_32x32x16_bf16 v[144:159], v[192:195], a[20:23], v[144:159]
    ds_read_b64_tr_b16 v[206:207], v4 offset:6656
    buffer_load_dwordx4 v9, s[36:39], s53 offen offset:2048  lds
    v_exp_f32 v213, v213
    s_waitcnt lgkmcnt(4)
    v_mfma_f32_32x32x16_bf16 v[160:175], v[196:199], a[16:19], v[160:175]
    ds_read_b64_tr_b16 v[192:193], v1 offset:16384
    v_mul_f32 v214, v66, v74
    v_mul_f32 v215, v67, v75
    v_mul_f32 v210, v210, v208
    v_mul_f32 v211, v211, v209
    v_cvt_pk_bf16_f32 v216, v210, v211
    v_mfma_f32_32x32x16_bf16 v[176:191], v[196:199], a[20:23], v[176:191]
    ds_read_b64_tr_b16 v[194:195], v1 offset:16896
    v_add_f32 v212, 1.0, v212
    v_add_f32 v213, 1.0, v213
    v_rcp_f32 v212, v212
    s_waitcnt lgkmcnt(4)
    v_mfma_f32_32x32x16_bf16 v[128:143], v[200:203], a[24:27], v[128:143]
    ds_read_b64_tr_b16 v[196:197], v4 offset:16384
    v_rcp_f32 v213, v213
    v_mul_f32 v208, s60, v68
    v_mul_f32 v209, s60, v69
    v_mfma_f32_32x32x16_bf16 v[144:159], v[200:203], a[28:31], v[144:159]
    ds_read_b64_tr_b16 v[198:199], v4 offset:16896
    buffer_load_dwordx4 v10, s[36:39], s53 offen offset:3072  lds
    v_exp_f32 v208, v208
    s_waitcnt lgkmcnt(4)
    v_mfma_f32_32x32x16_bf16 v[160:175], v[204:207], a[24:27], v[160:175]
    ds_read_b64_tr_b16 v[200:201], v1 offset:18432
    v_exp_f32 v209, v209
    v_mul_f32 v210, v68, v76
    v_mul_f32 v211, v69, v77
    v_mul_f32 v214, v214, v212
    v_mfma_f32_32x32x16_bf16 v[176:191], v[204:207], a[28:31], v[176:191]
    ds_read_b64_tr_b16 v[202:203], v1 offset:18944
    v_mul_f32 v215, v215, v213
    v_cvt_pk_bf16_f32 v217, v214, v215
    v_add_f32 v208, 1.0, v208
    v_add_f32 v209, 1.0, v209
    s_waitcnt vmcnt(26)
    s_barrier
    s_waitcnt lgkmcnt(4)
    v_mfma_f32_32x32x16_bf16 v[128:143], v[192:195], a[32:35], v[128:143]
    ds_read_b64_tr_b16 v[204:205], v4 offset:18432
    v_rcp_f32 v208, v208
    v_rcp_f32 v209, v209
    v_mul_f32 v212, s60, v70
    v_mfma_f32_32x32x16_bf16 v[144:159], v[192:195], a[36:39], v[144:159]
    ds_read_b64_tr_b16 v[206:207], v4 offset:18944
    v_mul_f32 v213, s60, v71
    v_exp_f32 v212, v212
    s_waitcnt lgkmcnt(4)
    v_mfma_f32_32x32x16_bf16 v[160:175], v[196:199], a[32:35], v[160:175]
    ds_read_b64_tr_b16 v[192:193], v1 offset:20480
    v_exp_f32 v213, v213
    v_mul_f32 v214, v70, v78
    v_mul_f32 v215, v71, v79
    v_mul_f32 v210, v210, v208
    v_mfma_f32_32x32x16_bf16 v[176:191], v[196:199], a[36:39], v[176:191]
    ds_read_b64_tr_b16 v[194:195], v1 offset:20992
    v_mul_f32 v211, v211, v209
    v_cvt_pk_bf16_f32 v218, v210, v211
    v_add_f32 v212, 1.0, v212
    v_add_f32 v213, 1.0, v213
    s_waitcnt lgkmcnt(4)
    v_mfma_f32_32x32x16_bf16 v[128:143], v[200:203], a[40:43], v[128:143]
    ds_read_b64_tr_b16 v[196:197], v4 offset:20480
    v_rcp_f32 v212, v212
    v_rcp_f32 v213, v213
    s_nop 1
    v_mfma_f32_32x32x16_bf16 v[144:159], v[200:203], a[44:47], v[144:159]
    ds_read_b64_tr_b16 v[198:199], v4 offset:20992
    v_mul_f32 v214, v214, v212
    v_mul_f32 v215, v215, v213
    v_cvt_pk_bf16_f32 v219, v214, v215
    s_waitcnt lgkmcnt(4)
    v_mfma_f32_32x32x16_bf16 v[160:175], v[204:207], a[40:43], v[160:175]
    ds_read_b64_tr_b16 v[200:201], v1 offset:22528
    buffer_store_dwordx4 v[216:219], v23, s[44:47], s48 offen offset:0 sc1
    v_mul_f32 v208, s60, v80
    v_mul_f32 v209, s60, v81
    v_mfma_f32_32x32x16_bf16 v[176:191], v[204:207], a[44:47], v[176:191]
    ds_read_b64_tr_b16 v[202:203], v1 offset:23040
    v_exp_f32 v208, v208
    v_exp_f32 v209, v209
    s_waitcnt lgkmcnt(4)
    v_mfma_f32_32x32x16_bf16 v[128:143], v[192:195], a[48:51], v[128:143]
    ds_read_b64_tr_b16 v[204:205], v4 offset:22528
    v_mul_f32 v210, v80, v88
    v_mul_f32 v211, v81, v89
    v_add_f32 v208, 1.0, v208
    v_add_f32 v209, 1.0, v209
    v_mfma_f32_32x32x16_bf16 v[144:159], v[192:195], a[52:55], v[144:159]
    ds_read_b64_tr_b16 v[206:207], v4 offset:23040
    v_rcp_f32 v208, v208
    v_rcp_f32 v209, v209
    s_waitcnt lgkmcnt(4)
    v_mfma_f32_32x32x16_bf16 v[160:175], v[196:199], a[48:51], v[160:175]
    ds_read_b64_tr_b16 v[192:193], v1 offset:32768
    v_mul_f32 v212, s60, v82
    v_mul_f32 v213, s60, v83
    v_exp_f32 v212, v212
    v_mfma_f32_32x32x16_bf16 v[176:191], v[196:199], a[52:55], v[176:191]
    ds_read_b64_tr_b16 v[194:195], v1 offset:33280
    v_exp_f32 v213, v213
    v_mul_f32 v214, v82, v90
    v_mul_f32 v215, v83, v91
    s_waitcnt lgkmcnt(4)
    v_mfma_f32_32x32x16_bf16 v[128:143], v[200:203], a[56:59], v[128:143]
    ds_read_b64_tr_b16 v[196:197], v4 offset:32768
    v_mul_f32 v210, v210, v208
    v_mul_f32 v211, v211, v209
    v_cvt_pk_bf16_f32 v220, v210, v211
    v_add_f32 v212, 1.0, v212
    v_add_f32 v213, 1.0, v213
    v_mfma_f32_32x32x16_bf16 v[144:159], v[200:203], a[60:63], v[144:159]
    ds_read_b64_tr_b16 v[198:199], v4 offset:33280
    v_rcp_f32 v212, v212
    v_rcp_f32 v213, v213
    s_waitcnt lgkmcnt(4)
    v_mfma_f32_32x32x16_bf16 v[160:175], v[204:207], a[56:59], v[160:175]
    ds_read_b64_tr_b16 v[200:201], v1 offset:34816
    v_mul_f32 v208, s60, v84
    v_mul_f32 v209, s60, v85
    v_exp_f32 v208, v208
    v_mfma_f32_32x32x16_bf16 v[176:191], v[204:207], a[60:63], v[176:191]
    ds_read_b64_tr_b16 v[202:203], v1 offset:35328
    v_exp_f32 v209, v209
    v_mul_f32 v210, v84, v92
    v_mul_f32 v211, v85, v93
    s_waitcnt vmcnt(9)
    s_barrier
    s_cmp_lg_u32 s26, 0
    s_cbranch_scc1 k1_pFx

k1_pF:
    v_cmp_gt_u32 vcc, 12, v25
    v_readfirstlane_b32 s31, v29
    s_cmp_ge_u32 s31, 3
    s_cselect_b32 s31, 0, 1
    s_or_b32 s31, s31, vcc_lo
    s_or_b32 s31, s31, vcc_hi
    s_cmp_eq_u32 s31, 0
    s_cbranch_scc1 k1_pFx

    s_sleep 8
    s_add_u32 s101, s101, 1
    s_cmp_ge_u32 s101, 4194304
    s_cbranch_scc1 k1_pFx
    global_load_dword v25, v24, s[98:99] sc1
    global_load_dword v29, v30, s[98:99] sc1
    s_waitcnt vmcnt(0)
    s_branch k1_pF

k1_pFx:
    s_add_u32 s98, s10, 58720256
    s_addc_u32 s99, s11, 0
    s_cmp_lg_u32 s26, 0
    s_cbranch_scc1 k1_sigA
    s_lshl_b32 s31, s24, 2
    s_add_u32 s31, s31, s21
    s_lshl_b32 s31, s31, 7
    s_add_u32 s31, s31, 8192
    v_mov_b32 v7, s31
    v_mov_b32 v8, 1
    s_mov_b64 exec, 1
    global_atomic_add v7, v8, s[98:99]
    s_mov_b64 exec, -1

k1_sigA:
    s_waitcnt lgkmcnt(4)
    v_mfma_f32_32x32x16_bf16 v[128:143], v[192:195], a[64:67], v[128:143]
    ds_read_b64_tr_b16 v[204:205], v4 offset:34816
    v_mul_f32 v214, v214, v212
    v_mul_f32 v215, v215, v213
    v_cvt_pk_bf16_f32 v221, v214, v215
    v_add_f32 v208, 1.0, v208
    v_add_f32 v209, 1.0, v209
    v_mfma_f32_32x32x16_bf16 v[144:159], v[192:195], a[68:71], v[144:159]
    ds_read_b64_tr_b16 v[206:207], v4 offset:35328
    v_rcp_f32 v208, v208
    v_rcp_f32 v209, v209
    s_waitcnt lgkmcnt(4)
    v_mfma_f32_32x32x16_bf16 v[160:175], v[196:199], a[64:67], v[160:175]
    ds_read_b64_tr_b16 v[192:193], v1 offset:36864
    v_mul_f32 v212, s60, v86
    v_mul_f32 v213, s60, v87
    v_exp_f32 v212, v212
    v_mfma_f32_32x32x16_bf16 v[176:191], v[196:199], a[68:71], v[176:191]
    ds_read_b64_tr_b16 v[194:195], v1 offset:37376
    v_exp_f32 v213, v213
    v_mul_f32 v214, v86, v94
    v_mul_f32 v215, v87, v95
    s_waitcnt lgkmcnt(4)
    v_mfma_f32_32x32x16_bf16 v[128:143], v[200:203], a[72:75], v[128:143]
    ds_read_b64_tr_b16 v[196:197], v4 offset:36864
    v_mul_f32 v210, v210, v208
    v_mul_f32 v211, v211, v209
    v_cvt_pk_bf16_f32 v222, v210, v211
    v_add_f32 v212, 1.0, v212
    v_add_f32 v213, 1.0, v213
    v_mfma_f32_32x32x16_bf16 v[144:159], v[200:203], a[76:79], v[144:159]
    ds_read_b64_tr_b16 v[198:199], v4 offset:37376
    v_rcp_f32 v212, v212
    v_rcp_f32 v213, v213
    s_waitcnt lgkmcnt(4)
    v_mfma_f32_32x32x16_bf16 v[160:175], v[204:207], a[72:75], v[160:175]
    ds_read_b64_tr_b16 v[200:201], v1 offset:38912
    s_nop 1
    v_mul_f32 v214, v214, v212
    v_mul_f32 v215, v215, v213
    v_cvt_pk_bf16_f32 v223, v214, v215
    v_mfma_f32_32x32x16_bf16 v[176:191], v[204:207], a[76:79], v[176:191]
    ds_read_b64_tr_b16 v[202:203], v1 offset:39424
    buffer_store_dwordx4 v[220:223], v23, s[44:47], s48 offen offset:2048 sc1
    v_mul_f32 v208, s60, v96
    v_mul_f32 v209, s60, v97
    s_waitcnt lgkmcnt(4)
    v_mfma_f32_32x32x16_bf16 v[128:143], v[192:195], a[80:83], v[128:143]
    ds_read_b64_tr_b16 v[204:205], v4 offset:38912
    v_exp_f32 v208, v208
    v_exp_f32 v209, v209
    v_mul_f32 v210, v96, v104
    v_mfma_f32_32x32x16_bf16 v[144:159], v[192:195], a[84:87], v[144:159]
    ds_read_b64_tr_b16 v[206:207], v4 offset:39424
    v_mul_f32 v211, v97, v105
    v_add_f32 v208, 1.0, v208
    v_add_f32 v209, 1.0, v209
    s_waitcnt lgkmcnt(4)
    v_mfma_f32_32x32x16_bf16 v[160:175], v[196:199], a[80:83], v[160:175]
    ds_read_b64_tr_b16 v[192:193], v1 offset:49152
    v_rcp_f32 v208, v208
    v_rcp_f32 v209, v209
    v_mul_f32 v212, s60, v98
    v_mfma_f32_32x32x16_bf16 v[176:191], v[196:199], a[84:87], v[176:191]
    ds_read_b64_tr_b16 v[194:195], v1 offset:49664
    v_mul_f32 v213, s60, v99
    v_exp_f32 v212, v212
    s_waitcnt lgkmcnt(4)
    v_mfma_f32_32x32x16_bf16 v[128:143], v[200:203], a[88:91], v[128:143]
    ds_read_b64_tr_b16 v[196:197], v4 offset:49152
    v_exp_f32 v213, v213
    v_mul_f32 v214, v98, v106
    v_mul_f32 v215, v99, v107
    v_mul_f32 v210, v210, v208
    v_mfma_f32_32x32x16_bf16 v[144:159], v[200:203], a[92:95], v[144:159]
    ds_read_b64_tr_b16 v[198:199], v4 offset:49664
    v_mul_f32 v211, v211, v209
    v_cvt_pk_bf16_f32 v216, v210, v211
    v_add_f32 v212, 1.0, v212
    v_add_f32 v213, 1.0, v213
    s_waitcnt lgkmcnt(4)
    v_mfma_f32_32x32x16_bf16 v[160:175], v[204:207], a[88:91], v[160:175]
    ds_read_b64_tr_b16 v[200:201], v1 offset:51200
    v_rcp_f32 v212, v212
    v_rcp_f32 v213, v213
    v_mul_f32 v208, s60, v100
    v_mfma_f32_32x32x16_bf16 v[176:191], v[204:207], a[92:95], v[176:191]
    ds_read_b64_tr_b16 v[202:203], v1 offset:51712
    v_mul_f32 v209, s60, v101
    v_exp_f32 v208, v208
    s_waitcnt vmcnt(18)
    s_barrier
    s_waitcnt lgkmcnt(4)
    v_mfma_f32_32x32x16_bf16 v[128:143], v[192:195], a[96:99], v[128:143]
    ds_read_b64_tr_b16 v[204:205], v4 offset:51200
    s_add_u32 m0, s73, 0
    s_nop 0
    buffer_load_dwordx4 v11, s[16:19], s82 offen offset:0 sc1 lds
    v_mfma_f32_32x32x16_bf16 v[144:159], v[192:195], a[100:103], v[144:159]
    ds_read_b64_tr_b16 v[206:207], v4 offset:51712
    buffer_load_dwordx4 v11, s[16:19], s82 offen offset:1024 sc1 lds
    v_exp_f32 v209, v209
    s_waitcnt lgkmcnt(4)
    v_mfma_f32_32x32x16_bf16 v[160:175], v[196:199], a[96:99], v[160:175]
    ds_read_b64_tr_b16 v[192:193], v1 offset:53248
    v_mul_f32 v210, v100, v108
    v_mul_f32 v211, v101, v109
    v_mul_f32 v214, v214, v212
    v_mul_f32 v215, v215, v213
    v_cvt_pk_bf16_f32 v217, v214, v215
    v_mfma_f32_32x32x16_bf16 v[176:191], v[196:199], a[100:103], v[176:191]
    ds_read_b64_tr_b16 v[194:195], v1 offset:53760
    buffer_load_dwordx4 v11, s[16:19], s82 offen offset:2048 sc1 lds
    v_add_f32 v208, 1.0, v208
    v_add_f32 v209, 1.0, v209
    s_waitcnt lgkmcnt(4)
    v_mfma_f32_32x32x16_bf16 v[128:143], v[200:203], a[104:107], v[128:143]
    ds_read_b64_tr_b16 v[196:197], v4 offset:53248
    v_rcp_f32 v208, v208
    v_rcp_f32 v209, v209
    v_mul_f32 v212, s60, v102
    v_mfma_f32_32x32x16_bf16 v[144:159], v[200:203], a[108:111], v[144:159]
    ds_read_b64_tr_b16 v[198:199], v4 offset:53760
    buffer_load_dwordx4 v11, s[16:19], s82 offen offset:3072 sc1 lds
    v_mul_f32 v213, s60, v103
    s_waitcnt lgkmcnt(4)
    v_mfma_f32_32x32x16_bf16 v[160:175], v[204:207], a[104:107], v[160:175]
    ds_read_b64_tr_b16 v[200:201], v1 offset:55296
    v_exp_f32 v212, v212
    v_exp_f32 v213, v213
    v_mul_f32 v214, v102, v110
    v_mfma_f32_32x32x16_bf16 v[176:191], v[204:207], a[108:111], v[176:191]
    ds_read_b64_tr_b16 v[202:203], v1 offset:55808
    s_add_u32 m0, s73, 4096
    s_nop 0
    buffer_load_dwordx4 v12, s[16:19], s82 offen offset:0 sc1 lds
    s_waitcnt lgkmcnt(4)
    v_mfma_f32_32x32x16_bf16 v[128:143], v[192:195], a[112:115], v[128:143]
    ds_read_b64_tr_b16 v[204:205], v4 offset:55296
    buffer_load_dwordx4 v12, s[16:19], s82 offen offset:1024 sc1 lds
    v_mul_f32 v215, v103, v111
    v_mul_f32 v210, v210, v208
    v_mul_f32 v211, v211, v209
    v_mfma_f32_32x32x16_bf16 v[144:159], v[192:195], a[116:119], v[144:159]
    ds_read_b64_tr_b16 v[206:207], v4 offset:55808
    v_cvt_pk_bf16_f32 v218, v210, v211
    v_add_f32 v212, 1.0, v212
    v_add_f32 v213, 1.0, v213
    s_waitcnt lgkmcnt(4)
    v_mfma_f32_32x32x16_bf16 v[160:175], v[196:199], a[112:115], v[160:175]
    ds_read_b64_tr_b16 v[192:193], v2 offset:0
    buffer_load_dwordx4 v12, s[16:19], s82 offen offset:2048 sc1 lds
    v_rcp_f32 v212, v212
    v_mfma_f32_32x32x16_bf16 v[176:191], v[196:199], a[116:119], v[176:191]
    ds_read_b64_tr_b16 v[194:195], v2 offset:512
    v_rcp_f32 v213, v213
    s_nop 1
    v_mul_f32 v214, v214, v212
    s_waitcnt lgkmcnt(4)
    v_mfma_f32_32x32x16_bf16 v[128:143], v[200:203], a[120:123], v[128:143]
    ds_read_b64_tr_b16 v[196:197], v5 offset:0
    buffer_load_dwordx4 v12, s[16:19], s82 offen offset:3072 sc1 lds
    v_mul_f32 v215, v215, v213
    v_cvt_pk_bf16_f32 v219, v214, v215
    v_mfma_f32_32x32x16_bf16 v[144:159], v[200:203], a[124:127], v[144:159]
    ds_read_b64_tr_b16 v[198:199], v5 offset:512
    buffer_store_dwordx4 v[216:219], v23, s[44:47], s48 offen offset:512 sc1
    v_mul_f32 v208, s60, v112
    v_mul_f32 v209, s60, v113
    s_waitcnt lgkmcnt(4)
    v_mfma_f32_32x32x16_bf16 v[160:175], v[204:207], a[120:123], v[160:175]
    ds_read_b64_tr_b16 v[200:201], v2 offset:2048
    s_add_u32 m0, s73, 8192
    s_nop 0
    buffer_load_dwordx4 v13, s[16:19], s82 offen offset:0 sc1 lds
    v_mfma_f32_32x32x16_bf16 v[176:191], v[204:207], a[124:127], v[176:191]
    ds_read_b64_tr_b16 v[202:203], v2 offset:2560
    v_exp_f32 v208, v208
    v_exp_f32 v209, v209
    s_waitcnt vmcnt(20)
    s_barrier
    s_waitcnt lgkmcnt(4)
    v_mfma_f32_32x32x16_bf16 v[128:143], v[192:195], a[128:131], v[128:143]
    ds_read_b64_tr_b16 v[204:205], v5 offset:2048
    v_mul_f32 v210, v112, v120
    v_mul_f32 v211, v113, v121
    v_add_f32 v208, 1.0, v208
    v_add_f32 v209, 1.0, v209
    v_mfma_f32_32x32x16_bf16 v[144:159], v[192:195], a[132:135], v[144:159]
    ds_read_b64_tr_b16 v[206:207], v5 offset:2560
    s_add_u32 s80, s75, 0
    buffer_load_dwordx4 a[0:3], v18, s[12:15], s80 offen offset:0 sc1
    s_waitcnt lgkmcnt(4)
    v_mfma_f32_32x32x16_bf16 v[160:175], v[196:199], a[128:131], v[160:175]
    ds_read_b64_tr_b16 v[192:193], v2 offset:4096
    v_rcp_f32 v208, v208
    v_rcp_f32 v209, v209
    v_mul_f32 v212, s60, v114
    v_mfma_f32_32x32x16_bf16 v[176:191], v[196:199], a[132:135], v[176:191]
    ds_read_b64_tr_b16 v[194:195], v2 offset:4608
    buffer_load_dwordx4 a[4:7], v18, s[12:15], s80 offen offset:1024 sc1
    v_mul_f32 v213, s60, v115
    s_waitcnt lgkmcnt(4)
    v_mfma_f32_32x32x16_bf16 v[128:143], v[200:203], a[136:139], v[128:143]
    ds_read_b64_tr_b16 v[196:197], v5 offset:4096
    v_exp_f32 v212, v212
    v_exp_f32 v213, v213
    v_mul_f32 v214, v114, v122
    v_mfma_f32_32x32x16_bf16 v[144:159], v[200:203], a[140:143], v[144:159]
    ds_read_b64_tr_b16 v[198:199], v5 offset:4608
    s_add_u32 s80, s75, 131072
    buffer_load_dwordx4 a[8:11], v18, s[12:15], s80 offen offset:0 sc1
    v_mul_f32 v215, v115, v123
    s_waitcnt lgkmcnt(4)
    v_mfma_f32_32x32x16_bf16 v[160:175], v[204:207], a[136:139], v[160:175]
    ds_read_b64_tr_b16 v[200:201], v2 offset:6144
    v_mul_f32 v210, v210, v208
    v_mul_f32 v211, v211, v209
    v_cvt_pk_bf16_f32 v220, v210, v211
    v_add_f32 v212, 1.0, v212
    v_add_f32 v213, 1.0, v213
    v_mfma_f32_32x32x16_bf16 v[176:191], v[204:207], a[140:143], v[176:191]
    ds_read_b64_tr_b16 v[202:203], v2 offset:6656
    buffer_load_dwordx4 a[12:15], v18, s[12:15], s80 offen offset:1024 sc1
    v_rcp_f32 v212, v212
    s_waitcnt lgkmcnt(4)
    v_mfma_f32_32x32x16_bf16 v[128:143], v[192:195], a[144:147], v[128:143]
    ds_read_b64_tr_b16 v[204:205], v5 offset:6144
    v_rcp_f32 v213, v213
    v_mul_f32 v208, s60, v116
    v_mul_f32 v209, s60, v117
    v_mfma_f32_32x32x16_bf16 v[144:159], v[192:195], a[148:151], v[144:159]
    ds_read_b64_tr_b16 v[206:207], v5 offset:6656
    s_add_u32 s80, s75, 1572864
    buffer_load_dwordx4 a[16:19], v18, s[12:15], s80 offen offset:0 sc1
    s_waitcnt lgkmcnt(4)
    v_mfma_f32_32x32x16_bf16 v[160:175], v[196:199], a[144:147], v[160:175]
    ds_read_b64_tr_b16 v[192:193], v2 offset:16384
    v_exp_f32 v208, v208
    v_exp_f32 v209, v209
    v_mul_f32 v210, v116, v124
    v_mfma_f32_32x32x16_bf16 v[176:191], v[196:199], a[148:151], v[176:191]
    ds_read_b64_tr_b16 v[194:195], v2 offset:16896
    buffer_load_dwordx4 a[20:23], v18, s[12:15], s80 offen offset:1024 sc1
    v_mul_f32 v211, v117, v125
    v_mul_f32 v214, v214, v212
    s_waitcnt lgkmcnt(4)
    v_mfma_f32_32x32x16_bf16 v[128:143], v[200:203], a[152:155], v[128:143]
    ds_read_b64_tr_b16 v[196:197], v2 offset:18432
    v_mul_f32 v215, v215, v213
    v_cvt_pk_bf16_f32 v221, v214, v215
    v_add_f32 v208, 1.0, v208
    v_add_f32 v209, 1.0, v209
    v_mfma_f32_32x32x16_bf16 v[144:159], v[200:203], a[156:159], v[144:159]
    ds_read_b64_tr_b16 v[198:199], v2 offset:18944
    s_add_u32 s80, s75, 1703936
    buffer_load_dwordx4 a[24:27], v18, s[12:15], s80 offen offset:0 sc1
    s_waitcnt lgkmcnt(4)
    v_mfma_f32_32x32x16_bf16 v[160:175], v[204:207], a[152:155], v[160:175]
    ds_read_b64_tr_b16 v[200:201], v2 offset:20480
    v_rcp_f32 v208, v208
    v_rcp_f32 v209, v209
    v_mul_f32 v212, s60, v118
    v_mfma_f32_32x32x16_bf16 v[176:191], v[204:207], a[156:159], v[176:191]
    ds_read_b64_tr_b16 v[202:203], v2 offset:20992
    buffer_load_dwordx4 a[28:31], v18, s[12:15], s80 offen offset:1024 sc1
    v_mul_f32 v213, s60, v119
    s_waitcnt vmcnt(24)
    s_barrier
    s_waitcnt lgkmcnt(4)
    v_mfma_f32_32x32x16_bf16 v[128:143], v[192:195], a[160:163], v[128:143]
    ds_read_b64_tr_b16 v[204:205], v2 offset:22528
    s_add_u32 m0, s73, 36864
    s_nop 0
    buffer_load_dwordx4 v11, s[16:19], s83 offen offset:0 sc1 lds
    v_mfma_f32_32x32x16_bf16 v[144:159], v[192:195], a[164:167], v[144:159]
    ds_read_b64_tr_b16 v[206:207], v2 offset:23040
    buffer_load_dwordx4 v11, s[16:19], s83 offen offset:1024 sc1 lds
    v_exp_f32 v212, v212
    s_waitcnt lgkmcnt(4)
    v_mfma_f32_32x32x16_bf16 v[128:143], v[196:199], a[168:171], v[128:143]
    ds_read_b64_tr_b16 v[192:193], v2 offset:32768
    v_exp_f32 v213, v213
    v_mul_f32 v214, v118, v126
    v_mul_f32 v215, v119, v127
    v_mul_f32 v210, v210, v208
    v_mfma_f32_32x32x16_bf16 v[144:159], v[196:199], a[172:175], v[144:159]
    ds_read_b64_tr_b16 v[194:195], v2 offset:33280
    buffer_load_dwordx4 v11, s[16:19], s83 offen offset:2048 sc1 lds
    v_mul_f32 v211, v211, v209
    v_cvt_pk_bf16_f32 v222, v210, v211
    s_waitcnt lgkmcnt(4)
    v_mfma_f32_32x32x16_bf16 v[128:143], v[200:203], a[176:179], v[128:143]
    ds_read_b64_tr_b16 v[196:197], v2 offset:34816
    v_add_f32 v212, 1.0, v212
    v_add_f32 v213, 1.0, v213
    v_rcp_f32 v212, v212
    v_mfma_f32_32x32x16_bf16 v[144:159], v[200:203], a[180:183], v[144:159]
    ds_read_b64_tr_b16 v[198:199], v2 offset:35328
    buffer_load_dwordx4 v11, s[16:19], s83 offen offset:3072 sc1 lds
    v_rcp_f32 v213, v213
    s_waitcnt lgkmcnt(4)
    v_mfma_f32_32x32x16_bf16 v[128:143], v[204:207], a[184:187], v[128:143]
    ds_read_b64_tr_b16 v[200:201], v2 offset:36864
    s_nop 1
    v_mul_f32 v214, v214, v212
    v_mul_f32 v215, v215, v213
    v_cvt_pk_bf16_f32 v223, v214, v215
    v_mfma_f32_32x32x16_bf16 v[144:159], v[204:207], a[188:191], v[144:159]
    ds_read_b64_tr_b16 v[202:203], v2 offset:37376
    s_add_u32 m0, s73, 40960
    s_nop 0
    buffer_load_dwordx4 v12, s[16:19], s83 offen offset:0 sc1 lds
    s_waitcnt lgkmcnt(4)
    v_mfma_f32_32x32x16_bf16 v[128:143], v[192:195], a[192:195], v[128:143]
    ds_read_b64_tr_b16 v[204:205], v2 offset:38912
    buffer_load_dwordx4 v12, s[16:19], s83 offen offset:1024 sc1 lds
    buffer_store_dwordx4 v[220:223], v23, s[44:47], s48 offen offset:2560 sc1
    s_add_u32 s48, s48, 262144
    v_mfma_f32_32x32x16_bf16 v[144:159], v[192:195], a[196:199], v[144:159]
    ds_read_b64_tr_b16 v[206:207], v2 offset:39424
    s_waitcnt lgkmcnt(4)
    v_mfma_f32_32x32x16_bf16 v[128:143], v[196:199], a[200:203], v[128:143]
    ds_read_b64_tr_b16 v[192:193], v2 offset:49152
    buffer_load_dwordx4 v12, s[16:19], s83 offen offset:2048 sc1 lds
    v_mfma_f32_32x32x16_bf16 v[144:159], v[196:199], a[204:207], v[144:159]
    ds_read_b64_tr_b16 v[194:195], v2 offset:49664
    s_waitcnt lgkmcnt(4)
    v_mfma_f32_32x32x16_bf16 v[128:143], v[200:203], a[208:211], v[128:143]
    ds_read_b64_tr_b16 v[196:197], v2 offset:51200
    buffer_load_dwordx4 v12, s[16:19], s83 offen offset:3072 sc1 lds
    v_mfma_f32_32x32x16_bf16 v[144:159], v[200:203], a[212:215], v[144:159]
    ds_read_b64_tr_b16 v[198:199], v2 offset:51712
    s_waitcnt lgkmcnt(4)
    v_mfma_f32_32x32x16_bf16 v[128:143], v[204:207], a[216:219], v[128:143]
    ds_read_b64_tr_b16 v[200:201], v2 offset:53248
    s_add_u32 m0, s73, 45056
    s_nop 0
    buffer_load_dwordx4 v13, s[16:19], s83 offen offset:0 sc1 lds
    v_mfma_f32_32x32x16_bf16 v[144:159], v[204:207], a[220:223], v[144:159]
    ds_read_b64_tr_b16 v[202:203], v2 offset:53760
    s_waitcnt vmcnt(30)
    s_barrier
    s_cmp_lg_u32 s26, 0
    s_cbranch_scc1 k1_npA
    global_load_dword v8, v7, s[98:99] sc1

k1_npA:
    s_waitcnt lgkmcnt(4)
    v_mfma_f32_32x32x16_bf16 v[128:143], v[192:195], a[224:227], v[128:143]
    ds_read_b64_tr_b16 v[204:205], v2 offset:55296
    v_mfma_f32_32x32x16_bf16 v[144:159], v[192:195], a[228:231], v[144:159]
    ds_read_b64_tr_b16 v[206:207], v2 offset:55808
    s_add_u32 s80, s75, 3145728
    buffer_load_dwordx4 a[32:35], v18, s[12:15], s80 offen offset:0 sc1
    s_waitcnt lgkmcnt(4)
    v_mfma_f32_32x32x16_bf16 v[128:143], v[196:199], a[232:235], v[128:143]
    ds_read_b64_tr_b16 v[192:193], v3 offset:0
    v_mfma_f32_32x32x16_bf16 v[144:159], v[196:199], a[236:239], v[144:159]
    ds_read_b64_tr_b16 v[194:195], v3 offset:512
    buffer_load_dwordx4 a[36:39], v18, s[12:15], s80 offen offset:1024 sc1
    s_waitcnt lgkmcnt(4)
    v_mfma_f32_32x32x16_bf16 v[128:143], v[200:203], a[240:243], v[128:143]
    ds_read_b64_tr_b16 v[196:197], v3 offset:2048
    v_mfma_f32_32x32x16_bf16 v[144:159], v[200:203], a[244:247], v[144:159]
    ds_read_b64_tr_b16 v[198:199], v3 offset:2560
    s_add_u32 s80, s75, 3276800
    buffer_load_dwordx4 a[40:43], v18, s[12:15], s80 offen offset:0 sc1
    s_waitcnt lgkmcnt(4)
    v_mfma_f32_32x32x16_bf16 v[128:143], v[204:207], a[248:251], v[128:143]
    ds_read_b64_tr_b16 v[200:201], v3 offset:4096
    v_mfma_f32_32x32x16_bf16 v[144:159], v[204:207], a[252:255], v[144:159]
    ds_read_b64_tr_b16 v[202:203], v3 offset:4608
    buffer_load_dwordx4 a[44:47], v18, s[12:15], s80 offen offset:1024 sc1
    s_waitcnt lgkmcnt(4)
    v_mfma_f32_32x32x16_bf16 v[128:143], v[192:195], v[32:35], v[128:143]
    ds_read_b64_tr_b16 v[204:205], v3 offset:6144
    v_mfma_f32_32x32x16_bf16 v[144:159], v[192:195], v[36:39], v[144:159]
    ds_read_b64_tr_b16 v[206:207], v3 offset:6656
    s_add_u32 s80, s75, 262144
    buffer_load_dwordx4 a[48:51], v18, s[12:15], s80 offen offset:0 sc1
    s_waitcnt lgkmcnt(4)
    v_mfma_f32_32x32x16_bf16 v[128:143], v[196:199], v[40:43], v[128:143]
    ds_read_b64_tr_b16 v[192:193], v5 offset:16384
    v_mfma_f32_32x32x16_bf16 v[144:159], v[196:199], v[44:47], v[144:159]
    ds_read_b64_tr_b16 v[194:195], v5 offset:16896
    buffer_load_dwordx4 a[52:55], v18, s[12:15], s80 offen offset:1024 sc1
    s_waitcnt lgkmcnt(4)
    v_mfma_f32_32x32x16_bf16 v[128:143], v[200:203], v[48:51], v[128:143]
    ds_read_b64_tr_b16 v[196:197], v5 offset:18432
    v_mfma_f32_32x32x16_bf16 v[144:159], v[200:203], v[52:55], v[144:159]
    ds_read_b64_tr_b16 v[198:199], v5 offset:18944
    s_add_u32 s80, s75, 393216
    buffer_load_dwordx4 a[56:59], v18, s[12:15], s80 offen offset:0 sc1
    s_waitcnt lgkmcnt(4)
    v_mfma_f32_32x32x16_bf16 v[128:143], v[204:207], v[56:59], v[128:143]
    ds_read_b64_tr_b16 v[200:201], v5 offset:20480
    v_mfma_f32_32x32x16_bf16 v[144:159], v[204:207], v[60:63], v[144:159]
    ds_read_b64_tr_b16 v[202:203], v5 offset:20992
    buffer_load_dwordx4 a[60:63], v18, s[12:15], s80 offen offset:1024 sc1
    s_waitcnt vmcnt(38)
    s_barrier
    s_waitcnt lgkmcnt(4)
    v_mfma_f32_32x32x16_bf16 v[160:175], v[192:195], a[160:163], v[160:175]
    ds_read_b64_tr_b16 v[204:205], v5 offset:22528
    v_mfma_f32_32x32x16_bf16 v[176:191], v[192:195], a[164:167], v[176:191]
    ds_read_b64_tr_b16 v[206:207], v5 offset:23040
    s_waitcnt lgkmcnt(4)
    v_mfma_f32_32x32x16_bf16 v[160:175], v[196:199], a[168:171], v[160:175]
    ds_read_b64_tr_b16 v[192:193], v5 offset:32768
    v_mfma_f32_32x32x16_bf16 v[176:191], v[196:199], a[172:175], v[176:191]
    ds_read_b64_tr_b16 v[194:195], v5 offset:33280
    s_waitcnt lgkmcnt(4)
    v_mfma_f32_32x32x16_bf16 v[160:175], v[200:203], a[176:179], v[160:175]
    ds_read_b64_tr_b16 v[196:197], v5 offset:34816
    v_mfma_f32_32x32x16_bf16 v[176:191], v[200:203], a[180:183], v[176:191]
    ds_read_b64_tr_b16 v[198:199], v5 offset:35328
    v_mul_f32 v208, s60, v128
    v_mul_f32 v209, s60, v129
    v_exp_f32 v208, v208
    v_exp_f32 v209, v209
    s_waitcnt lgkmcnt(4)
    v_mfma_f32_32x32x16_bf16 v[160:175], v[204:207], a[184:187], v[160:175]
    ds_read_b64_tr_b16 v[200:201], v5 offset:36864
    v_mul_f32 v210, v128, v136
    v_mul_f32 v211, v129, v137
    v_add_f32 v208, 1.0, v208
    v_add_f32 v209, 1.0, v209
    v_rcp_f32 v208, v208
    v_mfma_f32_32x32x16_bf16 v[176:191], v[204:207], a[188:191], v[176:191]
    ds_read_b64_tr_b16 v[202:203], v5 offset:37376
    v_rcp_f32 v209, v209
    v_mul_f32 v212, s60, v130
    v_mul_f32 v213, s60, v131
    v_exp_f32 v212, v212
    s_waitcnt lgkmcnt(4)
    v_mfma_f32_32x32x16_bf16 v[160:175], v[192:195], a[192:195], v[160:175]
    ds_read_b64_tr_b16 v[204:205], v5 offset:38912
    v_exp_f32 v213, v213
    v_mul_f32 v214, v130, v138
    v_mul_f32 v215, v131, v139
    v_mul_f32 v210, v210, v208
    v_mul_f32 v211, v211, v209
    v_cvt_pk_bf16_f32 v216, v210, v211
    v_mfma_f32_32x32x16_bf16 v[176:191], v[192:195], a[196:199], v[176:191]
    ds_read_b64_tr_b16 v[206:207], v5 offset:39424
    v_add_f32 v212, 1.0, v212
    v_add_f32 v213, 1.0, v213
    v_rcp_f32 v212, v212
    v_rcp_f32 v213, v213
    s_waitcnt lgkmcnt(4)
    v_mfma_f32_32x32x16_bf16 v[160:175], v[196:199], a[200:203], v[160:175]
    ds_read_b64_tr_b16 v[192:193], v5 offset:49152
    v_mul_f32 v208, s60, v132
    v_mul_f32 v209, s60, v133
    v_exp_f32 v208, v208
    v_exp_f32 v209, v209
    v_mul_f32 v210, v132, v140
    v_mfma_f32_32x32x16_bf16 v[176:191], v[196:199], a[204:207], v[176:191]
    ds_read_b64_tr_b16 v[194:195], v5 offset:49664
    v_mul_f32 v211, v133, v141
    v_mul_f32 v214, v214, v212
    v_mul_f32 v215, v215, v213
    v_cvt_pk_bf16_f32 v217, v214, v215
    v_add_f32 v208, 1.0, v208
    v_add_f32 v209, 1.0, v209
    s_waitcnt lgkmcnt(4)
    v_mfma_f32_32x32x16_bf16 v[160:175], v[200:203], a[208:211], v[160:175]
    ds_read_b64_tr_b16 v[196:197], v5 offset:51200
    v_rcp_f32 v208, v208
    v_rcp_f32 v209, v209
    v_mul_f32 v212, s60, v134
    v_mul_f32 v213, s60, v135
    v_mfma_f32_32x32x16_bf16 v[176:191], v[200:203], a[212:215], v[176:191]
    ds_read_b64_tr_b16 v[198:199], v5 offset:51712
    v_exp_f32 v212, v212
    v_exp_f32 v213, v213
    v_mul_f32 v214, v134, v142
    v_mul_f32 v215, v135, v143
    s_waitcnt lgkmcnt(4)
    v_mfma_f32_32x32x16_bf16 v[160:175], v[204:207], a[216:219], v[160:175]
    ds_read_b64_tr_b16 v[200:201], v5 offset:53248
    v_mul_f32 v210, v210, v208
    v_mul_f32 v211, v211, v209
    v_cvt_pk_bf16_f32 v218, v210, v211
    v_add_f32 v212, 1.0, v212
    v_add_f32 v213, 1.0, v213
    v_rcp_f32 v212, v212
    v_mfma_f32_32x32x16_bf16 v[176:191], v[204:207], a[220:223], v[176:191]
    ds_read_b64_tr_b16 v[202:203], v5 offset:53760
    v_rcp_f32 v213, v213
    s_nop 1
    v_mul_f32 v214, v214, v212
    v_mul_f32 v215, v215, v213
    v_cvt_pk_bf16_f32 v219, v214, v215
    s_barrier
    s_waitcnt lgkmcnt(4)
    v_mfma_f32_32x32x16_bf16 v[160:175], v[192:195], a[224:227], v[160:175]
    ds_read_b64_tr_b16 v[204:205], v5 offset:55296
    s_add_u32 m0, s73, 73728
    s_nop 0
    buffer_load_dwordx4 v11, s[16:19], s84 offen offset:0 sc1 lds
    buffer_store_dwordx4 v[216:219], v23, s[44:47], s48 offen offset:0 sc1
    v_mul_f32 v208, s60, v144
    v_mfma_f32_32x32x16_bf16 v[176:191], v[192:195], a[228:231], v[176:191]
    ds_read_b64_tr_b16 v[206:207], v5 offset:55808
    buffer_load_dwordx4 v11, s[16:19], s84 offen offset:1024 sc1 lds
    v_mul_f32 v209, s60, v145
    v_exp_f32 v208, v208
    s_waitcnt lgkmcnt(4)
    v_mfma_f32_32x32x16_bf16 v[160:175], v[196:199], a[232:235], v[160:175]
    ds_read_b64_tr_b16 v[192:193], v6 offset:0
    v_exp_f32 v209, v209
    v_mul_f32 v210, v144, v152
    v_mul_f32 v211, v145, v153
    v_add_f32 v208, 1.0, v208
    v_add_f32 v209, 1.0, v209
    v_mfma_f32_32x32x16_bf16 v[176:191], v[196:199], a[236:239], v[176:191]
    ds_read_b64_tr_b16 v[194:195], v6 offset:512
    buffer_load_dwordx4 v11, s[16:19], s84 offen offset:2048 sc1 lds
    v_rcp_f32 v208, v208
    v_rcp_f32 v209, v209
    s_waitcnt lgkmcnt(4)
    v_mfma_f32_32x32x16_bf16 v[160:175], v[200:203], a[240:243], v[160:175]
    ds_read_b64_tr_b16 v[196:197], v6 offset:2048
    v_mul_f32 v212, s60, v146
    v_mul_f32 v213, s60, v147
    v_exp_f32 v212, v212
    v_exp_f32 v213, v213
    v_mul_f32 v214, v146, v154
    v_mfma_f32_32x32x16_bf16 v[176:191], v[200:203], a[244:247], v[176:191]
    ds_read_b64_tr_b16 v[198:199], v6 offset:2560
    buffer_load_dwordx4 v11, s[16:19], s84 offen offset:3072 sc1 lds
    v_mul_f32 v215, v147, v155
    v_mul_f32 v210, v210, v208
    v_mul_f32 v211, v211, v209
    v_cvt_pk_bf16_f32 v220, v210, v211
    s_waitcnt lgkmcnt(4)
    v_mfma_f32_32x32x16_bf16 v[160:175], v[204:207], a[248:251], v[160:175]
    ds_read_b64_tr_b16 v[200:201], v6 offset:4096
    v_add_f32 v212, 1.0, v212
    v_add_f32 v213, 1.0, v213
    v_rcp_f32 v212, v212
    v_rcp_f32 v213, v213
    v_mul_f32 v208, s60, v148
    v_mfma_f32_32x32x16_bf16 v[176:191], v[204:207], a[252:255], v[176:191]
    ds_read_b64_tr_b16 v[202:203], v6 offset:4608
    s_add_u32 m0, s73, 77824
    s_nop 0
    buffer_load_dwordx4 v12, s[16:19], s84 offen offset:0 sc1 lds
    v_mul_f32 v209, s60, v149
    s_waitcnt lgkmcnt(4)
    v_mfma_f32_32x32x16_bf16 v[160:175], v[192:195], v[32:35], v[160:175]
    ds_read_b64_tr_b16 v[204:205], v6 offset:6144
    buffer_load_dwordx4 v12, s[16:19], s84 offen offset:1024 sc1 lds
    v_exp_f32 v208, v208
    v_exp_f32 v209, v209
    v_mul_f32 v210, v148, v156
    v_mfma_f32_32x32x16_bf16 v[176:191], v[192:195], v[36:39], v[176:191]
    ds_read_b64_tr_b16 v[206:207], v6 offset:6656
    v_mul_f32 v211, v149, v157
    v_mul_f32 v214, v214, v212
    v_mul_f32 v215, v215, v213
    v_cvt_pk_bf16_f32 v221, v214, v215
    v_add_f32 v208, 1.0, v208
    v_add_f32 v209, 1.0, v209
    s_waitcnt lgkmcnt(4)
    v_mfma_f32_32x32x16_bf16 v[160:175], v[196:199], v[40:43], v[160:175]
    buffer_load_dwordx4 v12, s[16:19], s84 offen offset:2048 sc1 lds
    v_rcp_f32 v208, v208
    v_rcp_f32 v209, v209
    v_mul_f32 v212, s60, v150
    v_mul_f32 v213, s60, v151
    v_mfma_f32_32x32x16_bf16 v[176:191], v[196:199], v[44:47], v[176:191]
    v_exp_f32 v212, v212
    v_exp_f32 v213, v213
    v_mul_f32 v214, v150, v158
    v_mul_f32 v215, v151, v159
    v_mul_f32 v210, v210, v208
    s_waitcnt lgkmcnt(2)
    v_mfma_f32_32x32x16_bf16 v[160:175], v[200:203], v[48:51], v[160:175]
    buffer_load_dwordx4 v12, s[16:19], s84 offen offset:3072 sc1 lds
    v_mul_f32 v211, v211, v209
    v_cvt_pk_bf16_f32 v222, v210, v211
    v_add_f32 v212, 1.0, v212
    v_add_f32 v213, 1.0, v213
    v_rcp_f32 v212, v212
    v_mfma_f32_32x32x16_bf16 v[176:191], v[200:203], v[52:55], v[176:191]
    v_rcp_f32 v213, v213
    s_nop 1
    v_mul_f32 v214, v214, v212
    v_mul_f32 v215, v215, v213
    v_cvt_pk_bf16_f32 v223, v214, v215
    s_waitcnt lgkmcnt(0)
    v_mfma_f32_32x32x16_bf16 v[160:175], v[204:207], v[56:59], v[160:175]
    s_add_u32 m0, s73, 81920
    s_nop 0
    buffer_load_dwordx4 v13, s[16:19], s84 offen offset:0 sc1 lds
    buffer_store_dwordx4 v[220:223], v23, s[44:47], s48 offen offset:2048 sc1
    v_mfma_f32_32x32x16_bf16 v[176:191], v[204:207], v[60:63], v[176:191]
    s_cmp_lg_u32 s26, 0
    s_cbranch_scc1 k1_pax
    s_waitcnt vmcnt(19)

k1_pa:
    v_readfirstlane_b32 s27, v8
    s_cmp_ge_u32 s27, 3
    s_cbranch_scc1 k1_pax
    s_sleep 4
    s_add_u32 s101, s101, 1
    s_cmp_ge_u32 s101, 4194304
    s_cbranch_scc1 k1_pax
    global_load_dword v8, v7, s[98:99] sc1
    s_waitcnt vmcnt(0)
    s_branch k1_pa

k1_pax:
    s_barrier
    s_branch m_k2
    s_endpgm
k1_att:
    s_waitcnt lgkmcnt(0)
    s_load_dwordx2 s[4:5], s[0:1], 0
    s_load_dwordx2 s[6:7], s[0:1], 8
    s_load_dwordx2 s[8:9], s[0:1], 56
    s_load_dwordx2 s[12:13], s[0:1], 72

    v_lshrrev_b32 v22, 3, v0
    v_and_b32 v23, 7, v0
    v_lshrrev_b32 v24, 1, v22
    s_lshl_b32 s29, s26, 5
    v_add_u32 v25, s29, v22
    v_mul_u32_u24 v25, 1152, v25

    v_add_u32 v26, 0, v24
    v_and_b32 v26, 7, v26
    v_xor_b32 v26, v26, v23
    v_lshlrev_b32 v26, 4, v26
    v_add_u32 v10, v25, v26
    v_add_u32 v26, 4, v24
    v_and_b32 v26, 7, v26
    v_xor_b32 v26, v26, v23
    v_lshlrev_b32 v26, 4, v26
    v_add_u32 v11, v25, v26
    v_add_u32 v11, 8192, v11
    v_add_u32 v26, 8, v24
    v_and_b32 v26, 7, v26
    v_xor_b32 v26, v26, v23
    v_lshlrev_b32 v26, 4, v26
    v_add_u32 v12, v25, v26
    v_add_u32 v12, 16384, v12
    v_add_u32 v26, 12, v24
    v_and_b32 v26, 7, v26
    v_xor_b32 v26, v26, v23
    v_lshlrev_b32 v26, 4, v26
    v_add_u32 v13, v25, v26
    v_add_u32 v13, 24576, v13
    s_mov_b32 s28, 3277
    s_mul_i32 s27, s21, 288
    s_lshl_b32 s29, s26, 4
    v_add_u32 v22, 0, v0
    v_mul_u32_u24 v23, s28, v22
    v_lshrrev_b32 v23, 16, v23
    v_mul_u32_u24 v24, 20, v23
    v_sub_u32 v24, v22, v24
    v_min_u32 v24, 17, v24
    v_add_u32 v23, s29, v23
    v_mul_u32_u24 v23, 3456, v23
    v_lshlrev_b32 v24, 4, v24
    v_add3_u32 v5, v23, v24, s27
    v_add_u32 v22, 64, v0
    v_mul_u32_u24 v23, s28, v22
    v_lshrrev_b32 v23, 16, v23
    v_mul_u32_u24 v24, 20, v23
    v_sub_u32 v24, v22, v24
    v_min_u32 v24, 17, v24
    v_add_u32 v23, s29, v23
    v_mul_u32_u24 v23, 3456, v23
    v_lshlrev_b32 v24, 4, v24
    v_add3_u32 v6, v23, v24, s27
    v_subrev_u32 v6, 1024, v6
    v_add_u32 v22, 128, v0
    v_mul_u32_u24 v23, s28, v22
    v_lshrrev_b32 v23, 16, v23
    v_mul_u32_u24 v24, 20, v23
    v_sub_u32 v24, v22, v24
    v_min_u32 v24, 17, v24
    v_add_u32 v23, s29, v23
    v_mul_u32_u24 v23, 3456, v23
    v_lshlrev_b32 v24, 4, v24
    v_add3_u32 v7, v23, v24, s27
    v_subrev_u32 v7, 2048, v7
    v_add_u32 v22, 192, v0
    v_mul_u32_u24 v23, s28, v22
    v_lshrrev_b32 v23, 16, v23
    v_mul_u32_u24 v24, 20, v23
    v_sub_u32 v24, v22, v24
    v_min_u32 v24, 17, v24
    v_add_u32 v23, s29, v23
    v_mul_u32_u24 v23, 3456, v23
    v_lshlrev_b32 v24, 4, v24
    v_add3_u32 v8, v23, v24, s27
    v_subrev_u32 v8, 3072, v8
    v_add_u32 v22, 256, v0
    v_mul_u32_u24 v23, s28, v22
    v_lshrrev_b32 v23, 16, v23
    v_mul_u32_u24 v24, 20, v23
    v_sub_u32 v24, v22, v24
    v_min_u32 v24, 17, v24
    v_add_u32 v23, s29, v23
    v_mul_u32_u24 v23, 3456, v23
    v_lshlrev_b32 v24, 4, v24
    v_add3_u32 v9, v23, v24, s27
    v_lshlrev_b32 v19, 4, v0
    s_waitcnt lgkmcnt(0)
    s_mov_b32 s36, s6
    s_mov_b32 s37, s7
    s_mov_b32 s38, 1990656
    s_mov_b32 s39, 0x20000
    s_mov_b32 s40, s4
    s_mov_b32 s41, s5
    s_mov_b32 s42, 2359296
    s_mov_b32 s43, 0x20000
    s_mov_b32 s44, s10
    s_mov_b32 s45, s11
    s_mov_b32 s46, 21233664
    s_mov_b32 s47, 0x20000
    s_mov_b32 s16, s8
    s_mov_b32 s17, s9
    s_mov_b32 s18, 1152
    s_mov_b32 s19, 0x20000
    s_mov_b32 s32, s10
    s_mov_b32 s33, s11
    s_mov_b32 s34, 58728448
    s_mov_b32 s35, 0x20000
    s_mov_b32 s60, 0x3fb8aa3b
    s_mov_b32 s61, 0x3fb8aa3b
    s_mov_b32 s59, 0xbfb8aa3b
    s_mov_b32 s62, 0x358637bd
    s_mov_b32 s63, 0x358637bd
    s_mul_i32 s50, s24, 147456
    s_mul_i32 s52, s26, 5120
    s_lshl_b32 s54, s26, 12

    s_cmp_lg_u32 s26, 0
    s_cbranch_scc1 k1_at_nogw
    s_mov_b32 m0, 131072
    s_nop 0
    buffer_load_dwordx4 v19, s[16:19], 0 offen lds
    buffer_load_dwordx4 v19, s[16:19], 0 offen offset:1024 lds

k1_at_nogw:
    s_add_u32 m0, s54, 81920
    s_add_u32 s55, s50, 0
    buffer_load_dwordx4 v10, s[40:43], s55 offen offset:0 lds
    buffer_load_dwordx4 v11, s[40:43], s55 offen offset:1024 lds
    buffer_load_dwordx4 v12, s[40:43], s55 offen offset:2048 lds
    buffer_load_dwordx4 v13, s[40:43], s55 offen offset:3072 lds
    s_add_u32 m0, s52, 0
    s_mov_b32 s53, 1152
    buffer_load_dwordx4 v5, s[36:39], s53 offen offset:0 lds
    buffer_load_dwordx4 v6, s[36:39], s53 offen offset:1024 lds
    buffer_load_dwordx4 v7, s[36:39], s53 offen offset:2048 lds
    buffer_load_dwordx4 v8, s[36:39], s53 offen offset:3072 lds
    s_add_u32 m0, s52, 4096
    s_nop 0
    buffer_load_dwordx4 v9, s[36:39], s53 offen offset:0 lds
    s_add_u32 m0, s54, 98304
    s_add_u32 s55, s50, 128
    buffer_load_dwordx4 v10, s[40:43], s55 offen offset:0 lds
    buffer_load_dwordx4 v11, s[40:43], s55 offen offset:1024 lds
    buffer_load_dwordx4 v12, s[40:43], s55 offen offset:2048 lds
    buffer_load_dwordx4 v13, s[40:43], s55 offen offset:3072 lds
    s_add_u32 m0, s52, 20480
    s_mov_b32 s53, 222336
    buffer_load_dwordx4 v5, s[36:39], s53 offen offset:0 lds
    buffer_load_dwordx4 v6, s[36:39], s53 offen offset:1024 lds
    buffer_load_dwordx4 v7, s[36:39], s53 offen offset:2048 lds
    buffer_load_dwordx4 v8, s[36:39], s53 offen offset:3072 lds
    s_add_u32 m0, s52, 24576
    s_nop 0
    buffer_load_dwordx4 v9, s[36:39], s53 offen offset:0 lds
    v_bfe_u32 v22, v0, 4, 1
    v_lshrrev_b32 v23, 5, v0
    v_bfe_u32 v24, v0, 2, 2
    v_and_b32 v25, 3, v0
    v_lshlrev_b32 v26, 3, v23
    v_add_u32 v26, v26, v24
    v_mul_u32_u24 v26, 320, v26
    v_lshlrev_b32 v25, 3, v25
    v_add_u32 v26, v26, v25
    v_lshlrev_b32 v27, 5, v22
    v_add_u32 v1, v26, v27
    v_add_u32 v2, 40960, v1
    v_mov_b32 v3, v26
    v_add_u32 v4, 40960, v26

    v_and_b32 v22, 31, v0
    v_bfe_u32 v24, v22, 1, 3
    s_lshl_b32 s29, s26, 5
    v_add_u32 v25, s29, v22
    v_lshlrev_b32 v25, 7, v25
    v_add_u32 v25, 81920, v25

    v_add_u32 v26, 0, v23
    v_xor_b32 v26, v26, v24
    v_lshlrev_b32 v26, 4, v26
    v_add_u32 v14, v25, v26
    v_add_u32 v26, 2, v23
    v_xor_b32 v26, v26, v24
    v_lshlrev_b32 v26, 4, v26
    v_add_u32 v15, v25, v26
    v_add_u32 v26, 4, v23
    v_xor_b32 v26, v26, v24
    v_lshlrev_b32 v26, 4, v26
    v_add_u32 v16, v25, v26
    v_add_u32 v26, 6, v23
    v_xor_b32 v26, v26, v24
    v_lshlrev_b32 v26, 4, v26
    v_add_u32 v17, v25, v26
    v_lshlrev_b32 v20, 4, v23
    v_add_u32 v20, 131072, v20
    s_lshl_b32 s29, s26, 11
    s_add_u32 s29, s29, 81920
    v_add_u32 v18, s29, v19

    v_lshrrev_b32 v24, 4, v22
    v_lshlrev_b32 v24, 10, v24
    v_and_b32 v25, 15, v0
    v_lshlrev_b32 v25, 4, v25
    v_lshlrev_b32 v26, 8, v23
    v_add3_u32 v24, v24, v25, v26
    s_lshl_b32 s29, s26, 11
    s_lshl_b32 s30, s24, 13
    s_add_u32 s29, s29, s30
    v_add_u32 v21, s29, v24

    s_waitcnt vmcnt(9)
    s_barrier
    ds_read_b128 a[0:3], v14 offset:0
    ds_read_b128 a[176:179], v20 offset:0
    ds_read_b128 a[4:7], v15 offset:0
    ds_read_b128 a[180:183], v20 offset:32
    ds_read_b128 a[8:11], v16 offset:0
    ds_read_b128 a[184:187], v20 offset:64
    ds_read_b128 a[12:15], v17 offset:0
    ds_read_b128 a[188:191], v20 offset:96
    ds_read_b64_tr_b16 a[144:145], v1 offset:0
    ds_read_b64_tr_b16 a[146:147], v1 offset:1280
    ds_read_b64_tr_b16 a[148:149], v1 offset:64
    ds_read_b64_tr_b16 a[150:151], v1 offset:1344
    ds_read_b64_tr_b16 a[152:153], v1 offset:128
    ds_read_b64_tr_b16 a[154:155], v1 offset:1408
    ds_read_b64_tr_b16 a[156:157], v1 offset:192
    ds_read_b64_tr_b16 a[158:159], v1 offset:1472
    ds_read_b64_tr_b16 a[160:161], v3 offset:256
    ds_read_b64_tr_b16 a[162:163], v3 offset:1536
    ds_read_b64_tr_b16 a[164:165], v1 offset:5120
    ds_read_b64_tr_b16 a[166:167], v1 offset:6400
    s_load_dwordx2 s[8:9], s[0:1], 64
    s_waitcnt vmcnt(0)
    s_barrier
    s_waitcnt lgkmcnt(8)
    v_mfma_f32_32x32x16_bf16 v[32:47], a[0:3], a[144:147], 0
    ds_read_b64_tr_b16 a[168:169], v1 offset:5184
    ds_read_b64_tr_b16 a[170:171], v1 offset:6464
    ds_read_b128 a[16:19], v14 offset:16384
    v_mfma_f32_32x32x16_bf16 v[48:63], a[0:3], a[148:151], 0
    ds_read_b64_tr_b16 a[172:173], v1 offset:5248
    ds_read_b64_tr_b16 a[174:175], v1 offset:6528
    ds_read_b128 a[192:195], v20 offset:128
    s_add_u32 m0, s54, 114688
    s_add_u32 s55, s50, 256
    buffer_load_dwordx4 v10, s[40:43], s55 offen offset:0 lds
    s_waitcnt lgkmcnt(10)
    v_mfma_f32_32x32x16_bf16 v[64:79], a[0:3], a[152:155], 0
    ds_read_b64_tr_b16 a[144:145], v1 offset:5312
    ds_read_b64_tr_b16 a[146:147], v1 offset:6592
    ds_read_b128 a[20:23], v15 offset:16384
    buffer_load_dwordx4 v11, s[40:43], s55 offen offset:1024 lds
    v_mfma_f32_32x32x16_bf16 v[80:95], a[0:3], a[156:159], 0
    ds_read_b64_tr_b16 a[148:149], v3 offset:5376
    ds_read_b64_tr_b16 a[150:151], v3 offset:6656
    ds_read_b128 a[196:199], v20 offset:160
    buffer_load_dwordx4 v12, s[40:43], s55 offen offset:2048 lds
    s_waitcnt lgkmcnt(12)
    v_mfma_f32_32x32x16_bf16 v[96:111], a[0:3], a[160:163], 0
    ds_read_b64_tr_b16 a[152:153], v1 offset:10240
    ds_read_b64_tr_b16 a[154:155], v1 offset:11520
    ds_read_b128 a[24:27], v16 offset:16384
    buffer_load_dwordx4 v13, s[40:43], s55 offen offset:3072 lds
    v_mfma_f32_32x32x16_bf16 v[192:207], a[176:179], a[0:3], 0
    ds_read_b128 a[200:203], v20 offset:192
    s_add_u32 m0, s52, 40960
    s_mov_b32 s53, 443520
    buffer_load_dwordx4 v5, s[36:39], s53 offen offset:0 lds
    v_mfma_f32_32x32x16_bf16 v[32:47], a[4:7], a[164:167], v[32:47]
    ds_read_b64_tr_b16 a[156:157], v1 offset:10304
    ds_read_b64_tr_b16 a[158:159], v1 offset:11584
    ds_read_b128 a[28:31], v17 offset:16384
    s_waitcnt lgkmcnt(14)
    v_mfma_f32_32x32x16_bf16 v[48:63], a[4:7], a[168:171], v[48:63]
    ds_read_b64_tr_b16 a[160:161], v1 offset:10368
    ds_read_b64_tr_b16 a[162:163], v1 offset:11648
    ds_read_b128 a[204:207], v20 offset:224
    buffer_load_dwordx4 v6, s[36:39], s53 offen offset:1024 lds
    v_mfma_f32_32x32x16_bf16 v[64:79], a[4:7], a[172:175], v[64:79]
    ds_read_b64_tr_b16 a[164:165], v1 offset:10432
    ds_read_b64_tr_b16 a[166:167], v1 offset:11712
    buffer_load_dwordx4 v7, s[36:39], s53 offen offset:2048 lds
    s_waitcnt lgkmcnt(13)
    v_mfma_f32_32x32x16_bf16 v[80:95], a[4:7], a[144:147], v[80:95]
    ds_read_b64_tr_b16 a[168:169], v3 offset:10496
    ds_read_b64_tr_b16 a[170:171], v3 offset:11776
    buffer_load_dwordx4 v8, s[36:39], s53 offen offset:3072 lds
    v_mfma_f32_32x32x16_bf16 v[96:111], a[4:7], a[148:151], v[96:111]
    ds_read_b64_tr_b16 a[172:173], v1 offset:15360
    ds_read_b64_tr_b16 a[174:175], v1 offset:16640
    s_add_u32 m0, s52, 45056
    s_nop 0
    buffer_load_dwordx4 v9, s[36:39], s53 offen offset:0 lds
    v_mfma_f32_32x32x16_bf16 v[192:207], a[180:183], a[4:7], v[192:207]
    s_waitcnt lgkmcnt(10)
    v_mfma_f32_32x32x16_bf16 v[32:47], a[8:11], a[152:155], v[32:47]
    ds_read_b64_tr_b16 a[144:145], v1 offset:15424
    ds_read_b64_tr_b16 a[146:147], v1 offset:16704
    s_add_u32 m0, s54, 81920
    s_add_u32 s55, s50, 384
    buffer_load_dwordx4 v10, s[40:43], s55 offen offset:0 lds
    v_mfma_f32_32x32x16_bf16 v[48:63], a[8:11], a[156:159], v[48:63]
    ds_read_b64_tr_b16 a[148:149], v1 offset:15488
    ds_read_b64_tr_b16 a[150:151], v1 offset:16768
    buffer_load_dwordx4 v11, s[40:43], s55 offen offset:1024 lds
    s_waitcnt lgkmcnt(8)
    v_mfma_f32_32x32x16_bf16 v[64:79], a[8:11], a[160:163], v[64:79]
    ds_read_b64_tr_b16 a[152:153], v1 offset:15552
    ds_read_b64_tr_b16 a[154:155], v1 offset:16832
    buffer_load_dwordx4 v12, s[40:43], s55 offen offset:2048 lds
    v_mfma_f32_32x32x16_bf16 v[80:95], a[8:11], a[164:167], v[80:95]
    ds_read_b64_tr_b16 a[156:157], v3 offset:15616
    ds_read_b64_tr_b16 a[158:159], v3 offset:16896
    buffer_load_dwordx4 v13, s[40:43], s55 offen offset:3072 lds
    s_waitcnt lgkmcnt(8)
    v_mfma_f32_32x32x16_bf16 v[96:111], a[8:11], a[168:171], v[96:111]
    ds_read_b64_tr_b16 a[160:161], v1 offset:20480
    ds_read_b64_tr_b16 a[162:163], v1 offset:21760
    s_add_u32 m0, s52, 61440
    s_mov_b32 s53, 664704
    buffer_load_dwordx4 v5, s[36:39], s53 offen offset:0 lds
    v_mfma_f32_32x32x16_bf16 v[192:207], a[184:187], a[8:11], v[192:207]
    v_mfma_f32_32x32x16_bf16 v[32:47], a[12:15], a[172:175], v[32:47]
    ds_read_b64_tr_b16 a[164:165], v1 offset:20544
    ds_read_b64_tr_b16 a[166:167], v1 offset:21824
    buffer_load_dwordx4 v6, s[36:39], s53 offen offset:1024 lds
    s_waitcnt lgkmcnt(8)
    v_mfma_f32_32x32x16_bf16 v[48:63], a[12:15], a[144:147], v[48:63]
    ds_read_b64_tr_b16 a[168:169], v1 offset:20608
    ds_read_b64_tr_b16 a[170:171], v1 offset:21888
    buffer_load_dwordx4 v7, s[36:39], s53 offen offset:2048 lds
    v_mfma_f32_32x32x16_bf16 v[64:79], a[12:15], a[148:151], v[64:79]
    ds_read_b64_tr_b16 a[172:173], v1 offset:20672
    ds_read_b64_tr_b16 a[174:175], v1 offset:21952
    buffer_load_dwordx4 v8, s[36:39], s53 offen offset:3072 lds
    s_waitcnt lgkmcnt(8)
    v_mfma_f32_32x32x16_bf16 v[80:95], a[12:15], a[152:155], v[80:95]
    ds_read_b64_tr_b16 a[144:145], v3 offset:20736
    ds_read_b64_tr_b16 a[146:147], v3 offset:22016
    s_add_u32 m0, s52, 65536
    s_nop 0
    buffer_load_dwordx4 v9, s[36:39], s53 offen offset:0 lds
    v_mfma_f32_32x32x16_bf16 v[96:111], a[12:15], a[156:159], v[96:111]
    ds_read_b64_tr_b16 a[148:149], v1 offset:25600
    ds_read_b64_tr_b16 a[150:151], v1 offset:26880
    v_mfma_f32_32x32x16_bf16 v[192:207], a[188:191], a[12:15], v[192:207]
    s_waitcnt vmcnt(9)
    s_barrier
    s_waitcnt lgkmcnt(8)
    v_mfma_f32_32x32x16_bf16 v[32:47], a[16:19], a[160:163], v[32:47]
    ds_read_b64_tr_b16 a[152:153], v1 offset:25664
    ds_read_b64_tr_b16 a[154:155], v1 offset:26944
    ds_read_b128 a[32:35], v14 offset:32768
    v_mfma_f32_32x32x16_bf16 v[48:63], a[16:19], a[164:167], v[48:63]
    ds_read_b64_tr_b16 a[156:157], v1 offset:25728
    ds_read_b64_tr_b16 a[158:159], v1 offset:27008
    ds_read_b128 a[176:179], v20 offset:256
    s_add_u32 m0, s54, 98304
    s_add_u32 s55, s50, 512
    buffer_load_dwordx4 v10, s[40:43], s55 offen offset:0 lds
    s_waitcnt lgkmcnt(10)
    v_mfma_f32_32x32x16_bf16 v[64:79], a[16:19], a[168:171], v[64:79]
    ds_read_b64_tr_b16 a[160:161], v1 offset:25792
    ds_read_b64_tr_b16 a[162:163], v1 offset:27072
    ds_read_b128 a[36:39], v15 offset:32768
    v_mfma_f32_32x32x16_bf16 v[80:95], a[16:19], a[172:175], v[80:95]
    ds_read_b64_tr_b16 a[164:165], v3 offset:25856
    ds_read_b64_tr_b16 a[166:167], v3 offset:27136
    ds_read_b128 a[180:183], v20 offset:288
    buffer_load_dwordx4 v11, s[40:43], s55 offen offset:1024 lds
    s_waitcnt lgkmcnt(12)
    v_mfma_f32_32x32x16_bf16 v[96:111], a[16:19], a[144:147], v[96:111]
    ds_read_b64_tr_b16 a[168:169], v1 offset:30720
    ds_read_b64_tr_b16 a[170:171], v1 offset:32000
    ds_read_b128 a[40:43], v16 offset:32768
    v_mfma_f32_32x32x16_bf16 v[192:207], a[192:195], a[16:19], v[192:207]
    ds_read_b128 a[184:187], v20 offset:320
    buffer_load_dwordx4 v12, s[40:43], s55 offen offset:2048 lds
    v_mfma_f32_32x32x16_bf16 v[32:47], a[20:23], a[148:151], v[32:47]
    ds_read_b64_tr_b16 a[172:173], v1 offset:30784
    ds_read_b64_tr_b16 a[174:175], v1 offset:32064
    ds_read_b128 a[44:47], v17 offset:32768
    s_waitcnt lgkmcnt(14)
    v_mfma_f32_32x32x16_bf16 v[48:63], a[20:23], a[152:155], v[48:63]
    ds_read_b64_tr_b16 a[144:145], v1 offset:30848
    ds_read_b64_tr_b16 a[146:147], v1 offset:32128
    ds_read_b128 a[188:191], v20 offset:352
    v_mfma_f32_32x32x16_bf16 v[64:79], a[20:23], a[156:159], v[64:79]
    ds_read_b64_tr_b16 a[148:149], v1 offset:30912
    ds_read_b64_tr_b16 a[150:151], v1 offset:32192
    buffer_load_dwordx4 v13, s[40:43], s55 offen offset:3072 lds
    s_waitcnt lgkmcnt(13)
    v_mfma_f32_32x32x16_bf16 v[80:95], a[20:23], a[160:163], v[80:95]
    ds_read_b64_tr_b16 a[152:153], v3 offset:30976
    ds_read_b64_tr_b16 a[154:155], v3 offset:32256
    v_mfma_f32_32x32x16_bf16 v[96:111], a[20:23], a[164:167], v[96:111]
    ds_read_b64_tr_b16 a[156:157], v1 offset:35840
    ds_read_b64_tr_b16 a[158:159], v1 offset:37120
    s_add_u32 m0, s52, 0
    s_mov_b32 s53, 885888
    buffer_load_dwordx4 v5, s[36:39], s53 offen offset:0 lds
    v_mfma_f32_32x32x16_bf16 v[192:207], a[196:199], a[20:23], v[192:207]
    s_waitcnt lgkmcnt(10)
    v_mfma_f32_32x32x16_bf16 v[32:47], a[24:27], a[168:171], v[32:47]
    ds_read_b64_tr_b16 a[160:161], v1 offset:35904
    ds_read_b64_tr_b16 a[162:163], v1 offset:37184
    v_mfma_f32_32x32x16_bf16 v[48:63], a[24:27], a[172:175], v[48:63]
    ds_read_b64_tr_b16 a[164:165], v1 offset:35968
    ds_read_b64_tr_b16 a[166:167], v1 offset:37248
    buffer_load_dwordx4 v6, s[36:39], s53 offen offset:1024 lds
    s_waitcnt lgkmcnt(8)
    v_mfma_f32_32x32x16_bf16 v[64:79], a[24:27], a[144:147], v[64:79]
    ds_read_b64_tr_b16 a[168:169], v1 offset:36032
    ds_read_b64_tr_b16 a[170:171], v1 offset:37312
    v_mfma_f32_32x32x16_bf16 v[80:95], a[24:27], a[148:151], v[80:95]
    ds_read_b64_tr_b16 a[172:173], v3 offset:36096
    ds_read_b64_tr_b16 a[174:175], v3 offset:37376
    buffer_load_dwordx4 v7, s[36:39], s53 offen offset:2048 lds
    s_waitcnt lgkmcnt(8)
    v_mfma_f32_32x32x16_bf16 v[96:111], a[24:27], a[152:155], v[96:111]
    ds_read_b64_tr_b16 a[144:145], v2 offset:0
    ds_read_b64_tr_b16 a[146:147], v2 offset:1280
    v_mfma_f32_32x32x16_bf16 v[192:207], a[200:203], a[24:27], v[192:207]
    v_mfma_f32_32x32x16_bf16 v[32:47], a[28:31], a[156:159], v[32:47]
    ds_read_b64_tr_b16 a[148:149], v2 offset:64
    ds_read_b64_tr_b16 a[150:151], v2 offset:1344
    buffer_load_dwordx4 v8, s[36:39], s53 offen offset:3072 lds
    s_waitcnt lgkmcnt(8)
    v_mfma_f32_32x32x16_bf16 v[48:63], a[28:31], a[160:163], v[48:63]
    ds_read_b64_tr_b16 a[152:153], v2 offset:128
    ds_read_b64_tr_b16 a[154:155], v2 offset:1408
    v_mfma_f32_32x32x16_bf16 v[64:79], a[28:31], a[164:167], v[64:79]
    ds_read_b64_tr_b16 a[156:157], v2 offset:192
    ds_read_b64_tr_b16 a[158:159], v2 offset:1472
    s_add_u32 m0, s52, 4096
    s_nop 0
    buffer_load_dwordx4 v9, s[36:39], s53 offen offset:0 lds
    s_waitcnt lgkmcnt(8)
    v_mfma_f32_32x32x16_bf16 v[80:95], a[28:31], a[168:171], v[80:95]
    ds_read_b64_tr_b16 a[160:161], v4 offset:256
    ds_read_b64_tr_b16 a[162:163], v4 offset:1536
    v_mfma_f32_32x32x16_bf16 v[96:111], a[28:31], a[172:175], v[96:111]
    ds_read_b64_tr_b16 a[164:165], v2 offset:5120
    ds_read_b64_tr_b16 a[166:167], v2 offset:6400
    v_mfma_f32_32x32x16_bf16 v[192:207], a[204:207], a[28:31], v[192:207]
    s_waitcnt vmcnt(9)
    s_barrier
    s_waitcnt lgkmcnt(8)
    v_mfma_f32_32x32x16_bf16 v[32:47], a[32:35], a[144:147], v[32:47]
    ds_read_b64_tr_b16 a[168:169], v2 offset:5184
    ds_read_b64_tr_b16 a[170:171], v2 offset:6464
    ds_read_b128 a[48:51], v14 offset:0
    v_mfma_f32_32x32x16_bf16 v[48:63], a[32:35], a[148:151], v[48:63]
    ds_read_b64_tr_b16 a[172:173], v2 offset:5248
    ds_read_b64_tr_b16 a[174:175], v2 offset:6528
    ds_read_b128 a[192:195], v20 offset:384
    s_add_u32 m0, s54, 114688
    s_add_u32 s55, s50, 640
    buffer_load_dwordx4 v10, s[40:43], s55 offen offset:0 lds
    s_waitcnt lgkmcnt(10)
    v_mfma_f32_32x32x16_bf16 v[64:79], a[32:35], a[152:155], v[64:79]
    ds_read_b64_tr_b16 a[144:145], v2 offset:5312
    ds_read_b64_tr_b16 a[146:147], v2 offset:6592
    ds_read_b128 a[52:55], v15 offset:0
    v_mfma_f32_32x32x16_bf16 v[80:95], a[32:35], a[156:159], v[80:95]
    ds_read_b64_tr_b16 a[148:149], v4 offset:5376
    ds_read_b64_tr_b16 a[150:151], v4 offset:6656
    ds_read_b128 a[196:199], v20 offset:416
    buffer_load_dwordx4 v11, s[40:43], s55 offen offset:1024 lds
    s_waitcnt lgkmcnt(12)
    v_mfma_f32_32x32x16_bf16 v[96:111], a[32:35], a[160:163], v[96:111]
    ds_read_b64_tr_b16 a[152:153], v2 offset:10240
    ds_read_b64_tr_b16 a[154:155], v2 offset:11520
    ds_read_b128 a[56:59], v16 offset:0
    v_mfma_f32_32x32x16_bf16 v[192:207], a[176:179], a[32:35], v[192:207]
    ds_read_b128 a[200:203], v20 offset:448
    buffer_load_dwordx4 v12, s[40:43], s55 offen offset:2048 lds
    v_mfma_f32_32x32x16_bf16 v[32:47], a[36:39], a[164:167], v[32:47]
    ds_read_b64_tr_b16 a[156:157], v2 offset:10304
    ds_read_b64_tr_b16 a[158:159], v2 offset:11584
    ds_read_b128 a[60:63], v17 offset:0
    s_waitcnt lgkmcnt(14)
    v_mfma_f32_32x32x16_bf16 v[48:63], a[36:39], a[168:171], v[48:63]
    ds_read_b64_tr_b16 a[160:161], v2 offset:10368
    ds_read_b64_tr_b16 a[162:163], v2 offset:11648
    ds_read_b128 a[204:207], v20 offset:480
    v_mfma_f32_32x32x16_bf16 v[64:79], a[36:39], a[172:175], v[64:79]
    ds_read_b64_tr_b16 a[164:165], v2 offset:10432
    ds_read_b64_tr_b16 a[166:167], v2 offset:11712
    buffer_load_dwordx4 v13, s[40:43], s55 offen offset:3072 lds
    s_waitcnt lgkmcnt(13)
    v_mfma_f32_32x32x16_bf16 v[80:95], a[36:39], a[144:147], v[80:95]
    ds_read_b64_tr_b16 a[168:169], v4 offset:10496
    ds_read_b64_tr_b16 a[170:171], v4 offset:11776
    v_mfma_f32_32x32x16_bf16 v[96:111], a[36:39], a[148:151], v[96:111]
    ds_read_b64_tr_b16 a[172:173], v2 offset:15360
    ds_read_b64_tr_b16 a[174:175], v2 offset:16640
    s_add_u32 m0, s52, 20480
    s_mov_b32 s53, 1107072
    buffer_load_dwordx4 v5, s[36:39], s53 offen offset:0 lds
    v_mfma_f32_32x32x16_bf16 v[192:207], a[180:183], a[36:39], v[192:207]
    s_waitcnt lgkmcnt(10)
    v_mfma_f32_32x32x16_bf16 v[32:47], a[40:43], a[152:155], v[32:47]
    ds_read_b64_tr_b16 a[144:145], v2 offset:15424
    ds_read_b64_tr_b16 a[146:147], v2 offset:16704
    v_mfma_f32_32x32x16_bf16 v[48:63], a[40:43], a[156:159], v[48:63]
    ds_read_b64_tr_b16 a[148:149], v2 offset:15488
    ds_read_b64_tr_b16 a[150:151], v2 offset:16768
    buffer_load_dwordx4 v6, s[36:39], s53 offen offset:1024 lds
    s_waitcnt lgkmcnt(8)
    v_mfma_f32_32x32x16_bf16 v[64:79], a[40:43], a[160:163], v[64:79]
    ds_read_b64_tr_b16 a[152:153], v2 offset:15552
    ds_read_b64_tr_b16 a[154:155], v2 offset:16832
    v_mfma_f32_32x32x16_bf16 v[80:95], a[40:43], a[164:167], v[80:95]
    ds_read_b64_tr_b16 a[156:157], v4 offset:15616
    ds_read_b64_tr_b16 a[158:159], v4 offset:16896
    buffer_load_dwordx4 v7, s[36:39], s53 offen offset:2048 lds
    s_waitcnt lgkmcnt(8)
    v_mfma_f32_32x32x16_bf16 v[96:111], a[40:43], a[168:171], v[96:111]
    ds_read_b64_tr_b16 a[160:161], v2 offset:20480
    ds_read_b64_tr_b16 a[162:163], v2 offset:21760
    v_mfma_f32_32x32x16_bf16 v[192:207], a[184:187], a[40:43], v[192:207]
    v_mfma_f32_32x32x16_bf16 v[32:47], a[44:47], a[172:175], v[32:47]
    ds_read_b64_tr_b16 a[164:165], v2 offset:20544
    ds_read_b64_tr_b16 a[166:167], v2 offset:21824
    buffer_load_dwordx4 v8, s[36:39], s53 offen offset:3072 lds
    s_waitcnt lgkmcnt(8)
    v_mfma_f32_32x32x16_bf16 v[48:63], a[44:47], a[144:147], v[48:63]
    ds_read_b64_tr_b16 a[168:169], v2 offset:20608
    ds_read_b64_tr_b16 a[170:171], v2 offset:21888
    v_mfma_f32_32x32x16_bf16 v[64:79], a[44:47], a[148:151], v[64:79]
    ds_read_b64_tr_b16 a[172:173], v2 offset:20672
    ds_read_b64_tr_b16 a[174:175], v2 offset:21952
    s_add_u32 m0, s52, 24576
    s_nop 0
    buffer_load_dwordx4 v9, s[36:39], s53 offen offset:0 lds
    s_waitcnt lgkmcnt(8)
    v_mfma_f32_32x32x16_bf16 v[80:95], a[44:47], a[152:155], v[80:95]
    ds_read_b64_tr_b16 a[144:145], v4 offset:20736
    ds_read_b64_tr_b16 a[146:147], v4 offset:22016
    v_mfma_f32_32x32x16_bf16 v[96:111], a[44:47], a[156:159], v[96:111]
    ds_read_b64_tr_b16 a[148:149], v2 offset:25600
    ds_read_b64_tr_b16 a[150:151], v2 offset:26880
    v_mfma_f32_32x32x16_bf16 v[192:207], a[188:191], a[44:47], v[192:207]
    s_waitcnt vmcnt(9)
    s_barrier
    s_waitcnt lgkmcnt(8)
    v_mfma_f32_32x32x16_bf16 v[32:47], a[48:51], a[160:163], v[32:47]
    ds_read_b64_tr_b16 a[152:153], v2 offset:25664
    ds_read_b64_tr_b16 a[154:155], v2 offset:26944
    ds_read_b128 a[64:67], v14 offset:16384
    v_mfma_f32_32x32x16_bf16 v[48:63], a[48:51], a[164:167], v[48:63]
    ds_read_b64_tr_b16 a[156:157], v2 offset:25728
    ds_read_b64_tr_b16 a[158:159], v2 offset:27008
    ds_read_b128 a[176:179], v20 offset:512
    s_add_u32 m0, s54, 81920
    s_add_u32 s55, s50, 768
    buffer_load_dwordx4 v10, s[40:43], s55 offen offset:0 lds
    s_waitcnt lgkmcnt(10)
    v_mfma_f32_32x32x16_bf16 v[64:79], a[48:51], a[168:171], v[64:79]
    ds_read_b64_tr_b16 a[160:161], v2 offset:25792
    ds_read_b64_tr_b16 a[162:163], v2 offset:27072
    ds_read_b128 a[68:71], v15 offset:16384
    v_mfma_f32_32x32x16_bf16 v[80:95], a[48:51], a[172:175], v[80:95]
    ds_read_b64_tr_b16 a[164:165], v4 offset:25856
    ds_read_b64_tr_b16 a[166:167], v4 offset:27136
    ds_read_b128 a[180:183], v20 offset:544
    buffer_load_dwordx4 v11, s[40:43], s55 offen offset:1024 lds
    s_waitcnt lgkmcnt(12)
    v_mfma_f32_32x32x16_bf16 v[96:111], a[48:51], a[144:147], v[96:111]
    ds_read_b64_tr_b16 a[168:169], v2 offset:30720
    ds_read_b64_tr_b16 a[170:171], v2 offset:32000
    ds_read_b128 a[72:75], v16 offset:16384
    v_mfma_f32_32x32x16_bf16 v[192:207], a[192:195], a[48:51], v[192:207]
    ds_read_b128 a[184:187], v20 offset:576
    buffer_load_dwordx4 v12, s[40:43], s55 offen offset:2048 lds
    v_mfma_f32_32x32x16_bf16 v[32:47], a[52:55], a[148:151], v[32:47]
    ds_read_b64_tr_b16 a[172:173], v2 offset:30784
    ds_read_b64_tr_b16 a[174:175], v2 offset:32064
    ds_read_b128 a[76:79], v17 offset:16384
    s_waitcnt lgkmcnt(14)
    v_mfma_f32_32x32x16_bf16 v[48:63], a[52:55], a[152:155], v[48:63]
    ds_read_b64_tr_b16 a[144:145], v2 offset:30848
    ds_read_b64_tr_b16 a[146:147], v2 offset:32128
    ds_read_b128 a[188:191], v20 offset:608
    v_mfma_f32_32x32x16_bf16 v[64:79], a[52:55], a[156:159], v[64:79]
    ds_read_b64_tr_b16 a[148:149], v2 offset:30912
    ds_read_b64_tr_b16 a[150:151], v2 offset:32192
    buffer_load_dwordx4 v13, s[40:43], s55 offen offset:3072 lds
    s_waitcnt lgkmcnt(13)
    v_mfma_f32_32x32x16_bf16 v[80:95], a[52:55], a[160:163], v[80:95]
    ds_read_b64_tr_b16 a[152:153], v4 offset:30976
    ds_read_b64_tr_b16 a[154:155], v4 offset:32256
    v_mfma_f32_32x32x16_bf16 v[96:111], a[52:55], a[164:167], v[96:111]
    ds_read_b64_tr_b16 a[156:157], v2 offset:35840
    ds_read_b64_tr_b16 a[158:159], v2 offset:37120
    s_add_u32 m0, s52, 40960
    s_mov_b32 s53, 1328256
    buffer_load_dwordx4 v5, s[36:39], s53 offen offset:0 lds
    v_mfma_f32_32x32x16_bf16 v[192:207], a[196:199], a[52:55], v[192:207]
    s_waitcnt lgkmcnt(10)
    v_mfma_f32_32x32x16_bf16 v[32:47], a[56:59], a[168:171], v[32:47]
    ds_read_b64_tr_b16 a[160:161], v2 offset:35904
    ds_read_b64_tr_b16 a[162:163], v2 offset:37184
    v_mfma_f32_32x32x16_bf16 v[48:63], a[56:59], a[172:175], v[48:63]
    ds_read_b64_tr_b16 a[164:165], v2 offset:35968
    ds_read_b64_tr_b16 a[166:167], v2 offset:37248
    buffer_load_dwordx4 v6, s[36:39], s53 offen offset:1024 lds
    s_waitcnt lgkmcnt(8)
    v_mfma_f32_32x32x16_bf16 v[64:79], a[56:59], a[144:147], v[64:79]
    ds_read_b64_tr_b16 a[168:169], v2 offset:36032
    ds_read_b64_tr_b16 a[170:171], v2 offset:37312
    v_mfma_f32_32x32x16_bf16 v[80:95], a[56:59], a[148:151], v[80:95]
    ds_read_b64_tr_b16 a[172:173], v4 offset:36096
    ds_read_b64_tr_b16 a[174:175], v4 offset:37376
    buffer_load_dwordx4 v7, s[36:39], s53 offen offset:2048 lds
    s_waitcnt lgkmcnt(8)
    v_mfma_f32_32x32x16_bf16 v[96:111], a[56:59], a[152:155], v[96:111]
    ds_read_b64_tr_b16 a[144:145], v1 offset:0
    ds_read_b64_tr_b16 a[146:147], v1 offset:1280
    v_mfma_f32_32x32x16_bf16 v[192:207], a[200:203], a[56:59], v[192:207]
    v_mfma_f32_32x32x16_bf16 v[32:47], a[60:63], a[156:159], v[32:47]
    ds_read_b64_tr_b16 a[148:149], v1 offset:64
    ds_read_b64_tr_b16 a[150:151], v1 offset:1344
    buffer_load_dwordx4 v8, s[36:39], s53 offen offset:3072 lds
    s_waitcnt lgkmcnt(8)
    v_mfma_f32_32x32x16_bf16 v[48:63], a[60:63], a[160:163], v[48:63]
    ds_read_b64_tr_b16 a[152:153], v1 offset:128
    ds_read_b64_tr_b16 a[154:155], v1 offset:1408
    v_mfma_f32_32x32x16_bf16 v[64:79], a[60:63], a[164:167], v[64:79]
    ds_read_b64_tr_b16 a[156:157], v1 offset:192
    ds_read_b64_tr_b16 a[158:159], v1 offset:1472
    s_add_u32 m0, s52, 45056
    s_nop 0
    buffer_load_dwordx4 v9, s[36:39], s53 offen offset:0 lds
    s_waitcnt lgkmcnt(8)
    v_mfma_f32_32x32x16_bf16 v[80:95], a[60:63], a[168:171], v[80:95]
    ds_read_b64_tr_b16 a[160:161], v3 offset:256
    ds_read_b64_tr_b16 a[162:163], v3 offset:1536
    v_mfma_f32_32x32x16_bf16 v[96:111], a[60:63], a[172:175], v[96:111]
    ds_read_b64_tr_b16 a[164:165], v1 offset:5120
    ds_read_b64_tr_b16 a[166:167], v1 offset:6400
    v_mfma_f32_32x32x16_bf16 v[192:207], a[204:207], a[60:63], v[192:207]
    s_waitcnt vmcnt(9)
    s_barrier
    s_waitcnt lgkmcnt(8)
    v_mfma_f32_32x32x16_bf16 v[32:47], a[64:67], a[144:147], v[32:47]
    ds_read_b64_tr_b16 a[168:169], v1 offset:5184
    ds_read_b64_tr_b16 a[170:171], v1 offset:6464
    ds_read_b128 a[80:83], v14 offset:32768
    v_mfma_f32_32x32x16_bf16 v[48:63], a[64:67], a[148:151], v[48:63]
    ds_read_b64_tr_b16 a[172:173], v1 offset:5248
    ds_read_b64_tr_b16 a[174:175], v1 offset:6528
    ds_read_b128 a[192:195], v20 offset:640
    s_add_u32 m0, s54, 98304
    s_add_u32 s55, s50, 896
    buffer_load_dwordx4 v10, s[40:43], s55 offen offset:0 lds
    s_waitcnt lgkmcnt(10)
    v_mfma_f32_32x32x16_bf16 v[64:79], a[64:67], a[152:155], v[64:79]
    ds_read_b64_tr_b16 a[144:145], v1 offset:5312
    ds_read_b64_tr_b16 a[146:147], v1 offset:6592
    ds_read_b128 a[84:87], v15 offset:32768
    v_mfma_f32_32x32x16_bf16 v[80:95], a[64:67], a[156:159], v[80:95]
    ds_read_b64_tr_b16 a[148:149], v3 offset:5376
    ds_read_b64_tr_b16 a[150:151], v3 offset:6656
    ds_read_b128 a[196:199], v20 offset:672
    buffer_load_dwordx4 v11, s[40:43], s55 offen offset:1024 lds
    s_waitcnt lgkmcnt(12)
    v_mfma_f32_32x32x16_bf16 v[96:111], a[64:67], a[160:163], v[96:111]
    ds_read_b64_tr_b16 a[152:153], v1 offset:10240
    ds_read_b64_tr_b16 a[154:155], v1 offset:11520
    ds_read_b128 a[88:91], v16 offset:32768
    v_mfma_f32_32x32x16_bf16 v[192:207], a[176:179], a[64:67], v[192:207]
    ds_read_b128 a[200:203], v20 offset:704
    buffer_load_dwordx4 v12, s[40:43], s55 offen offset:2048 lds
    v_mfma_f32_32x32x16_bf16 v[32:47], a[68:71], a[164:167], v[32:47]
    ds_read_b64_tr_b16 a[156:157], v1 offset:10304
    ds_read_b64_tr_b16 a[158:159], v1 offset:11584
    ds_read_b128 a[92:95], v17 offset:32768
    s_waitcnt lgkmcnt(14)
    v_mfma_f32_32x32x16_bf16 v[48:63], a[68:71], a[168:171], v[48:63]
    ds_read_b64_tr_b16 a[160:161], v1 offset:10368
    ds_read_b64_tr_b16 a[162:163], v1 offset:11648
    ds_read_b128 a[204:207], v20 offset:736
    v_mfma_f32_32x32x16_bf16 v[64:79], a[68:71], a[172:175], v[64:79]
    ds_read_b64_tr_b16 a[164:165], v1 offset:10432
    ds_read_b64_tr_b16 a[166:167], v1 offset:11712
    buffer_load_dwordx4 v13, s[40:43], s55 offen offset:3072 lds
    s_waitcnt lgkmcnt(13)
    v_mfma_f32_32x32x16_bf16 v[80:95], a[68:71], a[144:147], v[80:95]
    ds_read_b64_tr_b16 a[168:169], v3 offset:10496
    ds_read_b64_tr_b16 a[170:171], v3 offset:11776
    v_mfma_f32_32x32x16_bf16 v[96:111], a[68:71], a[148:151], v[96:111]
    ds_read_b64_tr_b16 a[172:173], v1 offset:15360
    ds_read_b64_tr_b16 a[174:175], v1 offset:16640
    s_add_u32 m0, s52, 61440
    s_mov_b32 s53, 1549440
    buffer_load_dwordx4 v5, s[36:39], s53 offen offset:0 lds
    v_mfma_f32_32x32x16_bf16 v[192:207], a[180:183], a[68:71], v[192:207]
    s_waitcnt lgkmcnt(10)
    v_mfma_f32_32x32x16_bf16 v[32:47], a[72:75], a[152:155], v[32:47]
    ds_read_b64_tr_b16 a[144:145], v1 offset:15424
    ds_read_b64_tr_b16 a[146:147], v1 offset:16704
    v_mfma_f32_32x32x16_bf16 v[48:63], a[72:75], a[156:159], v[48:63]
    ds_read_b64_tr_b16 a[148:149], v1 offset:15488
    ds_read_b64_tr_b16 a[150:151], v1 offset:16768
    buffer_load_dwordx4 v6, s[36:39], s53 offen offset:1024 lds
    s_waitcnt lgkmcnt(8)
    v_mfma_f32_32x32x16_bf16 v[64:79], a[72:75], a[160:163], v[64:79]
    ds_read_b64_tr_b16 a[152:153], v1 offset:15552
    ds_read_b64_tr_b16 a[154:155], v1 offset:16832
    v_mfma_f32_32x32x16_bf16 v[80:95], a[72:75], a[164:167], v[80:95]
    ds_read_b64_tr_b16 a[156:157], v3 offset:15616
    ds_read_b64_tr_b16 a[158:159], v3 offset:16896
    buffer_load_dwordx4 v7, s[36:39], s53 offen offset:2048 lds
    s_waitcnt lgkmcnt(8)
    v_mfma_f32_32x32x16_bf16 v[96:111], a[72:75], a[168:171], v[96:111]
    ds_read_b64_tr_b16 a[160:161], v1 offset:20480
    ds_read_b64_tr_b16 a[162:163], v1 offset:21760
    v_mfma_f32_32x32x16_bf16 v[192:207], a[184:187], a[72:75], v[192:207]
    v_mfma_f32_32x32x16_bf16 v[32:47], a[76:79], a[172:175], v[32:47]
    ds_read_b64_tr_b16 a[164:165], v1 offset:20544
    ds_read_b64_tr_b16 a[166:167], v1 offset:21824
    buffer_load_dwordx4 v8, s[36:39], s53 offen offset:3072 lds
    s_waitcnt lgkmcnt(8)
    v_mfma_f32_32x32x16_bf16 v[48:63], a[76:79], a[144:147], v[48:63]
    ds_read_b64_tr_b16 a[168:169], v1 offset:20608
    ds_read_b64_tr_b16 a[170:171], v1 offset:21888
    v_mfma_f32_32x32x16_bf16 v[64:79], a[76:79], a[148:151], v[64:79]
    ds_read_b64_tr_b16 a[172:173], v1 offset:20672
    ds_read_b64_tr_b16 a[174:175], v1 offset:21952
    s_add_u32 m0, s52, 65536
    s_nop 0
    buffer_load_dwordx4 v9, s[36:39], s53 offen offset:0 lds
    s_waitcnt lgkmcnt(8)
    v_mfma_f32_32x32x16_bf16 v[80:95], a[76:79], a[152:155], v[80:95]
    ds_read_b64_tr_b16 a[144:145], v3 offset:20736
    ds_read_b64_tr_b16 a[146:147], v3 offset:22016
    v_mfma_f32_32x32x16_bf16 v[96:111], a[76:79], a[156:159], v[96:111]
    ds_read_b64_tr_b16 a[148:149], v1 offset:25600
    ds_read_b64_tr_b16 a[150:151], v1 offset:26880
    v_mfma_f32_32x32x16_bf16 v[192:207], a[188:191], a[76:79], v[192:207]
    s_waitcnt vmcnt(9)
    s_barrier
    s_waitcnt lgkmcnt(8)
    v_mfma_f32_32x32x16_bf16 v[32:47], a[80:83], a[160:163], v[32:47]
    ds_read_b64_tr_b16 a[152:153], v1 offset:25664
    ds_read_b64_tr_b16 a[154:155], v1 offset:26944
    ds_read_b128 a[96:99], v14 offset:0
    v_mfma_f32_32x32x16_bf16 v[48:63], a[80:83], a[164:167], v[48:63]
    ds_read_b64_tr_b16 a[156:157], v1 offset:25728
    ds_read_b64_tr_b16 a[158:159], v1 offset:27008
    ds_read_b128 a[176:179], v20 offset:768
    s_add_u32 m0, s54, 114688
    s_add_u32 s55, s50, 1024
    buffer_load_dwordx4 v10, s[40:43], s55 offen offset:0 lds
    s_waitcnt lgkmcnt(10)
    v_mfma_f32_32x32x16_bf16 v[64:79], a[80:83], a[168:171], v[64:79]
    ds_read_b64_tr_b16 a[160:161], v1 offset:25792
    ds_read_b64_tr_b16 a[162:163], v1 offset:27072
    ds_read_b128 a[100:103], v15 offset:0
    v_mfma_f32_32x32x16_bf16 v[80:95], a[80:83], a[172:175], v[80:95]
    ds_read_b64_tr_b16 a[164:165], v3 offset:25856
    ds_read_b64_tr_b16 a[166:167], v3 offset:27136
    ds_read_b128 a[180:183], v20 offset:800
    buffer_load_dwordx4 v11, s[40:43], s55 offen offset:1024 lds
    s_waitcnt lgkmcnt(12)
    v_mfma_f32_32x32x16_bf16 v[96:111], a[80:83], a[144:147], v[96:111]
    ds_read_b64_tr_b16 a[168:169], v1 offset:30720
    ds_read_b64_tr_b16 a[170:171], v1 offset:32000
    ds_read_b128 a[104:107], v16 offset:0
    v_mfma_f32_32x32x16_bf16 v[192:207], a[192:195], a[80:83], v[192:207]
    ds_read_b128 a[184:187], v20 offset:832
    buffer_load_dwordx4 v12, s[40:43], s55 offen offset:2048 lds
    v_mfma_f32_32x32x16_bf16 v[32:47], a[84:87], a[148:151], v[32:47]
    ds_read_b64_tr_b16 a[172:173], v1 offset:30784
    ds_read_b64_tr_b16 a[174:175], v1 offset:32064
    ds_read_b128 a[108:111], v17 offset:0
    s_waitcnt lgkmcnt(14)
    v_mfma_f32_32x32x16_bf16 v[48:63], a[84:87], a[152:155], v[48:63]
    ds_read_b64_tr_b16 a[144:145], v1 offset:30848
    ds_read_b64_tr_b16 a[146:147], v1 offset:32128
    ds_read_b128 a[188:191], v20 offset:864
    v_mfma_f32_32x32x16_bf16 v[64:79], a[84:87], a[156:159], v[64:79]
    ds_read_b64_tr_b16 a[148:149], v1 offset:30912
    ds_read_b64_tr_b16 a[150:151], v1 offset:32192
    buffer_load_dwordx4 v13, s[40:43], s55 offen offset:3072 lds
    s_waitcnt lgkmcnt(13)
    v_mfma_f32_32x32x16_bf16 v[80:95], a[84:87], a[160:163], v[80:95]
    ds_read_b64_tr_b16 a[152:153], v3 offset:30976
    ds_read_b64_tr_b16 a[154:155], v3 offset:32256
    v_mfma_f32_32x32x16_bf16 v[96:111], a[84:87], a[164:167], v[96:111]
    ds_read_b64_tr_b16 a[156:157], v1 offset:35840
    ds_read_b64_tr_b16 a[158:159], v1 offset:37120
    s_add_u32 m0, s52, 0
    s_mov_b32 s53, 1770624
    buffer_load_dwordx4 v5, s[36:39], s53 offen offset:0 lds
    v_mfma_f32_32x32x16_bf16 v[192:207], a[196:199], a[84:87], v[192:207]
    s_waitcnt lgkmcnt(10)
    v_mfma_f32_32x32x16_bf16 v[32:47], a[88:91], a[168:171], v[32:47]
    ds_read_b64_tr_b16 a[160:161], v1 offset:35904
    ds_read_b64_tr_b16 a[162:163], v1 offset:37184
    v_mfma_f32_32x32x16_bf16 v[48:63], a[88:91], a[172:175], v[48:63]
    ds_read_b64_tr_b16 a[164:165], v1 offset:35968
    ds_read_b64_tr_b16 a[166:167], v1 offset:37248
    buffer_load_dwordx4 v6, s[36:39], s53 offen offset:1024 lds
    s_waitcnt lgkmcnt(8)
    v_mfma_f32_32x32x16_bf16 v[64:79], a[88:91], a[144:147], v[64:79]
    ds_read_b64_tr_b16 a[168:169], v1 offset:36032
    ds_read_b64_tr_b16 a[170:171], v1 offset:37312
    v_mfma_f32_32x32x16_bf16 v[80:95], a[88:91], a[148:151], v[80:95]
    ds_read_b64_tr_b16 a[172:173], v3 offset:36096
    ds_read_b64_tr_b16 a[174:175], v3 offset:37376
    buffer_load_dwordx4 v7, s[36:39], s53 offen offset:2048 lds
    s_waitcnt lgkmcnt(8)
    v_mfma_f32_32x32x16_bf16 v[96:111], a[88:91], a[152:155], v[96:111]
    ds_read_b64_tr_b16 a[144:145], v2 offset:0
    ds_read_b64_tr_b16 a[146:147], v2 offset:1280
    v_mfma_f32_32x32x16_bf16 v[192:207], a[200:203], a[88:91], v[192:207]
    v_mfma_f32_32x32x16_bf16 v[32:47], a[92:95], a[156:159], v[32:47]
    ds_read_b64_tr_b16 a[148:149], v2 offset:64
    ds_read_b64_tr_b16 a[150:151], v2 offset:1344
    buffer_load_dwordx4 v8, s[36:39], s53 offen offset:3072 lds
    s_waitcnt lgkmcnt(8)
    v_mfma_f32_32x32x16_bf16 v[48:63], a[92:95], a[160:163], v[48:63]
    ds_read_b64_tr_b16 a[152:153], v2 offset:128
    ds_read_b64_tr_b16 a[154:155], v2 offset:1408
    v_mfma_f32_32x32x16_bf16 v[64:79], a[92:95], a[164:167], v[64:79]
    ds_read_b64_tr_b16 a[156:157], v2 offset:192
    ds_read_b64_tr_b16 a[158:159], v2 offset:1472
    s_add_u32 m0, s52, 4096
    s_nop 0
    buffer_load_dwordx4 v9, s[36:39], s53 offen offset:0 lds
    s_waitcnt lgkmcnt(8)
    v_mfma_f32_32x32x16_bf16 v[80:95], a[92:95], a[168:171], v[80:95]
    ds_read_b64_tr_b16 a[160:161], v4 offset:256
    ds_read_b64_tr_b16 a[162:163], v4 offset:1536
    v_mfma_f32_32x32x16_bf16 v[96:111], a[92:95], a[172:175], v[96:111]
    ds_read_b64_tr_b16 a[164:165], v2 offset:5120
    ds_read_b64_tr_b16 a[166:167], v2 offset:6400
    v_mfma_f32_32x32x16_bf16 v[192:207], a[204:207], a[92:95], v[192:207]
    s_waitcnt vmcnt(9)
    s_barrier
    s_waitcnt lgkmcnt(8)
    v_mfma_f32_32x32x16_bf16 v[32:47], a[96:99], a[144:147], v[32:47]
    ds_read_b64_tr_b16 a[168:169], v2 offset:5184
    ds_read_b64_tr_b16 a[170:171], v2 offset:6464
    ds_read_b128 a[112:115], v14 offset:16384
    v_mfma_f32_32x32x16_bf16 v[48:63], a[96:99], a[148:151], v[48:63]
    ds_read_b64_tr_b16 a[172:173], v2 offset:5248
    ds_read_b64_tr_b16 a[174:175], v2 offset:6528
    ds_read_b128 a[192:195], v20 offset:896
    s_add_u32 m0, s52, 20480
    s_mov_b32 s53, 2304
    buffer_load_dwordx4 v5, s[36:39], s53 offen offset:0 lds
    s_waitcnt lgkmcnt(10)
    v_mfma_f32_32x32x16_bf16 v[64:79], a[96:99], a[152:155], v[64:79]
    ds_read_b64_tr_b16 a[144:145], v2 offset:5312
    ds_read_b64_tr_b16 a[146:147], v2 offset:6592
    ds_read_b128 a[116:119], v15 offset:16384
    v_mfma_f32_32x32x16_bf16 v[80:95], a[96:99], a[156:159], v[80:95]
    ds_read_b64_tr_b16 a[148:149], v4 offset:5376
    ds_read_b64_tr_b16 a[150:151], v4 offset:6656
    ds_read_b128 a[196:199], v20 offset:928
    s_waitcnt lgkmcnt(12)
    v_mfma_f32_32x32x16_bf16 v[96:111], a[96:99], a[160:163], v[96:111]
    ds_read_b64_tr_b16 a[152:153], v2 offset:10240
    ds_read_b64_tr_b16 a[154:155], v2 offset:11520
    ds_read_b128 a[120:123], v16 offset:16384
    v_mfma_f32_32x32x16_bf16 v[192:207], a[176:179], a[96:99], v[192:207]
    ds_read_b128 a[200:203], v20 offset:960
    buffer_load_dwordx4 v6, s[36:39], s53 offen offset:1024 lds
    v_mfma_f32_32x32x16_bf16 v[32:47], a[100:103], a[164:167], v[32:47]
    ds_read_b64_tr_b16 a[156:157], v2 offset:10304
    ds_read_b64_tr_b16 a[158:159], v2 offset:11584
    ds_read_b128 a[124:127], v17 offset:16384
    s_waitcnt lgkmcnt(14)
    v_mfma_f32_32x32x16_bf16 v[48:63], a[100:103], a[168:171], v[48:63]
    ds_read_b64_tr_b16 a[160:161], v2 offset:10368
    ds_read_b64_tr_b16 a[162:163], v2 offset:11648
    ds_read_b128 a[204:207], v20 offset:992
    v_mfma_f32_32x32x16_bf16 v[64:79], a[100:103], a[172:175], v[64:79]
    ds_read_b64_tr_b16 a[164:165], v2 offset:10432
    ds_read_b64_tr_b16 a[166:167], v2 offset:11712
    s_waitcnt lgkmcnt(13)
    v_mfma_f32_32x32x16_bf16 v[80:95], a[100:103], a[144:147], v[80:95]
    ds_read_b64_tr_b16 a[168:169], v4 offset:10496
    ds_read_b64_tr_b16 a[170:171], v4 offset:11776
    buffer_load_dwordx4 v7, s[36:39], s53 offen offset:2048 lds
    v_mfma_f32_32x32x16_bf16 v[96:111], a[100:103], a[148:151], v[96:111]
    ds_read_b64_tr_b16 a[172:173], v2 offset:15360
    ds_read_b64_tr_b16 a[174:175], v2 offset:16640
    v_mfma_f32_32x32x16_bf16 v[192:207], a[180:183], a[100:103], v[192:207]
    s_waitcnt lgkmcnt(10)
    v_mfma_f32_32x32x16_bf16 v[32:47], a[104:107], a[152:155], v[32:47]
    ds_read_b64_tr_b16 a[144:145], v2 offset:15424
    ds_read_b64_tr_b16 a[146:147], v2 offset:16704
    v_mfma_f32_32x32x16_bf16 v[48:63], a[104:107], a[156:159], v[48:63]
    ds_read_b64_tr_b16 a[148:149], v2 offset:15488
    ds_read_b64_tr_b16 a[150:151], v2 offset:16768
    s_waitcnt lgkmcnt(8)
    v_mfma_f32_32x32x16_bf16 v[64:79], a[104:107], a[160:163], v[64:79]
    ds_read_b64_tr_b16 a[152:153], v2 offset:15552
    ds_read_b64_tr_b16 a[154:155], v2 offset:16832
    buffer_load_dwordx4 v8, s[36:39], s53 offen offset:3072 lds
    v_mfma_f32_32x32x16_bf16 v[80:95], a[104:107], a[164:167], v[80:95]
    ds_read_b64_tr_b16 a[156:157], v4 offset:15616
    ds_read_b64_tr_b16 a[158:159], v4 offset:16896
    s_waitcnt lgkmcnt(8)
    v_mfma_f32_32x32x16_bf16 v[96:111], a[104:107], a[168:171], v[96:111]
    ds_read_b64_tr_b16 a[160:161], v2 offset:20480
    ds_read_b64_tr_b16 a[162:163], v2 offset:21760
    v_mfma_f32_32x32x16_bf16 v[192:207], a[184:187], a[104:107], v[192:207]
    v_mfma_f32_32x32x16_bf16 v[32:47], a[108:111], a[172:175], v[32:47]
    ds_read_b64_tr_b16 a[164:165], v2 offset:20544
    ds_read_b64_tr_b16 a[166:167], v2 offset:21824
    s_add_u32 m0, s52, 24576
    s_nop 0
    buffer_load_dwordx4 v9, s[36:39], s53 offen offset:0 lds
    s_waitcnt lgkmcnt(8)
    v_mfma_f32_32x32x16_bf16 v[48:63], a[108:111], a[144:147], v[48:63]
    ds_read_b64_tr_b16 a[168:169], v2 offset:20608
    ds_read_b64_tr_b16 a[170:171], v2 offset:21888
    v_mfma_f32_32x32x16_bf16 v[64:79], a[108:111], a[148:151], v[64:79]
    ds_read_b64_tr_b16 a[172:173], v2 offset:20672
    ds_read_b64_tr_b16 a[174:175], v2 offset:21952
    s_waitcnt lgkmcnt(8)
    v_mfma_f32_32x32x16_bf16 v[80:95], a[108:111], a[152:155], v[80:95]
    ds_read_b64_tr_b16 a[144:145], v4 offset:20736
    ds_read_b64_tr_b16 a[146:147], v4 offset:22016
    v_mfma_f32_32x32x16_bf16 v[96:111], a[108:111], a[156:159], v[96:111]
    ds_read_b64_tr_b16 a[148:149], v2 offset:25600
    ds_read_b64_tr_b16 a[150:151], v2 offset:26880
    v_mfma_f32_32x32x16_bf16 v[192:207], a[188:191], a[108:111], v[192:207]
    s_waitcnt vmcnt(5)
    s_barrier
    s_waitcnt lgkmcnt(8)
    v_mfma_f32_32x32x16_bf16 v[32:47], a[112:115], a[160:163], v[32:47]
    ds_read_b64_tr_b16 a[152:153], v2 offset:25664
    ds_read_b64_tr_b16 a[154:155], v2 offset:26944
    ds_read_b128 a[128:131], v14 offset:32768
    v_mfma_f32_32x32x16_bf16 v[48:63], a[112:115], a[164:167], v[48:63]
    ds_read_b64_tr_b16 a[156:157], v2 offset:25728
    ds_read_b64_tr_b16 a[158:159], v2 offset:27008
    ds_read_b128 a[176:179], v20 offset:1024
    s_add_u32 m0, s52, 40960
    s_mov_b32 s53, 223488
    buffer_load_dwordx4 v5, s[36:39], s53 offen offset:0 lds
    s_waitcnt lgkmcnt(10)
    v_mfma_f32_32x32x16_bf16 v[64:79], a[112:115], a[168:171], v[64:79]
    ds_read_b64_tr_b16 a[160:161], v2 offset:25792
    ds_read_b64_tr_b16 a[162:163], v2 offset:27072
    ds_read_b128 a[132:135], v15 offset:32768
    v_mfma_f32_32x32x16_bf16 v[80:95], a[112:115], a[172:175], v[80:95]
    ds_read_b64_tr_b16 a[164:165], v4 offset:25856
    ds_read_b64_tr_b16 a[166:167], v4 offset:27136
    ds_read_b128 a[180:183], v20 offset:1056
    s_waitcnt lgkmcnt(12)
    v_mfma_f32_32x32x16_bf16 v[96:111], a[112:115], a[144:147], v[96:111]
    ds_read_b64_tr_b16 a[168:169], v2 offset:30720
    ds_read_b64_tr_b16 a[170:171], v2 offset:32000
    ds_read_b128 a[136:139], v16 offset:32768
    v_mfma_f32_32x32x16_bf16 v[192:207], a[192:195], a[112:115], v[192:207]
    ds_read_b128 a[184:187], v20 offset:1088
    buffer_load_dwordx4 v6, s[36:39], s53 offen offset:1024 lds
    v_mfma_f32_32x32x16_bf16 v[32:47], a[116:119], a[148:151], v[32:47]
    ds_read_b64_tr_b16 a[172:173], v2 offset:30784
    ds_read_b64_tr_b16 a[174:175], v2 offset:32064
    ds_read_b128 a[140:143], v17 offset:32768
    s_waitcnt lgkmcnt(14)
    v_mfma_f32_32x32x16_bf16 v[48:63], a[116:119], a[152:155], v[48:63]
    ds_read_b64_tr_b16 a[144:145], v2 offset:30848
    ds_read_b64_tr_b16 a[146:147], v2 offset:32128
    ds_read_b128 a[188:191], v20 offset:1120
    v_mfma_f32_32x32x16_bf16 v[64:79], a[116:119], a[156:159], v[64:79]
    ds_read_b64_tr_b16 a[148:149], v2 offset:30912
    ds_read_b64_tr_b16 a[150:151], v2 offset:32192
    s_waitcnt lgkmcnt(13)
    v_mfma_f32_32x32x16_bf16 v[80:95], a[116:119], a[160:163], v[80:95]
    ds_read_b64_tr_b16 a[152:153], v4 offset:30976
    ds_read_b64_tr_b16 a[154:155], v4 offset:32256
    buffer_load_dwordx4 v7, s[36:39], s53 offen offset:2048 lds
    v_mfma_f32_32x32x16_bf16 v[96:111], a[116:119], a[164:167], v[96:111]
    ds_read_b64_tr_b16 a[156:157], v2 offset:35840
    ds_read_b64_tr_b16 a[158:159], v2 offset:37120
    v_mfma_f32_32x32x16_bf16 v[192:207], a[196:199], a[116:119], v[192:207]
    s_waitcnt lgkmcnt(10)
    v_mfma_f32_32x32x16_bf16 v[32:47], a[120:123], a[168:171], v[32:47]
    ds_read_b64_tr_b16 a[160:161], v2 offset:35904
    ds_read_b64_tr_b16 a[162:163], v2 offset:37184
    v_mfma_f32_32x32x16_bf16 v[48:63], a[120:123], a[172:175], v[48:63]
    ds_read_b64_tr_b16 a[164:165], v2 offset:35968
    ds_read_b64_tr_b16 a[166:167], v2 offset:37248
    s_waitcnt lgkmcnt(8)
    v_mfma_f32_32x32x16_bf16 v[64:79], a[120:123], a[144:147], v[64:79]
    ds_read_b64_tr_b16 a[168:169], v2 offset:36032
    ds_read_b64_tr_b16 a[170:171], v2 offset:37312
    buffer_load_dwordx4 v8, s[36:39], s53 offen offset:3072 lds
    v_mfma_f32_32x32x16_bf16 v[80:95], a[120:123], a[148:151], v[80:95]
    ds_read_b64_tr_b16 a[172:173], v4 offset:36096
    ds_read_b64_tr_b16 a[174:175], v4 offset:37376
    s_waitcnt lgkmcnt(8)
    v_mfma_f32_32x32x16_bf16 v[96:111], a[120:123], a[152:155], v[96:111]
    ds_read_b64_tr_b16 a[144:145], v1 offset:0
    ds_read_b64_tr_b16 a[146:147], v1 offset:1280
    v_mfma_f32_32x32x16_bf16 v[192:207], a[200:203], a[120:123], v[192:207]
    v_mfma_f32_32x32x16_bf16 v[32:47], a[124:127], a[156:159], v[32:47]
    ds_read_b64_tr_b16 a[148:149], v1 offset:64
    ds_read_b64_tr_b16 a[150:151], v1 offset:1344
    s_add_u32 m0, s52, 45056
    s_nop 0
    buffer_load_dwordx4 v9, s[36:39], s53 offen offset:0 lds
    s_waitcnt lgkmcnt(8)
    v_mfma_f32_32x32x16_bf16 v[48:63], a[124:127], a[160:163], v[48:63]
    ds_read_b64_tr_b16 a[152:153], v1 offset:128
    ds_read_b64_tr_b16 a[154:155], v1 offset:1408
    v_mfma_f32_32x32x16_bf16 v[64:79], a[124:127], a[164:167], v[64:79]
    ds_read_b64_tr_b16 a[156:157], v1 offset:192
    ds_read_b64_tr_b16 a[158:159], v1 offset:1472
    s_waitcnt lgkmcnt(8)
    v_mfma_f32_32x32x16_bf16 v[80:95], a[124:127], a[168:171], v[80:95]
    ds_read_b64_tr_b16 a[160:161], v3 offset:256
    ds_read_b64_tr_b16 a[162:163], v3 offset:1536
    v_mfma_f32_32x32x16_bf16 v[96:111], a[124:127], a[172:175], v[96:111]
    ds_read_b64_tr_b16 a[164:165], v1 offset:5120
    ds_read_b64_tr_b16 a[166:167], v1 offset:6400
    v_mfma_f32_32x32x16_bf16 v[192:207], a[204:207], a[124:127], v[192:207]
    s_waitcnt vmcnt(5)
    s_barrier
    s_waitcnt lgkmcnt(8)
    v_mfma_f32_32x32x16_bf16 v[32:47], a[128:131], a[144:147], v[32:47]
    ds_read_b64_tr_b16 a[168:169], v1 offset:5184
    ds_read_b64_tr_b16 a[170:171], v1 offset:6464
    v_mfma_f32_32x32x16_bf16 v[48:63], a[128:131], a[148:151], v[48:63]
    ds_read_b64_tr_b16 a[172:173], v1 offset:5248
    ds_read_b64_tr_b16 a[174:175], v1 offset:6528
    s_add_u32 m0, s52, 61440
    s_mov_b32 s53, 444672
    buffer_load_dwordx4 v5, s[36:39], s53 offen offset:0 lds
    s_waitcnt lgkmcnt(8)
    v_mfma_f32_32x32x16_bf16 v[64:79], a[128:131], a[152:155], v[64:79]
    ds_read_b64_tr_b16 a[144:145], v1 offset:5312
    ds_read_b64_tr_b16 a[146:147], v1 offset:6592
    v_mfma_f32_32x32x16_bf16 v[80:95], a[128:131], a[156:159], v[80:95]
    ds_read_b64_tr_b16 a[148:149], v3 offset:5376
    ds_read_b64_tr_b16 a[150:151], v3 offset:6656
    s_waitcnt lgkmcnt(8)
    v_mfma_f32_32x32x16_bf16 v[96:111], a[128:131], a[160:163], v[96:111]
    ds_read_b64_tr_b16 a[152:153], v1 offset:10240
    ds_read_b64_tr_b16 a[154:155], v1 offset:11520
    v_mfma_f32_32x32x16_bf16 v[192:207], a[176:179], a[128:131], v[192:207]
    buffer_load_dwordx4 v6, s[36:39], s53 offen offset:1024 lds
    v_mfma_f32_32x32x16_bf16 v[32:47], a[132:135], a[164:167], v[32:47]
    ds_read_b64_tr_b16 a[156:157], v1 offset:10304
    ds_read_b64_tr_b16 a[158:159], v1 offset:11584
    s_waitcnt lgkmcnt(8)
    v_mfma_f32_32x32x16_bf16 v[48:63], a[132:135], a[168:171], v[48:63]
    ds_read_b64_tr_b16 a[160:161], v1 offset:10368
    ds_read_b64_tr_b16 a[162:163], v1 offset:11648
    v_mfma_f32_32x32x16_bf16 v[64:79], a[132:135], a[172:175], v[64:79]
    ds_read_b64_tr_b16 a[164:165], v1 offset:10432
    ds_read_b64_tr_b16 a[166:167], v1 offset:11712
    s_waitcnt lgkmcnt(8)
    v_mfma_f32_32x32x16_bf16 v[80:95], a[132:135], a[144:147], v[80:95]
    ds_read_b64_tr_b16 a[168:169], v3 offset:10496
    ds_read_b64_tr_b16 a[170:171], v3 offset:11776
    buffer_load_dwordx4 v7, s[36:39], s53 offen offset:2048 lds
    v_mfma_f32_32x32x16_bf16 v[96:111], a[132:135], a[148:151], v[96:111]
    ds_read_b64_tr_b16 a[172:173], v1 offset:15360
    ds_read_b64_tr_b16 a[174:175], v1 offset:16640
    v_mfma_f32_32x32x16_bf16 v[192:207], a[180:183], a[132:135], v[192:207]
    s_waitcnt lgkmcnt(8)
    v_mfma_f32_32x32x16_bf16 v[32:47], a[136:139], a[152:155], v[32:47]
    ds_read_b64_tr_b16 a[144:145], v1 offset:15424
    ds_read_b64_tr_b16 a[146:147], v1 offset:16704
    v_mfma_f32_32x32x16_bf16 v[48:63], a[136:139], a[156:159], v[48:63]
    ds_read_b64_tr_b16 a[148:149], v1 offset:15488
    ds_read_b64_tr_b16 a[150:151], v1 offset:16768
    s_waitcnt lgkmcnt(8)
    v_mfma_f32_32x32x16_bf16 v[64:79], a[136:139], a[160:163], v[64:79]
    ds_read_b64_tr_b16 a[152:153], v1 offset:15552
    ds_read_b64_tr_b16 a[154:155], v1 offset:16832
    buffer_load_dwordx4 v8, s[36:39], s53 offen offset:3072 lds
    v_mfma_f32_32x32x16_bf16 v[80:95], a[136:139], a[164:167], v[80:95]
    ds_read_b64_tr_b16 a[156:157], v3 offset:15616
    ds_read_b64_tr_b16 a[158:159], v3 offset:16896
    s_waitcnt lgkmcnt(8)
    v_mfma_f32_32x32x16_bf16 v[96:111], a[136:139], a[168:171], v[96:111]
    ds_read_b64_tr_b16 a[160:161], v1 offset:20480
    ds_read_b64_tr_b16 a[162:163], v1 offset:21760
    v_mfma_f32_32x32x16_bf16 v[192:207], a[184:187], a[136:139], v[192:207]
    v_mfma_f32_32x32x16_bf16 v[32:47], a[140:143], a[172:175], v[32:47]
    ds_read_b64_tr_b16 a[164:165], v1 offset:20544
    ds_read_b64_tr_b16 a[166:167], v1 offset:21824
    s_add_u32 m0, s52, 65536
    s_nop 0
    buffer_load_dwordx4 v9, s[36:39], s53 offen offset:0 lds
    s_waitcnt lgkmcnt(8)
    v_mfma_f32_32x32x16_bf16 v[48:63], a[140:143], a[144:147], v[48:63]
    ds_read_b64_tr_b16 a[168:169], v1 offset:20608
    ds_read_b64_tr_b16 a[170:171], v1 offset:21888
    v_mfma_f32_32x32x16_bf16 v[64:79], a[140:143], a[148:151], v[64:79]
    ds_read_b64_tr_b16 a[172:173], v1 offset:20672
    ds_read_b64_tr_b16 a[174:175], v1 offset:21952
    s_waitcnt lgkmcnt(8)
    v_mfma_f32_32x32x16_bf16 v[80:95], a[140:143], a[152:155], v[80:95]
    ds_read_b64_tr_b16 a[144:145], v3 offset:20736
    ds_read_b64_tr_b16 a[146:147], v3 offset:22016
    v_mfma_f32_32x32x16_bf16 v[96:111], a[140:143], a[156:159], v[96:111]
    ds_read_b64_tr_b16 a[148:149], v1 offset:25600
    ds_read_b64_tr_b16 a[150:151], v1 offset:26880
    v_mfma_f32_32x32x16_bf16 v[192:207], a[188:191], a[140:143], v[192:207]
    s_add_u32 s64, s10, 58720256
    s_addc_u32 s65, s11, 0
    s_waitcnt vmcnt(5)
    s_barrier
    s_waitcnt lgkmcnt(8)
    v_mfma_f32_32x32x16_bf16 v[112:127], a[0:3], a[160:163], 0
    ds_read_b64_tr_b16 a[152:153], v1 offset:25664
    ds_read_b64_tr_b16 a[154:155], v1 offset:26944
    v_mfma_f32_32x32x16_bf16 v[128:143], a[0:3], a[164:167], 0
    ds_read_b64_tr_b16 a[156:157], v1 offset:25728
    ds_read_b64_tr_b16 a[158:159], v1 offset:27008
    s_add_u32 m0, s52, 0
    s_mov_b32 s53, 665856
    buffer_load_dwordx4 v5, s[36:39], s53 offen offset:0 lds
    s_waitcnt lgkmcnt(8)
    v_mfma_f32_32x32x16_bf16 v[144:159], a[0:3], a[168:171], 0
    ds_read_b64_tr_b16 a[160:161], v1 offset:25792
    ds_read_b64_tr_b16 a[162:163], v1 offset:27072
    v_mfma_f32_32x32x16_bf16 v[160:175], a[0:3], a[172:175], 0
    ds_read_b64_tr_b16 a[164:165], v3 offset:25856
    ds_read_b64_tr_b16 a[166:167], v3 offset:27136
    s_waitcnt lgkmcnt(8)
    v_mfma_f32_32x32x16_bf16 v[176:191], a[0:3], a[144:147], 0
    ds_read_b64_tr_b16 a[168:169], v1 offset:30720
    ds_read_b64_tr_b16 a[170:171], v1 offset:32000
    buffer_load_dwordx4 v6, s[36:39], s53 offen offset:1024 lds
    v_mfma_f32_32x32x16_bf16 v[112:127], a[4:7], a[148:151], v[112:127]
    ds_read_b64_tr_b16 a[172:173], v1 offset:30784
    ds_read_b64_tr_b16 a[174:175], v1 offset:32064
    v_mul_f32 v192, s59, v192
    v_exp_f32 v192, v192
    s_nop 0
    s_waitcnt lgkmcnt(8)
    v_mfma_f32_32x32x16_bf16 v[128:143], a[4:7], a[152:155], v[128:143]
    ds_read_b64_tr_b16 a[144:145], v1 offset:30848
    ds_read_b64_tr_b16 a[146:147], v1 offset:32128
    v_add_f32 v192, 1.0, v192
    v_rcp_f32 v192, v192
    s_nop 0
    v_mov_b32 v193, v192
    v_mfma_f32_32x32x16_bf16 v[144:159], a[4:7], a[156:159], v[144:159]
    ds_read_b64_tr_b16 a[148:149], v1 offset:30912
    ds_read_b64_tr_b16 a[150:151], v1 offset:32192
    v_mul_f32 v208, s60, v32
    v_mul_f32 v209, s60, v33
    v_exp_f32 v208, v208 clamp
    s_waitcnt lgkmcnt(8)
    v_mfma_f32_32x32x16_bf16 v[160:175], a[4:7], a[160:163], v[160:175]
    ds_read_b64_tr_b16 a[152:153], v3 offset:30976
    ds_read_b64_tr_b16 a[154:155], v3 offset:32256
    buffer_load_dwordx4 v7, s[36:39], s53 offen offset:2048 lds
    v_exp_f32 v209, v209 clamp
    v_max_f32 v210, 0, v32
    v_mfma_f32_32x32x16_bf16 v[176:191], a[4:7], a[164:167], v[176:191]
    ds_read_b64_tr_b16 a[156:157], v1 offset:35840
    ds_read_b64_tr_b16 a[158:159], v1 offset:37120
    v_max_f32 v211, 0, v33
    v_add_f32 v210, s62, v210
    v_add_f32 v211, s62, v211
    v_add_f32 v210, v210, v208
    s_waitcnt lgkmcnt(8)
    v_mfma_f32_32x32x16_bf16 v[112:127], a[8:11], a[168:171], v[112:127]
    ds_read_b64_tr_b16 a[160:161], v1 offset:35904
    ds_read_b64_tr_b16 a[162:163], v1 offset:37184
    v_add_f32 v211, v211, v209
    v_cvt_pk_bf16_f32 v216, v210, v211
    v_mul_f32 v212, s60, v34
    v_mul_f32 v213, s60, v35
    v_mfma_f32_32x32x16_bf16 v[128:143], a[8:11], a[172:175], v[128:143]
    ds_read_b64_tr_b16 a[164:165], v1 offset:35968
    ds_read_b64_tr_b16 a[166:167], v1 offset:37248
    buffer_load_dwordx4 v8, s[36:39], s53 offen offset:3072 lds
    v_exp_f32 v212, v212 clamp
    s_waitcnt lgkmcnt(8)
    v_mfma_f32_32x32x16_bf16 v[144:159], a[8:11], a[144:147], v[144:159]
    ds_read_b64_tr_b16 a[168:169], v1 offset:36032
    ds_read_b64_tr_b16 a[170:171], v1 offset:37312
    v_exp_f32 v213, v213 clamp
    v_max_f32 v214, 0, v34
    v_max_f32 v215, 0, v35
    v_add_f32 v214, s62, v214
    v_mfma_f32_32x32x16_bf16 v[160:175], a[8:11], a[148:151], v[160:175]
    ds_read_b64_tr_b16 a[172:173], v3 offset:36096
    ds_read_b64_tr_b16 a[174:175], v3 offset:37376
    v_add_f32 v215, s62, v215
    v_add_f32 v214, v214, v212
    v_add_f32 v215, v215, v213
    v_cvt_pk_bf16_f32 v217, v214, v215
    s_waitcnt lgkmcnt(8)
    v_mfma_f32_32x32x16_bf16 v[176:191], a[8:11], a[152:155], v[176:191]
    ds_read_b64_tr_b16 a[144:145], v2 offset:0
    ds_read_b64_tr_b16 a[146:147], v2 offset:1280
    v_mul_f32 v208, s60, v36
    v_mul_f32 v209, s60, v37
    v_exp_f32 v208, v208 clamp
    v_mfma_f32_32x32x16_bf16 v[112:127], a[12:15], a[156:159], v[112:127]
    ds_read_b64_tr_b16 a[148:149], v2 offset:64
    ds_read_b64_tr_b16 a[150:151], v2 offset:1344
    s_add_u32 m0, s52, 4096
    s_nop 0
    buffer_load_dwordx4 v9, s[36:39], s53 offen offset:0 lds
    s_waitcnt lgkmcnt(8)
    v_mfma_f32_32x32x16_bf16 v[128:143], a[12:15], a[160:163], v[128:143]
    ds_read_b64_tr_b16 a[152:153], v2 offset:128
    ds_read_b64_tr_b16 a[154:155], v2 offset:1408
    v_exp_f32 v209, v209 clamp
    v_max_f32 v210, 0, v36
    v_max_f32 v211, 0, v37
    v_add_f32 v210, s62, v210
    v_mfma_f32_32x32x16_bf16 v[144:159], a[12:15], a[164:167], v[144:159]
    ds_read_b64_tr_b16 a[156:157], v2 offset:192
    ds_read_b64_tr_b16 a[158:159], v2 offset:1472
    v_add_f32 v211, s62, v211
    v_add_f32 v210, v210, v208
    v_add_f32 v211, v211, v209
    v_cvt_pk_bf16_f32 v218, v210, v211
    s_waitcnt lgkmcnt(8)
    v_mfma_f32_32x32x16_bf16 v[160:175], a[12:15], a[168:171], v[160:175]
    ds_read_b64_tr_b16 a[160:161], v4 offset:256
    ds_read_b64_tr_b16 a[162:163], v4 offset:1536
    v_mul_f32 v212, s60, v38
    v_mul_f32 v213, s60, v39
    v_exp_f32 v212, v212 clamp
    v_mfma_f32_32x32x16_bf16 v[176:191], a[12:15], a[172:175], v[176:191]
    ds_read_b64_tr_b16 a[164:165], v2 offset:5120
    ds_read_b64_tr_b16 a[166:167], v2 offset:6400
    v_exp_f32 v213, v213 clamp
    v_max_f32 v214, 0, v38
    v_max_f32 v215, 0, v39
    s_waitcnt vmcnt(5)
    s_barrier
    s_waitcnt lgkmcnt(8)
    v_mfma_f32_32x32x16_bf16 v[112:127], a[16:19], a[144:147], v[112:127]
    ds_read_b64_tr_b16 a[168:169], v2 offset:5184
    ds_read_b64_tr_b16 a[170:171], v2 offset:6464
    v_add_f32 v214, s62, v214
    v_add_f32 v215, s62, v215
    v_add_f32 v214, v214, v212
    v_add_f32 v215, v215, v213
    v_cvt_pk_bf16_f32 v219, v214, v215
    v_mfma_f32_32x32x16_bf16 v[128:143], a[16:19], a[148:151], v[128:143]
    ds_read_b64_tr_b16 a[172:173], v2 offset:5248
    ds_read_b64_tr_b16 a[174:175], v2 offset:6528
    s_add_u32 m0, s52, 20480
    s_mov_b32 s53, 887040
    buffer_load_dwordx4 v5, s[36:39], s53 offen offset:0 lds
    s_waitcnt lgkmcnt(8)
    v_mfma_f32_32x32x16_bf16 v[144:159], a[16:19], a[152:155], v[144:159]
    ds_read_b64_tr_b16 a[144:145], v2 offset:5312
    ds_read_b64_tr_b16 a[146:147], v2 offset:6592
    ds_write_b128 v18, v[216:219] offset:0
    v_mul_f32 v208, s60, v40
    v_mul_f32 v209, s60, v41
    v_mfma_f32_32x32x16_bf16 v[160:175], a[16:19], a[156:159], v[160:175]
    ds_read_b64_tr_b16 a[148:149], v4 offset:5376
    ds_read_b64_tr_b16 a[150:151], v4 offset:6656
    v_exp_f32 v208, v208 clamp
    v_exp_f32 v209, v209 clamp
    s_waitcnt lgkmcnt(9)
    v_mfma_f32_32x32x16_bf16 v[176:191], a[16:19], a[160:163], v[176:191]
    ds_read_b64_tr_b16 a[152:153], v2 offset:10240
    ds_read_b64_tr_b16 a[154:155], v2 offset:11520
    buffer_load_dwordx4 v6, s[36:39], s53 offen offset:1024 lds
    v_max_f32 v210, 0, v40
    v_max_f32 v211, 0, v41
    v_add_f32 v210, s62, v210
    v_mfma_f32_32x32x16_bf16 v[112:127], a[20:23], a[164:167], v[112:127]
    ds_read_b64_tr_b16 a[156:157], v2 offset:10304
    ds_read_b64_tr_b16 a[158:159], v2 offset:11584
    v_add_f32 v211, s62, v211
    v_add_f32 v210, v210, v208
    v_add_f32 v211, v211, v209
    v_cvt_pk_bf16_f32 v220, v210, v211
    s_waitcnt lgkmcnt(9)
    v_mfma_f32_32x32x16_bf16 v[128:143], a[20:23], a[168:171], v[128:143]
    ds_read_b64_tr_b16 a[160:161], v2 offset:10368
    ds_read_b64_tr_b16 a[162:163], v2 offset:11648
    v_mul_f32 v212, s60, v42
    v_mul_f32 v213, s60, v43
    v_exp_f32 v212, v212 clamp
    v_mfma_f32_32x32x16_bf16 v[144:159], a[20:23], a[172:175], v[144:159]
    ds_read_b64_tr_b16 a[164:165], v2 offset:10432
    ds_read_b64_tr_b16 a[166:167], v2 offset:11712
    v_exp_f32 v213, v213 clamp
    v_max_f32 v214, 0, v42
    v_max_f32 v215, 0, v43
    s_waitcnt lgkmcnt(8)
    v_mfma_f32_32x32x16_bf16 v[160:175], a[20:23], a[144:147], v[160:175]
    ds_read_b64_tr_b16 a[168:169], v4 offset:10496
    ds_read_b64_tr_b16 a[170:171], v4 offset:11776
    buffer_load_dwordx4 v7, s[36:39], s53 offen offset:2048 lds
    v_add_f32 v214, s62, v214
    v_add_f32 v215, s62, v215
    v_add_f32 v214, v214, v212
    v_mfma_f32_32x32x16_bf16 v[176:191], a[20:23], a[148:151], v[176:191]
    ds_read_b64_tr_b16 a[172:173], v2 offset:15360
    ds_read_b64_tr_b16 a[174:175], v2 offset:16640
    v_add_f32 v215, v215, v213
    v_cvt_pk_bf16_f32 v221, v214, v215
    v_mul_f32 v208, s60, v44
    v_mul_f32 v209, s60, v45
    s_waitcnt lgkmcnt(8)
    v_mfma_f32_32x32x16_bf16 v[112:127], a[24:27], a[152:155], v[112:127]
    ds_read_b64_tr_b16 a[144:145], v2 offset:15424
    ds_read_b64_tr_b16 a[146:147], v2 offset:16704
    v_exp_f32 v208, v208 clamp
    v_exp_f32 v209, v209 clamp
    v_max_f32 v210, 0, v44
    v_mfma_f32_32x32x16_bf16 v[128:143], a[24:27], a[156:159], v[128:143]
    ds_read_b64_tr_b16 a[148:149], v2 offset:15488
    ds_read_b64_tr_b16 a[150:151], v2 offset:16768
    buffer_load_dwordx4 v8, s[36:39], s53 offen offset:3072 lds
    v_max_f32 v211, 0, v45
    v_add_f32 v210, s62, v210
    s_waitcnt lgkmcnt(8)
    v_mfma_f32_32x32x16_bf16 v[144:159], a[24:27], a[160:163], v[144:159]
    ds_read_b64_tr_b16 a[152:153], v2 offset:15552
    ds_read_b64_tr_b16 a[154:155], v2 offset:16832
    v_add_f32 v211, s62, v211
    v_add_f32 v210, v210, v208
    v_add_f32 v211, v211, v209
    v_cvt_pk_bf16_f32 v222, v210, v211
    v_mul_f32 v212, s60, v46
    v_mfma_f32_32x32x16_bf16 v[160:175], a[24:27], a[164:167], v[160:175]
    ds_read_b64_tr_b16 a[156:157], v4 offset:15616
    ds_read_b64_tr_b16 a[158:159], v4 offset:16896
    v_mul_f32 v213, s60, v47
    v_exp_f32 v212, v212 clamp
    s_waitcnt lgkmcnt(8)
    v_mfma_f32_32x32x16_bf16 v[176:191], a[24:27], a[168:171], v[176:191]
    ds_read_b64_tr_b16 a[160:161], v2 offset:20480
    ds_read_b64_tr_b16 a[162:163], v2 offset:21760
    v_exp_f32 v213, v213 clamp
    v_max_f32 v214, 0, v46
    v_max_f32 v215, 0, v47
    v_add_f32 v214, s62, v214
    v_mfma_f32_32x32x16_bf16 v[112:127], a[28:31], a[172:175], v[112:127]
    ds_read_b64_tr_b16 a[164:165], v2 offset:20544
    ds_read_b64_tr_b16 a[166:167], v2 offset:21824
    s_add_u32 m0, s52, 24576
    s_nop 0
    buffer_load_dwordx4 v9, s[36:39], s53 offen offset:0 lds
    s_waitcnt lgkmcnt(8)
    v_mfma_f32_32x32x16_bf16 v[128:143], a[28:31], a[144:147], v[128:143]
    ds_read_b64_tr_b16 a[168:169], v2 offset:20608
    ds_read_b64_tr_b16 a[170:171], v2 offset:21888
    v_add_f32 v215, s62, v215
    v_add_f32 v214, v214, v212
    v_add_f32 v215, v215, v213
    v_cvt_pk_bf16_f32 v223, v214, v215
    v_mfma_f32_32x32x16_bf16 v[144:159], a[28:31], a[148:151], v[144:159]
    ds_read_b64_tr_b16 a[172:173], v2 offset:20672
    ds_read_b64_tr_b16 a[174:175], v2 offset:21952
    ds_write_b128 v18, v[220:223] offset:1024
    v_mul_f32 v208, s60, v48
    v_mul_f32 v209, s60, v49
    s_waitcnt lgkmcnt(9)
    v_mfma_f32_32x32x16_bf16 v[160:175], a[28:31], a[152:155], v[160:175]
    ds_read_b64_tr_b16 a[144:145], v4 offset:20736
    ds_read_b64_tr_b16 a[146:147], v4 offset:22016
    v_exp_f32 v208, v208 clamp
    v_exp_f32 v209, v209 clamp
    v_max_f32 v210, 0, v48
    v_mfma_f32_32x32x16_bf16 v[176:191], a[28:31], a[156:159], v[176:191]
    ds_read_b64_tr_b16 a[148:149], v2 offset:25600
    ds_read_b64_tr_b16 a[150:151], v2 offset:26880
    v_max_f32 v211, 0, v49
    v_add_f32 v210, s62, v210
    v_add_f32 v211, s62, v211
    v_add_f32 v210, v210, v208
    s_waitcnt vmcnt(5)
    s_barrier
    s_waitcnt lgkmcnt(9)
    v_mfma_f32_32x32x16_bf16 v[112:127], a[32:35], a[160:163], v[112:127]
    ds_read_b64_tr_b16 a[152:153], v2 offset:25664
    ds_read_b64_tr_b16 a[154:155], v2 offset:26944
    v_add_f32 v211, v211, v209
    v_cvt_pk_bf16_f32 v216, v210, v211
    v_mul_f32 v212, s60, v50
    v_mul_f32 v213, s60, v51
    v_mfma_f32_32x32x16_bf16 v[128:143], a[32:35], a[164:167], v[128:143]
    ds_read_b64_tr_b16 a[156:157], v2 offset:25728
    ds_read_b64_tr_b16 a[158:159], v2 offset:27008
    s_add_u32 m0, s52, 40960
    s_mov_b32 s53, 1108224
    buffer_load_dwordx4 v5, s[36:39], s53 offen offset:0 lds
    s_waitcnt lgkmcnt(9)
    v_mfma_f32_32x32x16_bf16 v[144:159], a[32:35], a[168:171], v[144:159]
    ds_read_b64_tr_b16 a[160:161], v2 offset:25792
    ds_read_b64_tr_b16 a[162:163], v2 offset:27072
    v_exp_f32 v212, v212 clamp
    v_exp_f32 v213, v213 clamp
    v_max_f32 v214, 0, v50
    v_mfma_f32_32x32x16_bf16 v[160:175], a[32:35], a[172:175], v[160:175]
    ds_read_b64_tr_b16 a[164:165], v4 offset:25856
    ds_read_b64_tr_b16 a[166:167], v4 offset:27136
    v_max_f32 v215, 0, v51
    v_add_f32 v214, s62, v214
    v_add_f32 v215, s62, v215
    v_add_f32 v214, v214, v212
    s_waitcnt lgkmcnt(8)
    v_mfma_f32_32x32x16_bf16 v[176:191], a[32:35], a[144:147], v[176:191]
    ds_read_b64_tr_b16 a[168:169], v2 offset:30720
    ds_read_b64_tr_b16 a[170:171], v2 offset:32000
    buffer_load_dwordx4 v6, s[36:39], s53 offen offset:1024 lds
    v_add_f32 v215, v215, v213
    v_cvt_pk_bf16_f32 v217, v214, v215
    v_mul_f32 v208, s60, v52
    v_mfma_f32_32x32x16_bf16 v[112:127], a[36:39], a[148:151], v[112:127]
    ds_read_b64_tr_b16 a[172:173], v2 offset:30784
    ds_read_b64_tr_b16 a[174:175], v2 offset:32064
    v_mul_f32 v209, s60, v53
    v_exp_f32 v208, v208 clamp
    s_waitcnt lgkmcnt(8)
    v_mfma_f32_32x32x16_bf16 v[128:143], a[36:39], a[152:155], v[128:143]
    ds_read_b64_tr_b16 a[144:145], v2 offset:30848
    ds_read_b64_tr_b16 a[146:147], v2 offset:32128
    v_exp_f32 v209, v209 clamp
    v_max_f32 v210, 0, v52
    v_max_f32 v211, 0, v53
    v_add_f32 v210, s62, v210
    v_mfma_f32_32x32x16_bf16 v[144:159], a[36:39], a[156:159], v[144:159]
    ds_read_b64_tr_b16 a[148:149], v2 offset:30912
    ds_read_b64_tr_b16 a[150:151], v2 offset:32192
    v_add_f32 v211, s62, v211
    v_add_f32 v210, v210, v208
    v_add_f32 v211, v211, v209
    v_cvt_pk_bf16_f32 v218, v210, v211
    s_waitcnt lgkmcnt(8)
    v_mfma_f32_32x32x16_bf16 v[160:175], a[36:39], a[160:163], v[160:175]
    ds_read_b64_tr_b16 a[152:153], v4 offset:30976
    ds_read_b64_tr_b16 a[154:155], v4 offset:32256
    buffer_load_dwordx4 v7, s[36:39], s53 offen offset:2048 lds
    v_mul_f32 v212, s60, v54
    v_mul_f32 v213, s60, v55
    v_mfma_f32_32x32x16_bf16 v[176:191], a[36:39], a[164:167], v[176:191]
    ds_read_b64_tr_b16 a[156:157], v2 offset:35840
    ds_read_b64_tr_b16 a[158:159], v2 offset:37120
    v_exp_f32 v212, v212 clamp
    v_exp_f32 v213, v213 clamp
    s_waitcnt lgkmcnt(8)
    v_mfma_f32_32x32x16_bf16 v[112:127], a[40:43], a[168:171], v[112:127]
    ds_read_b64_tr_b16 a[160:161], v2 offset:35904
    ds_read_b64_tr_b16 a[162:163], v2 offset:37184
    v_max_f32 v214, 0, v54
    v_max_f32 v215, 0, v55
    v_add_f32 v214, s62, v214
    v_add_f32 v215, s62, v215
    v_add_f32 v214, v214, v212
    v_mfma_f32_32x32x16_bf16 v[128:143], a[40:43], a[172:175], v[128:143]
    ds_read_b64_tr_b16 a[164:165], v2 offset:35968
    ds_read_b64_tr_b16 a[166:167], v2 offset:37248
    buffer_load_dwordx4 v8, s[36:39], s53 offen offset:3072 lds
    v_add_f32 v215, v215, v213
    v_cvt_pk_bf16_f32 v219, v214, v215
    s_waitcnt lgkmcnt(8)
    v_mfma_f32_32x32x16_bf16 v[144:159], a[40:43], a[144:147], v[144:159]
    ds_read_b64_tr_b16 a[168:169], v2 offset:36032
    ds_read_b64_tr_b16 a[170:171], v2 offset:37312
    ds_write_b128 v18, v[216:219] offset:8192
    v_mul_f32 v208, s60, v56
    v_mul_f32 v209, s60, v57
    v_mfma_f32_32x32x16_bf16 v[160:175], a[40:43], a[148:151], v[160:175]
    ds_read_b64_tr_b16 a[172:173], v4 offset:36096
    ds_read_b64_tr_b16 a[174:175], v4 offset:37376
    v_exp_f32 v208, v208 clamp
    v_exp_f32 v209, v209 clamp
    s_waitcnt lgkmcnt(9)
    v_mfma_f32_32x32x16_bf16 v[176:191], a[40:43], a[152:155], v[176:191]
    ds_read_b64_tr_b16 a[144:145], v1 offset:0
    ds_read_b64_tr_b16 a[146:147], v1 offset:1280
    v_max_f32 v210, 0, v56
    v_max_f32 v211, 0, v57
    v_add_f32 v210, s62, v210
    v_add_f32 v211, s62, v211
    v_add_f32 v210, v210, v208
    v_mfma_f32_32x32x16_bf16 v[112:127], a[44:47], a[156:159], v[112:127]
    ds_read_b64_tr_b16 a[148:149], v1 offset:64
    ds_read_b64_tr_b16 a[150:151], v1 offset:1344
    s_add_u32 m0, s52, 45056
    s_nop 0
    buffer_load_dwordx4 v9, s[36:39], s53 offen offset:0 lds
    s_waitcnt lgkmcnt(9)
    v_mfma_f32_32x32x16_bf16 v[128:143], a[44:47], a[160:163], v[128:143]
    ds_read_b64_tr_b16 a[152:153], v1 offset:128
    ds_read_b64_tr_b16 a[154:155], v1 offset:1408
    v_add_f32 v211, v211, v209
    v_cvt_pk_bf16_f32 v220, v210, v211
    v_mul_f32 v212, s60, v58
    v_mul_f32 v213, s60, v59
    v_mfma_f32_32x32x16_bf16 v[144:159], a[44:47], a[164:167], v[144:159]
    ds_read_b64_tr_b16 a[156:157], v1 offset:192
    ds_read_b64_tr_b16 a[158:159], v1 offset:1472
    v_exp_f32 v212, v212 clamp
    v_exp_f32 v213, v213 clamp
    s_waitcnt lgkmcnt(8)
    v_mfma_f32_32x32x16_bf16 v[160:175], a[44:47], a[168:171], v[160:175]
    ds_read_b64_tr_b16 a[160:161], v3 offset:256
    ds_read_b64_tr_b16 a[162:163], v3 offset:1536
    v_max_f32 v214, 0, v58
    v_max_f32 v215, 0, v59
    v_add_f32 v214, s62, v214
    v_add_f32 v215, s62, v215
    v_add_f32 v214, v214, v212
    v_mfma_f32_32x32x16_bf16 v[176:191], a[44:47], a[172:175], v[176:191]
    ds_read_b64_tr_b16 a[164:165], v1 offset:5120
    ds_read_b64_tr_b16 a[166:167], v1 offset:6400
    v_add_f32 v215, v215, v213
    v_cvt_pk_bf16_f32 v221, v214, v215
    v_mul_f32 v208, s60, v60
    v_mul_f32 v209, s60, v61
    s_waitcnt vmcnt(5)
    s_barrier
    s_waitcnt lgkmcnt(8)
    v_mfma_f32_32x32x16_bf16 v[112:127], a[48:51], a[144:147], v[112:127]
    ds_read_b64_tr_b16 a[168:169], v1 offset:5184
    ds_read_b64_tr_b16 a[170:171], v1 offset:6464
    v_exp_f32 v208, v208 clamp
    v_exp_f32 v209, v209 clamp
    v_max_f32 v210, 0, v60
    v_mfma_f32_32x32x16_bf16 v[128:143], a[48:51], a[148:151], v[128:143]
    ds_read_b64_tr_b16 a[172:173], v1 offset:5248
    ds_read_b64_tr_b16 a[174:175], v1 offset:6528
    s_add_u32 m0, s52, 61440
    s_mov_b32 s53, 1329408
    buffer_load_dwordx4 v5, s[36:39], s53 offen offset:0 lds
    s_waitcnt lgkmcnt(8)
    v_mfma_f32_32x32x16_bf16 v[144:159], a[48:51], a[152:155], v[144:159]
    ds_read_b64_tr_b16 a[144:145], v1 offset:5312
    ds_read_b64_tr_b16 a[146:147], v1 offset:6592
    v_max_f32 v211, 0, v61
    v_add_f32 v210, s62, v210
    v_add_f32 v211, s62, v211
    v_add_f32 v210, v210, v208
    v_add_f32 v211, v211, v209
    v_mfma_f32_32x32x16_bf16 v[160:175], a[48:51], a[156:159], v[160:175]
    ds_read_b64_tr_b16 a[148:149], v3 offset:5376
    ds_read_b64_tr_b16 a[150:151], v3 offset:6656
    v_cvt_pk_bf16_f32 v222, v210, v211
    v_mul_f32 v212, s60, v62
    v_mul_f32 v213, s60, v63
    s_waitcnt lgkmcnt(8)
    v_mfma_f32_32x32x16_bf16 v[176:191], a[48:51], a[160:163], v[176:191]
    ds_read_b64_tr_b16 a[152:153], v1 offset:10240
    ds_read_b64_tr_b16 a[154:155], v1 offset:11520
    buffer_load_dwordx4 v6, s[36:39], s53 offen offset:1024 lds
    v_exp_f32 v212, v212 clamp
    v_mfma_f32_32x32x16_bf16 v[112:127], a[52:55], a[164:167], v[112:127]
    ds_read_b64_tr_b16 a[156:157], v1 offset:10304
    ds_read_b64_tr_b16 a[158:159], v1 offset:11584
    v_exp_f32 v213, v213 clamp
    v_max_f32 v214, 0, v62
    v_max_f32 v215, 0, v63
    s_waitcnt lgkmcnt(8)
    v_mfma_f32_32x32x16_bf16 v[128:143], a[52:55], a[168:171], v[128:143]
    ds_read_b64_tr_b16 a[160:161], v1 offset:10368
    ds_read_b64_tr_b16 a[162:163], v1 offset:11648
    v_add_f32 v214, s62, v214
    v_add_f32 v215, s62, v215
    v_add_f32 v214, v214, v212
    v_add_f32 v215, v215, v213
    v_cvt_pk_bf16_f32 v223, v214, v215
    v_mfma_f32_32x32x16_bf16 v[144:159], a[52:55], a[172:175], v[144:159]
    ds_read_b64_tr_b16 a[164:165], v1 offset:10432
    ds_read_b64_tr_b16 a[166:167], v1 offset:11712
    ds_write_b128 v18, v[220:223] offset:9216
    v_mul_f32 v208, s60, v64
    v_mul_f32 v209, s60, v65
    s_waitcnt lgkmcnt(9)
    v_mfma_f32_32x32x16_bf16 v[160:175], a[52:55], a[144:147], v[160:175]
    ds_read_b64_tr_b16 a[168:169], v3 offset:10496
    ds_read_b64_tr_b16 a[170:171], v3 offset:11776
    buffer_load_dwordx4 v7, s[36:39], s53 offen offset:2048 lds
    v_exp_f32 v208, v208 clamp
    v_mfma_f32_32x32x16_bf16 v[176:191], a[52:55], a[148:151], v[176:191]
    ds_read_b64_tr_b16 a[172:173], v1 offset:15360
    ds_read_b64_tr_b16 a[174:175], v1 offset:16640
    v_exp_f32 v209, v209 clamp
    v_max_f32 v210, 0, v64
    v_max_f32 v211, 0, v65
    s_waitcnt lgkmcnt(9)
    v_mfma_f32_32x32x16_bf16 v[112:127], a[56:59], a[152:155], v[112:127]
    ds_read_b64_tr_b16 a[144:145], v1 offset:15424
    ds_read_b64_tr_b16 a[146:147], v1 offset:16704
    v_add_f32 v210, s62, v210
    v_add_f32 v211, s62, v211
    v_add_f32 v210, v210, v208
    v_add_f32 v211, v211, v209
    v_cvt_pk_bf16_f32 v216, v210, v211
    v_mfma_f32_32x32x16_bf16 v[128:143], a[56:59], a[156:159], v[128:143]
    ds_read_b64_tr_b16 a[148:149], v1 offset:15488
    ds_read_b64_tr_b16 a[150:151], v1 offset:16768
    buffer_load_dwordx4 v8, s[36:39], s53 offen offset:3072 lds
    v_mul_f32 v212, s60, v66
    v_mul_f32 v213, s60, v67
    s_waitcnt lgkmcnt(9)
    v_mfma_f32_32x32x16_bf16 v[144:159], a[56:59], a[160:163], v[144:159]
    ds_read_b64_tr_b16 a[152:153], v1 offset:15552
    ds_read_b64_tr_b16 a[154:155], v1 offset:16832
    v_exp_f32 v212, v212 clamp
    v_exp_f32 v213, v213 clamp
    v_max_f32 v214, 0, v66
    v_mfma_f32_32x32x16_bf16 v[160:175], a[56:59], a[164:167], v[160:175]
    ds_read_b64_tr_b16 a[156:157], v3 offset:15616
    ds_read_b64_tr_b16 a[158:159], v3 offset:16896
    v_max_f32 v215, 0, v67
    v_add_f32 v214, s62, v214
    v_add_f32 v215, s62, v215
    v_add_f32 v214, v214, v212
    s_waitcnt lgkmcnt(8)
    v_mfma_f32_32x32x16_bf16 v[176:191], a[56:59], a[168:171], v[176:191]
    ds_read_b64_tr_b16 a[160:161], v1 offset:20480
    ds_read_b64_tr_b16 a[162:163], v1 offset:21760
    v_add_f32 v215, v215, v213
    v_cvt_pk_bf16_f32 v217, v214, v215
    v_mul_f32 v208, s60, v68
    v_mul_f32 v209, s60, v69
    v_mfma_f32_32x32x16_bf16 v[112:127], a[60:63], a[172:175], v[112:127]
    ds_read_b64_tr_b16 a[164:165], v1 offset:20544
    ds_read_b64_tr_b16 a[166:167], v1 offset:21824
    s_add_u32 m0, s52, 65536
    s_nop 0
    buffer_load_dwordx4 v9, s[36:39], s53 offen offset:0 lds
    s_waitcnt lgkmcnt(8)
    v_mfma_f32_32x32x16_bf16 v[128:143], a[60:63], a[144:147], v[128:143]
    ds_read_b64_tr_b16 a[168:169], v1 offset:20608
    ds_read_b64_tr_b16 a[170:171], v1 offset:21888
    v_exp_f32 v208, v208 clamp
    v_exp_f32 v209, v209 clamp
    v_max_f32 v210, 0, v68
    v_mfma_f32_32x32x16_bf16 v[144:159], a[60:63], a[148:151], v[144:159]
    ds_read_b64_tr_b16 a[172:173], v1 offset:20672
    ds_read_b64_tr_b16 a[174:175], v1 offset:21952
    v_max_f32 v211, 0, v69
    v_add_f32 v210, s62, v210
    v_add_f32 v211, s62, v211
    v_add_f32 v210, v210, v208
    s_waitcnt lgkmcnt(8)
    v_mfma_f32_32x32x16_bf16 v[160:175], a[60:63], a[152:155], v[160:175]
    ds_read_b64_tr_b16 a[144:145], v3 offset:20736
    ds_read_b64_tr_b16 a[146:147], v3 offset:22016
    v_add_f32 v211, v211, v209
    v_cvt_pk_bf16_f32 v218, v210, v211
    v_mul_f32 v212, s60, v70
    v_mul_f32 v213, s60, v71
    v_mfma_f32_32x32x16_bf16 v[176:191], a[60:63], a[156:159], v[176:191]
    ds_read_b64_tr_b16 a[148:149], v1 offset:25600
    ds_read_b64_tr_b16 a[150:151], v1 offset:26880
    v_exp_f32 v212, v212 clamp
    v_exp_f32 v213, v213 clamp
    s_waitcnt vmcnt(5)
    s_barrier
    s_waitcnt lgkmcnt(8)
    v_mfma_f32_32x32x16_bf16 v[112:127], a[64:67], a[160:163], v[112:127]
    ds_read_b64_tr_b16 a[152:153], v1 offset:25664
    ds_read_b64_tr_b16 a[154:155], v1 offset:26944
    v_max_f32 v214, 0, v70
    v_max_f32 v215, 0, v71
    v_add_f32 v214, s62, v214
    v_add_f32 v215, s62, v215
    v_add_f32 v214, v214, v212
    v_mfma_f32_32x32x16_bf16 v[128:143], a[64:67], a[164:167], v[128:143]
    ds_read_b64_tr_b16 a[156:157], v1 offset:25728
    ds_read_b64_tr_b16 a[158:159], v1 offset:27008
    s_add_u32 m0, s52, 0
    s_mov_b32 s53, 1550592
    buffer_load_dwordx4 v5, s[36:39], s53 offen offset:0 lds
    s_waitcnt lgkmcnt(8)
    v_mfma_f32_32x32x16_bf16 v[144:159], a[64:67], a[168:171], v[144:159]
    ds_read_b64_tr_b16 a[160:161], v1 offset:25792
    ds_read_b64_tr_b16 a[162:163], v1 offset:27072
    v_add_f32 v215, v215, v213
    v_cvt_pk_bf16_f32 v219, v214, v215
    ds_write_b128 v18, v[216:219] offset:16384
    v_mul_f32 v208, s60, v72
    v_mfma_f32_32x32x16_bf16 v[160:175], a[64:67], a[172:175], v[160:175]
    ds_read_b64_tr_b16 a[164:165], v3 offset:25856
    ds_read_b64_tr_b16 a[166:167], v3 offset:27136
    v_mul_f32 v209, s60, v73
    v_exp_f32 v208, v208 clamp
    s_waitcnt lgkmcnt(9)
    v_mfma_f32_32x32x16_bf16 v[176:191], a[64:67], a[144:147], v[176:191]
    ds_read_b64_tr_b16 a[168:169], v1 offset:30720
    ds_read_b64_tr_b16 a[170:171], v1 offset:32000
    buffer_load_dwordx4 v6, s[36:39], s53 offen offset:1024 lds
    v_exp_f32 v209, v209 clamp
    v_max_f32 v210, 0, v72
    v_mfma_f32_32x32x16_bf16 v[112:127], a[68:71], a[148:151], v[112:127]
    ds_read_b64_tr_b16 a[172:173], v1 offset:30784
    ds_read_b64_tr_b16 a[174:175], v1 offset:32064
    v_max_f32 v211, 0, v73
    v_add_f32 v210, s62, v210
    v_add_f32 v211, s62, v211
    v_add_f32 v210, v210, v208
    s_waitcnt lgkmcnt(9)
    v_mfma_f32_32x32x16_bf16 v[128:143], a[68:71], a[152:155], v[128:143]
    ds_read_b64_tr_b16 a[144:145], v1 offset:30848
    ds_read_b64_tr_b16 a[146:147], v1 offset:32128
    v_add_f32 v211, v211, v209
    v_cvt_pk_bf16_f32 v220, v210, v211
    v_mul_f32 v212, s60, v74
    v_mul_f32 v213, s60, v75
    v_mfma_f32_32x32x16_bf16 v[144:159], a[68:71], a[156:159], v[144:159]
    ds_read_b64_tr_b16 a[148:149], v1 offset:30912
    ds_read_b64_tr_b16 a[150:151], v1 offset:32192
    v_exp_f32 v212, v212 clamp
    v_exp_f32 v213, v213 clamp
    s_waitcnt lgkmcnt(8)
    v_mfma_f32_32x32x16_bf16 v[160:175], a[68:71], a[160:163], v[160:175]
    ds_read_b64_tr_b16 a[152:153], v3 offset:30976
    ds_read_b64_tr_b16 a[154:155], v3 offset:32256
    buffer_load_dwordx4 v7, s[36:39], s53 offen offset:2048 lds
    v_max_f32 v214, 0, v74
    v_max_f32 v215, 0, v75
    v_add_f32 v214, s62, v214
    v_mfma_f32_32x32x16_bf16 v[176:191], a[68:71], a[164:167], v[176:191]
    ds_read_b64_tr_b16 a[156:157], v1 offset:35840
    ds_read_b64_tr_b16 a[158:159], v1 offset:37120
    v_add_f32 v215, s62, v215
    v_add_f32 v214, v214, v212
    v_add_f32 v215, v215, v213
    v_cvt_pk_bf16_f32 v221, v214, v215
    s_waitcnt lgkmcnt(8)
    v_mfma_f32_32x32x16_bf16 v[112:127], a[72:75], a[168:171], v[112:127]
    ds_read_b64_tr_b16 a[160:161], v1 offset:35904
    ds_read_b64_tr_b16 a[162:163], v1 offset:37184
    v_mul_f32 v208, s60, v76
    v_mul_f32 v209, s60, v77
    v_exp_f32 v208, v208 clamp
    v_mfma_f32_32x32x16_bf16 v[128:143], a[72:75], a[172:175], v[128:143]
    ds_read_b64_tr_b16 a[164:165], v1 offset:35968
    ds_read_b64_tr_b16 a[166:167], v1 offset:37248
    buffer_load_dwordx4 v8, s[36:39], s53 offen offset:3072 lds
    v_exp_f32 v209, v209 clamp
    s_waitcnt lgkmcnt(8)
    v_mfma_f32_32x32x16_bf16 v[144:159], a[72:75], a[144:147], v[144:159]
    ds_read_b64_tr_b16 a[168:169], v1 offset:36032
    ds_read_b64_tr_b16 a[170:171], v1 offset:37312
    v_max_f32 v210, 0, v76
    v_max_f32 v211, 0, v77
    v_add_f32 v210, s62, v210
    v_add_f32 v211, s62, v211
    v_add_f32 v210, v210, v208
    v_mfma_f32_32x32x16_bf16 v[160:175], a[72:75], a[148:151], v[160:175]
    ds_read_b64_tr_b16 a[172:173], v3 offset:36096
    ds_read_b64_tr_b16 a[174:175], v3 offset:37376
    v_add_f32 v211, v211, v209
    v_cvt_pk_bf16_f32 v222, v210, v211
    v_mul_f32 v212, s60, v78
    v_mul_f32 v213, s60, v79
    s_waitcnt lgkmcnt(8)
    v_mfma_f32_32x32x16_bf16 v[176:191], a[72:75], a[152:155], v[176:191]
    ds_read_b64_tr_b16 a[144:145], v2 offset:0
    ds_read_b64_tr_b16 a[146:147], v2 offset:1280
    v_exp_f32 v212, v212 clamp
    v_exp_f32 v213, v213 clamp
    v_max_f32 v214, 0, v78
    v_mfma_f32_32x32x16_bf16 v[112:127], a[76:79], a[156:159], v[112:127]
    ds_read_b64_tr_b16 a[148:149], v2 offset:64
    ds_read_b64_tr_b16 a[150:151], v2 offset:1344
    s_add_u32 m0, s52, 4096
    s_nop 0
    buffer_load_dwordx4 v9, s[36:39], s53 offen offset:0 lds
    s_waitcnt lgkmcnt(8)
    v_mfma_f32_32x32x16_bf16 v[128:143], a[76:79], a[160:163], v[128:143]
    ds_read_b64_tr_b16 a[152:153], v2 offset:128
    ds_read_b64_tr_b16 a[154:155], v2 offset:1408
    v_max_f32 v215, 0, v79
    v_add_f32 v214, s62, v214
    v_add_f32 v215, s62, v215
    v_add_f32 v214, v214, v212
    v_add_f32 v215, v215, v213
    v_mfma_f32_32x32x16_bf16 v[144:159], a[76:79], a[164:167], v[144:159]
    ds_read_b64_tr_b16 a[156:157], v2 offset:192
    ds_read_b64_tr_b16 a[158:159], v2 offset:1472
    v_cvt_pk_bf16_f32 v223, v214, v215
    ds_write_b128 v18, v[220:223] offset:17408
    v_mul_f32 v208, s60, v80
    s_waitcnt lgkmcnt(9)
    v_mfma_f32_32x32x16_bf16 v[160:175], a[76:79], a[168:171], v[160:175]
    ds_read_b64_tr_b16 a[160:161], v4 offset:256
    ds_read_b64_tr_b16 a[162:163], v4 offset:1536
    v_mul_f32 v209, s60, v81
    v_exp_f32 v208, v208 clamp
    v_exp_f32 v209, v209 clamp
    v_mfma_f32_32x32x16_bf16 v[176:191], a[76:79], a[172:175], v[176:191]
    ds_read_b64_tr_b16 a[164:165], v2 offset:5120
    ds_read_b64_tr_b16 a[166:167], v2 offset:6400
    v_max_f32 v210, 0, v80
    v_max_f32 v211, 0, v81
    v_add_f32 v210, s62, v210
    v_add_f32 v211, s62, v211
    s_waitcnt vmcnt(5)
    s_barrier
    v_mov_b32 v30, 64
    global_load_dword v31, v30, s[12:13] sc1
    s_waitcnt lgkmcnt(9)
    v_mfma_f32_32x32x16_bf16 v[112:127], a[80:83], a[144:147], v[112:127]
    ds_read_b64_tr_b16 a[168:169], v2 offset:5184
    ds_read_b64_tr_b16 a[170:171], v2 offset:6464
    v_add_f32 v210, v210, v208
    v_add_f32 v211, v211, v209
    v_cvt_pk_bf16_f32 v216, v210, v211
    v_mul_f32 v212, s60, v82
    v_mul_f32 v213, s60, v83
    v_mfma_f32_32x32x16_bf16 v[128:143], a[80:83], a[148:151], v[128:143]
    ds_read_b64_tr_b16 a[172:173], v2 offset:5248
    ds_read_b64_tr_b16 a[174:175], v2 offset:6528
    s_add_u32 m0, s52, 20480
    s_mov_b32 s53, 1771776
    buffer_load_dwordx4 v5, s[36:39], s53 offen offset:0 lds
    s_waitcnt lgkmcnt(9)
    v_mfma_f32_32x32x16_bf16 v[144:159], a[80:83], a[152:155], v[144:159]
    ds_read_b64_tr_b16 a[144:145], v2 offset:5312
    ds_read_b64_tr_b16 a[146:147], v2 offset:6592
    v_exp_f32 v212, v212 clamp
    v_exp_f32 v213, v213 clamp
    v_max_f32 v214, 0, v82
    v_mfma_f32_32x32x16_bf16 v[160:175], a[80:83], a[156:159], v[160:175]
    ds_read_b64_tr_b16 a[148:149], v4 offset:5376
    ds_read_b64_tr_b16 a[150:151], v4 offset:6656
    v_max_f32 v215, 0, v83
    v_add_f32 v214, s62, v214
    v_add_f32 v215, s62, v215
    v_add_f32 v214, v214, v212
    s_waitcnt lgkmcnt(8)
    v_mfma_f32_32x32x16_bf16 v[176:191], a[80:83], a[160:163], v[176:191]
    ds_read_b64_tr_b16 a[152:153], v2 offset:10240
    ds_read_b64_tr_b16 a[154:155], v2 offset:11520
    buffer_load_dwordx4 v6, s[36:39], s53 offen offset:1024 lds
    v_add_f32 v215, v215, v213
    v_cvt_pk_bf16_f32 v217, v214, v215
    v_mul_f32 v208, s60, v84
    v_mfma_f32_32x32x16_bf16 v[112:127], a[84:87], a[164:167], v[112:127]
    ds_read_b64_tr_b16 a[156:157], v2 offset:10304
    ds_read_b64_tr_b16 a[158:159], v2 offset:11584
    v_mul_f32 v209, s60, v85
    v_exp_f32 v208, v208 clamp
    s_waitcnt lgkmcnt(8)
    v_mfma_f32_32x32x16_bf16 v[128:143], a[84:87], a[168:171], v[128:143]
    ds_read_b64_tr_b16 a[160:161], v2 offset:10368
    ds_read_b64_tr_b16 a[162:163], v2 offset:11648
    v_exp_f32 v209, v209 clamp
    v_max_f32 v210, 0, v84
    v_max_f32 v211, 0, v85
    v_add_f32 v210, s62, v210
    v_mfma_f32_32x32x16_bf16 v[144:159], a[84:87], a[172:175], v[144:159]
    ds_read_b64_tr_b16 a[164:165], v2 offset:10432
    ds_read_b64_tr_b16 a[166:167], v2 offset:11712
    v_add_f32 v211, s62, v211
    v_add_f32 v210, v210, v208
    v_add_f32 v211, v211, v209
    v_cvt_pk_bf16_f32 v218, v210, v211
    s_waitcnt lgkmcnt(8)
    v_mfma_f32_32x32x16_bf16 v[160:175], a[84:87], a[144:147], v[160:175]
    ds_read_b64_tr_b16 a[168:169], v4 offset:10496
    ds_read_b64_tr_b16 a[170:171], v4 offset:11776
    buffer_load_dwordx4 v7, s[36:39], s53 offen offset:2048 lds
    v_mul_f32 v212, s60, v86
    v_mul_f32 v213, s60, v87
    v_mfma_f32_32x32x16_bf16 v[176:191], a[84:87], a[148:151], v[176:191]
    ds_read_b64_tr_b16 a[172:173], v2 offset:15360
    ds_read_b64_tr_b16 a[174:175], v2 offset:16640
    v_exp_f32 v212, v212 clamp
    v_exp_f32 v213, v213 clamp
    s_waitcnt lgkmcnt(8)
    v_mfma_f32_32x32x16_bf16 v[112:127], a[88:91], a[152:155], v[112:127]
    ds_read_b64_tr_b16 a[144:145], v2 offset:15424
    ds_read_b64_tr_b16 a[146:147], v2 offset:16704
    v_max_f32 v214, 0, v86
    v_max_f32 v215, 0, v87
    v_add_f32 v214, s62, v214
    v_add_f32 v215, s62, v215
    v_add_f32 v214, v214, v212
    v_mfma_f32_32x32x16_bf16 v[128:143], a[88:91], a[156:159], v[128:143]
    ds_read_b64_tr_b16 a[148:149], v2 offset:15488
    ds_read_b64_tr_b16 a[150:151], v2 offset:16768
    buffer_load_dwordx4 v8, s[36:39], s53 offen offset:3072 lds
    v_add_f32 v215, v215, v213
    v_cvt_pk_bf16_f32 v219, v214, v215
    s_waitcnt lgkmcnt(8)
    v_mfma_f32_32x32x16_bf16 v[144:159], a[88:91], a[160:163], v[144:159]
    ds_read_b64_tr_b16 a[152:153], v2 offset:15552
    ds_read_b64_tr_b16 a[154:155], v2 offset:16832
    ds_write_b128 v18, v[216:219] offset:24576
    v_mul_f32 v208, s60, v88
    v_mul_f32 v209, s60, v89
    v_mfma_f32_32x32x16_bf16 v[160:175], a[88:91], a[164:167], v[160:175]
    ds_read_b64_tr_b16 a[156:157], v4 offset:15616
    ds_read_b64_tr_b16 a[158:159], v4 offset:16896
    v_exp_f32 v208, v208 clamp
    v_exp_f32 v209, v209 clamp
    s_waitcnt lgkmcnt(9)
    v_mfma_f32_32x32x16_bf16 v[176:191], a[88:91], a[168:171], v[176:191]
    ds_read_b64_tr_b16 a[160:161], v2 offset:20480
    ds_read_b64_tr_b16 a[162:163], v2 offset:21760
    v_max_f32 v210, 0, v88
    v_max_f32 v211, 0, v89
    v_add_f32 v210, s62, v210
    v_add_f32 v211, s62, v211
    v_add_f32 v210, v210, v208
    v_mfma_f32_32x32x16_bf16 v[112:127], a[92:95], a[172:175], v[112:127]
    ds_read_b64_tr_b16 a[164:165], v2 offset:20544
    ds_read_b64_tr_b16 a[166:167], v2 offset:21824
    s_add_u32 m0, s52, 24576
    s_nop 0
    buffer_load_dwordx4 v9, s[36:39], s53 offen offset:0 lds
    s_waitcnt lgkmcnt(9)
    v_mfma_f32_32x32x16_bf16 v[128:143], a[92:95], a[144:147], v[128:143]
    ds_read_b64_tr_b16 a[168:169], v2 offset:20608
    ds_read_b64_tr_b16 a[170:171], v2 offset:21888
    v_add_f32 v211, v211, v209
    v_cvt_pk_bf16_f32 v220, v210, v211
    v_mul_f32 v212, s60, v90
    v_mul_f32 v213, s60, v91
    v_mfma_f32_32x32x16_bf16 v[144:159], a[92:95], a[148:151], v[144:159]
    ds_read_b64_tr_b16 a[172:173], v2 offset:20672
    ds_read_b64_tr_b16 a[174:175], v2 offset:21952
    v_exp_f32 v212, v212 clamp
    v_exp_f32 v213, v213 clamp
    s_waitcnt lgkmcnt(8)
    v_mfma_f32_32x32x16_bf16 v[160:175], a[92:95], a[152:155], v[160:175]
    ds_read_b64_tr_b16 a[144:145], v4 offset:20736
    ds_read_b64_tr_b16 a[146:147], v4 offset:22016
    v_max_f32 v214, 0, v90
    v_max_f32 v215, 0, v91
    v_add_f32 v214, s62, v214
    v_add_f32 v215, s62, v215
    v_add_f32 v214, v214, v212
    v_mfma_f32_32x32x16_bf16 v[176:191], a[92:95], a[156:159], v[176:191]
    ds_read_b64_tr_b16 a[148:149], v2 offset:25600
    ds_read_b64_tr_b16 a[150:151], v2 offset:26880
    v_add_f32 v215, v215, v213
    v_cvt_pk_bf16_f32 v221, v214, v215
    v_mul_f32 v208, s60, v92
    v_mul_f32 v209, s60, v93
    s_waitcnt vmcnt(6)
    s_barrier
    s_waitcnt lgkmcnt(8)
    v_mfma_f32_32x32x16_bf16 v[112:127], a[96:99], a[160:163], v[112:127]
    ds_read_b64_tr_b16 a[152:153], v2 offset:25664
    ds_read_b64_tr_b16 a[154:155], v2 offset:26944
    v_exp_f32 v208, v208 clamp
    v_exp_f32 v209, v209 clamp
    v_max_f32 v210, 0, v92
    v_mfma_f32_32x32x16_bf16 v[128:143], a[96:99], a[164:167], v[128:143]
    ds_read_b64_tr_b16 a[156:157], v2 offset:25728
    ds_read_b64_tr_b16 a[158:159], v2 offset:27008
    s_add_u32 m0, s52, 40960
    s_mov_b32 s53, 0
    buffer_load_dwordx4 v5, s[36:39], s53 offen offset:0 lds
    s_waitcnt lgkmcnt(8)
    v_mfma_f32_32x32x16_bf16 v[144:159], a[96:99], a[168:171], v[144:159]
    ds_read_b64_tr_b16 a[160:161], v2 offset:25792
    ds_read_b64_tr_b16 a[162:163], v2 offset:27072
    v_max_f32 v211, 0, v93
    v_add_f32 v210, s62, v210
    v_add_f32 v211, s62, v211
    v_add_f32 v210, v210, v208
    v_add_f32 v211, v211, v209
    v_mfma_f32_32x32x16_bf16 v[160:175], a[96:99], a[172:175], v[160:175]
    ds_read_b64_tr_b16 a[164:165], v4 offset:25856
    ds_read_b64_tr_b16 a[166:167], v4 offset:27136
    v_cvt_pk_bf16_f32 v222, v210, v211
    v_mul_f32 v212, s60, v94
    v_mul_f32 v213, s60, v95
    s_waitcnt lgkmcnt(8)
    v_mfma_f32_32x32x16_bf16 v[176:191], a[96:99], a[144:147], v[176:191]
    ds_read_b64_tr_b16 a[168:169], v2 offset:30720
    ds_read_b64_tr_b16 a[170:171], v2 offset:32000
    buffer_load_dwordx4 v6, s[36:39], s53 offen offset:1024 lds
    v_exp_f32 v212, v212 clamp
    v_mfma_f32_32x32x16_bf16 v[112:127], a[100:103], a[148:151], v[112:127]
    ds_read_b64_tr_b16 a[172:173], v2 offset:30784
    ds_read_b64_tr_b16 a[174:175], v2 offset:32064
    v_exp_f32 v213, v213 clamp
    v_max_f32 v214, 0, v94
    v_max_f32 v215, 0, v95
    s_waitcnt lgkmcnt(8)
    v_mfma_f32_32x32x16_bf16 v[128:143], a[100:103], a[152:155], v[128:143]
    ds_read_b64_tr_b16 a[144:145], v2 offset:30848
    ds_read_b64_tr_b16 a[146:147], v2 offset:32128
    v_add_f32 v214, s62, v214
    v_add_f32 v215, s62, v215
    v_add_f32 v214, v214, v212
    v_add_f32 v215, v215, v213
    v_cvt_pk_bf16_f32 v223, v214, v215
    v_mfma_f32_32x32x16_bf16 v[144:159], a[100:103], a[156:159], v[144:159]
    ds_read_b64_tr_b16 a[148:149], v2 offset:30912
    ds_read_b64_tr_b16 a[150:151], v2 offset:32192
    ds_write_b128 v18, v[220:223] offset:25600
    v_mul_f32 v208, s60, v96
    v_mul_f32 v209, s60, v97
    s_waitcnt lgkmcnt(9)
    v_mfma_f32_32x32x16_bf16 v[160:175], a[100:103], a[160:163], v[160:175]
    ds_read_b64_tr_b16 a[152:153], v4 offset:30976
    ds_read_b64_tr_b16 a[154:155], v4 offset:32256
    buffer_load_dwordx4 v7, s[36:39], s53 offen offset:2048 lds
    v_exp_f32 v208, v208 clamp
    v_mfma_f32_32x32x16_bf16 v[176:191], a[100:103], a[164:167], v[176:191]
    ds_read_b64_tr_b16 a[156:157], v2 offset:35840
    ds_read_b64_tr_b16 a[158:159], v2 offset:37120
    v_exp_f32 v209, v209 clamp
    v_max_f32 v210, 0, v96
    v_max_f32 v211, 0, v97
    s_waitcnt lgkmcnt(9)
    v_mfma_f32_32x32x16_bf16 v[112:127], a[104:107], a[168:171], v[112:127]
    ds_read_b64_tr_b16 a[160:161], v2 offset:35904
    ds_read_b64_tr_b16 a[162:163], v2 offset:37184
    v_add_f32 v210, s62, v210
    v_add_f32 v211, s62, v211
    v_add_f32 v210, v210, v208
    v_add_f32 v211, v211, v209
    v_cvt_pk_bf16_f32 v216, v210, v211
    v_mfma_f32_32x32x16_bf16 v[128:143], a[104:107], a[172:175], v[128:143]
    ds_read_b64_tr_b16 a[164:165], v2 offset:35968
    ds_read_b64_tr_b16 a[166:167], v2 offset:37248
    buffer_load_dwordx4 v8, s[36:39], s53 offen offset:3072 lds
    v_mul_f32 v212, s60, v98
    v_mul_f32 v213, s60, v99
    s_waitcnt lgkmcnt(9)
    v_mfma_f32_32x32x16_bf16 v[144:159], a[104:107], a[144:147], v[144:159]
    ds_read_b64_tr_b16 a[168:169], v2 offset:36032
    ds_read_b64_tr_b16 a[170:171], v2 offset:37312
    v_exp_f32 v212, v212 clamp
    v_exp_f32 v213, v213 clamp
    v_max_f32 v214, 0, v98
    v_mfma_f32_32x32x16_bf16 v[160:175], a[104:107], a[148:151], v[160:175]
    ds_read_b64_tr_b16 a[172:173], v4 offset:36096
    ds_read_b64_tr_b16 a[174:175], v4 offset:37376
    v_max_f32 v215, 0, v99
    v_add_f32 v214, s62, v214
    v_add_f32 v215, s62, v215
    v_add_f32 v214, v214, v212
    s_waitcnt lgkmcnt(8)
    v_mfma_f32_32x32x16_bf16 v[176:191], a[104:107], a[152:155], v[176:191]
    ds_read_b64_tr_b16 a[144:145], v1 offset:0
    ds_read_b64_tr_b16 a[146:147], v1 offset:1280
    v_add_f32 v215, v215, v213
    v_cvt_pk_bf16_f32 v217, v214, v215
    v_mul_f32 v208, s60, v100
    v_mul_f32 v209, s60, v101
    v_mfma_f32_32x32x16_bf16 v[112:127], a[108:111], a[156:159], v[112:127]
    ds_read_b64_tr_b16 a[148:149], v1 offset:64
    ds_read_b64_tr_b16 a[150:151], v1 offset:1344
    s_add_u32 m0, s52, 45056
    s_nop 0
    buffer_load_dwordx4 v9, s[36:39], s53 offen offset:0 lds
    s_waitcnt lgkmcnt(8)
    v_mfma_f32_32x32x16_bf16 v[128:143], a[108:111], a[160:163], v[128:143]
    ds_read_b64_tr_b16 a[152:153], v1 offset:128
    ds_read_b64_tr_b16 a[154:155], v1 offset:1408
    v_exp_f32 v208, v208 clamp
    v_exp_f32 v209, v209 clamp
    v_max_f32 v210, 0, v100
    v_mfma_f32_32x32x16_bf16 v[144:159], a[108:111], a[164:167], v[144:159]
    ds_read_b64_tr_b16 a[156:157], v1 offset:192
    ds_read_b64_tr_b16 a[158:159], v1 offset:1472
    v_max_f32 v211, 0, v101
    v_add_f32 v210, s62, v210
    v_add_f32 v211, s62, v211
    v_add_f32 v210, v210, v208
    s_waitcnt lgkmcnt(8)
    v_mfma_f32_32x32x16_bf16 v[160:175], a[108:111], a[168:171], v[160:175]
    ds_read_b64_tr_b16 a[160:161], v3 offset:256
    ds_read_b64_tr_b16 a[162:163], v3 offset:1536
    v_add_f32 v211, v211, v209
    v_cvt_pk_bf16_f32 v218, v210, v211
    v_mul_f32 v212, s60, v102
    v_mul_f32 v213, s60, v103
    v_mfma_f32_32x32x16_bf16 v[176:191], a[108:111], a[172:175], v[176:191]
    ds_read_b64_tr_b16 a[164:165], v1 offset:5120
    ds_read_b64_tr_b16 a[166:167], v1 offset:6400
    v_exp_f32 v212, v212 clamp
    v_exp_f32 v213, v213 clamp
    s_waitcnt vmcnt(5)
    s_barrier
    s_waitcnt lgkmcnt(8)
    v_mfma_f32_32x32x16_bf16 v[112:127], a[112:115], a[144:147], v[112:127]
    ds_read_b64_tr_b16 a[168:169], v1 offset:5184
    ds_read_b64_tr_b16 a[170:171], v1 offset:6464
    v_max_f32 v214, 0, v102
    v_max_f32 v215, 0, v103
    v_add_f32 v214, s62, v214
    v_add_f32 v215, s62, v215
    v_add_f32 v214, v214, v212
    v_mfma_f32_32x32x16_bf16 v[128:143], a[112:115], a[148:151], v[128:143]
    ds_read_b64_tr_b16 a[172:173], v1 offset:5248
    ds_read_b64_tr_b16 a[174:175], v1 offset:6528
    s_add_u32 m0, s52, 61440
    s_mov_b32 s53, 221184
    buffer_load_dwordx4 v5, s[36:39], s53 offen offset:0 lds
    s_waitcnt lgkmcnt(8)
    v_mfma_f32_32x32x16_bf16 v[144:159], a[112:115], a[152:155], v[144:159]
    ds_read_b64_tr_b16 a[144:145], v1 offset:5312
    ds_read_b64_tr_b16 a[146:147], v1 offset:6592
    v_add_f32 v215, v215, v213
    v_cvt_pk_bf16_f32 v219, v214, v215
    ds_write_b128 v18, v[216:219] offset:32768
    v_mul_f32 v208, s60, v104
    v_mfma_f32_32x32x16_bf16 v[160:175], a[112:115], a[156:159], v[160:175]
    ds_read_b64_tr_b16 a[148:149], v3 offset:5376
    ds_read_b64_tr_b16 a[150:151], v3 offset:6656
    v_mul_f32 v209, s60, v105
    v_exp_f32 v208, v208 clamp
    s_waitcnt lgkmcnt(9)
    v_mfma_f32_32x32x16_bf16 v[176:191], a[112:115], a[160:163], v[176:191]
    ds_read_b64_tr_b16 a[152:153], v1 offset:10240
    ds_read_b64_tr_b16 a[154:155], v1 offset:11520
    buffer_load_dwordx4 v6, s[36:39], s53 offen offset:1024 lds
    v_exp_f32 v209, v209 clamp
    v_max_f32 v210, 0, v104
    v_mfma_f32_32x32x16_bf16 v[112:127], a[116:119], a[164:167], v[112:127]
    ds_read_b64_tr_b16 a[156:157], v1 offset:10304
    ds_read_b64_tr_b16 a[158:159], v1 offset:11584
    v_max_f32 v211, 0, v105
    v_add_f32 v210, s62, v210
    v_add_f32 v211, s62, v211
    v_add_f32 v210, v210, v208
    s_waitcnt lgkmcnt(9)
    v_mfma_f32_32x32x16_bf16 v[128:143], a[116:119], a[168:171], v[128:143]
    ds_read_b64_tr_b16 a[160:161], v1 offset:10368
    ds_read_b64_tr_b16 a[162:163], v1 offset:11648
    v_add_f32 v211, v211, v209
    v_cvt_pk_bf16_f32 v220, v210, v211
    v_mul_f32 v212, s60, v106
    v_mul_f32 v213, s60, v107
    v_mfma_f32_32x32x16_bf16 v[144:159], a[116:119], a[172:175], v[144:159]
    ds_read_b64_tr_b16 a[164:165], v1 offset:10432
    ds_read_b64_tr_b16 a[166:167], v1 offset:11712
    v_exp_f32 v212, v212 clamp
    v_exp_f32 v213, v213 clamp
    s_waitcnt lgkmcnt(8)
    v_mfma_f32_32x32x16_bf16 v[160:175], a[116:119], a[144:147], v[160:175]
    ds_read_b64_tr_b16 a[168:169], v3 offset:10496
    ds_read_b64_tr_b16 a[170:171], v3 offset:11776
    buffer_load_dwordx4 v7, s[36:39], s53 offen offset:2048 lds
    v_max_f32 v214, 0, v106
    v_max_f32 v215, 0, v107
    v_add_f32 v214, s62, v214
    v_mfma_f32_32x32x16_bf16 v[176:191], a[116:119], a[148:151], v[176:191]
    ds_read_b64_tr_b16 a[172:173], v1 offset:15360
    ds_read_b64_tr_b16 a[174:175], v1 offset:16640
    v_add_f32 v215, s62, v215
    v_add_f32 v214, v214, v212
    v_add_f32 v215, v215, v213
    v_cvt_pk_bf16_f32 v221, v214, v215
    s_waitcnt lgkmcnt(8)
    v_mfma_f32_32x32x16_bf16 v[112:127], a[120:123], a[152:155], v[112:127]
    ds_read_b64_tr_b16 a[144:145], v1 offset:15424
    ds_read_b64_tr_b16 a[146:147], v1 offset:16704
    v_mul_f32 v208, s60, v108
    v_mul_f32 v209, s60, v109
    v_exp_f32 v208, v208 clamp
    v_mfma_f32_32x32x16_bf16 v[128:143], a[120:123], a[156:159], v[128:143]
    ds_read_b64_tr_b16 a[148:149], v1 offset:15488
    ds_read_b64_tr_b16 a[150:151], v1 offset:16768
    buffer_load_dwordx4 v8, s[36:39], s53 offen offset:3072 lds
    v_exp_f32 v209, v209 clamp
    s_waitcnt lgkmcnt(8)
    v_mfma_f32_32x32x16_bf16 v[144:159], a[120:123], a[160:163], v[144:159]
    ds_read_b64_tr_b16 a[152:153], v1 offset:15552
    ds_read_b64_tr_b16 a[154:155], v1 offset:16832
    v_max_f32 v210, 0, v108
    v_max_f32 v211, 0, v109
    v_add_f32 v210, s62, v210
    v_add_f32 v211, s62, v211
    v_add_f32 v210, v210, v208
    v_mfma_f32_32x32x16_bf16 v[160:175], a[120:123], a[164:167], v[160:175]
    ds_read_b64_tr_b16 a[156:157], v3 offset:15616
    ds_read_b64_tr_b16 a[158:159], v3 offset:16896
    v_add_f32 v211, v211, v209
    v_cvt_pk_bf16_f32 v222, v210, v211
    v_mul_f32 v212, s60, v110
    v_mul_f32 v213, s60, v111
    s_waitcnt lgkmcnt(8)
    v_mfma_f32_32x32x16_bf16 v[176:191], a[120:123], a[168:171], v[176:191]
    ds_read_b64_tr_b16 a[160:161], v1 offset:20480
    ds_read_b64_tr_b16 a[162:163], v1 offset:21760
    v_exp_f32 v212, v212 clamp
    v_exp_f32 v213, v213 clamp
    v_max_f32 v214, 0, v110
    v_mfma_f32_32x32x16_bf16 v[112:127], a[124:127], a[172:175], v[112:127]
    ds_read_b64_tr_b16 a[164:165], v1 offset:20544
    ds_read_b64_tr_b16 a[166:167], v1 offset:21824
    s_add_u32 m0, s52, 65536
    s_nop 0
    buffer_load_dwordx4 v9, s[36:39], s53 offen offset:0 lds
    s_waitcnt lgkmcnt(8)
    v_mfma_f32_32x32x16_bf16 v[128:143], a[124:127], a[144:147], v[128:143]
    ds_read_b64_tr_b16 a[168:169], v1 offset:20608
    ds_read_b64_tr_b16 a[170:171], v1 offset:21888
    v_max_f32 v215, 0, v111
    v_add_f32 v214, s62, v214
    v_add_f32 v215, s62, v215
    v_add_f32 v214, v214, v212
    v_add_f32 v215, v215, v213
    v_mfma_f32_32x32x16_bf16 v[144:159], a[124:127], a[148:151], v[144:159]
    ds_read_b64_tr_b16 a[172:173], v1 offset:20672
    ds_read_b64_tr_b16 a[174:175], v1 offset:21952
    v_cvt_pk_bf16_f32 v223, v214, v215
    ds_write_b128 v18, v[220:223] offset:33792
    s_waitcnt lgkmcnt(9)
    v_mfma_f32_32x32x16_bf16 v[160:175], a[124:127], a[152:155], v[160:175]
    ds_read_b64_tr_b16 a[144:145], v3 offset:20736
    ds_read_b64_tr_b16 a[146:147], v3 offset:22016
    v_mfma_f32_32x32x16_bf16 v[176:191], a[124:127], a[156:159], v[176:191]
    ds_read_b64_tr_b16 a[148:149], v1 offset:25600
    ds_read_b64_tr_b16 a[150:151], v1 offset:26880
    s_waitcnt vmcnt(5)
    s_barrier
    s_waitcnt lgkmcnt(9)
    v_mfma_f32_32x32x16_bf16 v[112:127], a[128:131], a[160:163], v[112:127]
    ds_read_b64_tr_b16 a[152:153], v1 offset:25664
    ds_read_b64_tr_b16 a[154:155], v1 offset:26944
    v_mfma_f32_32x32x16_bf16 v[128:143], a[128:131], a[164:167], v[128:143]
    ds_read_b64_tr_b16 a[156:157], v1 offset:25728
    ds_read_b64_tr_b16 a[158:159], v1 offset:27008
    s_add_u32 m0, s52, 0
    s_mov_b32 s53, 442368
    buffer_load_dwordx4 v5, s[36:39], s53 offen offset:0 lds
    s_waitcnt lgkmcnt(9)
    v_mfma_f32_32x32x16_bf16 v[144:159], a[128:131], a[168:171], v[144:159]
    ds_read_b64_tr_b16 a[160:161], v1 offset:25792
    ds_read_b64_tr_b16 a[162:163], v1 offset:27072
    v_mfma_f32_32x32x16_bf16 v[160:175], a[128:131], a[172:175], v[160:175]
    ds_read_b64_tr_b16 a[164:165], v3 offset:25856
    ds_read_b64_tr_b16 a[166:167], v3 offset:27136
    s_waitcnt lgkmcnt(8)
    v_mfma_f32_32x32x16_bf16 v[176:191], a[128:131], a[144:147], v[176:191]
    ds_read_b64_tr_b16 a[168:169], v1 offset:30720
    ds_read_b64_tr_b16 a[170:171], v1 offset:32000
    buffer_load_dwordx4 v6, s[36:39], s53 offen offset:1024 lds
    v_mfma_f32_32x32x16_bf16 v[112:127], a[132:135], a[148:151], v[112:127]
    ds_read_b64_tr_b16 a[172:173], v1 offset:30784
    ds_read_b64_tr_b16 a[174:175], v1 offset:32064
    s_waitcnt lgkmcnt(8)
    v_mfma_f32_32x32x16_bf16 v[128:143], a[132:135], a[152:155], v[128:143]
    ds_read_b64_tr_b16 a[144:145], v1 offset:30848
    ds_read_b64_tr_b16 a[146:147], v1 offset:32128
    v_mfma_f32_32x32x16_bf16 v[144:159], a[132:135], a[156:159], v[144:159]
    ds_read_b64_tr_b16 a[148:149], v1 offset:30912
    ds_read_b64_tr_b16 a[150:151], v1 offset:32192
    s_waitcnt lgkmcnt(8)
    v_mfma_f32_32x32x16_bf16 v[160:175], a[132:135], a[160:163], v[160:175]
    ds_read_b64_tr_b16 a[152:153], v3 offset:30976
    ds_read_b64_tr_b16 a[154:155], v3 offset:32256
    buffer_load_dwordx4 v7, s[36:39], s53 offen offset:2048 lds
    v_mfma_f32_32x32x16_bf16 v[176:191], a[132:135], a[164:167], v[176:191]
    ds_read_b64_tr_b16 a[156:157], v1 offset:35840
    ds_read_b64_tr_b16 a[158:159], v1 offset:37120
    s_waitcnt lgkmcnt(8)
    v_mfma_f32_32x32x16_bf16 v[112:127], a[136:139], a[168:171], v[112:127]
    ds_read_b64_tr_b16 a[160:161], v1 offset:35904
    ds_read_b64_tr_b16 a[162:163], v1 offset:37184
    v_mfma_f32_32x32x16_bf16 v[128:143], a[136:139], a[172:175], v[128:143]
    ds_read_b64_tr_b16 a[164:165], v1 offset:35968
    ds_read_b64_tr_b16 a[166:167], v1 offset:37248
    buffer_load_dwordx4 v8, s[36:39], s53 offen offset:3072 lds
    s_waitcnt lgkmcnt(8)
    v_mfma_f32_32x32x16_bf16 v[144:159], a[136:139], a[144:147], v[144:159]
    ds_read_b64_tr_b16 a[168:169], v1 offset:36032
    ds_read_b64_tr_b16 a[170:171], v1 offset:37312
    v_mfma_f32_32x32x16_bf16 v[160:175], a[136:139], a[148:151], v[160:175]
    ds_read_b64_tr_b16 a[172:173], v3 offset:36096
    ds_read_b64_tr_b16 a[174:175], v3 offset:37376
    s_waitcnt lgkmcnt(8)
    v_mfma_f32_32x32x16_bf16 v[176:191], a[136:139], a[152:155], v[176:191]
    ds_read_b64_tr_b16 a[144:145], v2 offset:0
    ds_read_b64_tr_b16 a[146:147], v2 offset:1280
    v_mfma_f32_32x32x16_bf16 v[112:127], a[140:143], a[156:159], v[112:127]
    ds_read_b64_tr_b16 a[148:149], v2 offset:64
    ds_read_b64_tr_b16 a[150:151], v2 offset:1344
    s_add_u32 m0, s52, 4096
    s_nop 0
    buffer_load_dwordx4 v9, s[36:39], s53 offen offset:0 lds
    s_waitcnt lgkmcnt(8)
    v_mfma_f32_32x32x16_bf16 v[128:143], a[140:143], a[160:163], v[128:143]
    ds_read_b64_tr_b16 a[152:153], v2 offset:128
    ds_read_b64_tr_b16 a[154:155], v2 offset:1408
    v_mfma_f32_32x32x16_bf16 v[144:159], a[140:143], a[164:167], v[144:159]
    ds_read_b64_tr_b16 a[156:157], v2 offset:192
    ds_read_b64_tr_b16 a[158:159], v2 offset:1472
    s_waitcnt lgkmcnt(8)
    v_mfma_f32_32x32x16_bf16 v[160:175], a[140:143], a[168:171], v[160:175]
    ds_read_b64_tr_b16 a[160:161], v4 offset:256
    ds_read_b64_tr_b16 a[162:163], v4 offset:1536
    v_mfma_f32_32x32x16_bf16 v[176:191], a[140:143], a[172:175], v[176:191]
    ds_read_b64_tr_b16 a[164:165], v2 offset:5120
    ds_read_b64_tr_b16 a[166:167], v2 offset:6400
    s_waitcnt vmcnt(20)
k1_at_pz:
    v_readfirstlane_b32 s27, v31
    s_cmp_ge_u32 s27, 16
    s_cbranch_scc1 k1_at_pzx
    s_sleep 8
    s_add_u32 s101, s101, 1
    s_cmp_ge_u32 s101, 4194304
    s_cbranch_scc1 k1_at_pzx
    global_load_dword v31, v30, s[12:13] sc1
    s_waitcnt vmcnt(0)
    s_branch k1_at_pz

k1_at_pzx:
    s_cmp_lg_u32 s21, 0
    s_cbranch_scc1 k1_at_nog
    v_and_b32 v22, 31, v0
    s_lshl_b32 s29, s24, 7
    s_lshl_b32 s30, s26, 5
    s_add_u32 s29, s29, s30
    v_add_u32 v22, s29, v22
    v_lshlrev_b32 v22, 2, v22
    s_mov_b32 s29, 25165824
    buffer_store_dword v192, v22, s[32:35], s29 offen sc1

k1_at_nog:
    v_add_u32 v28, 40960, v18
    s_nop 7
    s_nop 3
    v_cvt_pk_bf16_f32 v216, v112, v113
    v_cvt_pk_bf16_f32 v217, v114, v115
    v_cvt_pk_bf16_f32 v218, v116, v117
    v_cvt_pk_bf16_f32 v219, v118, v119
    ds_write_b128 v28, v[216:219] offset:0
    v_cvt_pk_bf16_f32 v220, v120, v121
    v_cvt_pk_bf16_f32 v221, v122, v123
    v_cvt_pk_bf16_f32 v222, v124, v125
    v_cvt_pk_bf16_f32 v223, v126, v127
    ds_write_b128 v28, v[220:223] offset:1024
    v_cvt_pk_bf16_f32 v216, v128, v129
    v_cvt_pk_bf16_f32 v217, v130, v131
    v_cvt_pk_bf16_f32 v218, v132, v133
    v_cvt_pk_bf16_f32 v219, v134, v135
    ds_write_b128 v28, v[216:219] offset:8192
    v_cvt_pk_bf16_f32 v220, v136, v137
    v_cvt_pk_bf16_f32 v221, v138, v139
    v_cvt_pk_bf16_f32 v222, v140, v141
    v_cvt_pk_bf16_f32 v223, v142, v143
    ds_write_b128 v28, v[220:223] offset:9216
    v_cvt_pk_bf16_f32 v216, v144, v145
    v_cvt_pk_bf16_f32 v217, v146, v147
    v_cvt_pk_bf16_f32 v218, v148, v149
    v_cvt_pk_bf16_f32 v219, v150, v151
    ds_write_b128 v28, v[216:219] offset:16384
    v_cvt_pk_bf16_f32 v220, v152, v153
    v_cvt_pk_bf16_f32 v221, v154, v155
    v_cvt_pk_bf16_f32 v222, v156, v157
    v_cvt_pk_bf16_f32 v223, v158, v159
    ds_write_b128 v28, v[220:223] offset:17408
    v_cvt_pk_bf16_f32 v216, v160, v161
    v_cvt_pk_bf16_f32 v217, v162, v163
    v_cvt_pk_bf16_f32 v218, v164, v165
    v_cvt_pk_bf16_f32 v219, v166, v167
    ds_write_b128 v28, v[216:219] offset:24576
    v_cvt_pk_bf16_f32 v220, v168, v169
    v_cvt_pk_bf16_f32 v221, v170, v171
    v_cvt_pk_bf16_f32 v222, v172, v173
    v_cvt_pk_bf16_f32 v223, v174, v175
    ds_write_b128 v28, v[220:223] offset:25600
    v_cvt_pk_bf16_f32 v216, v176, v177
    v_cvt_pk_bf16_f32 v217, v178, v179
    v_cvt_pk_bf16_f32 v218, v180, v181
    v_cvt_pk_bf16_f32 v219, v182, v183
    ds_write_b128 v28, v[216:219] offset:32768
    v_cvt_pk_bf16_f32 v220, v184, v185
    v_cvt_pk_bf16_f32 v221, v186, v187
    v_cvt_pk_bf16_f32 v222, v188, v189
    v_cvt_pk_bf16_f32 v223, v190, v191
    ds_write_b128 v28, v[220:223] offset:33792
    s_waitcnt lgkmcnt(0)
    s_barrier
    v_mov_b32 v196, 0x3f803f80
    v_mov_b32 v197, 0x3f803f80
    v_mov_b32 v198, 0x3f803f80
    v_mov_b32 v199, 0x3f803f80
    v_add_u32 v22, 81920, v19
    v_add_u32 v23, 122880, v19
    s_lshl_b32 s27, s21, 4
    s_add_u32 s27, s27, s24
    s_mul_i32 s28, s27, 34816
    s_add_u32 s28, s28, 26214400
    v_add_u32 v24, s28, v19
    s_mul_i32 s28, s27, 576
    s_add_u32 s28, s28, 29884416
    v_lshrrev_b32 v25, 5, v0
    v_lshlrev_b32 v25, 5, v25
    v_add_u32 v25, s28, v25

    s_cmp_eq_u32 s26, 0
    s_cbranch_scc1 k1_at_j0
    s_cmp_eq_u32 s26, 1
    s_cbranch_scc1 k1_at_j1
    s_cmp_eq_u32 s26, 2
    s_cbranch_scc1 k1_at_j2
    s_branch k1_at_j3
k1_at_j0:
    ds_read_b128 v[208:211], v22 offset:0
    ds_read_b128 v[212:215], v23 offset:0
    ds_read_b128 v[216:219], v23 offset:8192
    ds_read_b128 v[224:227], v22 offset:32768
    ds_read_b128 v[228:231], v23 offset:24576
    ds_read_b128 v[232:235], v23 offset:32768
    s_waitcnt lgkmcnt(3)
    v_mfma_f32_32x32x16_bf16 v[32:47], v[208:211], v[212:215], 0
    v_mfma_f32_32x32x16_bf16 v[48:63], v[208:211], v[216:219], 0
    v_mfma_f32_32x32x16_bf16 v[64:79], v[208:211], v[196:199], 0
    ds_read_b128 v[240:243], v22 offset:1024
    ds_read_b128 v[244:247], v23 offset:1024
    ds_read_b128 v[248:251], v23 offset:9216
    s_waitcnt lgkmcnt(3)
    v_mfma_f32_32x32x16_bf16 v[80:95], v[224:227], v[228:231], 0
    v_mfma_f32_32x32x16_bf16 v[96:111], v[224:227], v[232:235], 0
    ds_read_b128 v[208:211], v22 offset:33792
    ds_read_b128 v[212:215], v23 offset:25600
    ds_read_b128 v[216:219], v23 offset:33792
    s_waitcnt lgkmcnt(3)
    v_mfma_f32_32x32x16_bf16 v[32:47], v[240:243], v[244:247], v[32:47]
    v_mfma_f32_32x32x16_bf16 v[48:63], v[240:243], v[248:251], v[48:63]
    v_mfma_f32_32x32x16_bf16 v[64:79], v[240:243], v[196:199], v[64:79]
    ds_read_b128 v[224:227], v22 offset:2048
    ds_read_b128 v[228:231], v23 offset:2048
    ds_read_b128 v[232:235], v23 offset:10240
    s_waitcnt lgkmcnt(3)
    v_mfma_f32_32x32x16_bf16 v[80:95], v[208:211], v[212:215], v[80:95]
    v_mfma_f32_32x32x16_bf16 v[96:111], v[208:211], v[216:219], v[96:111]
    ds_read_b128 v[240:243], v22 offset:34816
    ds_read_b128 v[244:247], v23 offset:26624
    ds_read_b128 v[248:251], v23 offset:34816
    s_waitcnt lgkmcnt(3)
    v_mfma_f32_32x32x16_bf16 v[32:47], v[224:227], v[228:231], v[32:47]
    v_mfma_f32_32x32x16_bf16 v[48:63], v[224:227], v[232:235], v[48:63]
    v_mfma_f32_32x32x16_bf16 v[64:79], v[224:227], v[196:199], v[64:79]
    ds_read_b128 v[208:211], v22 offset:3072
    ds_read_b128 v[212:215], v23 offset:3072
    ds_read_b128 v[216:219], v23 offset:11264
    s_waitcnt lgkmcnt(3)
    v_mfma_f32_32x32x16_bf16 v[80:95], v[240:243], v[244:247], v[80:95]
    v_mfma_f32_32x32x16_bf16 v[96:111], v[240:243], v[248:251], v[96:111]
    ds_read_b128 v[224:227], v22 offset:35840
    ds_read_b128 v[228:231], v23 offset:27648
    ds_read_b128 v[232:235], v23 offset:35840
    s_waitcnt lgkmcnt(3)
    v_mfma_f32_32x32x16_bf16 v[32:47], v[208:211], v[212:215], v[32:47]
    v_mfma_f32_32x32x16_bf16 v[48:63], v[208:211], v[216:219], v[48:63]
    v_mfma_f32_32x32x16_bf16 v[64:79], v[208:211], v[196:199], v[64:79]
    ds_read_b128 v[240:243], v22 offset:4096
    ds_read_b128 v[244:247], v23 offset:4096
    ds_read_b128 v[248:251], v23 offset:12288
    s_waitcnt lgkmcnt(3)
    v_mfma_f32_32x32x16_bf16 v[80:95], v[224:227], v[228:231], v[80:95]
    v_mfma_f32_32x32x16_bf16 v[96:111], v[224:227], v[232:235], v[96:111]
    ds_read_b128 v[208:211], v22 offset:36864
    ds_read_b128 v[212:215], v23 offset:28672
    ds_read_b128 v[216:219], v23 offset:36864
    s_waitcnt lgkmcnt(3)
    v_mfma_f32_32x32x16_bf16 v[32:47], v[240:243], v[244:247], v[32:47]
    v_mfma_f32_32x32x16_bf16 v[48:63], v[240:243], v[248:251], v[48:63]
    v_mfma_f32_32x32x16_bf16 v[64:79], v[240:243], v[196:199], v[64:79]
    ds_read_b128 v[224:227], v22 offset:5120
    ds_read_b128 v[228:231], v23 offset:5120
    ds_read_b128 v[232:235], v23 offset:13312
    s_waitcnt lgkmcnt(3)
    v_mfma_f32_32x32x16_bf16 v[80:95], v[208:211], v[212:215], v[80:95]
    v_mfma_f32_32x32x16_bf16 v[96:111], v[208:211], v[216:219], v[96:111]
    ds_read_b128 v[240:243], v22 offset:37888
    ds_read_b128 v[244:247], v23 offset:29696
    ds_read_b128 v[248:251], v23 offset:37888
    s_waitcnt lgkmcnt(3)
    v_mfma_f32_32x32x16_bf16 v[32:47], v[224:227], v[228:231], v[32:47]
    v_mfma_f32_32x32x16_bf16 v[48:63], v[224:227], v[232:235], v[48:63]
    v_mfma_f32_32x32x16_bf16 v[64:79], v[224:227], v[196:199], v[64:79]
    ds_read_b128 v[208:211], v22 offset:6144
    ds_read_b128 v[212:215], v23 offset:6144
    ds_read_b128 v[216:219], v23 offset:14336
    s_waitcnt lgkmcnt(3)
    v_mfma_f32_32x32x16_bf16 v[80:95], v[240:243], v[244:247], v[80:95]
    v_mfma_f32_32x32x16_bf16 v[96:111], v[240:243], v[248:251], v[96:111]
    ds_read_b128 v[224:227], v22 offset:38912
    ds_read_b128 v[228:231], v23 offset:30720
    ds_read_b128 v[232:235], v23 offset:38912
    s_waitcnt lgkmcnt(3)
    v_mfma_f32_32x32x16_bf16 v[32:47], v[208:211], v[212:215], v[32:47]
    v_mfma_f32_32x32x16_bf16 v[48:63], v[208:211], v[216:219], v[48:63]
    v_mfma_f32_32x32x16_bf16 v[64:79], v[208:211], v[196:199], v[64:79]
    ds_read_b128 v[240:243], v22 offset:7168
    ds_read_b128 v[244:247], v23 offset:7168
    ds_read_b128 v[248:251], v23 offset:15360
    s_waitcnt lgkmcnt(3)
    v_mfma_f32_32x32x16_bf16 v[80:95], v[224:227], v[228:231], v[80:95]
    v_mfma_f32_32x32x16_bf16 v[96:111], v[224:227], v[232:235], v[96:111]
    ds_read_b128 v[208:211], v22 offset:39936
    ds_read_b128 v[212:215], v23 offset:31744
    ds_read_b128 v[216:219], v23 offset:39936
    s_waitcnt lgkmcnt(3)
    v_mfma_f32_32x32x16_bf16 v[32:47], v[240:243], v[244:247], v[32:47]
    v_mfma_f32_32x32x16_bf16 v[48:63], v[240:243], v[248:251], v[48:63]
    v_mfma_f32_32x32x16_bf16 v[64:79], v[240:243], v[196:199], v[64:79]
    s_waitcnt lgkmcnt(0)
    v_mfma_f32_32x32x16_bf16 v[80:95], v[208:211], v[212:215], v[80:95]
    v_mfma_f32_32x32x16_bf16 v[96:111], v[208:211], v[216:219], v[96:111]
    s_nop 7
    s_nop 7
    s_mov_b32 s28, 0
    buffer_store_dwordx4 v[32:35], v24, s[32:35], s28 offen sc1
    buffer_store_dwordx4 v[36:39], v24, s[32:35], s28 offen offset:1024 sc1
    s_mov_b32 s28, 2048
    buffer_store_dwordx4 v[40:43], v24, s[32:35], s28 offen sc1
    buffer_store_dwordx4 v[44:47], v24, s[32:35], s28 offen offset:1024 sc1
    s_mov_b32 s28, 6144
    buffer_store_dwordx4 v[56:59], v24, s[32:35], s28 offen sc1
    buffer_store_dwordx4 v[60:63], v24, s[32:35], s28 offen offset:1024 sc1
    s_mov_b32 exec_lo, 1
    s_mov_b32 exec_hi, 1
    s_mov_b32 s28, 0
    buffer_store_dwordx4 v[64:67], v25, s[32:35], s28 offen sc1
    buffer_store_dwordx4 v[68:71], v25, s[32:35], s28 offen offset:16 sc1
    s_mov_b64 exec, -1
    s_mov_b32 exec_lo, 1
    s_mov_b32 exec_hi, 1
    s_mov_b32 s28, 64
    buffer_store_dwordx4 v[72:75], v25, s[32:35], s28 offen sc1
    buffer_store_dwordx4 v[76:79], v25, s[32:35], s28 offen offset:16 sc1
    s_mov_b64 exec, -1
    s_mov_b32 s28, 28672
    buffer_store_dwordx4 v[80:83], v24, s[32:35], s28 offen sc1
    buffer_store_dwordx4 v[84:87], v24, s[32:35], s28 offen offset:1024 sc1
    s_mov_b32 s28, 32768
    buffer_store_dwordx4 v[96:99], v24, s[32:35], s28 offen sc1
    buffer_store_dwordx4 v[100:103], v24, s[32:35], s28 offen offset:1024 sc1
    s_branch k1_at_jd
k1_at_j1:
    ds_read_b128 v[208:211], v22 offset:8192
    ds_read_b128 v[212:215], v23 offset:0
    ds_read_b128 v[216:219], v23 offset:8192
    ds_read_b128 v[220:223], v23 offset:16384
    ds_read_b128 v[224:227], v22 offset:32768
    s_waitcnt lgkmcnt(1)
    v_mfma_f32_32x32x16_bf16 v[32:47], v[208:211], v[212:215], 0
    v_mfma_f32_32x32x16_bf16 v[48:63], v[208:211], v[216:219], 0
    v_mfma_f32_32x32x16_bf16 v[64:79], v[208:211], v[220:223], 0
    v_mfma_f32_32x32x16_bf16 v[80:95], v[208:211], v[196:199], 0
    ds_read_b128 v[240:243], v22 offset:9216
    ds_read_b128 v[244:247], v23 offset:1024
    ds_read_b128 v[248:251], v23 offset:9216
    ds_read_b128 v[252:255], v23 offset:17408
    s_waitcnt lgkmcnt(4)
    v_mfma_f32_32x32x16_bf16 v[96:111], v[224:227], v[196:199], 0
    ds_read_b128 v[208:211], v22 offset:33792
    s_waitcnt lgkmcnt(1)
    v_mfma_f32_32x32x16_bf16 v[32:47], v[240:243], v[244:247], v[32:47]
    v_mfma_f32_32x32x16_bf16 v[48:63], v[240:243], v[248:251], v[48:63]
    v_mfma_f32_32x32x16_bf16 v[64:79], v[240:243], v[252:255], v[64:79]
    v_mfma_f32_32x32x16_bf16 v[80:95], v[240:243], v[196:199], v[80:95]
    ds_read_b128 v[224:227], v22 offset:10240
    ds_read_b128 v[228:231], v23 offset:2048
    ds_read_b128 v[232:235], v23 offset:10240
    ds_read_b128 v[236:239], v23 offset:18432
    s_waitcnt lgkmcnt(4)
    v_mfma_f32_32x32x16_bf16 v[96:111], v[208:211], v[196:199], v[96:111]
    ds_read_b128 v[240:243], v22 offset:34816
    s_waitcnt lgkmcnt(1)
    v_mfma_f32_32x32x16_bf16 v[32:47], v[224:227], v[228:231], v[32:47]
    v_mfma_f32_32x32x16_bf16 v[48:63], v[224:227], v[232:235], v[48:63]
    v_mfma_f32_32x32x16_bf16 v[64:79], v[224:227], v[236:239], v[64:79]
    v_mfma_f32_32x32x16_bf16 v[80:95], v[224:227], v[196:199], v[80:95]
    ds_read_b128 v[208:211], v22 offset:11264
    ds_read_b128 v[212:215], v23 offset:3072
    ds_read_b128 v[216:219], v23 offset:11264
    ds_read_b128 v[220:223], v23 offset:19456
    s_waitcnt lgkmcnt(4)
    v_mfma_f32_32x32x16_bf16 v[96:111], v[240:243], v[196:199], v[96:111]
    ds_read_b128 v[224:227], v22 offset:35840
    s_waitcnt lgkmcnt(1)
    v_mfma_f32_32x32x16_bf16 v[32:47], v[208:211], v[212:215], v[32:47]
    v_mfma_f32_32x32x16_bf16 v[48:63], v[208:211], v[216:219], v[48:63]
    v_mfma_f32_32x32x16_bf16 v[64:79], v[208:211], v[220:223], v[64:79]
    v_mfma_f32_32x32x16_bf16 v[80:95], v[208:211], v[196:199], v[80:95]
    ds_read_b128 v[240:243], v22 offset:12288
    ds_read_b128 v[244:247], v23 offset:4096
    ds_read_b128 v[248:251], v23 offset:12288
    ds_read_b128 v[252:255], v23 offset:20480
    s_waitcnt lgkmcnt(4)
    v_mfma_f32_32x32x16_bf16 v[96:111], v[224:227], v[196:199], v[96:111]
    ds_read_b128 v[208:211], v22 offset:36864
    s_waitcnt lgkmcnt(1)
    v_mfma_f32_32x32x16_bf16 v[32:47], v[240:243], v[244:247], v[32:47]
    v_mfma_f32_32x32x16_bf16 v[48:63], v[240:243], v[248:251], v[48:63]
    v_mfma_f32_32x32x16_bf16 v[64:79], v[240:243], v[252:255], v[64:79]
    v_mfma_f32_32x32x16_bf16 v[80:95], v[240:243], v[196:199], v[80:95]
    ds_read_b128 v[224:227], v22 offset:13312
    ds_read_b128 v[228:231], v23 offset:5120
    ds_read_b128 v[232:235], v23 offset:13312
    ds_read_b128 v[236:239], v23 offset:21504
    s_waitcnt lgkmcnt(4)
    v_mfma_f32_32x32x16_bf16 v[96:111], v[208:211], v[196:199], v[96:111]
    ds_read_b128 v[240:243], v22 offset:37888
    s_waitcnt lgkmcnt(1)
    v_mfma_f32_32x32x16_bf16 v[32:47], v[224:227], v[228:231], v[32:47]
    v_mfma_f32_32x32x16_bf16 v[48:63], v[224:227], v[232:235], v[48:63]
    v_mfma_f32_32x32x16_bf16 v[64:79], v[224:227], v[236:239], v[64:79]
    v_mfma_f32_32x32x16_bf16 v[80:95], v[224:227], v[196:199], v[80:95]
    ds_read_b128 v[208:211], v22 offset:14336
    ds_read_b128 v[212:215], v23 offset:6144
    ds_read_b128 v[216:219], v23 offset:14336
    ds_read_b128 v[220:223], v23 offset:22528
    s_waitcnt lgkmcnt(4)
    v_mfma_f32_32x32x16_bf16 v[96:111], v[240:243], v[196:199], v[96:111]
    ds_read_b128 v[224:227], v22 offset:38912
    s_waitcnt lgkmcnt(1)
    v_mfma_f32_32x32x16_bf16 v[32:47], v[208:211], v[212:215], v[32:47]
    v_mfma_f32_32x32x16_bf16 v[48:63], v[208:211], v[216:219], v[48:63]
    v_mfma_f32_32x32x16_bf16 v[64:79], v[208:211], v[220:223], v[64:79]
    v_mfma_f32_32x32x16_bf16 v[80:95], v[208:211], v[196:199], v[80:95]
    ds_read_b128 v[240:243], v22 offset:15360
    ds_read_b128 v[244:247], v23 offset:7168
    ds_read_b128 v[248:251], v23 offset:15360
    ds_read_b128 v[252:255], v23 offset:23552
    s_waitcnt lgkmcnt(4)
    v_mfma_f32_32x32x16_bf16 v[96:111], v[224:227], v[196:199], v[96:111]
    ds_read_b128 v[208:211], v22 offset:39936
    s_waitcnt lgkmcnt(1)
    v_mfma_f32_32x32x16_bf16 v[32:47], v[240:243], v[244:247], v[32:47]
    v_mfma_f32_32x32x16_bf16 v[48:63], v[240:243], v[248:251], v[48:63]
    v_mfma_f32_32x32x16_bf16 v[64:79], v[240:243], v[252:255], v[64:79]
    v_mfma_f32_32x32x16_bf16 v[80:95], v[240:243], v[196:199], v[80:95]
    s_waitcnt lgkmcnt(0)
    v_mfma_f32_32x32x16_bf16 v[96:111], v[208:211], v[196:199], v[96:111]
    s_nop 7
    s_nop 7
    s_mov_b32 s28, 4096
    buffer_store_dwordx4 v[32:35], v24, s[32:35], s28 offen sc1
    buffer_store_dwordx4 v[36:39], v24, s[32:35], s28 offen offset:1024 sc1
    s_mov_b32 s28, 8192
    buffer_store_dwordx4 v[48:51], v24, s[32:35], s28 offen sc1
    buffer_store_dwordx4 v[52:55], v24, s[32:35], s28 offen offset:1024 sc1
    s_mov_b32 s28, 10240
    buffer_store_dwordx4 v[56:59], v24, s[32:35], s28 offen sc1
    buffer_store_dwordx4 v[60:63], v24, s[32:35], s28 offen offset:1024 sc1
    s_mov_b32 s28, 14336
    buffer_store_dwordx4 v[72:75], v24, s[32:35], s28 offen sc1
    buffer_store_dwordx4 v[76:79], v24, s[32:35], s28 offen offset:1024 sc1
    s_mov_b32 exec_lo, 1
    s_mov_b32 exec_hi, 1
    s_mov_b32 s28, 128
    buffer_store_dwordx4 v[80:83], v25, s[32:35], s28 offen sc1
    buffer_store_dwordx4 v[84:87], v25, s[32:35], s28 offen offset:16 sc1
    s_mov_b64 exec, -1
    s_mov_b32 exec_lo, 1
    s_mov_b32 exec_hi, 1
    s_mov_b32 s28, 192
    buffer_store_dwordx4 v[88:91], v25, s[32:35], s28 offen sc1
    buffer_store_dwordx4 v[92:95], v25, s[32:35], s28 offen offset:16 sc1
    s_mov_b64 exec, -1
    s_mov_b32 exec_lo, 1
    s_mov_b32 exec_hi, 1
    s_mov_b32 s28, 512
    buffer_store_dwordx4 v[96:99], v25, s[32:35], s28 offen sc1
    buffer_store_dwordx4 v[100:103], v25, s[32:35], s28 offen offset:16 sc1
    s_mov_b64 exec, -1
    s_branch k1_at_jd
k1_at_j2:
    ds_read_b128 v[208:211], v22 offset:16384
    ds_read_b128 v[212:215], v23 offset:8192
    ds_read_b128 v[216:219], v23 offset:16384
    ds_read_b128 v[220:223], v23 offset:24576
    ds_read_b128 v[224:227], v22 offset:17408
    ds_read_b128 v[228:231], v23 offset:9216
    ds_read_b128 v[232:235], v23 offset:17408
    ds_read_b128 v[236:239], v23 offset:25600
    s_waitcnt lgkmcnt(4)
    v_mfma_f32_32x32x16_bf16 v[32:47], v[208:211], v[212:215], 0
    v_mfma_f32_32x32x16_bf16 v[48:63], v[208:211], v[216:219], 0
    v_mfma_f32_32x32x16_bf16 v[64:79], v[208:211], v[220:223], 0
    v_mfma_f32_32x32x16_bf16 v[80:95], v[208:211], v[196:199], 0
    ds_read_b128 v[240:243], v22 offset:18432
    ds_read_b128 v[244:247], v23 offset:10240
    ds_read_b128 v[248:251], v23 offset:18432
    ds_read_b128 v[252:255], v23 offset:26624
    s_waitcnt lgkmcnt(4)
    v_mfma_f32_32x32x16_bf16 v[32:47], v[224:227], v[228:231], v[32:47]
    v_mfma_f32_32x32x16_bf16 v[48:63], v[224:227], v[232:235], v[48:63]
    v_mfma_f32_32x32x16_bf16 v[64:79], v[224:227], v[236:239], v[64:79]
    v_mfma_f32_32x32x16_bf16 v[80:95], v[224:227], v[196:199], v[80:95]
    ds_read_b128 v[208:211], v22 offset:19456
    ds_read_b128 v[212:215], v23 offset:11264
    ds_read_b128 v[216:219], v23 offset:19456
    ds_read_b128 v[220:223], v23 offset:27648
    s_waitcnt lgkmcnt(4)
    v_mfma_f32_32x32x16_bf16 v[32:47], v[240:243], v[244:247], v[32:47]
    v_mfma_f32_32x32x16_bf16 v[48:63], v[240:243], v[248:251], v[48:63]
    v_mfma_f32_32x32x16_bf16 v[64:79], v[240:243], v[252:255], v[64:79]
    v_mfma_f32_32x32x16_bf16 v[80:95], v[240:243], v[196:199], v[80:95]
    ds_read_b128 v[224:227], v22 offset:20480
    ds_read_b128 v[228:231], v23 offset:12288
    ds_read_b128 v[232:235], v23 offset:20480
    ds_read_b128 v[236:239], v23 offset:28672
    s_waitcnt lgkmcnt(4)
    v_mfma_f32_32x32x16_bf16 v[32:47], v[208:211], v[212:215], v[32:47]
    v_mfma_f32_32x32x16_bf16 v[48:63], v[208:211], v[216:219], v[48:63]
    v_mfma_f32_32x32x16_bf16 v[64:79], v[208:211], v[220:223], v[64:79]
    v_mfma_f32_32x32x16_bf16 v[80:95], v[208:211], v[196:199], v[80:95]
    ds_read_b128 v[240:243], v22 offset:21504
    ds_read_b128 v[244:247], v23 offset:13312
    ds_read_b128 v[248:251], v23 offset:21504
    ds_read_b128 v[252:255], v23 offset:29696
    s_waitcnt lgkmcnt(4)
    v_mfma_f32_32x32x16_bf16 v[32:47], v[224:227], v[228:231], v[32:47]
    v_mfma_f32_32x32x16_bf16 v[48:63], v[224:227], v[232:235], v[48:63]
    v_mfma_f32_32x32x16_bf16 v[64:79], v[224:227], v[236:239], v[64:79]
    v_mfma_f32_32x32x16_bf16 v[80:95], v[224:227], v[196:199], v[80:95]
    ds_read_b128 v[208:211], v22 offset:22528
    ds_read_b128 v[212:215], v23 offset:14336
    ds_read_b128 v[216:219], v23 offset:22528
    ds_read_b128 v[220:223], v23 offset:30720
    s_waitcnt lgkmcnt(4)
    v_mfma_f32_32x32x16_bf16 v[32:47], v[240:243], v[244:247], v[32:47]
    v_mfma_f32_32x32x16_bf16 v[48:63], v[240:243], v[248:251], v[48:63]
    v_mfma_f32_32x32x16_bf16 v[64:79], v[240:243], v[252:255], v[64:79]
    v_mfma_f32_32x32x16_bf16 v[80:95], v[240:243], v[196:199], v[80:95]
    ds_read_b128 v[224:227], v22 offset:23552
    ds_read_b128 v[228:231], v23 offset:15360
    ds_read_b128 v[232:235], v23 offset:23552
    ds_read_b128 v[236:239], v23 offset:31744
    s_waitcnt lgkmcnt(4)
    v_mfma_f32_32x32x16_bf16 v[32:47], v[208:211], v[212:215], v[32:47]
    v_mfma_f32_32x32x16_bf16 v[48:63], v[208:211], v[216:219], v[48:63]
    v_mfma_f32_32x32x16_bf16 v[64:79], v[208:211], v[220:223], v[64:79]
    v_mfma_f32_32x32x16_bf16 v[80:95], v[208:211], v[196:199], v[80:95]
    s_waitcnt lgkmcnt(0)
    v_mfma_f32_32x32x16_bf16 v[32:47], v[224:227], v[228:231], v[32:47]
    v_mfma_f32_32x32x16_bf16 v[48:63], v[224:227], v[232:235], v[48:63]
    v_mfma_f32_32x32x16_bf16 v[64:79], v[224:227], v[236:239], v[64:79]
    v_mfma_f32_32x32x16_bf16 v[80:95], v[224:227], v[196:199], v[80:95]
    s_nop 7
    s_nop 7
    s_mov_b32 s28, 12288
    buffer_store_dwordx4 v[32:35], v24, s[32:35], s28 offen sc1
    buffer_store_dwordx4 v[36:39], v24, s[32:35], s28 offen offset:1024 sc1
    s_mov_b32 s28, 16384
    buffer_store_dwordx4 v[48:51], v24, s[32:35], s28 offen sc1
    buffer_store_dwordx4 v[52:55], v24, s[32:35], s28 offen offset:1024 sc1
    s_mov_b32 s28, 18432
    buffer_store_dwordx4 v[56:59], v24, s[32:35], s28 offen sc1
    buffer_store_dwordx4 v[60:63], v24, s[32:35], s28 offen offset:1024 sc1
    s_mov_b32 s28, 22528
    buffer_store_dwordx4 v[72:75], v24, s[32:35], s28 offen sc1
    buffer_store_dwordx4 v[76:79], v24, s[32:35], s28 offen offset:1024 sc1
    s_mov_b32 exec_lo, 1
    s_mov_b32 exec_hi, 1
    s_mov_b32 s28, 256
    buffer_store_dwordx4 v[80:83], v25, s[32:35], s28 offen sc1
    buffer_store_dwordx4 v[84:87], v25, s[32:35], s28 offen offset:16 sc1
    s_mov_b64 exec, -1
    s_mov_b32 exec_lo, 1
    s_mov_b32 exec_hi, 1
    s_mov_b32 s28, 320
    buffer_store_dwordx4 v[88:91], v25, s[32:35], s28 offen sc1
    buffer_store_dwordx4 v[92:95], v25, s[32:35], s28 offen offset:16 sc1
    s_mov_b64 exec, -1
    s_branch k1_at_jd
k1_at_j3:
    ds_read_b128 v[208:211], v22 offset:24576
    ds_read_b128 v[212:215], v23 offset:16384
    ds_read_b128 v[216:219], v23 offset:24576
    ds_read_b128 v[220:223], v23 offset:32768
    ds_read_b128 v[224:227], v22 offset:25600
    ds_read_b128 v[228:231], v23 offset:17408
    ds_read_b128 v[232:235], v23 offset:25600
    ds_read_b128 v[236:239], v23 offset:33792
    s_waitcnt lgkmcnt(4)
    v_mfma_f32_32x32x16_bf16 v[32:47], v[208:211], v[212:215], 0
    v_mfma_f32_32x32x16_bf16 v[48:63], v[208:211], v[216:219], 0
    v_mfma_f32_32x32x16_bf16 v[64:79], v[208:211], v[220:223], 0
    v_mfma_f32_32x32x16_bf16 v[80:95], v[208:211], v[196:199], 0
    ds_read_b128 v[240:243], v22 offset:26624
    ds_read_b128 v[244:247], v23 offset:18432
    ds_read_b128 v[248:251], v23 offset:26624
    ds_read_b128 v[252:255], v23 offset:34816
    s_waitcnt lgkmcnt(4)
    v_mfma_f32_32x32x16_bf16 v[32:47], v[224:227], v[228:231], v[32:47]
    v_mfma_f32_32x32x16_bf16 v[48:63], v[224:227], v[232:235], v[48:63]
    v_mfma_f32_32x32x16_bf16 v[64:79], v[224:227], v[236:239], v[64:79]
    v_mfma_f32_32x32x16_bf16 v[80:95], v[224:227], v[196:199], v[80:95]
    ds_read_b128 v[208:211], v22 offset:27648
    ds_read_b128 v[212:215], v23 offset:19456
    ds_read_b128 v[216:219], v23 offset:27648
    ds_read_b128 v[220:223], v23 offset:35840
    s_waitcnt lgkmcnt(4)
    v_mfma_f32_32x32x16_bf16 v[32:47], v[240:243], v[244:247], v[32:47]
    v_mfma_f32_32x32x16_bf16 v[48:63], v[240:243], v[248:251], v[48:63]
    v_mfma_f32_32x32x16_bf16 v[64:79], v[240:243], v[252:255], v[64:79]
    v_mfma_f32_32x32x16_bf16 v[80:95], v[240:243], v[196:199], v[80:95]
    ds_read_b128 v[224:227], v22 offset:28672
    ds_read_b128 v[228:231], v23 offset:20480
    ds_read_b128 v[232:235], v23 offset:28672
    ds_read_b128 v[236:239], v23 offset:36864
    s_waitcnt lgkmcnt(4)
    v_mfma_f32_32x32x16_bf16 v[32:47], v[208:211], v[212:215], v[32:47]
    v_mfma_f32_32x32x16_bf16 v[48:63], v[208:211], v[216:219], v[48:63]
    v_mfma_f32_32x32x16_bf16 v[64:79], v[208:211], v[220:223], v[64:79]
    v_mfma_f32_32x32x16_bf16 v[80:95], v[208:211], v[196:199], v[80:95]
    ds_read_b128 v[240:243], v22 offset:29696
    ds_read_b128 v[244:247], v23 offset:21504
    ds_read_b128 v[248:251], v23 offset:29696
    ds_read_b128 v[252:255], v23 offset:37888
    s_waitcnt lgkmcnt(4)
    v_mfma_f32_32x32x16_bf16 v[32:47], v[224:227], v[228:231], v[32:47]
    v_mfma_f32_32x32x16_bf16 v[48:63], v[224:227], v[232:235], v[48:63]
    v_mfma_f32_32x32x16_bf16 v[64:79], v[224:227], v[236:239], v[64:79]
    v_mfma_f32_32x32x16_bf16 v[80:95], v[224:227], v[196:199], v[80:95]
    ds_read_b128 v[208:211], v22 offset:30720
    ds_read_b128 v[212:215], v23 offset:22528
    ds_read_b128 v[216:219], v23 offset:30720
    ds_read_b128 v[220:223], v23 offset:38912
    s_waitcnt lgkmcnt(4)
    v_mfma_f32_32x32x16_bf16 v[32:47], v[240:243], v[244:247], v[32:47]
    v_mfma_f32_32x32x16_bf16 v[48:63], v[240:243], v[248:251], v[48:63]
    v_mfma_f32_32x32x16_bf16 v[64:79], v[240:243], v[252:255], v[64:79]
    v_mfma_f32_32x32x16_bf16 v[80:95], v[240:243], v[196:199], v[80:95]
    ds_read_b128 v[224:227], v22 offset:31744
    ds_read_b128 v[228:231], v23 offset:23552
    ds_read_b128 v[232:235], v23 offset:31744
    ds_read_b128 v[236:239], v23 offset:39936
    s_waitcnt lgkmcnt(4)
    v_mfma_f32_32x32x16_bf16 v[32:47], v[208:211], v[212:215], v[32:47]
    v_mfma_f32_32x32x16_bf16 v[48:63], v[208:211], v[216:219], v[48:63]
    v_mfma_f32_32x32x16_bf16 v[64:79], v[208:211], v[220:223], v[64:79]
    v_mfma_f32_32x32x16_bf16 v[80:95], v[208:211], v[196:199], v[80:95]
    s_waitcnt lgkmcnt(0)
    v_mfma_f32_32x32x16_bf16 v[32:47], v[224:227], v[228:231], v[32:47]
    v_mfma_f32_32x32x16_bf16 v[48:63], v[224:227], v[232:235], v[48:63]
    v_mfma_f32_32x32x16_bf16 v[64:79], v[224:227], v[236:239], v[64:79]
    v_mfma_f32_32x32x16_bf16 v[80:95], v[224:227], v[196:199], v[80:95]
    s_nop 7
    s_nop 7
    s_mov_b32 s28, 20480
    buffer_store_dwordx4 v[32:35], v24, s[32:35], s28 offen sc1
    buffer_store_dwordx4 v[36:39], v24, s[32:35], s28 offen offset:1024 sc1
    s_mov_b32 s28, 24576
    buffer_store_dwordx4 v[48:51], v24, s[32:35], s28 offen sc1
    buffer_store_dwordx4 v[52:55], v24, s[32:35], s28 offen offset:1024 sc1
    s_mov_b32 s28, 26624
    buffer_store_dwordx4 v[56:59], v24, s[32:35], s28 offen sc1
    buffer_store_dwordx4 v[60:63], v24, s[32:35], s28 offen offset:1024 sc1
    s_mov_b32 s28, 30720
    buffer_store_dwordx4 v[72:75], v24, s[32:35], s28 offen sc1
    buffer_store_dwordx4 v[76:79], v24, s[32:35], s28 offen offset:1024 sc1
    s_mov_b32 exec_lo, 1
    s_mov_b32 exec_hi, 1
    s_mov_b32 s28, 384
    buffer_store_dwordx4 v[80:83], v25, s[32:35], s28 offen sc1
    buffer_store_dwordx4 v[84:87], v25, s[32:35], s28 offen offset:16 sc1
    s_mov_b64 exec, -1
    s_mov_b32 exec_lo, 1
    s_mov_b32 exec_hi, 1
    s_mov_b32 s28, 448
    buffer_store_dwordx4 v[88:91], v25, s[32:35], s28 offen sc1
    buffer_store_dwordx4 v[92:95], v25, s[32:35], s28 offen offset:16 sc1
    s_mov_b64 exec, -1
    s_branch k1_at_jd
k1_at_jd:
    s_lshl_b32 s56, s21, 7
    s_add_u32 s57, s56, 37376
    s_add_u32 s56, s56, 36864
    s_lshl_b32 s27, s24, 2
    s_add_u32 s27, s27, s26
    s_cmp_lt_u32 s27, 34
    s_cselect_b32 s58, 1, 0

    s_waitcnt vmcnt(17)
    s_barrier
    s_waitcnt lgkmcnt(15)
    v_mfma_f32_32x32x16_bf16 v[112:127], a[144:147], a[0:3], 0
    ds_read_b64_tr_b16 a[168:169], v2 offset:5184
    ds_read_b64_tr_b16 a[170:171], v2 offset:6464
    v_mfma_f32_32x32x16_bf16 v[128:143], a[148:151], a[0:3], 0
    ds_read_b64_tr_b16 a[172:173], v2 offset:5248
    ds_read_b64_tr_b16 a[174:175], v2 offset:6528
    s_add_u32 m0, s52, 20480
    s_mov_b32 s53, 663552
    buffer_load_dwordx4 v5, s[36:39], s53 offen offset:0 lds
    s_waitcnt lgkmcnt(15)
    v_mfma_f32_32x32x16_bf16 v[144:159], a[152:155], a[0:3], 0
    ds_read_b64_tr_b16 a[144:145], v2 offset:5312
    ds_read_b64_tr_b16 a[146:147], v2 offset:6592
    v_mfma_f32_32x32x16_bf16 v[160:175], a[156:159], a[0:3], 0
    ds_read_b64_tr_b16 a[148:149], v4 offset:5376
    ds_read_b64_tr_b16 a[150:151], v4 offset:6656
    s_waitcnt lgkmcnt(15)
    v_mfma_f32_32x32x16_bf16 v[176:191], a[160:163], a[0:3], 0
    ds_read_b64_tr_b16 a[152:153], v2 offset:10240
    ds_read_b64_tr_b16 a[154:155], v2 offset:11520
    buffer_load_dwordx4 v6, s[36:39], s53 offen offset:1024 lds
    v_mfma_f32_32x32x16_bf16 v[112:127], a[164:167], a[4:7], v[112:127]
    ds_read_b64_tr_b16 a[156:157], v2 offset:10304
    ds_read_b64_tr_b16 a[158:159], v2 offset:11584
    s_waitcnt lgkmcnt(8)
    v_mfma_f32_32x32x16_bf16 v[128:143], a[168:171], a[4:7], v[128:143]
    ds_read_b64_tr_b16 a[160:161], v2 offset:10368
    ds_read_b64_tr_b16 a[162:163], v2 offset:11648
    v_mfma_f32_32x32x16_bf16 v[144:159], a[172:175], a[4:7], v[144:159]
    ds_read_b64_tr_b16 a[164:165], v2 offset:10432
    ds_read_b64_tr_b16 a[166:167], v2 offset:11712
    s_waitcnt lgkmcnt(8)
    v_mfma_f32_32x32x16_bf16 v[160:175], a[144:147], a[4:7], v[160:175]
    ds_read_b64_tr_b16 a[168:169], v4 offset:10496
    ds_read_b64_tr_b16 a[170:171], v4 offset:11776
    buffer_load_dwordx4 v7, s[36:39], s53 offen offset:2048 lds
    v_mfma_f32_32x32x16_bf16 v[176:191], a[148:151], a[4:7], v[176:191]
    ds_read_b64_tr_b16 a[172:173], v2 offset:15360
    ds_read_b64_tr_b16 a[174:175], v2 offset:16640
    s_waitcnt lgkmcnt(8)
    v_mfma_f32_32x32x16_bf16 v[112:127], a[152:155], a[8:11], v[112:127]
    ds_read_b64_tr_b16 a[144:145], v2 offset:15424
    ds_read_b64_tr_b16 a[146:147], v2 offset:16704
    v_mfma_f32_32x32x16_bf16 v[128:143], a[156:159], a[8:11], v[128:143]
    ds_read_b64_tr_b16 a[148:149], v2 offset:15488
    ds_read_b64_tr_b16 a[150:151], v2 offset:16768
    buffer_load_dwordx4 v8, s[36:39], s53 offen offset:3072 lds
    s_waitcnt lgkmcnt(8)
    v_mfma_f32_32x32x16_bf16 v[144:159], a[160:163], a[8:11], v[144:159]
    ds_read_b64_tr_b16 a[152:153], v2 offset:15552
    ds_read_b64_tr_b16 a[154:155], v2 offset:16832
    v_mfma_f32_32x32x16_bf16 v[160:175], a[164:167], a[8:11], v[160:175]
    ds_read_b64_tr_b16 a[156:157], v4 offset:15616
    ds_read_b64_tr_b16 a[158:159], v4 offset:16896
    s_waitcnt lgkmcnt(8)
    v_mfma_f32_32x32x16_bf16 v[176:191], a[168:171], a[8:11], v[176:191]
    ds_read_b64_tr_b16 a[160:161], v2 offset:20480
    ds_read_b64_tr_b16 a[162:163], v2 offset:21760
    v_mfma_f32_32x32x16_bf16 v[112:127], a[172:175], a[12:15], v[112:127]
    ds_read_b64_tr_b16 a[164:165], v2 offset:20544
    ds_read_b64_tr_b16 a[166:167], v2 offset:21824
    s_add_u32 m0, s52, 24576
    s_nop 0
    buffer_load_dwordx4 v9, s[36:39], s53 offen offset:0 lds
    s_waitcnt lgkmcnt(8)
    v_mfma_f32_32x32x16_bf16 v[128:143], a[144:147], a[12:15], v[128:143]
    ds_read_b64_tr_b16 a[168:169], v2 offset:20608
    ds_read_b64_tr_b16 a[170:171], v2 offset:21888
    v_mfma_f32_32x32x16_bf16 v[144:159], a[148:151], a[12:15], v[144:159]
    ds_read_b64_tr_b16 a[172:173], v2 offset:20672
    ds_read_b64_tr_b16 a[174:175], v2 offset:21952
    s_waitcnt lgkmcnt(8)
    v_mfma_f32_32x32x16_bf16 v[160:175], a[152:155], a[12:15], v[160:175]
    ds_read_b64_tr_b16 a[144:145], v4 offset:20736
    ds_read_b64_tr_b16 a[146:147], v4 offset:22016
    v_mfma_f32_32x32x16_bf16 v[176:191], a[156:159], a[12:15], v[176:191]
    ds_read_b64_tr_b16 a[148:149], v2 offset:25600
    ds_read_b64_tr_b16 a[150:151], v2 offset:26880
    s_waitcnt vmcnt(17)
    s_barrier
    s_waitcnt lgkmcnt(8)
    v_mfma_f32_32x32x16_bf16 v[112:127], a[160:163], a[16:19], v[112:127]
    ds_read_b64_tr_b16 a[152:153], v2 offset:25664
    ds_read_b64_tr_b16 a[154:155], v2 offset:26944
    v_mfma_f32_32x32x16_bf16 v[128:143], a[164:167], a[16:19], v[128:143]
    ds_read_b64_tr_b16 a[156:157], v2 offset:25728
    ds_read_b64_tr_b16 a[158:159], v2 offset:27008
    s_add_u32 m0, s52, 40960
    s_mov_b32 s53, 884736
    buffer_load_dwordx4 v5, s[36:39], s53 offen offset:0 lds
    s_waitcnt lgkmcnt(8)
    v_mfma_f32_32x32x16_bf16 v[144:159], a[168:171], a[16:19], v[144:159]
    ds_read_b64_tr_b16 a[160:161], v2 offset:25792
    ds_read_b64_tr_b16 a[162:163], v2 offset:27072
    v_mfma_f32_32x32x16_bf16 v[160:175], a[172:175], a[16:19], v[160:175]
    ds_read_b64_tr_b16 a[164:165], v4 offset:25856
    ds_read_b64_tr_b16 a[166:167], v4 offset:27136
    s_waitcnt lgkmcnt(8)
    v_mfma_f32_32x32x16_bf16 v[176:191], a[144:147], a[16:19], v[176:191]
    ds_read_b64_tr_b16 a[168:169], v2 offset:30720
    ds_read_b64_tr_b16 a[170:171], v2 offset:32000
    buffer_load_dwordx4 v6, s[36:39], s53 offen offset:1024 lds
    v_mfma_f32_32x32x16_bf16 v[112:127], a[148:151], a[20:23], v[112:127]
    ds_read_b64_tr_b16 a[172:173], v2 offset:30784
    ds_read_b64_tr_b16 a[174:175], v2 offset:32064
    s_waitcnt lgkmcnt(8)
    v_mfma_f32_32x32x16_bf16 v[128:143], a[152:155], a[20:23], v[128:143]
    ds_read_b64_tr_b16 a[144:145], v2 offset:30848
    ds_read_b64_tr_b16 a[146:147], v2 offset:32128
    v_mfma_f32_32x32x16_bf16 v[144:159], a[156:159], a[20:23], v[144:159]
    ds_read_b64_tr_b16 a[148:149], v2 offset:30912
    ds_read_b64_tr_b16 a[150:151], v2 offset:32192
    s_waitcnt lgkmcnt(8)
    v_mfma_f32_32x32x16_bf16 v[160:175], a[160:163], a[20:23], v[160:175]
    ds_read_b64_tr_b16 a[152:153], v4 offset:30976
    ds_read_b64_tr_b16 a[154:155], v4 offset:32256
    buffer_load_dwordx4 v7, s[36:39], s53 offen offset:2048 lds
    v_mfma_f32_32x32x16_bf16 v[176:191], a[164:167], a[20:23], v[176:191]
    ds_read_b64_tr_b16 a[156:157], v2 offset:35840
    ds_read_b64_tr_b16 a[158:159], v2 offset:37120
    s_waitcnt lgkmcnt(8)
    v_mfma_f32_32x32x16_bf16 v[112:127], a[168:171], a[24:27], v[112:127]
    ds_read_b64_tr_b16 a[160:161], v2 offset:35904
    ds_read_b64_tr_b16 a[162:163], v2 offset:37184
    v_mfma_f32_32x32x16_bf16 v[128:143], a[172:175], a[24:27], v[128:143]
    ds_read_b64_tr_b16 a[164:165], v2 offset:35968
    ds_read_b64_tr_b16 a[166:167], v2 offset:37248
    buffer_load_dwordx4 v8, s[36:39], s53 offen offset:3072 lds
    s_waitcnt lgkmcnt(8)
    v_mfma_f32_32x32x16_bf16 v[144:159], a[144:147], a[24:27], v[144:159]
    ds_read_b64_tr_b16 a[168:169], v2 offset:36032
    ds_read_b64_tr_b16 a[170:171], v2 offset:37312
    v_mfma_f32_32x32x16_bf16 v[160:175], a[148:151], a[24:27], v[160:175]
    ds_read_b64_tr_b16 a[172:173], v4 offset:36096
    ds_read_b64_tr_b16 a[174:175], v4 offset:37376
    s_waitcnt lgkmcnt(8)
    v_mfma_f32_32x32x16_bf16 v[176:191], a[152:155], a[24:27], v[176:191]
    ds_read_b64_tr_b16 a[144:145], v1 offset:0
    ds_read_b64_tr_b16 a[146:147], v1 offset:1280
    v_mfma_f32_32x32x16_bf16 v[112:127], a[156:159], a[28:31], v[112:127]
    ds_read_b64_tr_b16 a[148:149], v1 offset:64
    ds_read_b64_tr_b16 a[150:151], v1 offset:1344
    s_add_u32 m0, s52, 45056
    s_nop 0
    buffer_load_dwordx4 v9, s[36:39], s53 offen offset:0 lds
    s_waitcnt lgkmcnt(8)
    v_mfma_f32_32x32x16_bf16 v[128:143], a[160:163], a[28:31], v[128:143]
    ds_read_b64_tr_b16 a[152:153], v1 offset:128
    ds_read_b64_tr_b16 a[154:155], v1 offset:1408
    v_mfma_f32_32x32x16_bf16 v[144:159], a[164:167], a[28:31], v[144:159]
    ds_read_b64_tr_b16 a[156:157], v1 offset:192
    ds_read_b64_tr_b16 a[158:159], v1 offset:1472
    s_waitcnt lgkmcnt(8)
    v_mfma_f32_32x32x16_bf16 v[160:175], a[168:171], a[28:31], v[160:175]
    ds_read_b64_tr_b16 a[160:161], v3 offset:256
    ds_read_b64_tr_b16 a[162:163], v3 offset:1536
    v_mfma_f32_32x32x16_bf16 v[176:191], a[172:175], a[28:31], v[176:191]
    ds_read_b64_tr_b16 a[164:165], v1 offset:5120
    ds_read_b64_tr_b16 a[166:167], v1 offset:6400
    s_waitcnt vmcnt(5)
    s_barrier
    s_cmp_lg_u32 s26, 0
    s_cbranch_scc1 k1_at_s1
    v_mov_b32 v22, s56
    v_mov_b32 v23, 1
    s_mov_b64 exec, 1
    global_atomic_add v22, v23, s[64:65]
    s_mov_b64 exec, -1

k1_at_s1:
    s_waitcnt lgkmcnt(8)
    v_mfma_f32_32x32x16_bf16 v[112:127], a[144:147], a[32:35], v[112:127]
    ds_read_b64_tr_b16 a[168:169], v1 offset:5184
    ds_read_b64_tr_b16 a[170:171], v1 offset:6464
    v_mfma_f32_32x32x16_bf16 v[128:143], a[148:151], a[32:35], v[128:143]
    ds_read_b64_tr_b16 a[172:173], v1 offset:5248
    ds_read_b64_tr_b16 a[174:175], v1 offset:6528
    s_add_u32 m0, s52, 61440
    s_mov_b32 s53, 1105920
    buffer_load_dwordx4 v5, s[36:39], s53 offen offset:0 lds
    s_waitcnt lgkmcnt(8)
    v_mfma_f32_32x32x16_bf16 v[144:159], a[152:155], a[32:35], v[144:159]
    ds_read_b64_tr_b16 a[144:145], v1 offset:5312
    ds_read_b64_tr_b16 a[146:147], v1 offset:6592
    v_mfma_f32_32x32x16_bf16 v[160:175], a[156:159], a[32:35], v[160:175]
    ds_read_b64_tr_b16 a[148:149], v3 offset:5376
    ds_read_b64_tr_b16 a[150:151], v3 offset:6656
    s_waitcnt lgkmcnt(8)
    v_mfma_f32_32x32x16_bf16 v[176:191], a[160:163], a[32:35], v[176:191]
    ds_read_b64_tr_b16 a[152:153], v1 offset:10240
    ds_read_b64_tr_b16 a[154:155], v1 offset:11520
    buffer_load_dwordx4 v6, s[36:39], s53 offen offset:1024 lds
    v_mfma_f32_32x32x16_bf16 v[112:127], a[164:167], a[36:39], v[112:127]
    ds_read_b64_tr_b16 a[156:157], v1 offset:10304
    ds_read_b64_tr_b16 a[158:159], v1 offset:11584
    s_waitcnt lgkmcnt(8)
    v_mfma_f32_32x32x16_bf16 v[128:143], a[168:171], a[36:39], v[128:143]
    ds_read_b64_tr_b16 a[160:161], v1 offset:10368
    ds_read_b64_tr_b16 a[162:163], v1 offset:11648
    v_mfma_f32_32x32x16_bf16 v[144:159], a[172:175], a[36:39], v[144:159]
    ds_read_b64_tr_b16 a[164:165], v1 offset:10432
    ds_read_b64_tr_b16 a[166:167], v1 offset:11712
    s_waitcnt lgkmcnt(8)
    v_mfma_f32_32x32x16_bf16 v[160:175], a[144:147], a[36:39], v[160:175]
    ds_read_b64_tr_b16 a[168:169], v3 offset:10496
    ds_read_b64_tr_b16 a[170:171], v3 offset:11776
    buffer_load_dwordx4 v7, s[36:39], s53 offen offset:2048 lds
    v_mfma_f32_32x32x16_bf16 v[176:191], a[148:151], a[36:39], v[176:191]
    ds_read_b64_tr_b16 a[172:173], v1 offset:15360
    ds_read_b64_tr_b16 a[174:175], v1 offset:16640
    s_waitcnt lgkmcnt(8)
    v_mfma_f32_32x32x16_bf16 v[112:127], a[152:155], a[40:43], v[112:127]
    ds_read_b64_tr_b16 a[144:145], v1 offset:15424
    ds_read_b64_tr_b16 a[146:147], v1 offset:16704
    v_mfma_f32_32x32x16_bf16 v[128:143], a[156:159], a[40:43], v[128:143]
    ds_read_b64_tr_b16 a[148:149], v1 offset:15488
    ds_read_b64_tr_b16 a[150:151], v1 offset:16768
    buffer_load_dwordx4 v8, s[36:39], s53 offen offset:3072 lds
    s_waitcnt lgkmcnt(8)
    v_mfma_f32_32x32x16_bf16 v[144:159], a[160:163], a[40:43], v[144:159]
    ds_read_b64_tr_b16 a[152:153], v1 offset:15552
    ds_read_b64_tr_b16 a[154:155], v1 offset:16832
    v_mfma_f32_32x32x16_bf16 v[160:175], a[164:167], a[40:43], v[160:175]
    ds_read_b64_tr_b16 a[156:157], v3 offset:15616
    ds_read_b64_tr_b16 a[158:159], v3 offset:16896
    s_waitcnt lgkmcnt(8)
    v_mfma_f32_32x32x16_bf16 v[176:191], a[168:171], a[40:43], v[176:191]
    ds_read_b64_tr_b16 a[160:161], v1 offset:20480
    ds_read_b64_tr_b16 a[162:163], v1 offset:21760
    v_mfma_f32_32x32x16_bf16 v[112:127], a[172:175], a[44:47], v[112:127]
    ds_read_b64_tr_b16 a[164:165], v1 offset:20544
    ds_read_b64_tr_b16 a[166:167], v1 offset:21824
    s_add_u32 m0, s52, 65536
    s_nop 0
    buffer_load_dwordx4 v9, s[36:39], s53 offen offset:0 lds
    s_waitcnt lgkmcnt(8)
    v_mfma_f32_32x32x16_bf16 v[128:143], a[144:147], a[44:47], v[128:143]
    ds_read_b64_tr_b16 a[168:169], v1 offset:20608
    ds_read_b64_tr_b16 a[170:171], v1 offset:21888
    v_mfma_f32_32x32x16_bf16 v[144:159], a[148:151], a[44:47], v[144:159]
    ds_read_b64_tr_b16 a[172:173], v1 offset:20672
    ds_read_b64_tr_b16 a[174:175], v1 offset:21952
    s_waitcnt lgkmcnt(8)
    v_mfma_f32_32x32x16_bf16 v[160:175], a[152:155], a[44:47], v[160:175]
    ds_read_b64_tr_b16 a[144:145], v3 offset:20736
    ds_read_b64_tr_b16 a[146:147], v3 offset:22016
    v_mfma_f32_32x32x16_bf16 v[176:191], a[156:159], a[44:47], v[176:191]
    ds_read_b64_tr_b16 a[148:149], v1 offset:25600
    ds_read_b64_tr_b16 a[150:151], v1 offset:26880
    s_waitcnt vmcnt(5)
    s_barrier
    v_mov_b32 v22, s56
    global_load_dword v23, v22, s[64:65] sc1
    s_waitcnt lgkmcnt(8)
    v_mfma_f32_32x32x16_bf16 v[112:127], a[160:163], a[48:51], v[112:127]
    ds_read_b64_tr_b16 a[152:153], v1 offset:25664
    ds_read_b64_tr_b16 a[154:155], v1 offset:26944
    v_mfma_f32_32x32x16_bf16 v[128:143], a[164:167], a[48:51], v[128:143]
    ds_read_b64_tr_b16 a[156:157], v1 offset:25728
    ds_read_b64_tr_b16 a[158:159], v1 offset:27008
    s_add_u32 m0, s52, 0
    s_mov_b32 s53, 1327104
    buffer_load_dwordx4 v5, s[36:39], s53 offen offset:0 lds
    s_waitcnt lgkmcnt(8)
    v_mfma_f32_32x32x16_bf16 v[144:159], a[168:171], a[48:51], v[144:159]
    ds_read_b64_tr_b16 a[160:161], v1 offset:25792
    ds_read_b64_tr_b16 a[162:163], v1 offset:27072
    v_mfma_f32_32x32x16_bf16 v[160:175], a[172:175], a[48:51], v[160:175]
    ds_read_b64_tr_b16 a[164:165], v3 offset:25856
    ds_read_b64_tr_b16 a[166:167], v3 offset:27136
    s_waitcnt lgkmcnt(8)
    v_mfma_f32_32x32x16_bf16 v[176:191], a[144:147], a[48:51], v[176:191]
    ds_read_b64_tr_b16 a[168:169], v1 offset:30720
    ds_read_b64_tr_b16 a[170:171], v1 offset:32000
    buffer_load_dwordx4 v6, s[36:39], s53 offen offset:1024 lds
    v_mfma_f32_32x32x16_bf16 v[112:127], a[148:151], a[52:55], v[112:127]
    ds_read_b64_tr_b16 a[172:173], v1 offset:30784
    ds_read_b64_tr_b16 a[174:175], v1 offset:32064
    s_waitcnt lgkmcnt(8)
    v_mfma_f32_32x32x16_bf16 v[128:143], a[152:155], a[52:55], v[128:143]
    ds_read_b64_tr_b16 a[144:145], v1 offset:30848
    ds_read_b64_tr_b16 a[146:147], v1 offset:32128
    v_mfma_f32_32x32x16_bf16 v[144:159], a[156:159], a[52:55], v[144:159]
    ds_read_b64_tr_b16 a[148:149], v1 offset:30912
    ds_read_b64_tr_b16 a[150:151], v1 offset:32192
    s_waitcnt lgkmcnt(8)
    v_mfma_f32_32x32x16_bf16 v[160:175], a[160:163], a[52:55], v[160:175]
    ds_read_b64_tr_b16 a[152:153], v3 offset:30976
    ds_read_b64_tr_b16 a[154:155], v3 offset:32256
    buffer_load_dwordx4 v7, s[36:39], s53 offen offset:2048 lds
    v_mfma_f32_32x32x16_bf16 v[176:191], a[164:167], a[52:55], v[176:191]
    ds_read_b64_tr_b16 a[156:157], v1 offset:35840
    ds_read_b64_tr_b16 a[158:159], v1 offset:37120
    s_waitcnt lgkmcnt(8)
    v_mfma_f32_32x32x16_bf16 v[112:127], a[168:171], a[56:59], v[112:127]
    ds_read_b64_tr_b16 a[160:161], v1 offset:35904
    ds_read_b64_tr_b16 a[162:163], v1 offset:37184
    v_mfma_f32_32x32x16_bf16 v[128:143], a[172:175], a[56:59], v[128:143]
    ds_read_b64_tr_b16 a[164:165], v1 offset:35968
    ds_read_b64_tr_b16 a[166:167], v1 offset:37248
    buffer_load_dwordx4 v8, s[36:39], s53 offen offset:3072 lds
    s_waitcnt lgkmcnt(8)
    v_mfma_f32_32x32x16_bf16 v[144:159], a[144:147], a[56:59], v[144:159]
    ds_read_b64_tr_b16 a[168:169], v1 offset:36032
    ds_read_b64_tr_b16 a[170:171], v1 offset:37312
    v_mfma_f32_32x32x16_bf16 v[160:175], a[148:151], a[56:59], v[160:175]
    ds_read_b64_tr_b16 a[172:173], v3 offset:36096
    ds_read_b64_tr_b16 a[174:175], v3 offset:37376
    s_waitcnt lgkmcnt(8)
    v_mfma_f32_32x32x16_bf16 v[176:191], a[152:155], a[56:59], v[176:191]
    ds_read_b64_tr_b16 a[144:145], v2 offset:0
    ds_read_b64_tr_b16 a[146:147], v2 offset:1280
    v_mfma_f32_32x32x16_bf16 v[112:127], a[156:159], a[60:63], v[112:127]
    ds_read_b64_tr_b16 a[148:149], v2 offset:64
    ds_read_b64_tr_b16 a[150:151], v2 offset:1344
    s_add_u32 m0, s52, 4096
    s_nop 0
    buffer_load_dwordx4 v9, s[36:39], s53 offen offset:0 lds
    s_waitcnt lgkmcnt(8)
    v_mfma_f32_32x32x16_bf16 v[128:143], a[160:163], a[60:63], v[128:143]
    ds_read_b64_tr_b16 a[152:153], v2 offset:128
    ds_read_b64_tr_b16 a[154:155], v2 offset:1408
    v_mfma_f32_32x32x16_bf16 v[144:159], a[164:167], a[60:63], v[144:159]
    ds_read_b64_tr_b16 a[156:157], v2 offset:192
    ds_read_b64_tr_b16 a[158:159], v2 offset:1472
    s_waitcnt lgkmcnt(8)
    v_mfma_f32_32x32x16_bf16 v[160:175], a[168:171], a[60:63], v[160:175]
    ds_read_b64_tr_b16 a[160:161], v4 offset:256
    ds_read_b64_tr_b16 a[162:163], v4 offset:1536
    v_mfma_f32_32x32x16_bf16 v[176:191], a[172:175], a[60:63], v[176:191]
    ds_read_b64_tr_b16 a[164:165], v2 offset:5120
    ds_read_b64_tr_b16 a[166:167], v2 offset:6400
    s_waitcnt vmcnt(5)
    s_barrier
    s_cmp_eq_u32 s58, 0
    s_cbranch_scc1 k1_at_nold

k1_at_p1:
    v_readfirstlane_b32 s28, v23
    s_cmp_ge_u32 s28, 16
    s_cbranch_scc1 k1_at_p1x
    s_sleep 4
    s_add_u32 s101, s101, 1
    s_cmp_ge_u32 s101, 4194304
    s_cbranch_scc1 k1_at_p1x
    global_load_dword v23, v22, s[64:65] sc1
    s_waitcnt vmcnt(0)
    s_branch k1_at_p1

k1_at_p1x:
    s_lshl_b32 s27, s24, 2
    s_add_u32 s27, s27, s26
    s_lshr_b32 s28, s27, 1
    s_and_b32 s29, s27, 1
    s_add_u32 s30, s28, 1
    s_lshr_b32 s30, s30, 2
    s_lshl_b32 s31, s30, 1
    s_sub_u32 s31, s28, s31
    s_mul_i32 s14, s21, 557056
    s_lshl_b32 s15, s28, 11
    s_add_u32 s14, s14, s15
    s_lshl_b32 s15, s29, 10
    s_add_u32 s14, s14, s15
    s_add_u32 s14, s14, 26214400
    s_mul_i32 s15, s21, 9216
    s_lshl_b32 s27, s31, 6
    s_add_u32 s15, s15, s27
    s_lshl_b32 s27, s29, 4
    s_add_u32 s15, s15, s27
    s_add_u32 s15, s15, 29884416
    v_lshrrev_b32 v24, 5, v0
    v_lshlrev_b32 v25, 5, v24
    v_and_b32 v26, 15, v0
    v_mul_u32_u24 v26, 576, v26
    v_add_u32 v25, v25, v26
    buffer_load_dwordx4 v[96:99], v25, s[32:35], s15 offen sc1

    buffer_load_dwordx4 v[32:35], v19, s[32:35], s14 offen sc1
    s_add_u32 s14, s14, 34816
    buffer_load_dwordx4 v[36:39], v19, s[32:35], s14 offen sc1
    s_add_u32 s14, s14, 34816
    buffer_load_dwordx4 v[40:43], v19, s[32:35], s14 offen sc1
    s_add_u32 s14, s14, 34816
    buffer_load_dwordx4 v[44:47], v19, s[32:35], s14 offen sc1
    s_add_u32 s14, s14, 34816
    buffer_load_dwordx4 v[48:51], v19, s[32:35], s14 offen sc1
    s_add_u32 s14, s14, 34816
    buffer_load_dwordx4 v[52:55], v19, s[32:35], s14 offen sc1
    s_add_u32 s14, s14, 34816
    buffer_load_dwordx4 v[56:59], v19, s[32:35], s14 offen sc1
    s_add_u32 s14, s14, 34816
    buffer_load_dwordx4 v[60:63], v19, s[32:35], s14 offen sc1
    s_add_u32 s14, s14, 34816
    buffer_load_dwordx4 v[64:67], v19, s[32:35], s14 offen sc1
    s_add_u32 s14, s14, 34816
    buffer_load_dwordx4 v[68:71], v19, s[32:35], s14 offen sc1
    s_add_u32 s14, s14, 34816
    buffer_load_dwordx4 v[72:75], v19, s[32:35], s14 offen sc1
    s_add_u32 s14, s14, 34816
    buffer_load_dwordx4 v[76:79], v19, s[32:35], s14 offen sc1
    s_add_u32 s14, s14, 34816
    buffer_load_dwordx4 v[80:83], v19, s[32:35], s14 offen sc1
    s_add_u32 s14, s14, 34816
    buffer_load_dwordx4 v[84:87], v19, s[32:35], s14 offen sc1
    s_add_u32 s14, s14, 34816
    buffer_load_dwordx4 v[88:91], v19, s[32:35], s14 offen sc1
    s_add_u32 s14, s14, 34816
    buffer_load_dwordx4 v[92:95], v19, s[32:35], s14 offen sc1
k1_at_nold:
    s_waitcnt lgkmcnt(8)
    v_mfma_f32_32x32x16_bf16 v[112:127], a[144:147], a[64:67], v[112:127]
    ds_read_b64_tr_b16 a[168:169], v2 offset:5184
    ds_read_b64_tr_b16 a[170:171], v2 offset:6464
    v_mfma_f32_32x32x16_bf16 v[128:143], a[148:151], a[64:67], v[128:143]
    ds_read_b64_tr_b16 a[172:173], v2 offset:5248
    ds_read_b64_tr_b16 a[174:175], v2 offset:6528
    s_add_u32 m0, s52, 20480
    s_mov_b32 s53, 1548288
    buffer_load_dwordx4 v5, s[36:39], s53 offen offset:0 lds
    s_waitcnt lgkmcnt(8)
    v_mfma_f32_32x32x16_bf16 v[144:159], a[152:155], a[64:67], v[144:159]
    ds_read_b64_tr_b16 a[144:145], v2 offset:5312
    ds_read_b64_tr_b16 a[146:147], v2 offset:6592
    v_mfma_f32_32x32x16_bf16 v[160:175], a[156:159], a[64:67], v[160:175]
    ds_read_b64_tr_b16 a[148:149], v4 offset:5376
    ds_read_b64_tr_b16 a[150:151], v4 offset:6656
    s_waitcnt lgkmcnt(8)
    v_mfma_f32_32x32x16_bf16 v[176:191], a[160:163], a[64:67], v[176:191]
    ds_read_b64_tr_b16 a[152:153], v2 offset:10240
    ds_read_b64_tr_b16 a[154:155], v2 offset:11520
    buffer_load_dwordx4 v6, s[36:39], s53 offen offset:1024 lds
    v_mfma_f32_32x32x16_bf16 v[112:127], a[164:167], a[68:71], v[112:127]
    ds_read_b64_tr_b16 a[156:157], v2 offset:10304
    ds_read_b64_tr_b16 a[158:159], v2 offset:11584
    s_waitcnt lgkmcnt(8)
    v_mfma_f32_32x32x16_bf16 v[128:143], a[168:171], a[68:71], v[128:143]
    ds_read_b64_tr_b16 a[160:161], v2 offset:10368
    ds_read_b64_tr_b16 a[162:163], v2 offset:11648
    v_mfma_f32_32x32x16_bf16 v[144:159], a[172:175], a[68:71], v[144:159]
    ds_read_b64_tr_b16 a[164:165], v2 offset:10432
    ds_read_b64_tr_b16 a[166:167], v2 offset:11712
    s_waitcnt lgkmcnt(8)
    v_mfma_f32_32x32x16_bf16 v[160:175], a[144:147], a[68:71], v[160:175]
    ds_read_b64_tr_b16 a[168:169], v4 offset:10496
    ds_read_b64_tr_b16 a[170:171], v4 offset:11776
    buffer_load_dwordx4 v7, s[36:39], s53 offen offset:2048 lds
    v_mfma_f32_32x32x16_bf16 v[176:191], a[148:151], a[68:71], v[176:191]
    ds_read_b64_tr_b16 a[172:173], v2 offset:15360
    ds_read_b64_tr_b16 a[174:175], v2 offset:16640
    s_waitcnt lgkmcnt(8)
    v_mfma_f32_32x32x16_bf16 v[112:127], a[152:155], a[72:75], v[112:127]
    ds_read_b64_tr_b16 a[144:145], v2 offset:15424
    ds_read_b64_tr_b16 a[146:147], v2 offset:16704
    v_mfma_f32_32x32x16_bf16 v[128:143], a[156:159], a[72:75], v[128:143]
    ds_read_b64_tr_b16 a[148:149], v2 offset:15488
    ds_read_b64_tr_b16 a[150:151], v2 offset:16768
    buffer_load_dwordx4 v8, s[36:39], s53 offen offset:3072 lds
    s_waitcnt lgkmcnt(8)
    v_mfma_f32_32x32x16_bf16 v[144:159], a[160:163], a[72:75], v[144:159]
    ds_read_b64_tr_b16 a[152:153], v2 offset:15552
    ds_read_b64_tr_b16 a[154:155], v2 offset:16832
    v_mfma_f32_32x32x16_bf16 v[160:175], a[164:167], a[72:75], v[160:175]
    ds_read_b64_tr_b16 a[156:157], v4 offset:15616
    ds_read_b64_tr_b16 a[158:159], v4 offset:16896
    s_waitcnt lgkmcnt(8)
    v_mfma_f32_32x32x16_bf16 v[176:191], a[168:171], a[72:75], v[176:191]
    ds_read_b64_tr_b16 a[160:161], v2 offset:20480
    ds_read_b64_tr_b16 a[162:163], v2 offset:21760
    v_mfma_f32_32x32x16_bf16 v[112:127], a[172:175], a[76:79], v[112:127]
    ds_read_b64_tr_b16 a[164:165], v2 offset:20544
    ds_read_b64_tr_b16 a[166:167], v2 offset:21824
    s_add_u32 m0, s52, 24576
    s_nop 0
    buffer_load_dwordx4 v9, s[36:39], s53 offen offset:0 lds
    s_waitcnt lgkmcnt(8)
    v_mfma_f32_32x32x16_bf16 v[128:143], a[144:147], a[76:79], v[128:143]
    ds_read_b64_tr_b16 a[168:169], v2 offset:20608
    ds_read_b64_tr_b16 a[170:171], v2 offset:21888
    v_mfma_f32_32x32x16_bf16 v[144:159], a[148:151], a[76:79], v[144:159]
    ds_read_b64_tr_b16 a[172:173], v2 offset:20672
    ds_read_b64_tr_b16 a[174:175], v2 offset:21952
    s_waitcnt lgkmcnt(8)
    v_mfma_f32_32x32x16_bf16 v[160:175], a[152:155], a[76:79], v[160:175]
    ds_read_b64_tr_b16 a[144:145], v4 offset:20736
    ds_read_b64_tr_b16 a[146:147], v4 offset:22016
    v_mfma_f32_32x32x16_bf16 v[176:191], a[156:159], a[76:79], v[176:191]
    ds_read_b64_tr_b16 a[148:149], v2 offset:25600
    ds_read_b64_tr_b16 a[150:151], v2 offset:26880
    s_cmp_eq_u32 s58, 1
    s_cbranch_scc1 k1_at_w23a
    s_waitcnt vmcnt(5)
    s_branch k1_at_w23b
k1_at_w23a:
    s_waitcnt vmcnt(22)
k1_at_w23b:
    s_barrier
    s_waitcnt lgkmcnt(8)
    v_mfma_f32_32x32x16_bf16 v[112:127], a[160:163], a[80:83], v[112:127]
    ds_read_b64_tr_b16 a[152:153], v2 offset:25664
    ds_read_b64_tr_b16 a[154:155], v2 offset:26944
    v_mfma_f32_32x32x16_bf16 v[128:143], a[164:167], a[80:83], v[128:143]
    ds_read_b64_tr_b16 a[156:157], v2 offset:25728
    ds_read_b64_tr_b16 a[158:159], v2 offset:27008
    s_add_u32 m0, s52, 40960
    s_mov_b32 s53, 1769472
    buffer_load_dwordx4 v5, s[36:39], s53 offen offset:0 lds
    s_waitcnt lgkmcnt(8)
    v_mfma_f32_32x32x16_bf16 v[144:159], a[168:171], a[80:83], v[144:159]
    ds_read_b64_tr_b16 a[160:161], v2 offset:25792
    ds_read_b64_tr_b16 a[162:163], v2 offset:27072
    v_mfma_f32_32x32x16_bf16 v[160:175], a[172:175], a[80:83], v[160:175]
    ds_read_b64_tr_b16 a[164:165], v4 offset:25856
    ds_read_b64_tr_b16 a[166:167], v4 offset:27136
    s_waitcnt lgkmcnt(8)
    v_mfma_f32_32x32x16_bf16 v[176:191], a[144:147], a[80:83], v[176:191]
    ds_read_b64_tr_b16 a[168:169], v2 offset:30720
    ds_read_b64_tr_b16 a[170:171], v2 offset:32000
    buffer_load_dwordx4 v6, s[36:39], s53 offen offset:1024 lds
    v_mfma_f32_32x32x16_bf16 v[112:127], a[148:151], a[84:87], v[112:127]
    ds_read_b64_tr_b16 a[172:173], v2 offset:30784
    ds_read_b64_tr_b16 a[174:175], v2 offset:32064
    s_waitcnt lgkmcnt(8)
    v_mfma_f32_32x32x16_bf16 v[128:143], a[152:155], a[84:87], v[128:143]
    ds_read_b64_tr_b16 a[144:145], v2 offset:30848
    ds_read_b64_tr_b16 a[146:147], v2 offset:32128
    v_mfma_f32_32x32x16_bf16 v[144:159], a[156:159], a[84:87], v[144:159]
    ds_read_b64_tr_b16 a[148:149], v2 offset:30912
    ds_read_b64_tr_b16 a[150:151], v2 offset:32192
    s_waitcnt lgkmcnt(8)
    v_mfma_f32_32x32x16_bf16 v[160:175], a[160:163], a[84:87], v[160:175]
    ds_read_b64_tr_b16 a[152:153], v4 offset:30976
    ds_read_b64_tr_b16 a[154:155], v4 offset:32256
    buffer_load_dwordx4 v7, s[36:39], s53 offen offset:2048 lds
    v_mfma_f32_32x32x16_bf16 v[176:191], a[164:167], a[84:87], v[176:191]
    ds_read_b64_tr_b16 a[156:157], v2 offset:35840
    ds_read_b64_tr_b16 a[158:159], v2 offset:37120
    s_waitcnt lgkmcnt(8)
    v_mfma_f32_32x32x16_bf16 v[112:127], a[168:171], a[88:91], v[112:127]
    ds_read_b64_tr_b16 a[160:161], v2 offset:35904
    ds_read_b64_tr_b16 a[162:163], v2 offset:37184
    v_mfma_f32_32x32x16_bf16 v[128:143], a[172:175], a[88:91], v[128:143]
    ds_read_b64_tr_b16 a[164:165], v2 offset:35968
    ds_read_b64_tr_b16 a[166:167], v2 offset:37248
    buffer_load_dwordx4 v8, s[36:39], s53 offen offset:3072 lds
    s_waitcnt lgkmcnt(8)
    v_mfma_f32_32x32x16_bf16 v[144:159], a[144:147], a[88:91], v[144:159]
    ds_read_b64_tr_b16 a[168:169], v2 offset:36032
    ds_read_b64_tr_b16 a[170:171], v2 offset:37312
    v_mfma_f32_32x32x16_bf16 v[160:175], a[148:151], a[88:91], v[160:175]
    ds_read_b64_tr_b16 a[172:173], v4 offset:36096
    ds_read_b64_tr_b16 a[174:175], v4 offset:37376
    s_waitcnt lgkmcnt(8)
    v_mfma_f32_32x32x16_bf16 v[176:191], a[152:155], a[88:91], v[176:191]
    ds_read_b64_tr_b16 a[144:145], v1 offset:0
    ds_read_b64_tr_b16 a[146:147], v1 offset:1280
    v_mfma_f32_32x32x16_bf16 v[112:127], a[156:159], a[92:95], v[112:127]
    ds_read_b64_tr_b16 a[148:149], v1 offset:64
    ds_read_b64_tr_b16 a[150:151], v1 offset:1344
    s_add_u32 m0, s52, 45056
    s_nop 0
    buffer_load_dwordx4 v9, s[36:39], s53 offen offset:0 lds
    s_waitcnt lgkmcnt(8)
    v_mfma_f32_32x32x16_bf16 v[128:143], a[160:163], a[92:95], v[128:143]
    ds_read_b64_tr_b16 a[152:153], v1 offset:128
    ds_read_b64_tr_b16 a[154:155], v1 offset:1408
    v_mfma_f32_32x32x16_bf16 v[144:159], a[164:167], a[92:95], v[144:159]
    ds_read_b64_tr_b16 a[156:157], v1 offset:192
    ds_read_b64_tr_b16 a[158:159], v1 offset:1472
    s_waitcnt lgkmcnt(8)
    v_mfma_f32_32x32x16_bf16 v[160:175], a[168:171], a[92:95], v[160:175]
    ds_read_b64_tr_b16 a[160:161], v3 offset:256
    ds_read_b64_tr_b16 a[162:163], v3 offset:1536
    v_mfma_f32_32x32x16_bf16 v[176:191], a[172:175], a[92:95], v[176:191]
    ds_read_b64_tr_b16 a[164:165], v1 offset:5120
    ds_read_b64_tr_b16 a[166:167], v1 offset:6400
    s_waitcnt vmcnt(5)
    s_barrier
    s_cmp_eq_u32 s58, 0
    s_cbranch_scc1 k1_at_nored
    v_and_b32 v25, 31, v0
    s_lshl_b32 s27, s30, 5
    v_add_u32 v26, s27, v25
    s_mov_b32 s27, 3641
    v_mul_u32_u24 v26, s27, v26
    v_lshrrev_b32 v26, 16, v26
    s_cmp_eq_u32 s30, 4
    s_cselect_b32 s14, 16, 32
    v_cmp_gt_u32 vcc, s14, v25
    v_mov_b32 v27, 0xff
    s_nop 0
    v_cndmask_b32 v25, v27, v26, vcc
    s_lshl_b32 s14, s31, 4
    s_lshl_b32 s15, s29, 3
    s_add_u32 s14, s14, s15
    v_lshlrev_b32 v26, 2, v24
    v_add_u32 v26, s14, v26
    s_waitcnt vmcnt(5)

    v_add_f32_dpp v96, v96, v96 row_ror:8 row_mask:0xf bank_mask:0xf
    v_add_f32_dpp v97, v97, v97 row_ror:8 row_mask:0xf bank_mask:0xf
    v_add_f32_dpp v98, v98, v98 row_ror:8 row_mask:0xf bank_mask:0xf
    v_add_f32_dpp v99, v99, v99 row_ror:8 row_mask:0xf bank_mask:0xf
    v_add_f32_dpp v96, v96, v96 row_ror:4 row_mask:0xf bank_mask:0xf
    v_add_f32_dpp v97, v97, v97 row_ror:4 row_mask:0xf bank_mask:0xf
    v_add_f32_dpp v98, v98, v98 row_ror:4 row_mask:0xf bank_mask:0xf
    v_add_f32_dpp v99, v99, v99 row_ror:4 row_mask:0xf bank_mask:0xf
    v_add_f32_dpp v96, v96, v96 row_ror:2 row_mask:0xf bank_mask:0xf
    v_add_f32_dpp v97, v97, v97 row_ror:2 row_mask:0xf bank_mask:0xf
    v_add_f32_dpp v98, v98, v98 row_ror:2 row_mask:0xf bank_mask:0xf
    v_add_f32_dpp v99, v99, v99 row_ror:2 row_mask:0xf bank_mask:0xf
    v_add_f32_dpp v96, v96, v96 row_ror:1 row_mask:0xf bank_mask:0xf
    v_add_f32_dpp v97, v97, v97 row_ror:1 row_mask:0xf bank_mask:0xf
    v_add_f32_dpp v98, v98, v98 row_ror:1 row_mask:0xf bank_mask:0xf
    v_add_f32_dpp v99, v99, v99 row_ror:1 row_mask:0xf bank_mask:0xf
    v_pk_add_f32 v[32:33], v[32:33], v[64:65]
    v_pk_add_f32 v[34:35], v[34:35], v[66:67]
    v_pk_add_f32 v[36:37], v[36:37], v[68:69]
    v_pk_add_f32 v[38:39], v[38:39], v[70:71]
    v_pk_add_f32 v[40:41], v[40:41], v[72:73]
    v_pk_add_f32 v[42:43], v[42:43], v[74:75]
    v_pk_add_f32 v[44:45], v[44:45], v[76:77]
    v_pk_add_f32 v[46:47], v[46:47], v[78:79]
    v_pk_add_f32 v[48:49], v[48:49], v[80:81]
    v_pk_add_f32 v[50:51], v[50:51], v[82:83]
    v_pk_add_f32 v[52:53], v[52:53], v[84:85]
    v_pk_add_f32 v[54:55], v[54:55], v[86:87]
    v_pk_add_f32 v[56:57], v[56:57], v[88:89]
    v_pk_add_f32 v[58:59], v[58:59], v[90:91]
    v_pk_add_f32 v[60:61], v[60:61], v[92:93]
    v_pk_add_f32 v[62:63], v[62:63], v[94:95]
    v_pk_add_f32 v[32:33], v[32:33], v[48:49]
    v_pk_add_f32 v[34:35], v[34:35], v[50:51]
    v_pk_add_f32 v[36:37], v[36:37], v[52:53]
    v_pk_add_f32 v[38:39], v[38:39], v[54:55]
    v_pk_add_f32 v[40:41], v[40:41], v[56:57]
    v_pk_add_f32 v[42:43], v[42:43], v[58:59]
    v_pk_add_f32 v[44:45], v[44:45], v[60:61]
    v_pk_add_f32 v[46:47], v[46:47], v[62:63]
    v_pk_add_f32 v[32:33], v[32:33], v[40:41]
    v_pk_add_f32 v[34:35], v[34:35], v[42:43]
    v_pk_add_f32 v[36:37], v[36:37], v[44:45]
    v_pk_add_f32 v[38:39], v[38:39], v[46:47]
    v_pk_add_f32 v[32:33], v[32:33], v[36:37]
    v_pk_add_f32 v[34:35], v[34:35], v[38:39]
    v_add_u32 v27, 0, v26
    v_mul_u32_u24 v27, s27, v27
    v_lshrrev_b32 v27, 16, v27
    v_cmp_eq_u32 vcc, v27, v25
    s_nop 1
    v_cndmask_b32 v32, 0, v32, vcc
    v_cndmask_b32 v96, 0, v96, vcc
    v_add_u32 v27, 1, v26
    v_mul_u32_u24 v27, s27, v27
    v_lshrrev_b32 v27, 16, v27
    v_cmp_eq_u32 vcc, v27, v25
    s_nop 1
    v_cndmask_b32 v33, 0, v33, vcc
    v_cndmask_b32 v97, 0, v97, vcc
    v_add_u32 v27, 2, v26
    v_mul_u32_u24 v27, s27, v27
    v_lshrrev_b32 v27, 16, v27
    v_cmp_eq_u32 vcc, v27, v25
    s_nop 1
    v_cndmask_b32 v34, 0, v34, vcc
    v_cndmask_b32 v98, 0, v98, vcc
    v_add_u32 v27, 3, v26
    v_mul_u32_u24 v27, s27, v27
    v_lshrrev_b32 v27, 16, v27
    v_cmp_eq_u32 vcc, v27, v25
    s_nop 1
    v_cndmask_b32 v35, 0, v35, vcc
    v_cndmask_b32 v99, 0, v99, vcc
    v_cvt_pk_bf16_f32 v100, v32, v33
    v_cvt_pk_bf16_f32 v101, v34, v35
    v_cvt_pk_bf16_f32 v102, v96, v97
    v_cvt_pk_bf16_f32 v103, v98, v99
    s_mul_i32 s14, s21, 17
    s_add_u32 s14, s14, s28
    s_lshl_b32 s14, s14, 10
    s_lshl_b32 s15, s29, 3
    s_add_u32 s14, s14, s15
    s_add_u32 s15, s14, 31981568
    s_add_u32 s14, s14, 31457280
    buffer_store_dwordx2 v[100:101], v19, s[32:35], s14 offen sc1
    buffer_store_dwordx2 v[102:103], v19, s[32:35], s15 offen sc1

k1_at_nored:
    s_waitcnt lgkmcnt(8)
    v_mfma_f32_32x32x16_bf16 v[112:127], a[144:147], a[96:99], v[112:127]
    ds_read_b64_tr_b16 a[168:169], v1 offset:5184
    ds_read_b64_tr_b16 a[170:171], v1 offset:6464
    v_mfma_f32_32x32x16_bf16 v[128:143], a[148:151], a[96:99], v[128:143]
    ds_read_b64_tr_b16 a[172:173], v1 offset:5248
    ds_read_b64_tr_b16 a[174:175], v1 offset:6528
    s_waitcnt lgkmcnt(8)
    v_mfma_f32_32x32x16_bf16 v[144:159], a[152:155], a[96:99], v[144:159]
    ds_read_b64_tr_b16 a[144:145], v1 offset:5312
    ds_read_b64_tr_b16 a[146:147], v1 offset:6592
    v_mfma_f32_32x32x16_bf16 v[160:175], a[156:159], a[96:99], v[160:175]
    ds_read_b64_tr_b16 a[148:149], v3 offset:5376
    ds_read_b64_tr_b16 a[150:151], v3 offset:6656
    s_waitcnt lgkmcnt(8)
    v_mfma_f32_32x32x16_bf16 v[176:191], a[160:163], a[96:99], v[176:191]
    ds_read_b64_tr_b16 a[152:153], v1 offset:10240
    ds_read_b64_tr_b16 a[154:155], v1 offset:11520
    v_mfma_f32_32x32x16_bf16 v[112:127], a[164:167], a[100:103], v[112:127]
    ds_read_b64_tr_b16 a[156:157], v1 offset:10304
    ds_read_b64_tr_b16 a[158:159], v1 offset:11584
    s_waitcnt lgkmcnt(8)
    v_mfma_f32_32x32x16_bf16 v[128:143], a[168:171], a[100:103], v[128:143]
    ds_read_b64_tr_b16 a[160:161], v1 offset:10368
    ds_read_b64_tr_b16 a[162:163], v1 offset:11648
    v_mfma_f32_32x32x16_bf16 v[144:159], a[172:175], a[100:103], v[144:159]
    ds_read_b64_tr_b16 a[164:165], v1 offset:10432
    ds_read_b64_tr_b16 a[166:167], v1 offset:11712
    s_waitcnt lgkmcnt(8)
    v_mfma_f32_32x32x16_bf16 v[160:175], a[144:147], a[100:103], v[160:175]
    ds_read_b64_tr_b16 a[168:169], v3 offset:10496
    ds_read_b64_tr_b16 a[170:171], v3 offset:11776
    v_mfma_f32_32x32x16_bf16 v[176:191], a[148:151], a[100:103], v[176:191]
    ds_read_b64_tr_b16 a[172:173], v1 offset:15360
    ds_read_b64_tr_b16 a[174:175], v1 offset:16640
    s_waitcnt lgkmcnt(8)
    v_mfma_f32_32x32x16_bf16 v[112:127], a[152:155], a[104:107], v[112:127]
    ds_read_b64_tr_b16 a[144:145], v1 offset:15424
    ds_read_b64_tr_b16 a[146:147], v1 offset:16704
    v_mfma_f32_32x32x16_bf16 v[128:143], a[156:159], a[104:107], v[128:143]
    ds_read_b64_tr_b16 a[148:149], v1 offset:15488
    ds_read_b64_tr_b16 a[150:151], v1 offset:16768
    s_waitcnt lgkmcnt(8)
    v_mfma_f32_32x32x16_bf16 v[144:159], a[160:163], a[104:107], v[144:159]
    ds_read_b64_tr_b16 a[152:153], v1 offset:15552
    ds_read_b64_tr_b16 a[154:155], v1 offset:16832
    v_mfma_f32_32x32x16_bf16 v[160:175], a[164:167], a[104:107], v[160:175]
    ds_read_b64_tr_b16 a[156:157], v3 offset:15616
    ds_read_b64_tr_b16 a[158:159], v3 offset:16896
    s_waitcnt lgkmcnt(8)
    v_mfma_f32_32x32x16_bf16 v[176:191], a[168:171], a[104:107], v[176:191]
    ds_read_b64_tr_b16 a[160:161], v1 offset:20480
    ds_read_b64_tr_b16 a[162:163], v1 offset:21760
    v_mfma_f32_32x32x16_bf16 v[112:127], a[172:175], a[108:111], v[112:127]
    ds_read_b64_tr_b16 a[164:165], v1 offset:20544
    ds_read_b64_tr_b16 a[166:167], v1 offset:21824
    s_waitcnt lgkmcnt(8)
    v_mfma_f32_32x32x16_bf16 v[128:143], a[144:147], a[108:111], v[128:143]
    ds_read_b64_tr_b16 a[168:169], v1 offset:20608
    ds_read_b64_tr_b16 a[170:171], v1 offset:21888
    v_mfma_f32_32x32x16_bf16 v[144:159], a[148:151], a[108:111], v[144:159]
    ds_read_b64_tr_b16 a[172:173], v1 offset:20672
    ds_read_b64_tr_b16 a[174:175], v1 offset:21952
    s_waitcnt lgkmcnt(8)
    v_mfma_f32_32x32x16_bf16 v[160:175], a[152:155], a[108:111], v[160:175]
    ds_read_b64_tr_b16 a[144:145], v3 offset:20736
    ds_read_b64_tr_b16 a[146:147], v3 offset:22016
    v_mfma_f32_32x32x16_bf16 v[176:191], a[156:159], a[108:111], v[176:191]
    ds_read_b64_tr_b16 a[148:149], v1 offset:25600
    ds_read_b64_tr_b16 a[150:151], v1 offset:26880
    s_waitcnt vmcnt(0)
    s_barrier
    s_waitcnt lgkmcnt(8)
    v_mfma_f32_32x32x16_bf16 v[112:127], a[160:163], a[112:115], v[112:127]
    ds_read_b64_tr_b16 a[152:153], v1 offset:25664
    ds_read_b64_tr_b16 a[154:155], v1 offset:26944
    v_mfma_f32_32x32x16_bf16 v[128:143], a[164:167], a[112:115], v[128:143]
    ds_read_b64_tr_b16 a[156:157], v1 offset:25728
    ds_read_b64_tr_b16 a[158:159], v1 offset:27008
    s_waitcnt lgkmcnt(8)
    v_mfma_f32_32x32x16_bf16 v[144:159], a[168:171], a[112:115], v[144:159]
    ds_read_b64_tr_b16 a[160:161], v1 offset:25792
    ds_read_b64_tr_b16 a[162:163], v1 offset:27072
    v_mfma_f32_32x32x16_bf16 v[160:175], a[172:175], a[112:115], v[160:175]
    ds_read_b64_tr_b16 a[164:165], v3 offset:25856
    ds_read_b64_tr_b16 a[166:167], v3 offset:27136
    s_waitcnt lgkmcnt(8)
    v_mfma_f32_32x32x16_bf16 v[176:191], a[144:147], a[112:115], v[176:191]
    ds_read_b64_tr_b16 a[168:169], v1 offset:30720
    ds_read_b64_tr_b16 a[170:171], v1 offset:32000
    v_mfma_f32_32x32x16_bf16 v[112:127], a[148:151], a[116:119], v[112:127]
    ds_read_b64_tr_b16 a[172:173], v1 offset:30784
    ds_read_b64_tr_b16 a[174:175], v1 offset:32064
    s_waitcnt lgkmcnt(8)
    v_mfma_f32_32x32x16_bf16 v[128:143], a[152:155], a[116:119], v[128:143]
    ds_read_b64_tr_b16 a[144:145], v1 offset:30848
    ds_read_b64_tr_b16 a[146:147], v1 offset:32128
    v_mfma_f32_32x32x16_bf16 v[144:159], a[156:159], a[116:119], v[144:159]
    ds_read_b64_tr_b16 a[148:149], v1 offset:30912
    ds_read_b64_tr_b16 a[150:151], v1 offset:32192
    s_waitcnt lgkmcnt(8)
    v_mfma_f32_32x32x16_bf16 v[160:175], a[160:163], a[116:119], v[160:175]
    ds_read_b64_tr_b16 a[152:153], v3 offset:30976
    ds_read_b64_tr_b16 a[154:155], v3 offset:32256
    v_mfma_f32_32x32x16_bf16 v[176:191], a[164:167], a[116:119], v[176:191]
    ds_read_b64_tr_b16 a[156:157], v1 offset:35840
    ds_read_b64_tr_b16 a[158:159], v1 offset:37120
    s_waitcnt lgkmcnt(8)
    v_mfma_f32_32x32x16_bf16 v[112:127], a[168:171], a[120:123], v[112:127]
    ds_read_b64_tr_b16 a[160:161], v1 offset:35904
    ds_read_b64_tr_b16 a[162:163], v1 offset:37184
    v_mfma_f32_32x32x16_bf16 v[128:143], a[172:175], a[120:123], v[128:143]
    ds_read_b64_tr_b16 a[164:165], v1 offset:35968
    ds_read_b64_tr_b16 a[166:167], v1 offset:37248
    s_waitcnt lgkmcnt(8)
    v_mfma_f32_32x32x16_bf16 v[144:159], a[144:147], a[120:123], v[144:159]
    ds_read_b64_tr_b16 a[168:169], v1 offset:36032
    ds_read_b64_tr_b16 a[170:171], v1 offset:37312
    v_mfma_f32_32x32x16_bf16 v[160:175], a[148:151], a[120:123], v[160:175]
    ds_read_b64_tr_b16 a[172:173], v3 offset:36096
    ds_read_b64_tr_b16 a[174:175], v3 offset:37376
    s_waitcnt lgkmcnt(8)
    v_mfma_f32_32x32x16_bf16 v[176:191], a[152:155], a[120:123], v[176:191]
    ds_read_b64_tr_b16 a[144:145], v2 offset:0
    ds_read_b64_tr_b16 a[146:147], v2 offset:1280
    v_mfma_f32_32x32x16_bf16 v[112:127], a[156:159], a[124:127], v[112:127]
    ds_read_b64_tr_b16 a[148:149], v2 offset:64
    ds_read_b64_tr_b16 a[150:151], v2 offset:1344
    s_waitcnt lgkmcnt(8)
    v_mfma_f32_32x32x16_bf16 v[128:143], a[160:163], a[124:127], v[128:143]
    ds_read_b64_tr_b16 a[152:153], v2 offset:128
    ds_read_b64_tr_b16 a[154:155], v2 offset:1408
    v_mfma_f32_32x32x16_bf16 v[144:159], a[164:167], a[124:127], v[144:159]
    ds_read_b64_tr_b16 a[156:157], v2 offset:192
    ds_read_b64_tr_b16 a[158:159], v2 offset:1472
    s_waitcnt lgkmcnt(8)
    v_mfma_f32_32x32x16_bf16 v[160:175], a[168:171], a[124:127], v[160:175]
    ds_read_b64_tr_b16 a[160:161], v4 offset:256
    ds_read_b64_tr_b16 a[162:163], v4 offset:1536
    v_mfma_f32_32x32x16_bf16 v[176:191], a[172:175], a[124:127], v[176:191]
    ds_read_b64_tr_b16 a[164:165], v2 offset:5120
    ds_read_b64_tr_b16 a[166:167], v2 offset:6400
    s_waitcnt vmcnt(0)
    s_barrier
    s_cmp_gt_u32 s24, 8
    s_cbranch_scc1 k1_at_s2

    s_cmp_lg_u32 s26, 0
    s_cbranch_scc1 k1_at_s2
    v_mov_b32 v22, s57
    v_mov_b32 v23, 1
    s_mov_b64 exec, 1
    global_atomic_add v22, v23, s[64:65]
    s_mov_b64 exec, -1

k1_at_s2:
    s_waitcnt lgkmcnt(8)
    v_mfma_f32_32x32x16_bf16 v[112:127], a[144:147], a[128:131], v[112:127]
    ds_read_b64_tr_b16 a[168:169], v2 offset:5184
    ds_read_b64_tr_b16 a[170:171], v2 offset:6464
    v_mfma_f32_32x32x16_bf16 v[128:143], a[148:151], a[128:131], v[128:143]
    ds_read_b64_tr_b16 a[172:173], v2 offset:5248
    ds_read_b64_tr_b16 a[174:175], v2 offset:6528
    s_waitcnt lgkmcnt(8)
    v_mfma_f32_32x32x16_bf16 v[144:159], a[152:155], a[128:131], v[144:159]
    ds_read_b64_tr_b16 a[144:145], v2 offset:5312
    ds_read_b64_tr_b16 a[146:147], v2 offset:6592
    v_mfma_f32_32x32x16_bf16 v[160:175], a[156:159], a[128:131], v[160:175]
    ds_read_b64_tr_b16 a[148:149], v4 offset:5376
    ds_read_b64_tr_b16 a[150:151], v4 offset:6656
    s_waitcnt lgkmcnt(8)
    v_mfma_f32_32x32x16_bf16 v[176:191], a[160:163], a[128:131], v[176:191]
    ds_read_b64_tr_b16 a[152:153], v2 offset:10240
    ds_read_b64_tr_b16 a[154:155], v2 offset:11520
    v_mfma_f32_32x32x16_bf16 v[112:127], a[164:167], a[132:135], v[112:127]
    ds_read_b64_tr_b16 a[156:157], v2 offset:10304
    ds_read_b64_tr_b16 a[158:159], v2 offset:11584
    s_waitcnt lgkmcnt(8)
    v_mfma_f32_32x32x16_bf16 v[128:143], a[168:171], a[132:135], v[128:143]
    ds_read_b64_tr_b16 a[160:161], v2 offset:10368
    ds_read_b64_tr_b16 a[162:163], v2 offset:11648
    v_mfma_f32_32x32x16_bf16 v[144:159], a[172:175], a[132:135], v[144:159]
    ds_read_b64_tr_b16 a[164:165], v2 offset:10432
    ds_read_b64_tr_b16 a[166:167], v2 offset:11712
    s_waitcnt lgkmcnt(8)
    v_mfma_f32_32x32x16_bf16 v[160:175], a[144:147], a[132:135], v[160:175]
    ds_read_b64_tr_b16 a[168:169], v4 offset:10496
    ds_read_b64_tr_b16 a[170:171], v4 offset:11776
    v_mfma_f32_32x32x16_bf16 v[176:191], a[148:151], a[132:135], v[176:191]
    ds_read_b64_tr_b16 a[172:173], v2 offset:15360
    ds_read_b64_tr_b16 a[174:175], v2 offset:16640
    s_waitcnt lgkmcnt(8)
    v_mfma_f32_32x32x16_bf16 v[112:127], a[152:155], a[136:139], v[112:127]
    ds_read_b64_tr_b16 a[144:145], v2 offset:15424
    ds_read_b64_tr_b16 a[146:147], v2 offset:16704
    v_mfma_f32_32x32x16_bf16 v[128:143], a[156:159], a[136:139], v[128:143]
    ds_read_b64_tr_b16 a[148:149], v2 offset:15488
    ds_read_b64_tr_b16 a[150:151], v2 offset:16768
    s_waitcnt lgkmcnt(8)
    v_mfma_f32_32x32x16_bf16 v[144:159], a[160:163], a[136:139], v[144:159]
    ds_read_b64_tr_b16 a[152:153], v2 offset:15552
    ds_read_b64_tr_b16 a[154:155], v2 offset:16832
    v_mfma_f32_32x32x16_bf16 v[160:175], a[164:167], a[136:139], v[160:175]
    ds_read_b64_tr_b16 a[156:157], v4 offset:15616
    ds_read_b64_tr_b16 a[158:159], v4 offset:16896
    s_waitcnt lgkmcnt(8)
    v_mfma_f32_32x32x16_bf16 v[176:191], a[168:171], a[136:139], v[176:191]
    v_mfma_f32_32x32x16_bf16 v[112:127], a[172:175], a[140:143], v[112:127]
    s_waitcnt lgkmcnt(4)
    v_mfma_f32_32x32x16_bf16 v[128:143], a[144:147], a[140:143], v[128:143]
    v_mfma_f32_32x32x16_bf16 v[144:159], a[148:151], a[140:143], v[144:159]
    s_waitcnt lgkmcnt(0)
    v_mfma_f32_32x32x16_bf16 v[160:175], a[152:155], a[140:143], v[160:175]
    v_mfma_f32_32x32x16_bf16 v[176:191], a[156:159], a[140:143], v[176:191]
    s_add_u32 s98, s10, 58720256
    s_addc_u32 s99, s11, 0
    v_mov_b32 v22, s57
    s_cmp_lg_u32 s26, 0
    s_cbranch_scc1 k1_at_np2
    global_load_dword v23, v22, s[98:99] sc1

k1_at_np2:
    s_and_b32 s27, s2, 7
    s_lshr_b32 s70, s27, 1
    s_and_b32 s27, s27, 1
    s_lshl_b32 s27, s27, 3
    s_bfe_u32 s71, s2, 0x30003
    s_add_u32 s71, s71, s27
    s_lshr_b32 s72, s2, 6
    s_lshl_b32 s81, s71, 2
    s_add_u32 s81, s81, s70
    v_lshlrev_b32 v11, 4, v0
    v_add_u32 v12, 4096, v11
    v_add_u32 v13, 8192, v11
    s_lshl_b32 s27, s71, 13
    s_lshl_b32 s28, s26, 11
    s_add_u32 s27, s27, s28
    v_add_u32 v18, s27, v11
    s_mul_i32 s73, s26, 9216
    s_mov_b32 s12, s10
    s_mov_b32 s13, s11
    s_mov_b32 s14, 21233664
    s_mov_b32 s15, 0x20000
    s_mul_i32 s27, s72, 9216
    s_sub_u32 s18, 5971968, s27
    s_add_u32 s27, s27, 67108864
    s_add_u32 s16, s10, s27
    s_addc_u32 s17, s11, 0
    s_mov_b32 s19, 0x20000
    s_mul_i32 s75, s70, 4718592
    s_mul_i32 s76, s70, 1327104
    s_mul_i32 s77, s70, 5
    s_lshl_b32 s78, s70, 2
    s_add_u32 s78, s78, 2
    s_min_u32 s77, s77, s78
    s_cmp_lt_u32 s70, 2
    s_cselect_b32 s78, 5, 4
    s_add_u32 s27, s26, 0
    s_mul_i32 s28, s27, 43
    s_lshr_b32 s28, s28, 8
    s_mul_i32 s29, s28, 6
    s_sub_u32 s27, s27, s29
    s_lshl_b32 s28, s28, 1
    s_and_b32 s29, s27, 1
    s_add_u32 s28, s28, s29
    s_lshr_b32 s27, s27, 1
    s_mul_i32 s27, s27, 12
    s_add_u32 s27, s27, s28
    s_mul_i32 s27, s27, 36864
    s_add_u32 s82, s27, s76
    s_add_u32 s27, s26, 4
    s_mul_i32 s28, s27, 43
    s_lshr_b32 s28, s28, 8
    s_mul_i32 s29, s28, 6
    s_sub_u32 s27, s27, s29
    s_lshl_b32 s28, s28, 1
    s_and_b32 s29, s27, 1
    s_add_u32 s28, s28, s29
    s_lshr_b32 s27, s27, 1
    s_mul_i32 s27, s27, 12
    s_add_u32 s27, s27, s28
    s_mul_i32 s27, s27, 36864
    s_add_u32 s83, s27, s76
    s_add_u32 s27, s26, 8
    s_mul_i32 s28, s27, 43
    s_lshr_b32 s28, s28, 8
    s_mul_i32 s29, s28, 6
    s_sub_u32 s27, s27, s29
    s_lshl_b32 s28, s28, 1
    s_and_b32 s29, s27, 1
    s_add_u32 s28, s28, s29
    s_lshr_b32 s27, s27, 1
    s_mul_i32 s27, s27, 12
    s_add_u32 s27, s27, s28
    s_mul_i32 s27, s27, 36864
    s_add_u32 s84, s27, s76
    s_add_u32 s27, s26, 12
    s_mul_i32 s28, s27, 43
    s_lshr_b32 s28, s28, 8
    s_mul_i32 s29, s28, 6
    s_sub_u32 s27, s27, s29
    s_lshl_b32 s28, s28, 1
    s_and_b32 s29, s27, 1
    s_add_u32 s28, s28, s29
    s_lshr_b32 s27, s27, 1
    s_mul_i32 s27, s27, 12
    s_add_u32 s27, s27, s28
    s_mul_i32 s27, s27, 36864
    s_add_u32 s85, s27, s76
    s_add_u32 s27, s26, 16
    s_mul_i32 s28, s27, 43
    s_lshr_b32 s28, s28, 8
    s_mul_i32 s29, s28, 6
    s_sub_u32 s27, s27, s29
    s_lshl_b32 s28, s28, 1
    s_and_b32 s29, s27, 1
    s_add_u32 s28, s28, s29
    s_lshr_b32 s27, s27, 1
    s_mul_i32 s27, s27, 12
    s_add_u32 s27, s27, s28
    s_mul_i32 s27, s27, 36864
    s_add_u32 s86, s27, s76
    s_add_u32 s27, s26, 20
    s_mul_i32 s28, s27, 43
    s_lshr_b32 s28, s28, 8
    s_mul_i32 s29, s28, 6
    s_sub_u32 s27, s27, s29
    s_lshl_b32 s28, s28, 1
    s_and_b32 s29, s27, 1
    s_add_u32 s28, s28, s29
    s_lshr_b32 s27, s27, 1
    s_mul_i32 s27, s27, 12
    s_add_u32 s27, s27, s28
    s_mul_i32 s27, s27, 36864
    s_add_u32 s87, s27, s76
    s_add_u32 s27, s26, 24
    s_mul_i32 s28, s27, 43
    s_lshr_b32 s28, s28, 8
    s_mul_i32 s29, s28, 6
    s_sub_u32 s27, s27, s29
    s_lshl_b32 s28, s28, 1
    s_and_b32 s29, s27, 1
    s_add_u32 s28, s28, s29
    s_lshr_b32 s27, s27, 1
    s_mul_i32 s27, s27, 12
    s_add_u32 s27, s27, s28
    s_mul_i32 s27, s27, 36864
    s_add_u32 s88, s27, s76
    s_add_u32 s27, s26, 28
    s_mul_i32 s28, s27, 43
    s_lshr_b32 s28, s28, 8
    s_mul_i32 s29, s28, 6
    s_sub_u32 s27, s27, s29
    s_lshl_b32 s28, s28, 1
    s_and_b32 s29, s27, 1
    s_add_u32 s28, s28, s29
    s_lshr_b32 s27, s27, 1
    s_mul_i32 s27, s27, 12
    s_add_u32 s27, s27, s28
    s_mul_i32 s27, s27, 36864
    s_add_u32 s89, s27, s76
    s_add_u32 s27, s26, 32
    s_mul_i32 s28, s27, 43
    s_lshr_b32 s28, s28, 8
    s_mul_i32 s29, s28, 6
    s_sub_u32 s27, s27, s29
    s_lshl_b32 s28, s28, 1
    s_and_b32 s29, s27, 1
    s_add_u32 s28, s28, s29
    s_lshr_b32 s27, s27, 1
    s_mul_i32 s27, s27, 12
    s_add_u32 s27, s27, s28
    s_mul_i32 s27, s27, 36864
    s_add_u32 s90, s27, s76
    v_pk_mul_f32 v[208:209], v[112:113], s[60:61]
    v_pk_mul_f32 v[212:213], v[114:115], s[60:61]
    v_pk_mul_f32 v[216:217], v[116:117], s[60:61]
    v_pk_mul_f32 v[220:221], v[118:119], s[60:61]
    v_max_f32 v210, 0, v112
    v_max_f32 v214, 0, v114
    v_max_f32 v218, 0, v116
    v_max_f32 v222, 0, v118
    v_exp_f32 v208, v208 clamp
    v_exp_f32 v212, v212 clamp
    v_exp_f32 v216, v216 clamp
    v_exp_f32 v220, v220 clamp
    v_exp_f32 v209, v209 clamp
    v_exp_f32 v213, v213 clamp
    v_exp_f32 v217, v217 clamp
    v_exp_f32 v221, v221 clamp
    v_max_f32 v211, 0, v113
    v_max_f32 v215, 0, v115
    v_max_f32 v219, 0, v117
    v_max_f32 v223, 0, v119
    v_pk_add_f32 v[210:211], v[210:211], s[62:63]
    v_pk_add_f32 v[214:215], v[214:215], s[62:63]
    v_pk_add_f32 v[218:219], v[218:219], s[62:63]
    v_pk_add_f32 v[222:223], v[222:223], s[62:63]
    v_pk_add_f32 v[210:211], v[210:211], v[208:209]
    v_pk_add_f32 v[214:215], v[214:215], v[212:213]
    v_pk_add_f32 v[218:219], v[218:219], v[216:217]
    v_pk_add_f32 v[222:223], v[222:223], v[220:221]
    v_cvt_pk_bf16_f32 v32, v210, v211
    v_cvt_pk_bf16_f32 v33, v214, v215
    v_cvt_pk_bf16_f32 v34, v218, v219
    v_cvt_pk_bf16_f32 v35, v222, v223
    v_pk_mul_f32 v[208:209], v[120:121], s[60:61]
    v_pk_mul_f32 v[212:213], v[122:123], s[60:61]
    v_pk_mul_f32 v[216:217], v[124:125], s[60:61]
    v_pk_mul_f32 v[220:221], v[126:127], s[60:61]
    v_max_f32 v210, 0, v120
    v_max_f32 v214, 0, v122
    v_max_f32 v218, 0, v124
    v_max_f32 v222, 0, v126
    v_exp_f32 v208, v208 clamp
    v_exp_f32 v212, v212 clamp
    v_exp_f32 v216, v216 clamp
    v_exp_f32 v220, v220 clamp
    v_exp_f32 v209, v209 clamp
    v_exp_f32 v213, v213 clamp
    v_exp_f32 v217, v217 clamp
    v_exp_f32 v221, v221 clamp
    v_max_f32 v211, 0, v121
    v_max_f32 v215, 0, v123
    v_max_f32 v219, 0, v125
    v_max_f32 v223, 0, v127
    v_pk_add_f32 v[210:211], v[210:211], s[62:63]
    v_pk_add_f32 v[214:215], v[214:215], s[62:63]
    v_pk_add_f32 v[218:219], v[218:219], s[62:63]
    v_pk_add_f32 v[222:223], v[222:223], s[62:63]
    v_pk_add_f32 v[210:211], v[210:211], v[208:209]
    v_pk_add_f32 v[214:215], v[214:215], v[212:213]
    v_pk_add_f32 v[218:219], v[218:219], v[216:217]
    v_pk_add_f32 v[222:223], v[222:223], v[220:221]
    v_cvt_pk_bf16_f32 v36, v210, v211
    v_cvt_pk_bf16_f32 v37, v214, v215
    v_cvt_pk_bf16_f32 v38, v218, v219
    v_cvt_pk_bf16_f32 v39, v222, v223
    v_pk_mul_f32 v[208:209], v[128:129], s[60:61]
    v_pk_mul_f32 v[212:213], v[130:131], s[60:61]
    v_pk_mul_f32 v[216:217], v[132:133], s[60:61]
    v_pk_mul_f32 v[220:221], v[134:135], s[60:61]
    v_max_f32 v210, 0, v128
    v_max_f32 v214, 0, v130
    v_max_f32 v218, 0, v132
    v_max_f32 v222, 0, v134
    v_exp_f32 v208, v208 clamp
    v_exp_f32 v212, v212 clamp
    v_exp_f32 v216, v216 clamp
    v_exp_f32 v220, v220 clamp
    v_exp_f32 v209, v209 clamp
    v_exp_f32 v213, v213 clamp
    v_exp_f32 v217, v217 clamp
    v_exp_f32 v221, v221 clamp
    v_max_f32 v211, 0, v129
    v_max_f32 v215, 0, v131
    v_max_f32 v219, 0, v133
    v_max_f32 v223, 0, v135
    v_pk_add_f32 v[210:211], v[210:211], s[62:63]
    v_pk_add_f32 v[214:215], v[214:215], s[62:63]
    v_pk_add_f32 v[218:219], v[218:219], s[62:63]
    v_pk_add_f32 v[222:223], v[222:223], s[62:63]
    v_pk_add_f32 v[210:211], v[210:211], v[208:209]
    v_pk_add_f32 v[214:215], v[214:215], v[212:213]
    v_pk_add_f32 v[218:219], v[218:219], v[216:217]
    v_pk_add_f32 v[222:223], v[222:223], v[220:221]
    v_cvt_pk_bf16_f32 v40, v210, v211
    v_cvt_pk_bf16_f32 v41, v214, v215
    v_cvt_pk_bf16_f32 v42, v218, v219
    v_cvt_pk_bf16_f32 v43, v222, v223
    v_pk_mul_f32 v[208:209], v[136:137], s[60:61]
    v_pk_mul_f32 v[212:213], v[138:139], s[60:61]
    v_pk_mul_f32 v[216:217], v[140:141], s[60:61]
    v_pk_mul_f32 v[220:221], v[142:143], s[60:61]
    v_max_f32 v210, 0, v136
    v_max_f32 v214, 0, v138
    v_max_f32 v218, 0, v140
    v_max_f32 v222, 0, v142
    v_exp_f32 v208, v208 clamp
    v_exp_f32 v212, v212 clamp
    v_exp_f32 v216, v216 clamp
    v_exp_f32 v220, v220 clamp
    v_exp_f32 v209, v209 clamp
    v_exp_f32 v213, v213 clamp
    v_exp_f32 v217, v217 clamp
    v_exp_f32 v221, v221 clamp
    v_max_f32 v211, 0, v137
    v_max_f32 v215, 0, v139
    v_max_f32 v219, 0, v141
    v_max_f32 v223, 0, v143
    v_pk_add_f32 v[210:211], v[210:211], s[62:63]
    v_pk_add_f32 v[214:215], v[214:215], s[62:63]
    v_pk_add_f32 v[218:219], v[218:219], s[62:63]
    v_pk_add_f32 v[222:223], v[222:223], s[62:63]
    v_pk_add_f32 v[210:211], v[210:211], v[208:209]
    v_pk_add_f32 v[214:215], v[214:215], v[212:213]
    v_pk_add_f32 v[218:219], v[218:219], v[216:217]
    v_pk_add_f32 v[222:223], v[222:223], v[220:221]
    v_cvt_pk_bf16_f32 v44, v210, v211
    v_cvt_pk_bf16_f32 v45, v214, v215
    v_cvt_pk_bf16_f32 v46, v218, v219
    v_cvt_pk_bf16_f32 v47, v222, v223
    v_pk_mul_f32 v[208:209], v[144:145], s[60:61]
    v_pk_mul_f32 v[212:213], v[146:147], s[60:61]
    v_pk_mul_f32 v[216:217], v[148:149], s[60:61]
    v_pk_mul_f32 v[220:221], v[150:151], s[60:61]
    v_max_f32 v210, 0, v144
    v_max_f32 v214, 0, v146
    v_max_f32 v218, 0, v148
    v_max_f32 v222, 0, v150
    v_exp_f32 v208, v208 clamp
    v_exp_f32 v212, v212 clamp
    v_exp_f32 v216, v216 clamp
    v_exp_f32 v220, v220 clamp
    v_exp_f32 v209, v209 clamp
    v_exp_f32 v213, v213 clamp
    v_exp_f32 v217, v217 clamp
    v_exp_f32 v221, v221 clamp
    v_max_f32 v211, 0, v145
    v_max_f32 v215, 0, v147
    v_max_f32 v219, 0, v149
    v_max_f32 v223, 0, v151
    v_pk_add_f32 v[210:211], v[210:211], s[62:63]
    v_pk_add_f32 v[214:215], v[214:215], s[62:63]
    v_pk_add_f32 v[218:219], v[218:219], s[62:63]
    v_pk_add_f32 v[222:223], v[222:223], s[62:63]
    v_pk_add_f32 v[210:211], v[210:211], v[208:209]
    v_pk_add_f32 v[214:215], v[214:215], v[212:213]
    v_pk_add_f32 v[218:219], v[218:219], v[216:217]
    v_pk_add_f32 v[222:223], v[222:223], v[220:221]
    v_cvt_pk_bf16_f32 v48, v210, v211
    v_cvt_pk_bf16_f32 v49, v214, v215
    v_cvt_pk_bf16_f32 v50, v218, v219
    v_cvt_pk_bf16_f32 v51, v222, v223
    s_cmp_lg_u32 s26, 0
    s_cbranch_scc1 k1_at_p2d
    s_waitcnt vmcnt(0)

k1_at_p2:
    v_readfirstlane_b32 s28, v23
    s_cmp_ge_u32 s28, 9
    s_cbranch_scc1 k1_at_p2d
    s_sleep 2
    s_add_u32 s101, s101, 1
    s_cmp_ge_u32 s101, 4194304
    s_cbranch_scc1 k1_at_p2d
    global_load_dword v23, v22, s[98:99] sc1
    s_waitcnt vmcnt(0)
    s_branch k1_at_p2

k1_at_p2d:
    s_barrier
    s_mul_i32 s48, s21, 17408
    s_add_u32 s49, s48, 31981568
    s_add_u32 s48, s48, 31457280

    s_add_u32 s27, s26, 0
    s_lshl_b32 s28, s27, 10
    s_add_u32 m0, s28, 81920
    s_sub_u32 s29, s28, 17408
    s_add_u32 s29, s29, s49
    s_add_u32 s28, s28, s48
    s_cmp_ge_u32 s27, 17
    s_cselect_b32 s28, s29, s28
    buffer_load_dwordx4 v19, s[32:35], s28 offen sc1 lds
    s_add_u32 s27, s26, 4
    s_lshl_b32 s28, s27, 10
    s_add_u32 m0, s28, 81920
    s_sub_u32 s29, s28, 17408
    s_add_u32 s29, s29, s49
    s_add_u32 s28, s28, s48
    s_cmp_ge_u32 s27, 17
    s_cselect_b32 s28, s29, s28
    buffer_load_dwordx4 v19, s[32:35], s28 offen sc1 lds
    s_add_u32 s27, s26, 8
    s_lshl_b32 s28, s27, 10
    s_add_u32 m0, s28, 81920
    s_sub_u32 s29, s28, 17408
    s_add_u32 s29, s29, s49
    s_add_u32 s28, s28, s48
    s_cmp_ge_u32 s27, 17
    s_cselect_b32 s28, s29, s28
    buffer_load_dwordx4 v19, s[32:35], s28 offen sc1 lds
    s_add_u32 s27, s26, 12
    s_lshl_b32 s28, s27, 10
    s_add_u32 m0, s28, 81920
    s_sub_u32 s29, s28, 17408
    s_add_u32 s29, s29, s49
    s_add_u32 s28, s28, s48
    s_cmp_ge_u32 s27, 17
    s_cselect_b32 s28, s29, s28
    buffer_load_dwordx4 v19, s[32:35], s28 offen sc1 lds
    s_add_u32 s27, s26, 16
    s_lshl_b32 s28, s27, 10
    s_add_u32 m0, s28, 81920
    s_sub_u32 s29, s28, 17408
    s_add_u32 s29, s29, s49
    s_add_u32 s28, s28, s48
    s_cmp_ge_u32 s27, 17
    s_cselect_b32 s28, s29, s28
    buffer_load_dwordx4 v19, s[32:35], s28 offen sc1 lds
    s_add_u32 s27, s26, 20
    s_lshl_b32 s28, s27, 10
    s_add_u32 m0, s28, 81920
    s_sub_u32 s29, s28, 17408
    s_add_u32 s29, s29, s49
    s_add_u32 s28, s28, s48
    s_cmp_ge_u32 s27, 17
    s_cselect_b32 s28, s29, s28
    buffer_load_dwordx4 v19, s[32:35], s28 offen sc1 lds
    s_add_u32 s27, s26, 24
    s_lshl_b32 s28, s27, 10
    s_add_u32 m0, s28, 81920
    s_sub_u32 s29, s28, 17408
    s_add_u32 s29, s29, s49
    s_add_u32 s28, s28, s48
    s_cmp_ge_u32 s27, 17
    s_cselect_b32 s28, s29, s28
    buffer_load_dwordx4 v19, s[32:35], s28 offen sc1 lds
    s_add_u32 s27, s26, 28
    s_lshl_b32 s28, s27, 10
    s_add_u32 m0, s28, 81920
    s_sub_u32 s29, s28, 17408
    s_add_u32 s29, s29, s49
    s_add_u32 s28, s28, s48
    s_cmp_ge_u32 s27, 17
    s_cselect_b32 s28, s29, s28
    buffer_load_dwordx4 v19, s[32:35], s28 offen sc1 lds
    s_add_u32 s27, s26, 32
    s_cmp_ge_u32 s27, 34
    s_cbranch_scc1 k1_at_fl8
    s_lshl_b32 s28, s27, 10
    s_add_u32 m0, s28, 81920
    s_sub_u32 s29, s28, 17408
    s_add_u32 s29, s29, s49
    s_add_u32 s28, s28, s48
    s_cmp_ge_u32 s27, 17
    s_cselect_b32 s28, s29, s28
    buffer_load_dwordx4 v19, s[32:35], s28 offen sc1 lds
k1_at_fl8:
    s_cmp_lg_u32 s26, 0
    s_cbranch_scc1 k1_at_npf
    v_and_b32 v24, 15, v0
    v_lshlrev_b32 v24, 7, v24
    v_add_u32 v24, 26624, v24
    s_lshl_b32 s27, s81, 7
    s_add_u32 s27, s27, 28672
    v_mov_b32 v26, s27
    global_load_dword v25, v24, s[98:99] sc1
    global_load_dword v27, v26, s[98:99] sc1

k1_at_npf:
    v_pk_mul_f32 v[208:209], v[152:153], s[60:61]
    v_pk_mul_f32 v[212:213], v[154:155], s[60:61]
    v_pk_mul_f32 v[216:217], v[156:157], s[60:61]
    v_pk_mul_f32 v[220:221], v[158:159], s[60:61]
    v_max_f32 v210, 0, v152
    v_max_f32 v214, 0, v154
    v_max_f32 v218, 0, v156
    v_max_f32 v222, 0, v158
    v_exp_f32 v208, v208 clamp
    v_exp_f32 v212, v212 clamp
    v_exp_f32 v216, v216 clamp
    v_exp_f32 v220, v220 clamp
    v_exp_f32 v209, v209 clamp
    v_exp_f32 v213, v213 clamp
    v_exp_f32 v217, v217 clamp
    v_exp_f32 v221, v221 clamp
    v_max_f32 v211, 0, v153
    v_max_f32 v215, 0, v155
    v_max_f32 v219, 0, v157
    v_max_f32 v223, 0, v159
    v_pk_add_f32 v[210:211], v[210:211], s[62:63]
    v_pk_add_f32 v[214:215], v[214:215], s[62:63]
    v_pk_add_f32 v[218:219], v[218:219], s[62:63]
    v_pk_add_f32 v[222:223], v[222:223], s[62:63]
    v_pk_add_f32 v[210:211], v[210:211], v[208:209]
    v_pk_add_f32 v[214:215], v[214:215], v[212:213]
    v_pk_add_f32 v[218:219], v[218:219], v[216:217]
    v_pk_add_f32 v[222:223], v[222:223], v[220:221]
    v_cvt_pk_bf16_f32 v52, v210, v211
    v_cvt_pk_bf16_f32 v53, v214, v215
    v_cvt_pk_bf16_f32 v54, v218, v219
    v_cvt_pk_bf16_f32 v55, v222, v223
    v_pk_mul_f32 v[208:209], v[160:161], s[60:61]
    v_pk_mul_f32 v[212:213], v[162:163], s[60:61]
    v_pk_mul_f32 v[216:217], v[164:165], s[60:61]
    v_pk_mul_f32 v[220:221], v[166:167], s[60:61]
    v_max_f32 v210, 0, v160
    v_max_f32 v214, 0, v162
    v_max_f32 v218, 0, v164
    v_max_f32 v222, 0, v166
    v_exp_f32 v208, v208 clamp
    v_exp_f32 v212, v212 clamp
    v_exp_f32 v216, v216 clamp
    v_exp_f32 v220, v220 clamp
    v_exp_f32 v209, v209 clamp
    v_exp_f32 v213, v213 clamp
    v_exp_f32 v217, v217 clamp
    v_exp_f32 v221, v221 clamp
    v_max_f32 v211, 0, v161
    v_max_f32 v215, 0, v163
    v_max_f32 v219, 0, v165
    v_max_f32 v223, 0, v167
    v_pk_add_f32 v[210:211], v[210:211], s[62:63]
    v_pk_add_f32 v[214:215], v[214:215], s[62:63]
    v_pk_add_f32 v[218:219], v[218:219], s[62:63]
    v_pk_add_f32 v[222:223], v[222:223], s[62:63]
    v_pk_add_f32 v[210:211], v[210:211], v[208:209]
    v_pk_add_f32 v[214:215], v[214:215], v[212:213]
    v_pk_add_f32 v[218:219], v[218:219], v[216:217]
    v_pk_add_f32 v[222:223], v[222:223], v[220:221]
    v_cvt_pk_bf16_f32 v56, v210, v211
    v_cvt_pk_bf16_f32 v57, v214, v215
    v_cvt_pk_bf16_f32 v58, v218, v219
    v_cvt_pk_bf16_f32 v59, v222, v223
    v_pk_mul_f32 v[208:209], v[168:169], s[60:61]
    v_pk_mul_f32 v[212:213], v[170:171], s[60:61]
    v_pk_mul_f32 v[216:217], v[172:173], s[60:61]
    v_pk_mul_f32 v[220:221], v[174:175], s[60:61]
    v_max_f32 v210, 0, v168
    v_max_f32 v214, 0, v170
    v_max_f32 v218, 0, v172
    v_max_f32 v222, 0, v174
    v_exp_f32 v208, v208 clamp
    v_exp_f32 v212, v212 clamp
    v_exp_f32 v216, v216 clamp
    v_exp_f32 v220, v220 clamp
    v_exp_f32 v209, v209 clamp
    v_exp_f32 v213, v213 clamp
    v_exp_f32 v217, v217 clamp
    v_exp_f32 v221, v221 clamp
    v_max_f32 v211, 0, v169
    v_max_f32 v215, 0, v171
    v_max_f32 v219, 0, v173
    v_max_f32 v223, 0, v175
    v_pk_add_f32 v[210:211], v[210:211], s[62:63]
    v_pk_add_f32 v[214:215], v[214:215], s[62:63]
    v_pk_add_f32 v[218:219], v[218:219], s[62:63]
    v_pk_add_f32 v[222:223], v[222:223], s[62:63]
    v_pk_add_f32 v[210:211], v[210:211], v[208:209]
    v_pk_add_f32 v[214:215], v[214:215], v[212:213]
    v_pk_add_f32 v[218:219], v[218:219], v[216:217]
    v_pk_add_f32 v[222:223], v[222:223], v[220:221]
    v_cvt_pk_bf16_f32 v60, v210, v211
    v_cvt_pk_bf16_f32 v61, v214, v215
    v_cvt_pk_bf16_f32 v62, v218, v219
    v_cvt_pk_bf16_f32 v63, v222, v223
    v_pk_mul_f32 v[208:209], v[176:177], s[60:61]
    v_pk_mul_f32 v[212:213], v[178:179], s[60:61]
    v_pk_mul_f32 v[216:217], v[180:181], s[60:61]
    v_pk_mul_f32 v[220:221], v[182:183], s[60:61]
    v_max_f32 v210, 0, v176
    v_max_f32 v214, 0, v178
    v_max_f32 v218, 0, v180
    v_max_f32 v222, 0, v182
    v_exp_f32 v208, v208 clamp
    v_exp_f32 v212, v212 clamp
    v_exp_f32 v216, v216 clamp
    v_exp_f32 v220, v220 clamp
    v_exp_f32 v209, v209 clamp
    v_exp_f32 v213, v213 clamp
    v_exp_f32 v217, v217 clamp
    v_exp_f32 v221, v221 clamp
    v_max_f32 v211, 0, v177
    v_max_f32 v215, 0, v179
    v_max_f32 v219, 0, v181
    v_max_f32 v223, 0, v183
    v_pk_add_f32 v[210:211], v[210:211], s[62:63]
    v_pk_add_f32 v[214:215], v[214:215], s[62:63]
    v_pk_add_f32 v[218:219], v[218:219], s[62:63]
    v_pk_add_f32 v[222:223], v[222:223], s[62:63]
    v_pk_add_f32 v[210:211], v[210:211], v[208:209]
    v_pk_add_f32 v[214:215], v[214:215], v[212:213]
    v_pk_add_f32 v[218:219], v[218:219], v[216:217]
    v_pk_add_f32 v[222:223], v[222:223], v[220:221]
    v_cvt_pk_bf16_f32 v64, v210, v211
    v_cvt_pk_bf16_f32 v65, v214, v215
    v_cvt_pk_bf16_f32 v66, v218, v219
    v_cvt_pk_bf16_f32 v67, v222, v223
    s_mul_i32 s56, s21, 9
    v_add_u32 v22, 81920, v19
    s_waitcnt vmcnt(0)
    s_cmp_lg_u32 s26, 0
    s_cbranch_scc1 k1_at_pfx

k1_at_pf0:
    v_cmp_gt_u32 vcc, 12, v25
    v_readfirstlane_b32 s27, v27
    s_cmp_ge_u32 s27, 3
    s_cselect_b32 s27, 0, 1
    s_or_b32 s27, s27, vcc_lo
    s_or_b32 s27, s27, vcc_hi
    s_cmp_eq_u32 s27, 0
    s_cbranch_scc1 k1_at_pfx
    s_sleep 4
    s_add_u32 s101, s101, 1
    s_cmp_ge_u32 s101, 4194304
    s_cbranch_scc1 k1_at_pfx
    global_load_dword v25, v24, s[98:99] sc1
    global_load_dword v27, v26, s[98:99] sc1
    s_waitcnt vmcnt(0)
    s_branch k1_at_pf0

k1_at_pfx:
    s_barrier
    s_cmp_lg_u32 s26, 0
    s_cbranch_scc1 k1_at_npa
    s_lshl_b32 s27, s81, 7
    s_add_u32 s27, s27, 8192
    v_mov_b32 v26, s27
    global_load_dword v27, v26, s[98:99] sc1

k1_at_npa:
    ds_read_b128 v[208:211], v22 offset:0
    ds_read_b128 v[212:215], v22 offset:17408
    ds_read_b128 v[216:219], v22 offset:1024
    ds_read_b128 v[220:223], v22 offset:18432
    ds_read_b128 v[224:227], v22 offset:2048
    ds_read_b128 v[228:231], v22 offset:19456
    s_waitcnt lgkmcnt(4)
    v_mfma_f32_32x32x16_bf16 v[112:127], v[208:211], v[32:35], 0
    s_add_u32 m0, s73, 0
    s_nop 0
    buffer_load_dwordx4 v11, s[16:19], s82 offen offset:0 sc1 lds
    v_mfma_f32_32x32x16_bf16 v[128:143], v[212:215], v[32:35], 0
    buffer_load_dwordx4 v11, s[16:19], s82 offen offset:1024 sc1 lds
    s_waitcnt lgkmcnt(2)
    v_mfma_f32_32x32x16_bf16 v[112:127], v[216:219], v[36:39], v[112:127]
    buffer_load_dwordx4 v11, s[16:19], s82 offen offset:2048 sc1 lds
    v_mfma_f32_32x32x16_bf16 v[128:143], v[220:223], v[36:39], v[128:143]
    buffer_load_dwordx4 v11, s[16:19], s82 offen offset:3072 sc1 lds
    s_waitcnt lgkmcnt(0)
    v_mfma_f32_32x32x16_bf16 v[112:127], v[224:227], v[40:43], v[112:127]
    s_add_u32 m0, s73, 4096
    s_nop 0
    buffer_load_dwordx4 v12, s[16:19], s82 offen offset:0 sc1 lds
    v_mfma_f32_32x32x16_bf16 v[128:143], v[228:231], v[40:43], v[128:143]
    buffer_load_dwordx4 v12, s[16:19], s82 offen offset:1024 sc1 lds
    ds_read_b128 v[208:211], v22 offset:3072
    ds_read_b128 v[212:215], v22 offset:20480
    ds_read_b128 v[216:219], v22 offset:4096
    ds_read_b128 v[220:223], v22 offset:21504
    ds_read_b128 v[224:227], v22 offset:5120
    ds_read_b128 v[228:231], v22 offset:22528
    ds_read_b128 v[232:235], v22 offset:6144
    ds_read_b128 v[236:239], v22 offset:23552
    s_waitcnt lgkmcnt(6)
    v_mfma_f32_32x32x16_bf16 v[144:159], v[208:211], v[36:39], 0
    v_mfma_f32_32x32x16_bf16 v[160:175], v[212:215], v[36:39], 0
    s_nop 3
    buffer_load_dwordx4 v12, s[16:19], s82 offen offset:2048 sc1 lds
    s_waitcnt lgkmcnt(4)
    v_mfma_f32_32x32x16_bf16 v[144:159], v[216:219], v[40:43], v[144:159]
    v_add_f32 v128, s62, v128
    v_add_f32 v129, s62, v129
    v_add_f32 v130, s62, v130
    v_add_f32 v131, s62, v131
    v_add_f32 v132, s62, v132
    v_add_f32 v133, s62, v133
    v_add_f32 v134, s62, v134
    v_mfma_f32_32x32x16_bf16 v[160:175], v[220:223], v[40:43], v[160:175]
    v_add_f32 v135, s62, v135
    v_rcp_f32 v128, v128
    v_rcp_f32 v129, v129
    v_rcp_f32 v130, v130
    v_rcp_f32 v131, v131
    v_rcp_f32 v132, v132
    v_rcp_f32 v133, v133
    buffer_load_dwordx4 v12, s[16:19], s82 offen offset:3072 sc1 lds
    s_waitcnt lgkmcnt(2)
    v_mfma_f32_32x32x16_bf16 v[144:159], v[224:227], v[44:47], v[144:159]
    v_rcp_f32 v134, v134
    v_rcp_f32 v135, v135
    v_mul_f32 v112, v112, v192
    v_mul_f32 v113, v113, v192
    v_mul_f32 v114, v114, v192
    v_mul_f32 v115, v115, v192
    v_mul_f32 v116, v116, v192
    v_mfma_f32_32x32x16_bf16 v[160:175], v[228:231], v[44:47], v[160:175]
    v_mul_f32 v117, v117, v192
    v_mul_f32 v118, v118, v192
    v_mul_f32 v119, v119, v192
    v_mul_f32 v112, v112, v128
    v_mul_f32 v113, v113, v129
    v_mul_f32 v114, v114, v130
    v_mul_f32 v115, v115, v131
    s_add_u32 m0, s73, 8192
    s_nop 0
    buffer_load_dwordx4 v13, s[16:19], s82 offen offset:0 sc1 lds
    s_waitcnt lgkmcnt(0)
    v_mfma_f32_32x32x16_bf16 v[144:159], v[232:235], v[48:51], v[144:159]
    v_mul_f32 v116, v116, v132
    v_mul_f32 v117, v117, v133
    v_mul_f32 v118, v118, v134
    v_mul_f32 v119, v119, v135
    v_cvt_pk_bf16_f32 v240, v112, v113
    v_cvt_pk_bf16_f32 v241, v114, v115
    v_cvt_pk_bf16_f32 v242, v116, v117
    v_mfma_f32_32x32x16_bf16 v[160:175], v[236:239], v[48:51], v[160:175]
    v_cvt_pk_bf16_f32 v243, v118, v119
    s_add_u32 s57, s56, 0
    s_lshr_b32 s58, s57, 1
    s_add_u32 s58, s58, 144
    s_lshl_b32 s58, s58, 17
    s_and_b32 s57, s57, 1
    s_lshl_b32 s57, s57, 9
    s_add_u32 s80, s75, 0
    buffer_load_dwordx4 a[0:3], v18, s[12:15], s80 offen offset:0 sc1
    s_add_u32 s58, s58, s57
    buffer_store_dwordx4 v[240:243], v21, s[44:47], s58 offen sc1
    v_add_f32 v136, s62, v136
    v_add_f32 v137, s62, v137
    v_add_f32 v138, s62, v138
    v_add_f32 v139, s62, v139
    v_add_f32 v140, s62, v140
    v_add_f32 v141, s62, v141
    v_add_f32 v142, s62, v142
    v_add_f32 v143, s62, v143
    v_rcp_f32 v136, v136
    v_rcp_f32 v137, v137
    buffer_load_dwordx4 a[4:7], v18, s[12:15], s80 offen offset:1024 sc1
    v_rcp_f32 v138, v138
    v_rcp_f32 v139, v139
    v_rcp_f32 v140, v140
    v_rcp_f32 v141, v141
    v_rcp_f32 v142, v142
    v_rcp_f32 v143, v143
    v_mul_f32 v120, v120, v192
    v_mul_f32 v121, v121, v192
    v_mul_f32 v122, v122, v192
    v_mul_f32 v123, v123, v192
    v_mul_f32 v124, v124, v192
    v_mul_f32 v125, v125, v192
    s_add_u32 s80, s75, 131072
    buffer_load_dwordx4 a[8:11], v18, s[12:15], s80 offen offset:0 sc1
    v_mul_f32 v126, v126, v192
    v_mul_f32 v127, v127, v192
    v_mul_f32 v120, v120, v136
    v_mul_f32 v121, v121, v137
    v_mul_f32 v122, v122, v138
    v_mul_f32 v123, v123, v139
    v_mul_f32 v124, v124, v140
    v_mul_f32 v125, v125, v141
    v_mul_f32 v126, v126, v142
    v_mul_f32 v127, v127, v143
    v_cvt_pk_bf16_f32 v244, v120, v121
    v_cvt_pk_bf16_f32 v245, v122, v123
    buffer_load_dwordx4 a[12:15], v18, s[12:15], s80 offen offset:1024 sc1
    v_cvt_pk_bf16_f32 v246, v124, v125
    v_cvt_pk_bf16_f32 v247, v126, v127
    s_add_u32 s57, s56, 1
    s_lshr_b32 s58, s57, 1
    s_add_u32 s58, s58, 144
    s_lshl_b32 s58, s58, 17
    s_and_b32 s57, s57, 1
    s_lshl_b32 s57, s57, 9
    s_add_u32 s58, s58, s57
    buffer_store_dwordx4 v[244:247], v21, s[44:47], s58 offen sc1
    ds_read_b128 v[208:211], v22 offset:7168
    ds_read_b128 v[212:215], v22 offset:24576
    ds_read_b128 v[216:219], v22 offset:8192
    ds_read_b128 v[220:223], v22 offset:25600
    ds_read_b128 v[224:227], v22 offset:9216
    ds_read_b128 v[228:231], v22 offset:26624
    ds_read_b128 v[232:235], v22 offset:10240
    ds_read_b128 v[236:239], v22 offset:27648
    s_waitcnt lgkmcnt(6)
    v_mfma_f32_32x32x16_bf16 v[112:127], v[208:211], v[44:47], 0
    v_mfma_f32_32x32x16_bf16 v[128:143], v[212:215], v[44:47], 0
    s_nop 3
    s_add_u32 s80, s75, 1572864
    buffer_load_dwordx4 a[16:19], v18, s[12:15], s80 offen offset:0 sc1
    s_waitcnt lgkmcnt(4)
    v_mfma_f32_32x32x16_bf16 v[112:127], v[216:219], v[48:51], v[112:127]
    v_add_f32 v160, s62, v160
    v_add_f32 v161, s62, v161
    v_add_f32 v162, s62, v162
    v_add_f32 v163, s62, v163
    v_add_f32 v164, s62, v164
    v_add_f32 v165, s62, v165
    v_add_f32 v166, s62, v166
    v_mfma_f32_32x32x16_bf16 v[128:143], v[220:223], v[48:51], v[128:143]
    v_add_f32 v167, s62, v167
    v_rcp_f32 v160, v160
    v_rcp_f32 v161, v161
    v_rcp_f32 v162, v162
    v_rcp_f32 v163, v163
    v_rcp_f32 v164, v164
    v_rcp_f32 v165, v165
    buffer_load_dwordx4 a[20:23], v18, s[12:15], s80 offen offset:1024 sc1
    s_waitcnt lgkmcnt(2)
    v_mfma_f32_32x32x16_bf16 v[112:127], v[224:227], v[52:55], v[112:127]
    v_rcp_f32 v166, v166
    v_rcp_f32 v167, v167
    v_mul_f32 v144, v144, v192
    v_mul_f32 v145, v145, v192
    v_mul_f32 v146, v146, v192
    v_mul_f32 v147, v147, v192
    v_mul_f32 v148, v148, v192
    v_mfma_f32_32x32x16_bf16 v[128:143], v[228:231], v[52:55], v[128:143]
    v_mul_f32 v149, v149, v192
    v_mul_f32 v150, v150, v192
    v_mul_f32 v151, v151, v192
    v_mul_f32 v144, v144, v160
    v_mul_f32 v145, v145, v161
    v_mul_f32 v146, v146, v162
    v_mul_f32 v147, v147, v163
    s_add_u32 s80, s75, 1703936
    buffer_load_dwordx4 a[24:27], v18, s[12:15], s80 offen offset:0 sc1
    s_waitcnt lgkmcnt(0)
    v_mfma_f32_32x32x16_bf16 v[112:127], v[232:235], v[56:59], v[112:127]
    v_mul_f32 v148, v148, v164
    v_mul_f32 v149, v149, v165
    v_mul_f32 v150, v150, v166
    v_mul_f32 v151, v151, v167
    v_cvt_pk_bf16_f32 v240, v144, v145
    v_cvt_pk_bf16_f32 v241, v146, v147
    v_cvt_pk_bf16_f32 v242, v148, v149
    v_mfma_f32_32x32x16_bf16 v[128:143], v[236:239], v[56:59], v[128:143]
    v_cvt_pk_bf16_f32 v243, v150, v151
    s_add_u32 s57, s56, 2
    s_lshr_b32 s58, s57, 1
    s_add_u32 s58, s58, 144
    s_lshl_b32 s58, s58, 17
    s_and_b32 s57, s57, 1
    s_lshl_b32 s57, s57, 9
    buffer_load_dwordx4 a[28:31], v18, s[12:15], s80 offen offset:1024 sc1
    s_add_u32 s58, s58, s57
    buffer_store_dwordx4 v[240:243], v21, s[44:47], s58 offen sc1
    v_add_f32 v168, s62, v168
    v_add_f32 v169, s62, v169
    v_add_f32 v170, s62, v170
    v_add_f32 v171, s62, v171
    v_add_f32 v172, s62, v172
    v_add_f32 v173, s62, v173
    v_add_f32 v174, s62, v174
    v_add_f32 v175, s62, v175
    v_rcp_f32 v168, v168
    v_rcp_f32 v169, v169
    s_add_u32 m0, s73, 36864
    s_nop 0
    buffer_load_dwordx4 v11, s[16:19], s83 offen offset:0 sc1 lds
    v_rcp_f32 v170, v170
    v_rcp_f32 v171, v171
    v_rcp_f32 v172, v172
    v_rcp_f32 v173, v173
    v_rcp_f32 v174, v174
    v_rcp_f32 v175, v175
    v_mul_f32 v152, v152, v192
    v_mul_f32 v153, v153, v192
    v_mul_f32 v154, v154, v192
    v_mul_f32 v155, v155, v192
    v_mul_f32 v156, v156, v192
    v_mul_f32 v157, v157, v192
    buffer_load_dwordx4 v11, s[16:19], s83 offen offset:1024 sc1 lds
    v_mul_f32 v158, v158, v192
    v_mul_f32 v159, v159, v192
    v_mul_f32 v152, v152, v168
    v_mul_f32 v153, v153, v169
    v_mul_f32 v154, v154, v170
    v_mul_f32 v155, v155, v171
    v_mul_f32 v156, v156, v172
    v_mul_f32 v157, v157, v173
    v_mul_f32 v158, v158, v174
    v_mul_f32 v159, v159, v175
    v_cvt_pk_bf16_f32 v244, v152, v153
    v_cvt_pk_bf16_f32 v245, v154, v155
    buffer_load_dwordx4 v11, s[16:19], s83 offen offset:2048 sc1 lds
    v_cvt_pk_bf16_f32 v246, v156, v157
    v_cvt_pk_bf16_f32 v247, v158, v159
    s_add_u32 s57, s56, 3
    s_lshr_b32 s58, s57, 1
    s_add_u32 s58, s58, 144
    s_lshl_b32 s58, s58, 17
    s_and_b32 s57, s57, 1
    s_lshl_b32 s57, s57, 9
    s_add_u32 s58, s58, s57
    buffer_store_dwordx4 v[244:247], v21, s[44:47], s58 offen sc1
    ds_read_b128 v[208:211], v22 offset:11264
    ds_read_b128 v[212:215], v22 offset:28672
    ds_read_b128 v[216:219], v22 offset:12288
    ds_read_b128 v[220:223], v22 offset:29696
    ds_read_b128 v[224:227], v22 offset:13312
    ds_read_b128 v[228:231], v22 offset:30720
    ds_read_b128 v[232:235], v22 offset:14336
    ds_read_b128 v[236:239], v22 offset:31744
    s_waitcnt lgkmcnt(6)
    v_mfma_f32_32x32x16_bf16 v[144:159], v[208:211], v[52:55], 0
    v_mfma_f32_32x32x16_bf16 v[160:175], v[212:215], v[52:55], 0
    s_nop 3
    buffer_load_dwordx4 v11, s[16:19], s83 offen offset:3072 sc1 lds
    s_waitcnt lgkmcnt(4)
    v_mfma_f32_32x32x16_bf16 v[144:159], v[216:219], v[56:59], v[144:159]
    v_add_f32 v128, s62, v128
    v_add_f32 v129, s62, v129
    v_add_f32 v130, s62, v130
    v_add_f32 v131, s62, v131
    v_add_f32 v132, s62, v132
    v_add_f32 v133, s62, v133
    v_add_f32 v134, s62, v134
    v_mfma_f32_32x32x16_bf16 v[160:175], v[220:223], v[56:59], v[160:175]
    v_add_f32 v135, s62, v135
    v_rcp_f32 v128, v128
    v_rcp_f32 v129, v129
    v_rcp_f32 v130, v130
    v_rcp_f32 v131, v131
    v_rcp_f32 v132, v132
    v_rcp_f32 v133, v133
    s_add_u32 m0, s73, 40960
    s_nop 0
    buffer_load_dwordx4 v12, s[16:19], s83 offen offset:0 sc1 lds
    s_waitcnt lgkmcnt(2)
    v_mfma_f32_32x32x16_bf16 v[144:159], v[224:227], v[60:63], v[144:159]
    v_rcp_f32 v134, v134
    v_rcp_f32 v135, v135
    v_mul_f32 v112, v112, v192
    v_mul_f32 v113, v113, v192
    v_mul_f32 v114, v114, v192
    v_mul_f32 v115, v115, v192
    v_mul_f32 v116, v116, v192
    v_mfma_f32_32x32x16_bf16 v[160:175], v[228:231], v[60:63], v[160:175]
    v_mul_f32 v117, v117, v192
    v_mul_f32 v118, v118, v192
    v_mul_f32 v119, v119, v192
    v_mul_f32 v112, v112, v128
    v_mul_f32 v113, v113, v129
    v_mul_f32 v114, v114, v130
    v_mul_f32 v115, v115, v131
    buffer_load_dwordx4 v12, s[16:19], s83 offen offset:1024 sc1 lds
    s_waitcnt lgkmcnt(0)
    v_mfma_f32_32x32x16_bf16 v[144:159], v[232:235], v[64:67], v[144:159]
    v_mul_f32 v116, v116, v132
    v_mul_f32 v117, v117, v133
    v_mul_f32 v118, v118, v134
    v_mul_f32 v119, v119, v135
    v_cvt_pk_bf16_f32 v240, v112, v113
    v_cvt_pk_bf16_f32 v241, v114, v115
    v_cvt_pk_bf16_f32 v242, v116, v117
    v_mfma_f32_32x32x16_bf16 v[160:175], v[236:239], v[64:67], v[160:175]
    v_cvt_pk_bf16_f32 v243, v118, v119
    s_add_u32 s57, s56, 4
    s_lshr_b32 s58, s57, 1
    s_add_u32 s58, s58, 144
    s_lshl_b32 s58, s58, 17
    s_and_b32 s57, s57, 1
    s_lshl_b32 s57, s57, 9
    buffer_load_dwordx4 v12, s[16:19], s83 offen offset:2048 sc1 lds
    s_add_u32 s58, s58, s57
    buffer_store_dwordx4 v[240:243], v21, s[44:47], s58 offen sc1
    v_add_f32 v136, s62, v136
    v_add_f32 v137, s62, v137
    v_add_f32 v138, s62, v138
    v_add_f32 v139, s62, v139
    v_add_f32 v140, s62, v140
    v_add_f32 v141, s62, v141
    v_add_f32 v142, s62, v142
    v_add_f32 v143, s62, v143
    v_rcp_f32 v136, v136
    v_rcp_f32 v137, v137
    buffer_load_dwordx4 v12, s[16:19], s83 offen offset:3072 sc1 lds
    v_rcp_f32 v138, v138
    v_rcp_f32 v139, v139
    v_rcp_f32 v140, v140
    v_rcp_f32 v141, v141
    v_rcp_f32 v142, v142
    v_rcp_f32 v143, v143
    v_mul_f32 v120, v120, v192
    v_mul_f32 v121, v121, v192
    v_mul_f32 v122, v122, v192
    v_mul_f32 v123, v123, v192
    v_mul_f32 v124, v124, v192
    v_mul_f32 v125, v125, v192
    s_add_u32 m0, s73, 45056
    s_nop 0
    buffer_load_dwordx4 v13, s[16:19], s83 offen offset:0 sc1 lds
    v_mul_f32 v126, v126, v192
    v_mul_f32 v127, v127, v192
    v_mul_f32 v120, v120, v136
    v_mul_f32 v121, v121, v137
    v_mul_f32 v122, v122, v138
    v_mul_f32 v123, v123, v139
    v_mul_f32 v124, v124, v140
    v_mul_f32 v125, v125, v141
    v_mul_f32 v126, v126, v142
    v_mul_f32 v127, v127, v143
    v_cvt_pk_bf16_f32 v244, v120, v121
    v_cvt_pk_bf16_f32 v245, v122, v123
    s_add_u32 s80, s75, 3145728
    buffer_load_dwordx4 a[32:35], v18, s[12:15], s80 offen offset:0 sc1
    v_cvt_pk_bf16_f32 v246, v124, v125
    v_cvt_pk_bf16_f32 v247, v126, v127
    s_add_u32 s57, s56, 5
    s_lshr_b32 s58, s57, 1
    s_add_u32 s58, s58, 144
    s_lshl_b32 s58, s58, 17
    s_and_b32 s57, s57, 1
    s_lshl_b32 s57, s57, 9
    s_add_u32 s58, s58, s57
    buffer_store_dwordx4 v[244:247], v21, s[44:47], s58 offen sc1
    ds_read_b128 v[208:211], v22 offset:15360
    ds_read_b128 v[212:215], v22 offset:32768
    ds_read_b128 v[216:219], v22 offset:16384
    ds_read_b128 v[220:223], v22 offset:33792
    s_waitcnt lgkmcnt(2)
    v_mfma_f32_32x32x16_bf16 v[112:127], v[208:211], v[60:63], 0
    v_mfma_f32_32x32x16_bf16 v[128:143], v[212:215], v[60:63], 0
    s_nop 3
    buffer_load_dwordx4 a[36:39], v18, s[12:15], s80 offen offset:1024 sc1
    s_waitcnt lgkmcnt(0)
    v_mfma_f32_32x32x16_bf16 v[112:127], v[216:219], v[64:67], v[112:127]
    v_add_f32 v160, s62, v160
    v_add_f32 v161, s62, v161
    v_add_f32 v162, s62, v162
    v_add_f32 v163, s62, v163
    v_add_f32 v164, s62, v164
    v_add_f32 v165, s62, v165
    v_add_f32 v166, s62, v166
    v_mfma_f32_32x32x16_bf16 v[128:143], v[220:223], v[64:67], v[128:143]
    v_add_f32 v167, s62, v167
    v_rcp_f32 v160, v160
    v_rcp_f32 v161, v161
    v_rcp_f32 v162, v162
    v_rcp_f32 v163, v163
    v_rcp_f32 v164, v164
    v_rcp_f32 v165, v165
    s_add_u32 s80, s75, 3276800
    buffer_load_dwordx4 a[40:43], v18, s[12:15], s80 offen offset:0 sc1
    v_rcp_f32 v166, v166
    v_rcp_f32 v167, v167
    v_mul_f32 v144, v144, v192
    v_mul_f32 v145, v145, v192
    v_mul_f32 v146, v146, v192
    v_mul_f32 v147, v147, v192
    v_mul_f32 v148, v148, v192
    v_mul_f32 v149, v149, v192
    v_mul_f32 v150, v150, v192
    v_mul_f32 v151, v151, v192
    v_mul_f32 v144, v144, v160
    v_mul_f32 v145, v145, v161
    buffer_load_dwordx4 a[44:47], v18, s[12:15], s80 offen offset:1024 sc1
    v_mul_f32 v146, v146, v162
    v_mul_f32 v147, v147, v163
    v_mul_f32 v148, v148, v164
    v_mul_f32 v149, v149, v165
    v_mul_f32 v150, v150, v166
    v_mul_f32 v151, v151, v167
    v_cvt_pk_bf16_f32 v240, v144, v145
    v_cvt_pk_bf16_f32 v241, v146, v147
    v_cvt_pk_bf16_f32 v242, v148, v149
    v_cvt_pk_bf16_f32 v243, v150, v151
    s_add_u32 s57, s56, 6
    s_lshr_b32 s58, s57, 1
    s_add_u32 s80, s75, 262144
    buffer_load_dwordx4 a[48:51], v18, s[12:15], s80 offen offset:0 sc1
    s_add_u32 s58, s58, 144
    s_lshl_b32 s58, s58, 17
    s_and_b32 s57, s57, 1
    s_lshl_b32 s57, s57, 9
    s_add_u32 s58, s58, s57
    buffer_store_dwordx4 v[240:243], v21, s[44:47], s58 offen sc1
    v_add_f32 v168, s62, v168
    v_add_f32 v169, s62, v169
    v_add_f32 v170, s62, v170
    v_add_f32 v171, s62, v171
    v_add_f32 v172, s62, v172
    v_add_f32 v173, s62, v173
    buffer_load_dwordx4 a[52:55], v18, s[12:15], s80 offen offset:1024 sc1
    v_add_f32 v174, s62, v174
    v_add_f32 v175, s62, v175
    v_rcp_f32 v168, v168
    v_rcp_f32 v169, v169
    v_rcp_f32 v170, v170
    v_rcp_f32 v171, v171
    v_rcp_f32 v172, v172
    v_rcp_f32 v173, v173
    v_rcp_f32 v174, v174
    v_rcp_f32 v175, v175
    v_mul_f32 v152, v152, v192
    v_mul_f32 v153, v153, v192
    s_add_u32 s80, s75, 393216
    buffer_load_dwordx4 a[56:59], v18, s[12:15], s80 offen offset:0 sc1
    v_mul_f32 v154, v154, v192
    v_mul_f32 v155, v155, v192
    v_mul_f32 v156, v156, v192
    v_mul_f32 v157, v157, v192
    v_mul_f32 v158, v158, v192
    v_mul_f32 v159, v159, v192
    v_mul_f32 v152, v152, v168
    v_mul_f32 v153, v153, v169
    v_mul_f32 v154, v154, v170
    v_mul_f32 v155, v155, v171
    v_mul_f32 v156, v156, v172
    v_mul_f32 v157, v157, v173
    buffer_load_dwordx4 a[60:63], v18, s[12:15], s80 offen offset:1024 sc1
    v_mul_f32 v158, v158, v174
    v_mul_f32 v159, v159, v175
    v_cvt_pk_bf16_f32 v244, v152, v153
    v_cvt_pk_bf16_f32 v245, v154, v155
    v_cvt_pk_bf16_f32 v246, v156, v157
    v_cvt_pk_bf16_f32 v247, v158, v159
    s_add_u32 s57, s56, 7
    s_lshr_b32 s58, s57, 1
    s_add_u32 s58, s58, 144
    s_lshl_b32 s58, s58, 17
    s_and_b32 s57, s57, 1
    s_lshl_b32 s57, s57, 9
    s_add_u32 s58, s58, s57
    buffer_store_dwordx4 v[244:247], v21, s[44:47], s58 offen sc1
    s_nop 7
    s_nop 7
    v_add_f32 v128, s62, v128
    v_add_f32 v129, s62, v129
    v_add_f32 v130, s62, v130
    v_add_f32 v131, s62, v131
    v_add_f32 v132, s62, v132
    v_add_f32 v133, s62, v133
    v_add_f32 v134, s62, v134
    v_add_f32 v135, s62, v135
    v_rcp_f32 v128, v128
    v_rcp_f32 v129, v129
    v_rcp_f32 v130, v130
    v_rcp_f32 v131, v131
    v_rcp_f32 v132, v132
    v_rcp_f32 v133, v133
    v_rcp_f32 v134, v134
    v_rcp_f32 v135, v135
    v_mul_f32 v112, v112, v192
    v_mul_f32 v113, v113, v192
    v_mul_f32 v114, v114, v192
    v_mul_f32 v115, v115, v192
    v_mul_f32 v116, v116, v192
    v_mul_f32 v117, v117, v192
    v_mul_f32 v118, v118, v192
    v_mul_f32 v119, v119, v192
    v_mul_f32 v112, v112, v128
    v_mul_f32 v113, v113, v129
    v_mul_f32 v114, v114, v130
    v_mul_f32 v115, v115, v131
    v_mul_f32 v116, v116, v132
    v_mul_f32 v117, v117, v133
    v_mul_f32 v118, v118, v134
    v_mul_f32 v119, v119, v135
    v_cvt_pk_bf16_f32 v240, v112, v113
    v_cvt_pk_bf16_f32 v241, v114, v115
    v_cvt_pk_bf16_f32 v242, v116, v117
    v_cvt_pk_bf16_f32 v243, v118, v119
    s_add_u32 s57, s56, 8
    s_lshr_b32 s58, s57, 1
    s_add_u32 s58, s58, 144
    s_lshl_b32 s58, s58, 17
    s_and_b32 s57, s57, 1
    s_lshl_b32 s57, s57, 9
    s_add_u32 s58, s58, s57
    buffer_store_dwordx4 v[240:243], v21, s[44:47], s58 offen sc1
    s_cmp_lg_u32 s26, 0
    s_cbranch_scc1 k1_at_pax
    s_waitcnt vmcnt(43)

k1_at_pa:
    v_readfirstlane_b32 s27, v27
    s_cmp_ge_u32 s27, 3
    s_cbranch_scc1 k1_at_pax
    s_sleep 4
    s_add_u32 s101, s101, 1
    s_cmp_ge_u32 s101, 4194304
    s_cbranch_scc1 k1_at_pax
    global_load_dword v27, v26, s[98:99] sc1
    s_waitcnt vmcnt(0)
    s_branch k1_at_pa

k1_at_pax:
    s_waitcnt lgkmcnt(0)
    s_barrier
    s_branch m_k2
k1_end:
    s_endpgm
m_k2:
    s_cmp_eq_u32 s25, 3
    s_cbranch_scc0 m_ffn_in
    s_add_u32 m0, s73, 73728
    s_nop 0
    buffer_load_dwordx4 v11, s[16:19], s84 offen offset:0 sc1 lds
    buffer_load_dwordx4 v11, s[16:19], s84 offen offset:1024 sc1 lds
    buffer_load_dwordx4 v11, s[16:19], s84 offen offset:2048 sc1 lds
    buffer_load_dwordx4 v11, s[16:19], s84 offen offset:3072 sc1 lds
    s_add_u32 m0, s73, 77824
    s_nop 0
    buffer_load_dwordx4 v12, s[16:19], s84 offen offset:0 sc1 lds
    buffer_load_dwordx4 v12, s[16:19], s84 offen offset:1024 sc1 lds
    buffer_load_dwordx4 v12, s[16:19], s84 offen offset:2048 sc1 lds
    buffer_load_dwordx4 v12, s[16:19], s84 offen offset:3072 sc1 lds
    s_add_u32 m0, s73, 81920
    s_nop 0
    buffer_load_dwordx4 v13, s[16:19], s84 offen offset:0 sc1 lds
    s_branch m_late
m_ffn_in:
    s_nop 7
    s_nop 3
    v_mul_f32 v208, s60, v160
    v_mul_f32 v209, s60, v161
    v_exp_f32 v208, v208
    v_exp_f32 v209, v209
    v_mul_f32 v210, v160, v168
    v_mul_f32 v211, v161, v169
    v_add_f32 v208, 1.0, v208
    v_add_f32 v209, 1.0, v209
    v_rcp_f32 v208, v208
    v_rcp_f32 v209, v209
    v_mul_f32 v212, s60, v162
    v_mul_f32 v213, s60, v163
    v_exp_f32 v212, v212
    v_exp_f32 v213, v213
    v_mul_f32 v214, v162, v170
    v_mul_f32 v215, v163, v171
    v_mul_f32 v210, v210, v208
    v_mul_f32 v211, v211, v209
    v_cvt_pk_bf16_f32 v216, v210, v211
    v_add_f32 v212, 1.0, v212
    v_add_f32 v213, 1.0, v213
    v_rcp_f32 v212, v212
    v_rcp_f32 v213, v213
    v_mul_f32 v208, s60, v164
    v_mul_f32 v209, s60, v165
    v_exp_f32 v208, v208
    v_exp_f32 v209, v209
    v_mul_f32 v210, v164, v172
    v_mul_f32 v211, v165, v173
    v_mul_f32 v214, v214, v212
    v_mul_f32 v215, v215, v213
    v_cvt_pk_bf16_f32 v217, v214, v215
    v_add_f32 v208, 1.0, v208
    v_add_f32 v209, 1.0, v209
    v_rcp_f32 v208, v208
    v_rcp_f32 v209, v209
    v_mul_f32 v212, s60, v166
    v_mul_f32 v213, s60, v167
    v_exp_f32 v212, v212
    v_exp_f32 v213, v213
    v_mul_f32 v214, v166, v174
    v_mul_f32 v215, v167, v175
    v_mul_f32 v210, v210, v208
    v_mul_f32 v211, v211, v209
    v_cvt_pk_bf16_f32 v218, v210, v211
    v_add_f32 v212, 1.0, v212
    v_add_f32 v213, 1.0, v213
    v_rcp_f32 v212, v212
    v_rcp_f32 v213, v213
    s_nop 1
    v_mul_f32 v214, v214, v212
    v_mul_f32 v215, v215, v213
    v_cvt_pk_bf16_f32 v219, v214, v215
    buffer_store_dwordx4 v[216:219], v23, s[44:47], s48 offen offset:512 sc1
    v_mul_f32 v208, s60, v176
    v_mul_f32 v209, s60, v177
    v_exp_f32 v208, v208
    v_exp_f32 v209, v209
    v_mul_f32 v210, v176, v184
    v_mul_f32 v211, v177, v185
    v_add_f32 v208, 1.0, v208
    v_add_f32 v209, 1.0, v209
    v_rcp_f32 v208, v208
    v_rcp_f32 v209, v209
    v_mul_f32 v212, s60, v178
    v_mul_f32 v213, s60, v179
    v_exp_f32 v212, v212
    v_exp_f32 v213, v213
    v_mul_f32 v214, v178, v186
    v_mul_f32 v215, v179, v187
    v_mul_f32 v210, v210, v208
    v_mul_f32 v211, v211, v209
    v_cvt_pk_bf16_f32 v220, v210, v211
    v_add_f32 v212, 1.0, v212
    v_add_f32 v213, 1.0, v213
    v_rcp_f32 v212, v212
    v_rcp_f32 v213, v213
    v_mul_f32 v208, s60, v180
    v_mul_f32 v209, s60, v181
    v_exp_f32 v208, v208
    v_exp_f32 v209, v209
    v_mul_f32 v210, v180, v188
    v_mul_f32 v211, v181, v189
    v_mul_f32 v214, v214, v212
    v_mul_f32 v215, v215, v213
    v_cvt_pk_bf16_f32 v221, v214, v215
    v_add_f32 v208, 1.0, v208
    v_add_f32 v209, 1.0, v209
    v_rcp_f32 v208, v208
    v_rcp_f32 v209, v209
    v_mul_f32 v212, s60, v182
    v_mul_f32 v213, s60, v183
    v_exp_f32 v212, v212
    v_exp_f32 v213, v213
    v_mul_f32 v214, v182, v190
    v_mul_f32 v215, v183, v191
    v_mul_f32 v210, v210, v208
    v_mul_f32 v211, v211, v209
    v_cvt_pk_bf16_f32 v222, v210, v211
    v_add_f32 v212, 1.0, v212
    v_add_f32 v213, 1.0, v213
    v_rcp_f32 v212, v212
    v_rcp_f32 v213, v213
    s_nop 1
    v_mul_f32 v214, v214, v212
    v_mul_f32 v215, v215, v213
    v_cvt_pk_bf16_f32 v223, v214, v215
    buffer_store_dwordx4 v[220:223], v23, s[44:47], s48 offen offset:2560 sc1
m_late:
    v_lshlrev_b32 v250, 4, v0
    v_mov_b32 v14, v250

    v_add_u32 v15, 36864, v250
    v_add_u32 v16, 73728, v250
    v_add_u32 v17, 110592, v250
    s_lshl_b32 s27, s71, 2
    s_add_u32 s27, s27, s72
    s_lshl_b32 s74, s27, 7
    s_lshl_b32 s27, s27, 2
    s_add_u32 s27, s27, s26
    s_mul_i32 s27, s27, 49152
    v_add_u32 v22, s27, v250
    s_lshl_b32 s27, s71, 7
    s_lshl_b32 s28, s26, 5
    s_add_u32 s27, s27, s28
    v_and_b32 v248, 15, v0
    v_add_u32 v248, s27, v248
    v_lshlrev_b32 v19, 2, v248
    v_mul_u32_u24 v248, 1152, v248
    v_lshrrev_b32 v249, 4, v0
    v_lshlrev_b32 v249, 3, v249
    s_mul_i32 s27, s72, 288
    v_add3_u32 v26, v248, v249, s27
    v_bfe_u32 v249, v0, 4, 1
    v_lshlrev_b32 v249, 5, v249
    v_lshrrev_b32 v25, 5, v0
    v_lshlrev_b32 v25, 4, v25
    v_add3_u32 v25, v25, v249, v248
    v_add_u32 v25, s27, v25
    s_waitcnt lgkmcnt(0)
    s_mov_b32 s36, s8
    s_mov_b32 s37, s9
    s_mov_b32 s38, 2359296
    s_mov_b32 s39, 0x20000
    s_add_u32 s40, s10, 25165824
    s_addc_u32 s41, s11, 0
    s_mov_b32 s42, 8192
    s_mov_b32 s43, 0x20000
    s_add_u32 s30, s10, 58720256
    s_addc_u32 s31, s11, 0
    s_add_u32 s52, s10, 33554432
    s_addc_u32 s53, s11, 0
    s_mov_b32 s54, 12582912
    s_mov_b32 s55, 0x20000

    s_waitcnt vmcnt(34)
    s_barrier
    ds_read_b128 v[104:107], v14 offset:0
    ds_read_b128 v[108:111], v14 offset:1024
    ds_read_b128 v[112:115], v14 offset:2048
    ds_read_b128 v[116:119], v14 offset:3072
    ds_read_b128 v[120:123], v14 offset:4096
    ds_read_b128 v[124:127], v14 offset:5120
    ds_read_b128 v[224:227], v14 offset:6144
    ds_read_b128 v[228:231], v14 offset:7168
    ds_read_b128 v[232:235], v14 offset:8192
    s_waitcnt vmcnt(17)
    s_barrier
    s_waitcnt lgkmcnt(6)
    v_mfma_f32_16x16x32_bf16 v[32:35], v[104:107], a[0:3], 0
    ds_read_b128 v[236:239], v14 offset:9216
    s_add_u32 m0, s73, 110592
    v_mfma_f32_16x16x32_bf16 v[68:71], v[104:107], a[4:7], 0
    buffer_load_dwordx4 v11, s[16:19], s85 offen offset:0 sc1 lds
    v_mfma_f32_16x16x32_bf16 v[36:39], v[108:111], a[0:3], 0
    ds_read_b128 v[240:243], v14 offset:10240
    v_mfma_f32_16x16x32_bf16 v[72:75], v[108:111], a[4:7], 0
    buffer_load_dwordx4 v11, s[16:19], s85 offen offset:1024 sc1 lds
    v_mfma_f32_16x16x32_bf16 v[40:43], v[112:115], a[0:3], 0
    ds_read_b128 v[244:247], v14 offset:11264
    v_mfma_f32_16x16x32_bf16 v[76:79], v[112:115], a[4:7], 0
    s_waitcnt lgkmcnt(6)
    v_mfma_f32_16x16x32_bf16 v[44:47], v[116:119], a[0:3], 0
    ds_read_b128 v[104:107], v14 offset:12288
    v_mfma_f32_16x16x32_bf16 v[80:83], v[116:119], a[4:7], 0
    buffer_load_dwordx4 v11, s[16:19], s85 offen offset:2048 sc1 lds
    v_mfma_f32_16x16x32_bf16 v[48:51], v[120:123], a[0:3], 0
    ds_read_b128 v[108:111], v14 offset:13312
    v_mfma_f32_16x16x32_bf16 v[84:87], v[120:123], a[4:7], 0
    v_mfma_f32_16x16x32_bf16 v[52:55], v[124:127], a[0:3], 0
    ds_read_b128 v[112:115], v14 offset:14336
    v_mfma_f32_16x16x32_bf16 v[88:91], v[124:127], a[4:7], 0
    s_waitcnt lgkmcnt(6)
    v_mfma_f32_16x16x32_bf16 v[56:59], v[224:227], a[0:3], 0
    ds_read_b128 v[116:119], v14 offset:15360
    v_mfma_f32_16x16x32_bf16 v[92:95], v[224:227], a[4:7], 0
    buffer_load_dwordx4 v11, s[16:19], s85 offen offset:3072 sc1 lds
    v_mfma_f32_16x16x32_bf16 v[60:63], v[228:231], a[0:3], 0
    ds_read_b128 v[120:123], v14 offset:16384
    s_add_u32 m0, s73, 114688
    v_mfma_f32_16x16x32_bf16 v[96:99], v[228:231], a[4:7], 0
    buffer_load_dwordx4 v12, s[16:19], s85 offen offset:0 sc1 lds
    v_mfma_f32_16x16x32_bf16 v[64:67], v[232:235], a[0:3], 0
    ds_read_b128 v[124:127], v14 offset:17408
    v_mfma_f32_16x16x32_bf16 v[100:103], v[232:235], a[4:7], 0
    s_waitcnt lgkmcnt(6)
    v_mfma_f32_16x16x32_bf16 v[32:35], v[236:239], a[8:11], v[32:35]
    ds_read_b128 v[224:227], v14 offset:18432
    v_mfma_f32_16x16x32_bf16 v[68:71], v[236:239], a[12:15], v[68:71]
    v_mfma_f32_16x16x32_bf16 v[36:39], v[240:243], a[8:11], v[36:39]
    ds_read_b128 v[228:231], v14 offset:19456
    v_mfma_f32_16x16x32_bf16 v[72:75], v[240:243], a[12:15], v[72:75]
    buffer_load_dwordx4 v12, s[16:19], s85 offen offset:1024 sc1 lds
    v_mfma_f32_16x16x32_bf16 v[40:43], v[244:247], a[8:11], v[40:43]
    ds_read_b128 v[232:235], v14 offset:20480
    v_mfma_f32_16x16x32_bf16 v[76:79], v[244:247], a[12:15], v[76:79]
    s_waitcnt lgkmcnt(6)
    v_mfma_f32_16x16x32_bf16 v[44:47], v[104:107], a[8:11], v[44:47]
    ds_read_b128 v[236:239], v14 offset:21504
    v_mfma_f32_16x16x32_bf16 v[80:83], v[104:107], a[12:15], v[80:83]
    buffer_load_dwordx4 v12, s[16:19], s85 offen offset:2048 sc1 lds
    v_mfma_f32_16x16x32_bf16 v[48:51], v[108:111], a[8:11], v[48:51]
    ds_read_b128 v[240:243], v14 offset:22528
    v_mfma_f32_16x16x32_bf16 v[84:87], v[108:111], a[12:15], v[84:87]
    buffer_load_dwordx4 v12, s[16:19], s85 offen offset:3072 sc1 lds
    v_mfma_f32_16x16x32_bf16 v[52:55], v[112:115], a[8:11], v[52:55]
    ds_read_b128 v[244:247], v14 offset:23552
    v_mfma_f32_16x16x32_bf16 v[88:91], v[112:115], a[12:15], v[88:91]
    s_waitcnt lgkmcnt(6)
    v_mfma_f32_16x16x32_bf16 v[56:59], v[116:119], a[8:11], v[56:59]
    ds_read_b128 v[104:107], v14 offset:24576
    v_mfma_f32_16x16x32_bf16 v[92:95], v[116:119], a[12:15], v[92:95]
    v_mfma_f32_16x16x32_bf16 v[60:63], v[120:123], a[8:11], v[60:63]
    ds_read_b128 v[108:111], v14 offset:25600
    s_add_u32 m0, s73, 118784
    v_mfma_f32_16x16x32_bf16 v[96:99], v[120:123], a[12:15], v[96:99]
    buffer_load_dwordx4 v13, s[16:19], s85 offen offset:0 sc1 lds
    v_mfma_f32_16x16x32_bf16 v[64:67], v[124:127], a[8:11], v[64:67]
    ds_read_b128 v[112:115], v14 offset:26624
    v_mfma_f32_16x16x32_bf16 v[100:103], v[124:127], a[12:15], v[100:103]
    s_waitcnt lgkmcnt(6)
    v_mfma_f32_16x16x32_bf16 v[32:35], v[224:227], a[16:19], v[32:35]
    ds_read_b128 v[116:119], v14 offset:27648
    s_add_u32 s80, s75, 1835008
    v_mfma_f32_16x16x32_bf16 v[68:71], v[224:227], a[20:23], v[68:71]
    buffer_load_dwordx4 a[64:67], v18, s[12:15], s80 offen offset:0 sc1
    v_mfma_f32_16x16x32_bf16 v[36:39], v[228:231], a[16:19], v[36:39]
    ds_read_b128 v[120:123], v14 offset:28672
    v_mfma_f32_16x16x32_bf16 v[72:75], v[228:231], a[20:23], v[72:75]
    v_mfma_f32_16x16x32_bf16 v[40:43], v[232:235], a[16:19], v[40:43]
    ds_read_b128 v[124:127], v14 offset:29696
    v_mfma_f32_16x16x32_bf16 v[76:79], v[232:235], a[20:23], v[76:79]
    s_waitcnt lgkmcnt(6)
    v_mfma_f32_16x16x32_bf16 v[44:47], v[236:239], a[16:19], v[44:47]
    ds_read_b128 v[224:227], v14 offset:30720
    v_mfma_f32_16x16x32_bf16 v[80:83], v[236:239], a[20:23], v[80:83]
    buffer_load_dwordx4 a[68:71], v18, s[12:15], s80 offen offset:1024 sc1
    v_mfma_f32_16x16x32_bf16 v[48:51], v[240:243], a[16:19], v[48:51]
    ds_read_b128 v[228:231], v14 offset:31744
    s_add_u32 s80, s75, 1966080
    v_mfma_f32_16x16x32_bf16 v[84:87], v[240:243], a[20:23], v[84:87]
    buffer_load_dwordx4 a[72:75], v18, s[12:15], s80 offen offset:0 sc1
    v_mfma_f32_16x16x32_bf16 v[52:55], v[244:247], a[16:19], v[52:55]
    ds_read_b128 v[232:235], v14 offset:32768
    v_mfma_f32_16x16x32_bf16 v[88:91], v[244:247], a[20:23], v[88:91]
    s_waitcnt lgkmcnt(6)
    v_mfma_f32_16x16x32_bf16 v[56:59], v[104:107], a[16:19], v[56:59]
    ds_read_b128 v[236:239], v14 offset:33792
    v_mfma_f32_16x16x32_bf16 v[92:95], v[104:107], a[20:23], v[92:95]
    buffer_load_dwordx4 a[76:79], v18, s[12:15], s80 offen offset:1024 sc1
    v_mfma_f32_16x16x32_bf16 v[60:63], v[108:111], a[16:19], v[60:63]
    ds_read_b128 v[240:243], v14 offset:34816
    v_mfma_f32_16x16x32_bf16 v[96:99], v[108:111], a[20:23], v[96:99]
    v_mfma_f32_16x16x32_bf16 v[64:67], v[112:115], a[16:19], v[64:67]
    ds_read_b128 v[244:247], v14 offset:35840
    v_mfma_f32_16x16x32_bf16 v[100:103], v[112:115], a[20:23], v[100:103]
    s_waitcnt lgkmcnt(6)
    v_mfma_f32_16x16x32_bf16 v[32:35], v[116:119], a[24:27], v[32:35]
    ds_read_b128 v[104:107], v15 offset:0
    s_add_u32 s80, s75, 3407872
    v_mfma_f32_16x16x32_bf16 v[68:71], v[116:119], a[28:31], v[68:71]
    buffer_load_dwordx4 a[80:83], v18, s[12:15], s80 offen offset:0 sc1
    v_mfma_f32_16x16x32_bf16 v[36:39], v[120:123], a[24:27], v[36:39]
    ds_read_b128 v[108:111], v15 offset:1024
    v_mfma_f32_16x16x32_bf16 v[72:75], v[120:123], a[28:31], v[72:75]
    buffer_load_dwordx4 a[84:87], v18, s[12:15], s80 offen offset:1024 sc1
    v_mfma_f32_16x16x32_bf16 v[40:43], v[124:127], a[24:27], v[40:43]
    ds_read_b128 v[112:115], v15 offset:2048
    v_mfma_f32_16x16x32_bf16 v[76:79], v[124:127], a[28:31], v[76:79]
    s_waitcnt lgkmcnt(6)
    v_mfma_f32_16x16x32_bf16 v[44:47], v[224:227], a[24:27], v[44:47]
    ds_read_b128 v[116:119], v15 offset:3072
    v_mfma_f32_16x16x32_bf16 v[80:83], v[224:227], a[28:31], v[80:83]
    v_mfma_f32_16x16x32_bf16 v[48:51], v[228:231], a[24:27], v[48:51]
    ds_read_b128 v[120:123], v15 offset:4096
    s_add_u32 s80, s75, 3538944
    v_mfma_f32_16x16x32_bf16 v[84:87], v[228:231], a[28:31], v[84:87]
    buffer_load_dwordx4 a[88:91], v18, s[12:15], s80 offen offset:0 sc1
    v_mfma_f32_16x16x32_bf16 v[52:55], v[232:235], a[24:27], v[52:55]
    ds_read_b128 v[124:127], v15 offset:5120
    v_mfma_f32_16x16x32_bf16 v[88:91], v[232:235], a[28:31], v[88:91]
    s_waitcnt lgkmcnt(6)
    v_mfma_f32_16x16x32_bf16 v[56:59], v[236:239], a[24:27], v[56:59]
    ds_read_b128 v[224:227], v15 offset:6144
    v_mfma_f32_16x16x32_bf16 v[92:95], v[236:239], a[28:31], v[92:95]
    buffer_load_dwordx4 a[92:95], v18, s[12:15], s80 offen offset:1024 sc1
    v_mfma_f32_16x16x32_bf16 v[60:63], v[240:243], a[24:27], v[60:63]
    ds_read_b128 v[228:231], v15 offset:7168
    v_mfma_f32_16x16x32_bf16 v[96:99], v[240:243], a[28:31], v[96:99]
    v_mfma_f32_16x16x32_bf16 v[64:67], v[244:247], a[24:27], v[64:67]
    ds_read_b128 v[232:235], v15 offset:8192
    v_mfma_f32_16x16x32_bf16 v[100:103], v[244:247], a[28:31], v[100:103]
    s_waitcnt vmcnt(17)
    s_barrier
    s_waitcnt lgkmcnt(6)
    v_mfma_f32_16x16x32_bf16 v[32:35], v[104:107], a[32:35], v[32:35]
    ds_read_b128 v[236:239], v15 offset:9216
    s_add_u32 m0, s73, 0
    v_mfma_f32_16x16x32_bf16 v[68:71], v[104:107], a[36:39], v[68:71]
    buffer_load_dwordx4 v11, s[16:19], s86 offen offset:0 sc1 lds
    v_mfma_f32_16x16x32_bf16 v[36:39], v[108:111], a[32:35], v[36:39]
    ds_read_b128 v[240:243], v15 offset:10240
    v_mfma_f32_16x16x32_bf16 v[72:75], v[108:111], a[36:39], v[72:75]
    buffer_load_dwordx4 v11, s[16:19], s86 offen offset:1024 sc1 lds
    v_mfma_f32_16x16x32_bf16 v[40:43], v[112:115], a[32:35], v[40:43]
    ds_read_b128 v[244:247], v15 offset:11264
    v_mfma_f32_16x16x32_bf16 v[76:79], v[112:115], a[36:39], v[76:79]
    s_waitcnt lgkmcnt(6)
    v_mfma_f32_16x16x32_bf16 v[44:47], v[116:119], a[32:35], v[44:47]
    ds_read_b128 v[104:107], v15 offset:12288
    v_mfma_f32_16x16x32_bf16 v[80:83], v[116:119], a[36:39], v[80:83]
    buffer_load_dwordx4 v11, s[16:19], s86 offen offset:2048 sc1 lds
    v_mfma_f32_16x16x32_bf16 v[48:51], v[120:123], a[32:35], v[48:51]
    ds_read_b128 v[108:111], v15 offset:13312
    v_mfma_f32_16x16x32_bf16 v[84:87], v[120:123], a[36:39], v[84:87]
    v_mfma_f32_16x16x32_bf16 v[52:55], v[124:127], a[32:35], v[52:55]
    ds_read_b128 v[112:115], v15 offset:14336
    v_mfma_f32_16x16x32_bf16 v[88:91], v[124:127], a[36:39], v[88:91]
    s_waitcnt lgkmcnt(6)
    v_mfma_f32_16x16x32_bf16 v[56:59], v[224:227], a[32:35], v[56:59]
    ds_read_b128 v[116:119], v15 offset:15360
    v_mfma_f32_16x16x32_bf16 v[92:95], v[224:227], a[36:39], v[92:95]
    buffer_load_dwordx4 v11, s[16:19], s86 offen offset:3072 sc1 lds
    v_mfma_f32_16x16x32_bf16 v[60:63], v[228:231], a[32:35], v[60:63]
    ds_read_b128 v[120:123], v15 offset:16384
    s_add_u32 m0, s73, 4096
    v_mfma_f32_16x16x32_bf16 v[96:99], v[228:231], a[36:39], v[96:99]
    buffer_load_dwordx4 v12, s[16:19], s86 offen offset:0 sc1 lds
    v_mfma_f32_16x16x32_bf16 v[64:67], v[232:235], a[32:35], v[64:67]
    ds_read_b128 v[124:127], v15 offset:17408
    v_mfma_f32_16x16x32_bf16 v[100:103], v[232:235], a[36:39], v[100:103]
    s_waitcnt lgkmcnt(6)
    v_mfma_f32_16x16x32_bf16 v[32:35], v[236:239], a[40:43], v[32:35]
    ds_read_b128 v[224:227], v15 offset:18432
    v_mfma_f32_16x16x32_bf16 v[68:71], v[236:239], a[44:47], v[68:71]
    v_mfma_f32_16x16x32_bf16 v[36:39], v[240:243], a[40:43], v[36:39]
    ds_read_b128 v[228:231], v15 offset:19456
    v_mfma_f32_16x16x32_bf16 v[72:75], v[240:243], a[44:47], v[72:75]
    buffer_load_dwordx4 v12, s[16:19], s86 offen offset:1024 sc1 lds
    v_mfma_f32_16x16x32_bf16 v[40:43], v[244:247], a[40:43], v[40:43]
    ds_read_b128 v[232:235], v15 offset:20480
    v_mfma_f32_16x16x32_bf16 v[76:79], v[244:247], a[44:47], v[76:79]
    s_waitcnt lgkmcnt(6)
    v_mfma_f32_16x16x32_bf16 v[44:47], v[104:107], a[40:43], v[44:47]
    ds_read_b128 v[236:239], v15 offset:21504
    v_mfma_f32_16x16x32_bf16 v[80:83], v[104:107], a[44:47], v[80:83]
    buffer_load_dwordx4 v12, s[16:19], s86 offen offset:2048 sc1 lds
    v_mfma_f32_16x16x32_bf16 v[48:51], v[108:111], a[40:43], v[48:51]
    ds_read_b128 v[240:243], v15 offset:22528
    v_mfma_f32_16x16x32_bf16 v[84:87], v[108:111], a[44:47], v[84:87]
    buffer_load_dwordx4 v12, s[16:19], s86 offen offset:3072 sc1 lds
    v_mfma_f32_16x16x32_bf16 v[52:55], v[112:115], a[40:43], v[52:55]
    ds_read_b128 v[244:247], v15 offset:23552
    v_mfma_f32_16x16x32_bf16 v[88:91], v[112:115], a[44:47], v[88:91]
    s_waitcnt lgkmcnt(6)
    v_mfma_f32_16x16x32_bf16 v[56:59], v[116:119], a[40:43], v[56:59]
    ds_read_b128 v[104:107], v15 offset:24576
    v_mfma_f32_16x16x32_bf16 v[92:95], v[116:119], a[44:47], v[92:95]
    v_mfma_f32_16x16x32_bf16 v[60:63], v[120:123], a[40:43], v[60:63]
    ds_read_b128 v[108:111], v15 offset:25600
    s_add_u32 m0, s73, 8192
    v_mfma_f32_16x16x32_bf16 v[96:99], v[120:123], a[44:47], v[96:99]
    buffer_load_dwordx4 v13, s[16:19], s86 offen offset:0 sc1 lds
    v_mfma_f32_16x16x32_bf16 v[64:67], v[124:127], a[40:43], v[64:67]
    ds_read_b128 v[112:115], v15 offset:26624
    v_mfma_f32_16x16x32_bf16 v[100:103], v[124:127], a[44:47], v[100:103]
    s_waitcnt lgkmcnt(6)
    v_mfma_f32_16x16x32_bf16 v[32:35], v[224:227], a[48:51], v[32:35]
    ds_read_b128 v[116:119], v15 offset:27648
    s_add_u32 s80, s75, 524288
    v_mfma_f32_16x16x32_bf16 v[68:71], v[224:227], a[52:55], v[68:71]
    buffer_load_dwordx4 a[96:99], v18, s[12:15], s80 offen offset:0 sc1
    v_mfma_f32_16x16x32_bf16 v[36:39], v[228:231], a[48:51], v[36:39]
    ds_read_b128 v[120:123], v15 offset:28672
    v_mfma_f32_16x16x32_bf16 v[72:75], v[228:231], a[52:55], v[72:75]
    v_mfma_f32_16x16x32_bf16 v[40:43], v[232:235], a[48:51], v[40:43]
    ds_read_b128 v[124:127], v15 offset:29696
    v_mfma_f32_16x16x32_bf16 v[76:79], v[232:235], a[52:55], v[76:79]
    s_waitcnt lgkmcnt(6)
    v_mfma_f32_16x16x32_bf16 v[44:47], v[236:239], a[48:51], v[44:47]
    ds_read_b128 v[224:227], v15 offset:30720
    v_mfma_f32_16x16x32_bf16 v[80:83], v[236:239], a[52:55], v[80:83]
    buffer_load_dwordx4 a[100:103], v18, s[12:15], s80 offen offset:1024 sc1
    v_mfma_f32_16x16x32_bf16 v[48:51], v[240:243], a[48:51], v[48:51]
    ds_read_b128 v[228:231], v15 offset:31744
    s_add_u32 s80, s75, 655360
    v_mfma_f32_16x16x32_bf16 v[84:87], v[240:243], a[52:55], v[84:87]
    buffer_load_dwordx4 a[104:107], v18, s[12:15], s80 offen offset:0 sc1
    v_mfma_f32_16x16x32_bf16 v[52:55], v[244:247], a[48:51], v[52:55]
    ds_read_b128 v[232:235], v15 offset:32768
    v_mfma_f32_16x16x32_bf16 v[88:91], v[244:247], a[52:55], v[88:91]
    s_waitcnt lgkmcnt(6)
    v_mfma_f32_16x16x32_bf16 v[56:59], v[104:107], a[48:51], v[56:59]
    ds_read_b128 v[236:239], v15 offset:33792
    v_mfma_f32_16x16x32_bf16 v[92:95], v[104:107], a[52:55], v[92:95]
    buffer_load_dwordx4 a[108:111], v18, s[12:15], s80 offen offset:1024 sc1
    v_mfma_f32_16x16x32_bf16 v[60:63], v[108:111], a[48:51], v[60:63]
    ds_read_b128 v[240:243], v15 offset:34816
    v_mfma_f32_16x16x32_bf16 v[96:99], v[108:111], a[52:55], v[96:99]
    v_mfma_f32_16x16x32_bf16 v[64:67], v[112:115], a[48:51], v[64:67]
    ds_read_b128 v[244:247], v15 offset:35840
    v_mfma_f32_16x16x32_bf16 v[100:103], v[112:115], a[52:55], v[100:103]
    s_waitcnt lgkmcnt(6)
    v_mfma_f32_16x16x32_bf16 v[32:35], v[116:119], a[56:59], v[32:35]
    ds_read_b128 v[104:107], v16 offset:0
    s_add_u32 s80, s75, 2097152
    v_mfma_f32_16x16x32_bf16 v[68:71], v[116:119], a[60:63], v[68:71]
    buffer_load_dwordx4 a[112:115], v18, s[12:15], s80 offen offset:0 sc1
    v_mfma_f32_16x16x32_bf16 v[36:39], v[120:123], a[56:59], v[36:39]
    ds_read_b128 v[108:111], v16 offset:1024
    v_mfma_f32_16x16x32_bf16 v[72:75], v[120:123], a[60:63], v[72:75]
    buffer_load_dwordx4 a[116:119], v18, s[12:15], s80 offen offset:1024 sc1
    v_mfma_f32_16x16x32_bf16 v[40:43], v[124:127], a[56:59], v[40:43]
    ds_read_b128 v[112:115], v16 offset:2048
    v_mfma_f32_16x16x32_bf16 v[76:79], v[124:127], a[60:63], v[76:79]
    s_waitcnt lgkmcnt(6)
    v_mfma_f32_16x16x32_bf16 v[44:47], v[224:227], a[56:59], v[44:47]
    ds_read_b128 v[116:119], v16 offset:3072
    v_mfma_f32_16x16x32_bf16 v[80:83], v[224:227], a[60:63], v[80:83]
    v_mfma_f32_16x16x32_bf16 v[48:51], v[228:231], a[56:59], v[48:51]
    ds_read_b128 v[120:123], v16 offset:4096
    s_add_u32 s80, s75, 2228224
    v_mfma_f32_16x16x32_bf16 v[84:87], v[228:231], a[60:63], v[84:87]
    buffer_load_dwordx4 a[120:123], v18, s[12:15], s80 offen offset:0 sc1
    v_mfma_f32_16x16x32_bf16 v[52:55], v[232:235], a[56:59], v[52:55]
    ds_read_b128 v[124:127], v16 offset:5120
    v_mfma_f32_16x16x32_bf16 v[88:91], v[232:235], a[60:63], v[88:91]
    s_waitcnt lgkmcnt(6)
    v_mfma_f32_16x16x32_bf16 v[56:59], v[236:239], a[56:59], v[56:59]
    ds_read_b128 v[224:227], v16 offset:6144
    v_mfma_f32_16x16x32_bf16 v[92:95], v[236:239], a[60:63], v[92:95]
    buffer_load_dwordx4 a[124:127], v18, s[12:15], s80 offen offset:1024 sc1
    v_mfma_f32_16x16x32_bf16 v[60:63], v[240:243], a[56:59], v[60:63]
    ds_read_b128 v[228:231], v16 offset:7168
    v_mfma_f32_16x16x32_bf16 v[96:99], v[240:243], a[60:63], v[96:99]
    v_mfma_f32_16x16x32_bf16 v[64:67], v[244:247], a[56:59], v[64:67]
    ds_read_b128 v[232:235], v16 offset:8192
    v_mfma_f32_16x16x32_bf16 v[100:103], v[244:247], a[60:63], v[100:103]
    s_waitcnt vmcnt(17)
    s_barrier
    s_cmp_lg_u32 s26, 0
    s_cbranch_scc1 m_sg
    s_lshl_b32 s27, s81, 7
    s_add_u32 s27, s27, 16384
    s_lshl_b32 s28, s71, 7
    s_add_u32 s28, s28, 24576
    s_cmp_eq_u32 s25, 3
    s_cselect_b32 s27, s28, s27
    v_mov_b32 v248, s27
    v_mov_b32 v249, 1
    s_mov_b64 exec, 1
    global_atomic_add v248, v249, s[30:31]
    s_mov_b64 exec, -1

m_sg:
    s_waitcnt lgkmcnt(6)
    v_mfma_f32_16x16x32_bf16 v[32:35], v[104:107], a[64:67], v[32:35]
    ds_read_b128 v[236:239], v16 offset:9216
    s_add_u32 m0, s73, 36864
    v_mfma_f32_16x16x32_bf16 v[68:71], v[104:107], a[68:71], v[68:71]
    buffer_load_dwordx4 v11, s[16:19], s87 offen offset:0 sc1 lds
    v_mfma_f32_16x16x32_bf16 v[36:39], v[108:111], a[64:67], v[36:39]
    ds_read_b128 v[240:243], v16 offset:10240
    v_mfma_f32_16x16x32_bf16 v[72:75], v[108:111], a[68:71], v[72:75]
    buffer_load_dwordx4 v11, s[16:19], s87 offen offset:1024 sc1 lds
    v_mfma_f32_16x16x32_bf16 v[40:43], v[112:115], a[64:67], v[40:43]
    ds_read_b128 v[244:247], v16 offset:11264
    v_mfma_f32_16x16x32_bf16 v[76:79], v[112:115], a[68:71], v[76:79]
    s_waitcnt lgkmcnt(6)
    v_mfma_f32_16x16x32_bf16 v[44:47], v[116:119], a[64:67], v[44:47]
    ds_read_b128 v[104:107], v16 offset:12288
    v_mfma_f32_16x16x32_bf16 v[80:83], v[116:119], a[68:71], v[80:83]
    buffer_load_dwordx4 v11, s[16:19], s87 offen offset:2048 sc1 lds
    v_mfma_f32_16x16x32_bf16 v[48:51], v[120:123], a[64:67], v[48:51]
    ds_read_b128 v[108:111], v16 offset:13312
    v_mfma_f32_16x16x32_bf16 v[84:87], v[120:123], a[68:71], v[84:87]
    v_mfma_f32_16x16x32_bf16 v[52:55], v[124:127], a[64:67], v[52:55]
    ds_read_b128 v[112:115], v16 offset:14336
    v_mfma_f32_16x16x32_bf16 v[88:91], v[124:127], a[68:71], v[88:91]
    s_waitcnt lgkmcnt(6)
    v_mfma_f32_16x16x32_bf16 v[56:59], v[224:227], a[64:67], v[56:59]
    ds_read_b128 v[116:119], v16 offset:15360
    v_mfma_f32_16x16x32_bf16 v[92:95], v[224:227], a[68:71], v[92:95]
    buffer_load_dwordx4 v11, s[16:19], s87 offen offset:3072 sc1 lds
    v_mfma_f32_16x16x32_bf16 v[60:63], v[228:231], a[64:67], v[60:63]
    ds_read_b128 v[120:123], v16 offset:16384
    s_add_u32 m0, s73, 40960
    v_mfma_f32_16x16x32_bf16 v[96:99], v[228:231], a[68:71], v[96:99]
    buffer_load_dwordx4 v12, s[16:19], s87 offen offset:0 sc1 lds
    v_mfma_f32_16x16x32_bf16 v[64:67], v[232:235], a[64:67], v[64:67]
    ds_read_b128 v[124:127], v16 offset:17408
    v_mfma_f32_16x16x32_bf16 v[100:103], v[232:235], a[68:71], v[100:103]
    s_waitcnt lgkmcnt(6)
    v_mfma_f32_16x16x32_bf16 v[32:35], v[236:239], a[72:75], v[32:35]
    ds_read_b128 v[224:227], v16 offset:18432
    v_mfma_f32_16x16x32_bf16 v[68:71], v[236:239], a[76:79], v[68:71]
    v_mfma_f32_16x16x32_bf16 v[36:39], v[240:243], a[72:75], v[36:39]
    ds_read_b128 v[228:231], v16 offset:19456
    v_mfma_f32_16x16x32_bf16 v[72:75], v[240:243], a[76:79], v[72:75]
    buffer_load_dwordx4 v12, s[16:19], s87 offen offset:1024 sc1 lds
    v_mfma_f32_16x16x32_bf16 v[40:43], v[244:247], a[72:75], v[40:43]
    ds_read_b128 v[232:235], v16 offset:20480
    v_mfma_f32_16x16x32_bf16 v[76:79], v[244:247], a[76:79], v[76:79]
    s_waitcnt lgkmcnt(6)
    v_mfma_f32_16x16x32_bf16 v[44:47], v[104:107], a[72:75], v[44:47]
    ds_read_b128 v[236:239], v16 offset:21504
    v_mfma_f32_16x16x32_bf16 v[80:83], v[104:107], a[76:79], v[80:83]
    buffer_load_dwordx4 v12, s[16:19], s87 offen offset:2048 sc1 lds
    v_mfma_f32_16x16x32_bf16 v[48:51], v[108:111], a[72:75], v[48:51]
    ds_read_b128 v[240:243], v16 offset:22528
    v_mfma_f32_16x16x32_bf16 v[84:87], v[108:111], a[76:79], v[84:87]
    buffer_load_dwordx4 v12, s[16:19], s87 offen offset:3072 sc1 lds
    v_mfma_f32_16x16x32_bf16 v[52:55], v[112:115], a[72:75], v[52:55]
    ds_read_b128 v[244:247], v16 offset:23552
    v_mfma_f32_16x16x32_bf16 v[88:91], v[112:115], a[76:79], v[88:91]
    s_waitcnt lgkmcnt(6)
    v_mfma_f32_16x16x32_bf16 v[56:59], v[116:119], a[72:75], v[56:59]
    ds_read_b128 v[104:107], v16 offset:24576
    v_mfma_f32_16x16x32_bf16 v[92:95], v[116:119], a[76:79], v[92:95]
    v_mfma_f32_16x16x32_bf16 v[60:63], v[120:123], a[72:75], v[60:63]
    ds_read_b128 v[108:111], v16 offset:25600
    s_add_u32 m0, s73, 45056
    v_mfma_f32_16x16x32_bf16 v[96:99], v[120:123], a[76:79], v[96:99]
    buffer_load_dwordx4 v13, s[16:19], s87 offen offset:0 sc1 lds
    v_mfma_f32_16x16x32_bf16 v[64:67], v[124:127], a[72:75], v[64:67]
    ds_read_b128 v[112:115], v16 offset:26624
    v_mfma_f32_16x16x32_bf16 v[100:103], v[124:127], a[76:79], v[100:103]
    s_waitcnt lgkmcnt(6)
    v_mfma_f32_16x16x32_bf16 v[32:35], v[224:227], a[80:83], v[32:35]
    ds_read_b128 v[116:119], v16 offset:27648
    s_add_u32 s80, s75, 3670016
    v_mfma_f32_16x16x32_bf16 v[68:71], v[224:227], a[84:87], v[68:71]
    buffer_load_dwordx4 a[0:3], v18, s[12:15], s80 offen offset:0 sc1
    v_mfma_f32_16x16x32_bf16 v[36:39], v[228:231], a[80:83], v[36:39]
    ds_read_b128 v[120:123], v16 offset:28672
    v_mfma_f32_16x16x32_bf16 v[72:75], v[228:231], a[84:87], v[72:75]
    v_mfma_f32_16x16x32_bf16 v[40:43], v[232:235], a[80:83], v[40:43]
    ds_read_b128 v[124:127], v16 offset:29696
    v_mfma_f32_16x16x32_bf16 v[76:79], v[232:235], a[84:87], v[76:79]
    s_waitcnt lgkmcnt(6)
    v_mfma_f32_16x16x32_bf16 v[44:47], v[236:239], a[80:83], v[44:47]
    ds_read_b128 v[224:227], v16 offset:30720
    v_mfma_f32_16x16x32_bf16 v[80:83], v[236:239], a[84:87], v[80:83]
    buffer_load_dwordx4 a[4:7], v18, s[12:15], s80 offen offset:1024 sc1
    v_mfma_f32_16x16x32_bf16 v[48:51], v[240:243], a[80:83], v[48:51]
    ds_read_b128 v[228:231], v16 offset:31744
    s_add_u32 s80, s75, 3801088
    v_mfma_f32_16x16x32_bf16 v[84:87], v[240:243], a[84:87], v[84:87]
    buffer_load_dwordx4 a[8:11], v18, s[12:15], s80 offen offset:0 sc1
    v_mfma_f32_16x16x32_bf16 v[52:55], v[244:247], a[80:83], v[52:55]
    ds_read_b128 v[232:235], v16 offset:32768
    v_mfma_f32_16x16x32_bf16 v[88:91], v[244:247], a[84:87], v[88:91]
    s_waitcnt lgkmcnt(6)
    v_mfma_f32_16x16x32_bf16 v[56:59], v[104:107], a[80:83], v[56:59]
    ds_read_b128 v[236:239], v16 offset:33792
    v_mfma_f32_16x16x32_bf16 v[92:95], v[104:107], a[84:87], v[92:95]
    buffer_load_dwordx4 a[12:15], v18, s[12:15], s80 offen offset:1024 sc1
    v_mfma_f32_16x16x32_bf16 v[60:63], v[108:111], a[80:83], v[60:63]
    ds_read_b128 v[240:243], v16 offset:34816
    v_mfma_f32_16x16x32_bf16 v[96:99], v[108:111], a[84:87], v[96:99]
    v_mfma_f32_16x16x32_bf16 v[64:67], v[112:115], a[80:83], v[64:67]
    ds_read_b128 v[244:247], v16 offset:35840
    v_mfma_f32_16x16x32_bf16 v[100:103], v[112:115], a[84:87], v[100:103]
    s_waitcnt lgkmcnt(6)
    v_mfma_f32_16x16x32_bf16 v[32:35], v[116:119], a[88:91], v[32:35]
    ds_read_b128 v[104:107], v17 offset:0
    s_add_u32 s80, s75, 786432
    v_mfma_f32_16x16x32_bf16 v[68:71], v[116:119], a[92:95], v[68:71]
    buffer_load_dwordx4 a[16:19], v18, s[12:15], s80 offen offset:0 sc1
    v_mfma_f32_16x16x32_bf16 v[36:39], v[120:123], a[88:91], v[36:39]
    ds_read_b128 v[108:111], v17 offset:1024
    v_mfma_f32_16x16x32_bf16 v[72:75], v[120:123], a[92:95], v[72:75]
    buffer_load_dwordx4 a[20:23], v18, s[12:15], s80 offen offset:1024 sc1
    v_mfma_f32_16x16x32_bf16 v[40:43], v[124:127], a[88:91], v[40:43]
    ds_read_b128 v[112:115], v17 offset:2048
    v_mfma_f32_16x16x32_bf16 v[76:79], v[124:127], a[92:95], v[76:79]
    s_waitcnt lgkmcnt(6)
    v_mfma_f32_16x16x32_bf16 v[44:47], v[224:227], a[88:91], v[44:47]
    ds_read_b128 v[116:119], v17 offset:3072
    v_mfma_f32_16x16x32_bf16 v[80:83], v[224:227], a[92:95], v[80:83]
    v_mfma_f32_16x16x32_bf16 v[48:51], v[228:231], a[88:91], v[48:51]
    ds_read_b128 v[120:123], v17 offset:4096
    s_add_u32 s80, s75, 917504
    v_mfma_f32_16x16x32_bf16 v[84:87], v[228:231], a[92:95], v[84:87]
    buffer_load_dwordx4 a[24:27], v18, s[12:15], s80 offen offset:0 sc1
    v_mfma_f32_16x16x32_bf16 v[52:55], v[232:235], a[88:91], v[52:55]
    ds_read_b128 v[124:127], v17 offset:5120
    v_mfma_f32_16x16x32_bf16 v[88:91], v[232:235], a[92:95], v[88:91]
    s_waitcnt lgkmcnt(6)
    v_mfma_f32_16x16x32_bf16 v[56:59], v[236:239], a[88:91], v[56:59]
    ds_read_b128 v[224:227], v17 offset:6144
    v_mfma_f32_16x16x32_bf16 v[92:95], v[236:239], a[92:95], v[92:95]
    buffer_load_dwordx4 a[28:31], v18, s[12:15], s80 offen offset:1024 sc1
    v_mfma_f32_16x16x32_bf16 v[60:63], v[240:243], a[88:91], v[60:63]
    ds_read_b128 v[228:231], v17 offset:7168
    v_mfma_f32_16x16x32_bf16 v[96:99], v[240:243], a[92:95], v[96:99]
    v_mfma_f32_16x16x32_bf16 v[64:67], v[244:247], a[88:91], v[64:67]
    ds_read_b128 v[232:235], v17 offset:8192
    v_mfma_f32_16x16x32_bf16 v[100:103], v[244:247], a[92:95], v[100:103]
    s_waitcnt vmcnt(17)
    s_barrier
    s_lshl_b32 s27, s81, 7
    s_add_u32 s27, s27, 16384
    v_mov_b32 v27, s27
    global_load_dword v28, v27, s[30:31] sc1
    s_waitcnt lgkmcnt(6)
    v_mfma_f32_16x16x32_bf16 v[32:35], v[104:107], a[96:99], v[32:35]
    ds_read_b128 v[236:239], v17 offset:9216
    s_add_u32 m0, s73, 73728
    v_mfma_f32_16x16x32_bf16 v[68:71], v[104:107], a[100:103], v[68:71]
    buffer_load_dwordx4 v11, s[16:19], s88 offen offset:0 sc1 lds
    v_mfma_f32_16x16x32_bf16 v[36:39], v[108:111], a[96:99], v[36:39]
    ds_read_b128 v[240:243], v17 offset:10240
    v_mfma_f32_16x16x32_bf16 v[72:75], v[108:111], a[100:103], v[72:75]
    buffer_load_dwordx4 v11, s[16:19], s88 offen offset:1024 sc1 lds
    v_mfma_f32_16x16x32_bf16 v[40:43], v[112:115], a[96:99], v[40:43]
    ds_read_b128 v[244:247], v17 offset:11264
    v_mfma_f32_16x16x32_bf16 v[76:79], v[112:115], a[100:103], v[76:79]
    s_waitcnt lgkmcnt(6)
    v_mfma_f32_16x16x32_bf16 v[44:47], v[116:119], a[96:99], v[44:47]
    ds_read_b128 v[104:107], v17 offset:12288
    v_mfma_f32_16x16x32_bf16 v[80:83], v[116:119], a[100:103], v[80:83]
    buffer_load_dwordx4 v11, s[16:19], s88 offen offset:2048 sc1 lds
    v_mfma_f32_16x16x32_bf16 v[48:51], v[120:123], a[96:99], v[48:51]
    ds_read_b128 v[108:111], v17 offset:13312
    v_mfma_f32_16x16x32_bf16 v[84:87], v[120:123], a[100:103], v[84:87]
    v_mfma_f32_16x16x32_bf16 v[52:55], v[124:127], a[96:99], v[52:55]
    ds_read_b128 v[112:115], v17 offset:14336
    v_mfma_f32_16x16x32_bf16 v[88:91], v[124:127], a[100:103], v[88:91]
    s_waitcnt lgkmcnt(6)
    v_mfma_f32_16x16x32_bf16 v[56:59], v[224:227], a[96:99], v[56:59]
    ds_read_b128 v[116:119], v17 offset:15360
    v_mfma_f32_16x16x32_bf16 v[92:95], v[224:227], a[100:103], v[92:95]
    buffer_load_dwordx4 v11, s[16:19], s88 offen offset:3072 sc1 lds
    v_mfma_f32_16x16x32_bf16 v[60:63], v[228:231], a[96:99], v[60:63]
    ds_read_b128 v[120:123], v17 offset:16384
    s_add_u32 m0, s73, 77824
    v_mfma_f32_16x16x32_bf16 v[96:99], v[228:231], a[100:103], v[96:99]
    buffer_load_dwordx4 v12, s[16:19], s88 offen offset:0 sc1 lds
    v_mfma_f32_16x16x32_bf16 v[64:67], v[232:235], a[96:99], v[64:67]
    ds_read_b128 v[124:127], v17 offset:17408
    v_mfma_f32_16x16x32_bf16 v[100:103], v[232:235], a[100:103], v[100:103]
    s_waitcnt lgkmcnt(6)
    v_mfma_f32_16x16x32_bf16 v[32:35], v[236:239], a[104:107], v[32:35]
    ds_read_b128 v[224:227], v17 offset:18432
    v_mfma_f32_16x16x32_bf16 v[68:71], v[236:239], a[108:111], v[68:71]
    v_mfma_f32_16x16x32_bf16 v[36:39], v[240:243], a[104:107], v[36:39]
    ds_read_b128 v[228:231], v17 offset:19456
    v_mfma_f32_16x16x32_bf16 v[72:75], v[240:243], a[108:111], v[72:75]
    buffer_load_dwordx4 v12, s[16:19], s88 offen offset:1024 sc1 lds
    v_mfma_f32_16x16x32_bf16 v[40:43], v[244:247], a[104:107], v[40:43]
    ds_read_b128 v[232:235], v17 offset:20480
    v_mfma_f32_16x16x32_bf16 v[76:79], v[244:247], a[108:111], v[76:79]
    s_waitcnt lgkmcnt(6)
    v_mfma_f32_16x16x32_bf16 v[44:47], v[104:107], a[104:107], v[44:47]
    ds_read_b128 v[236:239], v17 offset:21504
    v_mfma_f32_16x16x32_bf16 v[80:83], v[104:107], a[108:111], v[80:83]
    buffer_load_dwordx4 v12, s[16:19], s88 offen offset:2048 sc1 lds
    v_mfma_f32_16x16x32_bf16 v[48:51], v[108:111], a[104:107], v[48:51]
    ds_read_b128 v[240:243], v17 offset:22528
    v_mfma_f32_16x16x32_bf16 v[84:87], v[108:111], a[108:111], v[84:87]
    buffer_load_dwordx4 v12, s[16:19], s88 offen offset:3072 sc1 lds
    v_mfma_f32_16x16x32_bf16 v[52:55], v[112:115], a[104:107], v[52:55]
    ds_read_b128 v[244:247], v17 offset:23552
    v_mfma_f32_16x16x32_bf16 v[88:91], v[112:115], a[108:111], v[88:91]
    s_waitcnt lgkmcnt(6)
    v_mfma_f32_16x16x32_bf16 v[56:59], v[116:119], a[104:107], v[56:59]
    ds_read_b128 v[104:107], v17 offset:24576
    v_mfma_f32_16x16x32_bf16 v[92:95], v[116:119], a[108:111], v[92:95]
    v_mfma_f32_16x16x32_bf16 v[60:63], v[120:123], a[104:107], v[60:63]
    ds_read_b128 v[108:111], v17 offset:25600
    s_add_u32 m0, s73, 81920
    v_mfma_f32_16x16x32_bf16 v[96:99], v[120:123], a[108:111], v[96:99]
    buffer_load_dwordx4 v13, s[16:19], s88 offen offset:0 sc1 lds
    v_mfma_f32_16x16x32_bf16 v[64:67], v[124:127], a[104:107], v[64:67]
    ds_read_b128 v[112:115], v17 offset:26624
    v_mfma_f32_16x16x32_bf16 v[100:103], v[124:127], a[108:111], v[100:103]
    s_waitcnt lgkmcnt(6)
    v_mfma_f32_16x16x32_bf16 v[32:35], v[224:227], a[112:115], v[32:35]
    ds_read_b128 v[116:119], v17 offset:27648
    s_add_u32 s80, s75, 2359296
    v_mfma_f32_16x16x32_bf16 v[68:71], v[224:227], a[116:119], v[68:71]
    buffer_load_dwordx4 a[32:35], v18, s[12:15], s80 offen offset:0 sc1
    v_mfma_f32_16x16x32_bf16 v[36:39], v[228:231], a[112:115], v[36:39]
    ds_read_b128 v[120:123], v17 offset:28672
    v_mfma_f32_16x16x32_bf16 v[72:75], v[228:231], a[116:119], v[72:75]
    v_mfma_f32_16x16x32_bf16 v[40:43], v[232:235], a[112:115], v[40:43]
    ds_read_b128 v[124:127], v17 offset:29696
    v_mfma_f32_16x16x32_bf16 v[76:79], v[232:235], a[116:119], v[76:79]
    s_waitcnt lgkmcnt(6)
    v_mfma_f32_16x16x32_bf16 v[44:47], v[236:239], a[112:115], v[44:47]
    ds_read_b128 v[224:227], v17 offset:30720
    v_mfma_f32_16x16x32_bf16 v[80:83], v[236:239], a[116:119], v[80:83]
    buffer_load_dwordx4 a[36:39], v18, s[12:15], s80 offen offset:1024 sc1
    v_mfma_f32_16x16x32_bf16 v[48:51], v[240:243], a[112:115], v[48:51]
    ds_read_b128 v[228:231], v17 offset:31744
    s_add_u32 s80, s75, 2490368
    v_mfma_f32_16x16x32_bf16 v[84:87], v[240:243], a[116:119], v[84:87]
    buffer_load_dwordx4 a[40:43], v18, s[12:15], s80 offen offset:0 sc1
    v_mfma_f32_16x16x32_bf16 v[52:55], v[244:247], a[112:115], v[52:55]
    ds_read_b128 v[232:235], v17 offset:32768
    v_mfma_f32_16x16x32_bf16 v[88:91], v[244:247], a[116:119], v[88:91]
    s_waitcnt lgkmcnt(6)
    v_mfma_f32_16x16x32_bf16 v[56:59], v[104:107], a[112:115], v[56:59]
    ds_read_b128 v[236:239], v17 offset:33792
    v_mfma_f32_16x16x32_bf16 v[92:95], v[104:107], a[116:119], v[92:95]
    buffer_load_dwordx4 a[44:47], v18, s[12:15], s80 offen offset:1024 sc1
    v_mfma_f32_16x16x32_bf16 v[60:63], v[108:111], a[112:115], v[60:63]
    ds_read_b128 v[240:243], v17 offset:34816
    v_mfma_f32_16x16x32_bf16 v[96:99], v[108:111], a[116:119], v[96:99]
    v_mfma_f32_16x16x32_bf16 v[64:67], v[112:115], a[112:115], v[64:67]
    ds_read_b128 v[244:247], v17 offset:35840
    v_mfma_f32_16x16x32_bf16 v[100:103], v[112:115], a[116:119], v[100:103]
    s_waitcnt lgkmcnt(6)
    v_mfma_f32_16x16x32_bf16 v[32:35], v[116:119], a[120:123], v[32:35]
    ds_read_b128 v[104:107], v14 offset:0
    s_add_u32 s80, s75, 3932160
    v_mfma_f32_16x16x32_bf16 v[68:71], v[116:119], a[124:127], v[68:71]
    buffer_load_dwordx4 a[48:51], v18, s[12:15], s80 offen offset:0 sc1
    v_mfma_f32_16x16x32_bf16 v[36:39], v[120:123], a[120:123], v[36:39]
    ds_read_b128 v[108:111], v14 offset:1024
    v_mfma_f32_16x16x32_bf16 v[72:75], v[120:123], a[124:127], v[72:75]
    buffer_load_dwordx4 a[52:55], v18, s[12:15], s80 offen offset:1024 sc1
    v_mfma_f32_16x16x32_bf16 v[40:43], v[124:127], a[120:123], v[40:43]
    ds_read_b128 v[112:115], v14 offset:2048
    v_mfma_f32_16x16x32_bf16 v[76:79], v[124:127], a[124:127], v[76:79]
    s_waitcnt lgkmcnt(6)
    v_mfma_f32_16x16x32_bf16 v[44:47], v[224:227], a[120:123], v[44:47]
    ds_read_b128 v[116:119], v14 offset:3072
    v_mfma_f32_16x16x32_bf16 v[80:83], v[224:227], a[124:127], v[80:83]
    v_mfma_f32_16x16x32_bf16 v[48:51], v[228:231], a[120:123], v[48:51]
    ds_read_b128 v[120:123], v14 offset:4096
    s_add_u32 s80, s75, 4063232
    v_mfma_f32_16x16x32_bf16 v[84:87], v[228:231], a[124:127], v[84:87]
    buffer_load_dwordx4 a[56:59], v18, s[12:15], s80 offen offset:0 sc1
    v_mfma_f32_16x16x32_bf16 v[52:55], v[232:235], a[120:123], v[52:55]
    ds_read_b128 v[124:127], v14 offset:5120
    v_mfma_f32_16x16x32_bf16 v[88:91], v[232:235], a[124:127], v[88:91]
    s_waitcnt lgkmcnt(6)
    v_mfma_f32_16x16x32_bf16 v[56:59], v[236:239], a[120:123], v[56:59]
    ds_read_b128 v[224:227], v14 offset:6144
    v_mfma_f32_16x16x32_bf16 v[92:95], v[236:239], a[124:127], v[92:95]
    buffer_load_dwordx4 a[60:63], v18, s[12:15], s80 offen offset:1024 sc1
    v_mfma_f32_16x16x32_bf16 v[60:63], v[240:243], a[120:123], v[60:63]
    ds_read_b128 v[228:231], v14 offset:7168
    v_mfma_f32_16x16x32_bf16 v[96:99], v[240:243], a[124:127], v[96:99]
    v_mfma_f32_16x16x32_bf16 v[64:67], v[244:247], a[120:123], v[64:67]
    ds_read_b128 v[232:235], v14 offset:8192
    v_mfma_f32_16x16x32_bf16 v[100:103], v[244:247], a[124:127], v[100:103]
    s_waitcnt vmcnt(17)
    s_barrier
m_pb:
    v_cmp_gt_u32 vcc, 3, v28
    s_nop 1
    s_cmp_eq_u64 vcc, 0
    s_cbranch_scc1 m_pbx
    s_sleep 2
    s_add_u32 s101, s101, 1
    s_cmp_ge_u32 s101, 4194304
    s_cbranch_scc1 m_pbx
    global_load_dword v28, v27, s[30:31] sc1
    s_waitcnt vmcnt(0)
    s_branch m_pb

m_pbx:
    s_waitcnt lgkmcnt(6)
    v_mfma_f32_16x16x32_bf16 v[32:35], v[104:107], a[0:3], v[32:35]
    ds_read_b128 v[236:239], v14 offset:9216
    s_add_u32 m0, s73, 110592
    v_mfma_f32_16x16x32_bf16 v[68:71], v[104:107], a[4:7], v[68:71]
    buffer_load_dwordx4 v11, s[16:19], s89 offen offset:0 sc1 lds
    v_mfma_f32_16x16x32_bf16 v[36:39], v[108:111], a[0:3], v[36:39]
    ds_read_b128 v[240:243], v14 offset:10240
    v_mfma_f32_16x16x32_bf16 v[72:75], v[108:111], a[4:7], v[72:75]
    buffer_load_dwordx4 v11, s[16:19], s89 offen offset:1024 sc1 lds
    v_mfma_f32_16x16x32_bf16 v[40:43], v[112:115], a[0:3], v[40:43]
    ds_read_b128 v[244:247], v14 offset:11264
    v_mfma_f32_16x16x32_bf16 v[76:79], v[112:115], a[4:7], v[76:79]
    s_waitcnt lgkmcnt(6)
    v_mfma_f32_16x16x32_bf16 v[44:47], v[116:119], a[0:3], v[44:47]
    ds_read_b128 v[104:107], v14 offset:12288
    v_mfma_f32_16x16x32_bf16 v[80:83], v[116:119], a[4:7], v[80:83]
    buffer_load_dwordx4 v11, s[16:19], s89 offen offset:2048 sc1 lds
    v_mfma_f32_16x16x32_bf16 v[48:51], v[120:123], a[0:3], v[48:51]
    ds_read_b128 v[108:111], v14 offset:13312
    v_mfma_f32_16x16x32_bf16 v[84:87], v[120:123], a[4:7], v[84:87]
    v_mfma_f32_16x16x32_bf16 v[52:55], v[124:127], a[0:3], v[52:55]
    ds_read_b128 v[112:115], v14 offset:14336
    v_mfma_f32_16x16x32_bf16 v[88:91], v[124:127], a[4:7], v[88:91]
    s_waitcnt lgkmcnt(6)
    v_mfma_f32_16x16x32_bf16 v[56:59], v[224:227], a[0:3], v[56:59]
    ds_read_b128 v[116:119], v14 offset:15360
    v_mfma_f32_16x16x32_bf16 v[92:95], v[224:227], a[4:7], v[92:95]
    buffer_load_dwordx4 v11, s[16:19], s89 offen offset:3072 sc1 lds
    v_mfma_f32_16x16x32_bf16 v[60:63], v[228:231], a[0:3], v[60:63]
    ds_read_b128 v[120:123], v14 offset:16384
    s_add_u32 m0, s73, 114688
    v_mfma_f32_16x16x32_bf16 v[96:99], v[228:231], a[4:7], v[96:99]
    buffer_load_dwordx4 v12, s[16:19], s89 offen offset:0 sc1 lds
    v_mfma_f32_16x16x32_bf16 v[64:67], v[232:235], a[0:3], v[64:67]
    ds_read_b128 v[124:127], v14 offset:17408
    v_mfma_f32_16x16x32_bf16 v[100:103], v[232:235], a[4:7], v[100:103]
    s_waitcnt lgkmcnt(6)
    v_mfma_f32_16x16x32_bf16 v[32:35], v[236:239], a[8:11], v[32:35]
    ds_read_b128 v[224:227], v14 offset:18432
    v_mfma_f32_16x16x32_bf16 v[68:71], v[236:239], a[12:15], v[68:71]
    v_mfma_f32_16x16x32_bf16 v[36:39], v[240:243], a[8:11], v[36:39]
    ds_read_b128 v[228:231], v14 offset:19456
    v_mfma_f32_16x16x32_bf16 v[72:75], v[240:243], a[12:15], v[72:75]
    buffer_load_dwordx4 v12, s[16:19], s89 offen offset:1024 sc1 lds
    v_mfma_f32_16x16x32_bf16 v[40:43], v[244:247], a[8:11], v[40:43]
    ds_read_b128 v[232:235], v14 offset:20480
    v_mfma_f32_16x16x32_bf16 v[76:79], v[244:247], a[12:15], v[76:79]
    s_waitcnt lgkmcnt(6)
    v_mfma_f32_16x16x32_bf16 v[44:47], v[104:107], a[8:11], v[44:47]
    ds_read_b128 v[236:239], v14 offset:21504
    v_mfma_f32_16x16x32_bf16 v[80:83], v[104:107], a[12:15], v[80:83]
    buffer_load_dwordx4 v12, s[16:19], s89 offen offset:2048 sc1 lds
    v_mfma_f32_16x16x32_bf16 v[48:51], v[108:111], a[8:11], v[48:51]
    ds_read_b128 v[240:243], v14 offset:22528
    v_mfma_f32_16x16x32_bf16 v[84:87], v[108:111], a[12:15], v[84:87]
    buffer_load_dwordx4 v12, s[16:19], s89 offen offset:3072 sc1 lds
    v_mfma_f32_16x16x32_bf16 v[52:55], v[112:115], a[8:11], v[52:55]
    ds_read_b128 v[244:247], v14 offset:23552
    v_mfma_f32_16x16x32_bf16 v[88:91], v[112:115], a[12:15], v[88:91]
    s_waitcnt lgkmcnt(6)
    v_mfma_f32_16x16x32_bf16 v[56:59], v[116:119], a[8:11], v[56:59]
    ds_read_b128 v[104:107], v14 offset:24576
    v_mfma_f32_16x16x32_bf16 v[92:95], v[116:119], a[12:15], v[92:95]
    v_mfma_f32_16x16x32_bf16 v[60:63], v[120:123], a[8:11], v[60:63]
    ds_read_b128 v[108:111], v14 offset:25600
    s_add_u32 m0, s73, 118784
    v_mfma_f32_16x16x32_bf16 v[96:99], v[120:123], a[12:15], v[96:99]
    buffer_load_dwordx4 v13, s[16:19], s89 offen offset:0 sc1 lds
    v_mfma_f32_16x16x32_bf16 v[64:67], v[124:127], a[8:11], v[64:67]
    ds_read_b128 v[112:115], v14 offset:26624
    v_mfma_f32_16x16x32_bf16 v[100:103], v[124:127], a[12:15], v[100:103]
    s_waitcnt lgkmcnt(6)
    v_mfma_f32_16x16x32_bf16 v[32:35], v[224:227], a[16:19], v[32:35]
    ds_read_b128 v[116:119], v14 offset:27648
    s_add_u32 s80, s75, 1048576
    v_mfma_f32_16x16x32_bf16 v[68:71], v[224:227], a[20:23], v[68:71]
    buffer_load_dwordx4 a[64:67], v18, s[12:15], s80 offen offset:0 sc1
    v_mfma_f32_16x16x32_bf16 v[36:39], v[228:231], a[16:19], v[36:39]
    ds_read_b128 v[120:123], v14 offset:28672
    v_mfma_f32_16x16x32_bf16 v[72:75], v[228:231], a[20:23], v[72:75]
    v_mfma_f32_16x16x32_bf16 v[40:43], v[232:235], a[16:19], v[40:43]
    ds_read_b128 v[124:127], v14 offset:29696
    v_mfma_f32_16x16x32_bf16 v[76:79], v[232:235], a[20:23], v[76:79]
    s_waitcnt lgkmcnt(6)
    v_mfma_f32_16x16x32_bf16 v[44:47], v[236:239], a[16:19], v[44:47]
    ds_read_b128 v[224:227], v14 offset:30720
    v_mfma_f32_16x16x32_bf16 v[80:83], v[236:239], a[20:23], v[80:83]
    buffer_load_dwordx4 a[68:71], v18, s[12:15], s80 offen offset:1024 sc1
    v_mfma_f32_16x16x32_bf16 v[48:51], v[240:243], a[16:19], v[48:51]
    ds_read_b128 v[228:231], v14 offset:31744
    s_add_u32 s80, s75, 1179648
    v_mfma_f32_16x16x32_bf16 v[84:87], v[240:243], a[20:23], v[84:87]
    buffer_load_dwordx4 a[72:75], v18, s[12:15], s80 offen offset:0 sc1
    v_mfma_f32_16x16x32_bf16 v[52:55], v[244:247], a[16:19], v[52:55]
    ds_read_b128 v[232:235], v14 offset:32768
    v_mfma_f32_16x16x32_bf16 v[88:91], v[244:247], a[20:23], v[88:91]
    s_waitcnt lgkmcnt(6)
    v_mfma_f32_16x16x32_bf16 v[56:59], v[104:107], a[16:19], v[56:59]
    ds_read_b128 v[236:239], v14 offset:33792
    v_mfma_f32_16x16x32_bf16 v[92:95], v[104:107], a[20:23], v[92:95]
    buffer_load_dwordx4 a[76:79], v18, s[12:15], s80 offen offset:1024 sc1
    v_mfma_f32_16x16x32_bf16 v[60:63], v[108:111], a[16:19], v[60:63]
    ds_read_b128 v[240:243], v14 offset:34816
    v_mfma_f32_16x16x32_bf16 v[96:99], v[108:111], a[20:23], v[96:99]
    v_mfma_f32_16x16x32_bf16 v[64:67], v[112:115], a[16:19], v[64:67]
    ds_read_b128 v[244:247], v14 offset:35840
    v_mfma_f32_16x16x32_bf16 v[100:103], v[112:115], a[20:23], v[100:103]
    s_waitcnt lgkmcnt(6)
    v_mfma_f32_16x16x32_bf16 v[32:35], v[116:119], a[24:27], v[32:35]
    ds_read_b128 v[104:107], v15 offset:0
    s_add_u32 s80, s75, 2621440
    v_mfma_f32_16x16x32_bf16 v[68:71], v[116:119], a[28:31], v[68:71]
    buffer_load_dwordx4 a[80:83], v18, s[12:15], s80 offen offset:0 sc1
    v_mfma_f32_16x16x32_bf16 v[36:39], v[120:123], a[24:27], v[36:39]
    ds_read_b128 v[108:111], v15 offset:1024
    v_mfma_f32_16x16x32_bf16 v[72:75], v[120:123], a[28:31], v[72:75]
    buffer_load_dwordx4 a[84:87], v18, s[12:15], s80 offen offset:1024 sc1
    v_mfma_f32_16x16x32_bf16 v[40:43], v[124:127], a[24:27], v[40:43]
    ds_read_b128 v[112:115], v15 offset:2048
    v_mfma_f32_16x16x32_bf16 v[76:79], v[124:127], a[28:31], v[76:79]
    s_waitcnt lgkmcnt(6)
    v_mfma_f32_16x16x32_bf16 v[44:47], v[224:227], a[24:27], v[44:47]
    ds_read_b128 v[116:119], v15 offset:3072
    v_mfma_f32_16x16x32_bf16 v[80:83], v[224:227], a[28:31], v[80:83]
    v_mfma_f32_16x16x32_bf16 v[48:51], v[228:231], a[24:27], v[48:51]
    ds_read_b128 v[120:123], v15 offset:4096
    s_add_u32 s80, s75, 2752512
    v_mfma_f32_16x16x32_bf16 v[84:87], v[228:231], a[28:31], v[84:87]
    buffer_load_dwordx4 a[88:91], v18, s[12:15], s80 offen offset:0 sc1
    v_mfma_f32_16x16x32_bf16 v[52:55], v[232:235], a[24:27], v[52:55]
    ds_read_b128 v[124:127], v15 offset:5120
    v_mfma_f32_16x16x32_bf16 v[88:91], v[232:235], a[28:31], v[88:91]
    s_waitcnt lgkmcnt(6)
    v_mfma_f32_16x16x32_bf16 v[56:59], v[236:239], a[24:27], v[56:59]
    ds_read_b128 v[224:227], v15 offset:6144
    v_mfma_f32_16x16x32_bf16 v[92:95], v[236:239], a[28:31], v[92:95]
    buffer_load_dwordx4 a[92:95], v18, s[12:15], s80 offen offset:1024 sc1
    v_mfma_f32_16x16x32_bf16 v[60:63], v[240:243], a[24:27], v[60:63]
    ds_read_b128 v[228:231], v15 offset:7168
    v_mfma_f32_16x16x32_bf16 v[96:99], v[240:243], a[28:31], v[96:99]
    v_mfma_f32_16x16x32_bf16 v[64:67], v[244:247], a[24:27], v[64:67]
    ds_read_b128 v[232:235], v15 offset:8192
    v_mfma_f32_16x16x32_bf16 v[100:103], v[244:247], a[28:31], v[100:103]
    s_waitcnt vmcnt(17)
    s_barrier
    s_waitcnt lgkmcnt(6)
    v_mfma_f32_16x16x32_bf16 v[32:35], v[104:107], a[32:35], v[32:35]
    ds_read_b128 v[236:239], v15 offset:9216
    s_add_u32 m0, s73, 0
    v_mfma_f32_16x16x32_bf16 v[68:71], v[104:107], a[36:39], v[68:71]
    buffer_load_dwordx4 v11, s[16:19], s90 offen offset:0 sc1 lds
    v_mfma_f32_16x16x32_bf16 v[36:39], v[108:111], a[32:35], v[36:39]
    ds_read_b128 v[240:243], v15 offset:10240
    v_mfma_f32_16x16x32_bf16 v[72:75], v[108:111], a[36:39], v[72:75]
    buffer_load_dwordx4 v11, s[16:19], s90 offen offset:1024 sc1 lds
    v_mfma_f32_16x16x32_bf16 v[40:43], v[112:115], a[32:35], v[40:43]
    ds_read_b128 v[244:247], v15 offset:11264
    v_mfma_f32_16x16x32_bf16 v[76:79], v[112:115], a[36:39], v[76:79]
    s_waitcnt lgkmcnt(6)
    v_mfma_f32_16x16x32_bf16 v[44:47], v[116:119], a[32:35], v[44:47]
    ds_read_b128 v[104:107], v15 offset:12288
    v_mfma_f32_16x16x32_bf16 v[80:83], v[116:119], a[36:39], v[80:83]
    buffer_load_dwordx4 v11, s[16:19], s90 offen offset:2048 sc1 lds
    v_mfma_f32_16x16x32_bf16 v[48:51], v[120:123], a[32:35], v[48:51]
    ds_read_b128 v[108:111], v15 offset:13312
    v_mfma_f32_16x16x32_bf16 v[84:87], v[120:123], a[36:39], v[84:87]
    v_mfma_f32_16x16x32_bf16 v[52:55], v[124:127], a[32:35], v[52:55]
    ds_read_b128 v[112:115], v15 offset:14336
    v_mfma_f32_16x16x32_bf16 v[88:91], v[124:127], a[36:39], v[88:91]
    s_waitcnt lgkmcnt(6)
    v_mfma_f32_16x16x32_bf16 v[56:59], v[224:227], a[32:35], v[56:59]
    ds_read_b128 v[116:119], v15 offset:15360
    v_mfma_f32_16x16x32_bf16 v[92:95], v[224:227], a[36:39], v[92:95]
    buffer_load_dwordx4 v11, s[16:19], s90 offen offset:3072 sc1 lds
    v_mfma_f32_16x16x32_bf16 v[60:63], v[228:231], a[32:35], v[60:63]
    ds_read_b128 v[120:123], v15 offset:16384
    s_add_u32 m0, s73, 4096
    v_mfma_f32_16x16x32_bf16 v[96:99], v[228:231], a[36:39], v[96:99]
    buffer_load_dwordx4 v12, s[16:19], s90 offen offset:0 sc1 lds
    v_mfma_f32_16x16x32_bf16 v[64:67], v[232:235], a[32:35], v[64:67]
    ds_read_b128 v[124:127], v15 offset:17408
    v_mfma_f32_16x16x32_bf16 v[100:103], v[232:235], a[36:39], v[100:103]
    s_waitcnt lgkmcnt(6)
    v_mfma_f32_16x16x32_bf16 v[32:35], v[236:239], a[40:43], v[32:35]
    ds_read_b128 v[224:227], v15 offset:18432
    v_mfma_f32_16x16x32_bf16 v[68:71], v[236:239], a[44:47], v[68:71]
    v_mfma_f32_16x16x32_bf16 v[36:39], v[240:243], a[40:43], v[36:39]
    ds_read_b128 v[228:231], v15 offset:19456
    v_mfma_f32_16x16x32_bf16 v[72:75], v[240:243], a[44:47], v[72:75]
    buffer_load_dwordx4 v12, s[16:19], s90 offen offset:1024 sc1 lds
    v_mfma_f32_16x16x32_bf16 v[40:43], v[244:247], a[40:43], v[40:43]
    ds_read_b128 v[232:235], v15 offset:20480
    v_mfma_f32_16x16x32_bf16 v[76:79], v[244:247], a[44:47], v[76:79]
    s_waitcnt lgkmcnt(6)
    v_mfma_f32_16x16x32_bf16 v[44:47], v[104:107], a[40:43], v[44:47]
    ds_read_b128 v[236:239], v15 offset:21504
    v_mfma_f32_16x16x32_bf16 v[80:83], v[104:107], a[44:47], v[80:83]
    buffer_load_dwordx4 v12, s[16:19], s90 offen offset:2048 sc1 lds
    v_mfma_f32_16x16x32_bf16 v[48:51], v[108:111], a[40:43], v[48:51]
    ds_read_b128 v[240:243], v15 offset:22528
    v_mfma_f32_16x16x32_bf16 v[84:87], v[108:111], a[44:47], v[84:87]
    buffer_load_dwordx4 v12, s[16:19], s90 offen offset:3072 sc1 lds
    v_mfma_f32_16x16x32_bf16 v[52:55], v[112:115], a[40:43], v[52:55]
    ds_read_b128 v[244:247], v15 offset:23552
    v_mfma_f32_16x16x32_bf16 v[88:91], v[112:115], a[44:47], v[88:91]
    s_waitcnt lgkmcnt(6)
    v_mfma_f32_16x16x32_bf16 v[56:59], v[116:119], a[40:43], v[56:59]
    ds_read_b128 v[104:107], v15 offset:24576
    v_mfma_f32_16x16x32_bf16 v[92:95], v[116:119], a[44:47], v[92:95]
    v_mfma_f32_16x16x32_bf16 v[60:63], v[120:123], a[40:43], v[60:63]
    ds_read_b128 v[108:111], v15 offset:25600
    s_add_u32 m0, s73, 8192
    v_mfma_f32_16x16x32_bf16 v[96:99], v[120:123], a[44:47], v[96:99]
    buffer_load_dwordx4 v13, s[16:19], s90 offen offset:0 sc1 lds
    v_mfma_f32_16x16x32_bf16 v[64:67], v[124:127], a[40:43], v[64:67]
    ds_read_b128 v[112:115], v15 offset:26624
    v_mfma_f32_16x16x32_bf16 v[100:103], v[124:127], a[44:47], v[100:103]
    s_waitcnt lgkmcnt(6)
    v_mfma_f32_16x16x32_bf16 v[32:35], v[224:227], a[48:51], v[32:35]
    ds_read_b128 v[116:119], v15 offset:27648
    s_add_u32 s80, s75, 4194304
    v_mfma_f32_16x16x32_bf16 v[68:71], v[224:227], a[52:55], v[68:71]
    buffer_load_dwordx4 a[96:99], v18, s[12:15], s80 offen offset:0 sc1
    v_mfma_f32_16x16x32_bf16 v[36:39], v[228:231], a[48:51], v[36:39]
    ds_read_b128 v[120:123], v15 offset:28672
    v_mfma_f32_16x16x32_bf16 v[72:75], v[228:231], a[52:55], v[72:75]
    v_mfma_f32_16x16x32_bf16 v[40:43], v[232:235], a[48:51], v[40:43]
    ds_read_b128 v[124:127], v15 offset:29696
    v_mfma_f32_16x16x32_bf16 v[76:79], v[232:235], a[52:55], v[76:79]
    s_waitcnt lgkmcnt(6)
    v_mfma_f32_16x16x32_bf16 v[44:47], v[236:239], a[48:51], v[44:47]
    ds_read_b128 v[224:227], v15 offset:30720
    v_mfma_f32_16x16x32_bf16 v[80:83], v[236:239], a[52:55], v[80:83]
    buffer_load_dwordx4 a[100:103], v18, s[12:15], s80 offen offset:1024 sc1
    v_mfma_f32_16x16x32_bf16 v[48:51], v[240:243], a[48:51], v[48:51]
    ds_read_b128 v[228:231], v15 offset:31744
    s_add_u32 s80, s75, 4325376
    v_mfma_f32_16x16x32_bf16 v[84:87], v[240:243], a[52:55], v[84:87]
    buffer_load_dwordx4 a[104:107], v18, s[12:15], s80 offen offset:0 sc1
    v_mfma_f32_16x16x32_bf16 v[52:55], v[244:247], a[48:51], v[52:55]
    ds_read_b128 v[232:235], v15 offset:32768
    v_mfma_f32_16x16x32_bf16 v[88:91], v[244:247], a[52:55], v[88:91]
    s_waitcnt lgkmcnt(6)
    v_mfma_f32_16x16x32_bf16 v[56:59], v[104:107], a[48:51], v[56:59]
    ds_read_b128 v[236:239], v15 offset:33792
    v_mfma_f32_16x16x32_bf16 v[92:95], v[104:107], a[52:55], v[92:95]
    buffer_load_dwordx4 a[108:111], v18, s[12:15], s80 offen offset:1024 sc1
    v_mfma_f32_16x16x32_bf16 v[60:63], v[108:111], a[48:51], v[60:63]
    ds_read_b128 v[240:243], v15 offset:34816
    v_mfma_f32_16x16x32_bf16 v[96:99], v[108:111], a[52:55], v[96:99]
    v_mfma_f32_16x16x32_bf16 v[64:67], v[112:115], a[48:51], v[64:67]
    ds_read_b128 v[244:247], v15 offset:35840
    v_mfma_f32_16x16x32_bf16 v[100:103], v[112:115], a[52:55], v[100:103]
    s_waitcnt lgkmcnt(6)
    v_mfma_f32_16x16x32_bf16 v[32:35], v[116:119], a[56:59], v[32:35]
    ds_read_b128 v[104:107], v16 offset:0
    s_add_u32 s80, s75, 1310720
    v_mfma_f32_16x16x32_bf16 v[68:71], v[116:119], a[60:63], v[68:71]
    buffer_load_dwordx4 a[112:115], v18, s[12:15], s80 offen offset:0 sc1
    v_mfma_f32_16x16x32_bf16 v[36:39], v[120:123], a[56:59], v[36:39]
    ds_read_b128 v[108:111], v16 offset:1024
    v_mfma_f32_16x16x32_bf16 v[72:75], v[120:123], a[60:63], v[72:75]
    buffer_load_dwordx4 a[116:119], v18, s[12:15], s80 offen offset:1024 sc1
    v_mfma_f32_16x16x32_bf16 v[40:43], v[124:127], a[56:59], v[40:43]
    ds_read_b128 v[112:115], v16 offset:2048
    v_mfma_f32_16x16x32_bf16 v[76:79], v[124:127], a[60:63], v[76:79]
    s_waitcnt lgkmcnt(6)
    v_mfma_f32_16x16x32_bf16 v[44:47], v[224:227], a[56:59], v[44:47]
    ds_read_b128 v[116:119], v16 offset:3072
    v_mfma_f32_16x16x32_bf16 v[80:83], v[224:227], a[60:63], v[80:83]
    v_mfma_f32_16x16x32_bf16 v[48:51], v[228:231], a[56:59], v[48:51]
    ds_read_b128 v[120:123], v16 offset:4096
    s_add_u32 s80, s75, 1441792
    v_mfma_f32_16x16x32_bf16 v[84:87], v[228:231], a[60:63], v[84:87]
    buffer_load_dwordx4 a[120:123], v18, s[12:15], s80 offen offset:0 sc1
    v_mfma_f32_16x16x32_bf16 v[52:55], v[232:235], a[56:59], v[52:55]
    ds_read_b128 v[124:127], v16 offset:5120
    v_mfma_f32_16x16x32_bf16 v[88:91], v[232:235], a[60:63], v[88:91]
    s_waitcnt lgkmcnt(6)
    v_mfma_f32_16x16x32_bf16 v[56:59], v[236:239], a[56:59], v[56:59]
    ds_read_b128 v[224:227], v16 offset:6144
    v_mfma_f32_16x16x32_bf16 v[92:95], v[236:239], a[60:63], v[92:95]
    buffer_load_dwordx4 a[124:127], v18, s[12:15], s80 offen offset:1024 sc1
    v_mfma_f32_16x16x32_bf16 v[60:63], v[240:243], a[56:59], v[60:63]
    ds_read_b128 v[228:231], v16 offset:7168
    v_mfma_f32_16x16x32_bf16 v[96:99], v[240:243], a[60:63], v[96:99]
    v_mfma_f32_16x16x32_bf16 v[64:67], v[244:247], a[56:59], v[64:67]
    ds_read_b128 v[232:235], v16 offset:8192
    v_mfma_f32_16x16x32_bf16 v[100:103], v[244:247], a[60:63], v[100:103]
    s_waitcnt vmcnt(17)
    s_barrier
    s_lshl_b32 s27, s71, 7
    s_add_u32 s27, s27, 24576
    v_mov_b32 v27, s27
    global_load_dword v28, v27, s[30:31] sc1
    s_waitcnt lgkmcnt(6)
    v_mfma_f32_16x16x32_bf16 v[32:35], v[104:107], a[64:67], v[32:35]
    ds_read_b128 v[236:239], v16 offset:9216
    s_add_u32 s79, s77, s26
    s_add_u32 s79, s79, 144
    s_mul_i32 s79, s79, 36864
    s_add_u32 m0, s73, 36864
    v_mfma_f32_16x16x32_bf16 v[68:71], v[104:107], a[68:71], v[68:71]
    buffer_load_dwordx4 v11, s[16:19], s79 offen offset:0 sc1 lds
    v_mfma_f32_16x16x32_bf16 v[36:39], v[108:111], a[64:67], v[36:39]
    ds_read_b128 v[240:243], v16 offset:10240
    v_mfma_f32_16x16x32_bf16 v[72:75], v[108:111], a[68:71], v[72:75]
    buffer_load_dwordx4 v11, s[16:19], s79 offen offset:1024 sc1 lds
    v_mfma_f32_16x16x32_bf16 v[40:43], v[112:115], a[64:67], v[40:43]
    ds_read_b128 v[244:247], v16 offset:11264
    v_mfma_f32_16x16x32_bf16 v[76:79], v[112:115], a[68:71], v[76:79]
    s_waitcnt lgkmcnt(6)
    v_mfma_f32_16x16x32_bf16 v[44:47], v[116:119], a[64:67], v[44:47]
    ds_read_b128 v[104:107], v16 offset:12288
    v_mfma_f32_16x16x32_bf16 v[80:83], v[116:119], a[68:71], v[80:83]
    buffer_load_dwordx4 v11, s[16:19], s79 offen offset:2048 sc1 lds
    v_mfma_f32_16x16x32_bf16 v[48:51], v[120:123], a[64:67], v[48:51]
    ds_read_b128 v[108:111], v16 offset:13312
    v_mfma_f32_16x16x32_bf16 v[84:87], v[120:123], a[68:71], v[84:87]
    v_mfma_f32_16x16x32_bf16 v[52:55], v[124:127], a[64:67], v[52:55]
    ds_read_b128 v[112:115], v16 offset:14336
    v_mfma_f32_16x16x32_bf16 v[88:91], v[124:127], a[68:71], v[88:91]
    s_waitcnt lgkmcnt(6)
    v_mfma_f32_16x16x32_bf16 v[56:59], v[224:227], a[64:67], v[56:59]
    ds_read_b128 v[116:119], v16 offset:15360
    v_mfma_f32_16x16x32_bf16 v[92:95], v[224:227], a[68:71], v[92:95]
    buffer_load_dwordx4 v11, s[16:19], s79 offen offset:3072 sc1 lds
    v_mfma_f32_16x16x32_bf16 v[60:63], v[228:231], a[64:67], v[60:63]
    ds_read_b128 v[120:123], v16 offset:16384
    s_add_u32 m0, s73, 40960
    v_mfma_f32_16x16x32_bf16 v[96:99], v[228:231], a[68:71], v[96:99]
    buffer_load_dwordx4 v12, s[16:19], s79 offen offset:0 sc1 lds
    v_mfma_f32_16x16x32_bf16 v[64:67], v[232:235], a[64:67], v[64:67]
    ds_read_b128 v[124:127], v16 offset:17408
    v_mfma_f32_16x16x32_bf16 v[100:103], v[232:235], a[68:71], v[100:103]
    s_waitcnt lgkmcnt(6)
    v_mfma_f32_16x16x32_bf16 v[32:35], v[236:239], a[72:75], v[32:35]
    ds_read_b128 v[224:227], v16 offset:18432
    v_mfma_f32_16x16x32_bf16 v[68:71], v[236:239], a[76:79], v[68:71]
    v_mfma_f32_16x16x32_bf16 v[36:39], v[240:243], a[72:75], v[36:39]
    ds_read_b128 v[228:231], v16 offset:19456
    v_mfma_f32_16x16x32_bf16 v[72:75], v[240:243], a[76:79], v[72:75]
    buffer_load_dwordx4 v12, s[16:19], s79 offen offset:1024 sc1 lds
    v_mfma_f32_16x16x32_bf16 v[40:43], v[244:247], a[72:75], v[40:43]
    ds_read_b128 v[232:235], v16 offset:20480
    v_mfma_f32_16x16x32_bf16 v[76:79], v[244:247], a[76:79], v[76:79]
    s_waitcnt lgkmcnt(6)
    v_mfma_f32_16x16x32_bf16 v[44:47], v[104:107], a[72:75], v[44:47]
    ds_read_b128 v[236:239], v16 offset:21504
    v_mfma_f32_16x16x32_bf16 v[80:83], v[104:107], a[76:79], v[80:83]
    buffer_load_dwordx4 v12, s[16:19], s79 offen offset:2048 sc1 lds
    v_mfma_f32_16x16x32_bf16 v[48:51], v[108:111], a[72:75], v[48:51]
    ds_read_b128 v[240:243], v16 offset:22528
    v_mfma_f32_16x16x32_bf16 v[84:87], v[108:111], a[76:79], v[84:87]
    buffer_load_dwordx4 v12, s[16:19], s79 offen offset:3072 sc1 lds
    v_mfma_f32_16x16x32_bf16 v[52:55], v[112:115], a[72:75], v[52:55]
    ds_read_b128 v[244:247], v16 offset:23552
    v_mfma_f32_16x16x32_bf16 v[88:91], v[112:115], a[76:79], v[88:91]
    s_waitcnt lgkmcnt(6)
    v_mfma_f32_16x16x32_bf16 v[56:59], v[116:119], a[72:75], v[56:59]
    ds_read_b128 v[104:107], v16 offset:24576
    v_mfma_f32_16x16x32_bf16 v[92:95], v[116:119], a[76:79], v[92:95]
    v_mfma_f32_16x16x32_bf16 v[60:63], v[120:123], a[72:75], v[60:63]
    ds_read_b128 v[108:111], v16 offset:25600
    s_add_u32 m0, s73, 45056
    v_mfma_f32_16x16x32_bf16 v[96:99], v[120:123], a[76:79], v[96:99]
    buffer_load_dwordx4 v13, s[16:19], s79 offen offset:0 sc1 lds
    v_mfma_f32_16x16x32_bf16 v[64:67], v[124:127], a[72:75], v[64:67]
    ds_read_b128 v[112:115], v16 offset:26624
    v_mfma_f32_16x16x32_bf16 v[100:103], v[124:127], a[76:79], v[100:103]
    s_waitcnt lgkmcnt(6)
    v_mfma_f32_16x16x32_bf16 v[32:35], v[224:227], a[80:83], v[32:35]
    ds_read_b128 v[116:119], v16 offset:27648
    s_add_u32 s80, s75, 2883584
    v_mfma_f32_16x16x32_bf16 v[68:71], v[224:227], a[84:87], v[68:71]
    buffer_load_dwordx4 a[0:3], v18, s[12:15], s80 offen offset:0 sc1
    v_mfma_f32_16x16x32_bf16 v[36:39], v[228:231], a[80:83], v[36:39]
    ds_read_b128 v[120:123], v16 offset:28672
    v_mfma_f32_16x16x32_bf16 v[72:75], v[228:231], a[84:87], v[72:75]
    v_mfma_f32_16x16x32_bf16 v[40:43], v[232:235], a[80:83], v[40:43]
    ds_read_b128 v[124:127], v16 offset:29696
    v_mfma_f32_16x16x32_bf16 v[76:79], v[232:235], a[84:87], v[76:79]
    s_waitcnt lgkmcnt(6)
    v_mfma_f32_16x16x32_bf16 v[44:47], v[236:239], a[80:83], v[44:47]
    ds_read_b128 v[224:227], v16 offset:30720
    v_mfma_f32_16x16x32_bf16 v[80:83], v[236:239], a[84:87], v[80:83]
    buffer_load_dwordx4 a[4:7], v18, s[12:15], s80 offen offset:1024 sc1
    v_mfma_f32_16x16x32_bf16 v[48:51], v[240:243], a[80:83], v[48:51]
    ds_read_b128 v[228:231], v16 offset:31744
    s_add_u32 s80, s75, 3014656
    v_mfma_f32_16x16x32_bf16 v[84:87], v[240:243], a[84:87], v[84:87]
    buffer_load_dwordx4 a[8:11], v18, s[12:15], s80 offen offset:0 sc1
    v_mfma_f32_16x16x32_bf16 v[52:55], v[244:247], a[80:83], v[52:55]
    ds_read_b128 v[232:235], v16 offset:32768
    v_mfma_f32_16x16x32_bf16 v[88:91], v[244:247], a[84:87], v[88:91]
    s_waitcnt lgkmcnt(6)
    v_mfma_f32_16x16x32_bf16 v[56:59], v[104:107], a[80:83], v[56:59]
    ds_read_b128 v[236:239], v16 offset:33792
    v_mfma_f32_16x16x32_bf16 v[92:95], v[104:107], a[84:87], v[92:95]
    buffer_load_dwordx4 a[12:15], v18, s[12:15], s80 offen offset:1024 sc1
    v_mfma_f32_16x16x32_bf16 v[60:63], v[108:111], a[80:83], v[60:63]
    ds_read_b128 v[240:243], v16 offset:34816
    v_mfma_f32_16x16x32_bf16 v[96:99], v[108:111], a[84:87], v[96:99]
    v_mfma_f32_16x16x32_bf16 v[64:67], v[112:115], a[80:83], v[64:67]
    ds_read_b128 v[244:247], v16 offset:35840
    v_mfma_f32_16x16x32_bf16 v[100:103], v[112:115], a[84:87], v[100:103]
    s_waitcnt lgkmcnt(6)
    v_mfma_f32_16x16x32_bf16 v[32:35], v[116:119], a[88:91], v[32:35]
    ds_read_b128 v[104:107], v17 offset:0
    s_add_u32 s80, s75, 4456448
    v_mfma_f32_16x16x32_bf16 v[68:71], v[116:119], a[92:95], v[68:71]
    buffer_load_dwordx4 a[16:19], v18, s[12:15], s80 offen offset:0 sc1
    v_mfma_f32_16x16x32_bf16 v[36:39], v[120:123], a[88:91], v[36:39]
    ds_read_b128 v[108:111], v17 offset:1024
    v_mfma_f32_16x16x32_bf16 v[72:75], v[120:123], a[92:95], v[72:75]
    buffer_load_dwordx4 a[20:23], v18, s[12:15], s80 offen offset:1024 sc1
    v_mfma_f32_16x16x32_bf16 v[40:43], v[124:127], a[88:91], v[40:43]
    ds_read_b128 v[112:115], v17 offset:2048
    v_mfma_f32_16x16x32_bf16 v[76:79], v[124:127], a[92:95], v[76:79]
    s_waitcnt lgkmcnt(6)
    v_mfma_f32_16x16x32_bf16 v[44:47], v[224:227], a[88:91], v[44:47]
    ds_read_b128 v[116:119], v17 offset:3072
    v_mfma_f32_16x16x32_bf16 v[80:83], v[224:227], a[92:95], v[80:83]
    v_mfma_f32_16x16x32_bf16 v[48:51], v[228:231], a[88:91], v[48:51]
    ds_read_b128 v[120:123], v17 offset:4096
    s_add_u32 s80, s75, 4587520
    v_mfma_f32_16x16x32_bf16 v[84:87], v[228:231], a[92:95], v[84:87]
    buffer_load_dwordx4 a[24:27], v18, s[12:15], s80 offen offset:0 sc1
    v_mfma_f32_16x16x32_bf16 v[52:55], v[232:235], a[88:91], v[52:55]
    ds_read_b128 v[124:127], v17 offset:5120
    v_mfma_f32_16x16x32_bf16 v[88:91], v[232:235], a[92:95], v[88:91]
    s_waitcnt lgkmcnt(6)
    v_mfma_f32_16x16x32_bf16 v[56:59], v[236:239], a[88:91], v[56:59]
    ds_read_b128 v[224:227], v17 offset:6144
    v_mfma_f32_16x16x32_bf16 v[92:95], v[236:239], a[92:95], v[92:95]
    buffer_load_dwordx4 a[28:31], v18, s[12:15], s80 offen offset:1024 sc1
    v_mfma_f32_16x16x32_bf16 v[60:63], v[240:243], a[88:91], v[60:63]
    ds_read_b128 v[228:231], v17 offset:7168
    v_mfma_f32_16x16x32_bf16 v[96:99], v[240:243], a[92:95], v[96:99]
    v_mfma_f32_16x16x32_bf16 v[64:67], v[244:247], a[88:91], v[64:67]
    ds_read_b128 v[232:235], v17 offset:8192
    v_mfma_f32_16x16x32_bf16 v[100:103], v[244:247], a[92:95], v[100:103]
    s_waitcnt vmcnt(17)
    s_barrier
m_pc:
    v_cmp_gt_u32 vcc, 4, v28
    s_nop 1
    s_cmp_eq_u64 vcc, 0
    s_cbranch_scc1 m_pcx
    s_sleep 2
    s_add_u32 s101, s101, 1
    s_cmp_ge_u32 s101, 4194304
    s_cbranch_scc1 m_pcx
    global_load_dword v28, v27, s[30:31] sc1
    s_waitcnt vmcnt(0)
    s_branch m_pc

m_pcx:
    buffer_load_dword v20, v19, s[40:43], 0 offen sc1
    buffer_load_dword v21, v19, s[40:43], 0 offen offset:64 sc1
    s_waitcnt lgkmcnt(6)
    v_mfma_f32_16x16x32_bf16 v[32:35], v[104:107], a[96:99], v[32:35]
    ds_read_b128 v[236:239], v17 offset:9216
    s_add_u32 s79, s77, 148
    s_mul_i32 s79, s79, 36864
    s_cmp_eq_u32 s78, 5
    s_cselect_b32 s79, s79, 5971968
    s_cmp_eq_u32 s26, 0
    s_cselect_b32 s79, s79, 5971968
    s_add_u32 m0, s73, 73728
    v_mfma_f32_16x16x32_bf16 v[68:71], v[104:107], a[100:103], v[68:71]
    buffer_load_dwordx4 v11, s[16:19], s79 offen offset:0 sc1 lds
    v_mfma_f32_16x16x32_bf16 v[36:39], v[108:111], a[96:99], v[36:39]
    ds_read_b128 v[240:243], v17 offset:10240
    v_mfma_f32_16x16x32_bf16 v[72:75], v[108:111], a[100:103], v[72:75]
    buffer_load_dwordx4 v11, s[16:19], s79 offen offset:1024 sc1 lds
    v_mfma_f32_16x16x32_bf16 v[40:43], v[112:115], a[96:99], v[40:43]
    ds_read_b128 v[244:247], v17 offset:11264
    v_mfma_f32_16x16x32_bf16 v[76:79], v[112:115], a[100:103], v[76:79]
    s_waitcnt lgkmcnt(6)
    v_mfma_f32_16x16x32_bf16 v[44:47], v[116:119], a[96:99], v[44:47]
    ds_read_b128 v[104:107], v17 offset:12288
    v_mfma_f32_16x16x32_bf16 v[80:83], v[116:119], a[100:103], v[80:83]
    buffer_load_dwordx4 v11, s[16:19], s79 offen offset:2048 sc1 lds
    v_mfma_f32_16x16x32_bf16 v[48:51], v[120:123], a[96:99], v[48:51]
    ds_read_b128 v[108:111], v17 offset:13312
    v_mfma_f32_16x16x32_bf16 v[84:87], v[120:123], a[100:103], v[84:87]
    v_mfma_f32_16x16x32_bf16 v[52:55], v[124:127], a[96:99], v[52:55]
    ds_read_b128 v[112:115], v17 offset:14336
    v_mfma_f32_16x16x32_bf16 v[88:91], v[124:127], a[100:103], v[88:91]
    s_waitcnt lgkmcnt(6)
    v_mfma_f32_16x16x32_bf16 v[56:59], v[224:227], a[96:99], v[56:59]
    ds_read_b128 v[116:119], v17 offset:15360
    v_mfma_f32_16x16x32_bf16 v[92:95], v[224:227], a[100:103], v[92:95]
    buffer_load_dwordx4 v11, s[16:19], s79 offen offset:3072 sc1 lds
    v_mfma_f32_16x16x32_bf16 v[60:63], v[228:231], a[96:99], v[60:63]
    ds_read_b128 v[120:123], v17 offset:16384
    s_add_u32 m0, s73, 77824
    v_mfma_f32_16x16x32_bf16 v[96:99], v[228:231], a[100:103], v[96:99]
    buffer_load_dwordx4 v12, s[16:19], s79 offen offset:0 sc1 lds
    v_mfma_f32_16x16x32_bf16 v[64:67], v[232:235], a[96:99], v[64:67]
    ds_read_b128 v[124:127], v17 offset:17408
    v_mfma_f32_16x16x32_bf16 v[100:103], v[232:235], a[100:103], v[100:103]
    s_waitcnt lgkmcnt(6)
    v_mfma_f32_16x16x32_bf16 v[32:35], v[236:239], a[104:107], v[32:35]
    ds_read_b128 v[224:227], v17 offset:18432
    v_mfma_f32_16x16x32_bf16 v[68:71], v[236:239], a[108:111], v[68:71]
    v_mfma_f32_16x16x32_bf16 v[36:39], v[240:243], a[104:107], v[36:39]
    ds_read_b128 v[228:231], v17 offset:19456
    v_mfma_f32_16x16x32_bf16 v[72:75], v[240:243], a[108:111], v[72:75]
    buffer_load_dwordx4 v12, s[16:19], s79 offen offset:1024 sc1 lds
    v_mfma_f32_16x16x32_bf16 v[40:43], v[244:247], a[104:107], v[40:43]
    ds_read_b128 v[232:235], v17 offset:20480
    v_mfma_f32_16x16x32_bf16 v[76:79], v[244:247], a[108:111], v[76:79]
    s_waitcnt lgkmcnt(6)
    v_mfma_f32_16x16x32_bf16 v[44:47], v[104:107], a[104:107], v[44:47]
    ds_read_b128 v[236:239], v17 offset:21504
    v_mfma_f32_16x16x32_bf16 v[80:83], v[104:107], a[108:111], v[80:83]
    buffer_load_dwordx4 v12, s[16:19], s79 offen offset:2048 sc1 lds
    v_mfma_f32_16x16x32_bf16 v[48:51], v[108:111], a[104:107], v[48:51]
    ds_read_b128 v[240:243], v17 offset:22528
    v_mfma_f32_16x16x32_bf16 v[84:87], v[108:111], a[108:111], v[84:87]
    buffer_load_dwordx4 v12, s[16:19], s79 offen offset:3072 sc1 lds
    v_mfma_f32_16x16x32_bf16 v[52:55], v[112:115], a[104:107], v[52:55]
    ds_read_b128 v[244:247], v17 offset:23552
    v_mfma_f32_16x16x32_bf16 v[88:91], v[112:115], a[108:111], v[88:91]
    s_waitcnt lgkmcnt(6)
    v_mfma_f32_16x16x32_bf16 v[56:59], v[116:119], a[104:107], v[56:59]
    ds_read_b128 v[104:107], v17 offset:24576
    v_mfma_f32_16x16x32_bf16 v[92:95], v[116:119], a[108:111], v[92:95]
    v_mfma_f32_16x16x32_bf16 v[60:63], v[120:123], a[104:107], v[60:63]
    ds_read_b128 v[108:111], v17 offset:25600
    s_add_u32 m0, s73, 81920
    v_mfma_f32_16x16x32_bf16 v[96:99], v[120:123], a[108:111], v[96:99]
    buffer_load_dwordx4 v13, s[16:19], s79 offen offset:0 sc1 lds
    v_mfma_f32_16x16x32_bf16 v[64:67], v[124:127], a[104:107], v[64:67]
    ds_read_b128 v[112:115], v17 offset:26624
    v_mfma_f32_16x16x32_bf16 v[100:103], v[124:127], a[108:111], v[100:103]
    s_waitcnt lgkmcnt(6)
    v_mfma_f32_16x16x32_bf16 v[32:35], v[224:227], a[112:115], v[32:35]
    ds_read_b128 v[116:119], v17 offset:27648
    s_add_u32 s80, s77, 144
    s_lshl_b32 s80, s80, 17
    v_mfma_f32_16x16x32_bf16 v[68:71], v[224:227], a[116:119], v[68:71]
    buffer_load_dwordx4 a[32:35], v18, s[12:15], s80 offen offset:0 sc1
    v_mfma_f32_16x16x32_bf16 v[36:39], v[228:231], a[112:115], v[36:39]
    ds_read_b128 v[120:123], v17 offset:28672
    v_mfma_f32_16x16x32_bf16 v[72:75], v[228:231], a[116:119], v[72:75]
    v_mfma_f32_16x16x32_bf16 v[40:43], v[232:235], a[112:115], v[40:43]
    ds_read_b128 v[124:127], v17 offset:29696
    v_mfma_f32_16x16x32_bf16 v[76:79], v[232:235], a[116:119], v[76:79]
    s_waitcnt lgkmcnt(6)
    v_mfma_f32_16x16x32_bf16 v[44:47], v[236:239], a[112:115], v[44:47]
    ds_read_b128 v[224:227], v17 offset:30720
    v_mfma_f32_16x16x32_bf16 v[80:83], v[236:239], a[116:119], v[80:83]
    buffer_load_dwordx4 a[36:39], v18, s[12:15], s80 offen offset:1024 sc1
    v_mfma_f32_16x16x32_bf16 v[48:51], v[240:243], a[112:115], v[48:51]
    ds_read_b128 v[228:231], v17 offset:31744
    s_add_u32 s80, s77, 145
    s_lshl_b32 s80, s80, 17
    v_mfma_f32_16x16x32_bf16 v[84:87], v[240:243], a[116:119], v[84:87]
    buffer_load_dwordx4 a[40:43], v18, s[12:15], s80 offen offset:0 sc1
    v_mfma_f32_16x16x32_bf16 v[52:55], v[244:247], a[112:115], v[52:55]
    ds_read_b128 v[232:235], v17 offset:32768
    v_mfma_f32_16x16x32_bf16 v[88:91], v[244:247], a[116:119], v[88:91]
    s_waitcnt lgkmcnt(6)
    v_mfma_f32_16x16x32_bf16 v[56:59], v[104:107], a[112:115], v[56:59]
    ds_read_b128 v[236:239], v17 offset:33792
    v_mfma_f32_16x16x32_bf16 v[92:95], v[104:107], a[116:119], v[92:95]
    buffer_load_dwordx4 a[44:47], v18, s[12:15], s80 offen offset:1024 sc1
    v_mfma_f32_16x16x32_bf16 v[60:63], v[108:111], a[112:115], v[60:63]
    ds_read_b128 v[240:243], v17 offset:34816
    v_mfma_f32_16x16x32_bf16 v[96:99], v[108:111], a[116:119], v[96:99]
    v_mfma_f32_16x16x32_bf16 v[64:67], v[112:115], a[112:115], v[64:67]
    ds_read_b128 v[244:247], v17 offset:35840
    v_mfma_f32_16x16x32_bf16 v[100:103], v[112:115], a[116:119], v[100:103]
    s_waitcnt lgkmcnt(6)
    v_mfma_f32_16x16x32_bf16 v[32:35], v[116:119], a[120:123], v[32:35]
    ds_read_b128 v[104:107], v14 offset:0
    s_add_u32 s80, s77, 146
    s_lshl_b32 s80, s80, 17
    v_mfma_f32_16x16x32_bf16 v[68:71], v[116:119], a[124:127], v[68:71]
    buffer_load_dwordx4 a[48:51], v18, s[12:15], s80 offen offset:0 sc1
    v_mfma_f32_16x16x32_bf16 v[36:39], v[120:123], a[120:123], v[36:39]
    ds_read_b128 v[108:111], v14 offset:1024
    v_mfma_f32_16x16x32_bf16 v[72:75], v[120:123], a[124:127], v[72:75]
    buffer_load_dwordx4 a[52:55], v18, s[12:15], s80 offen offset:1024 sc1
    v_mfma_f32_16x16x32_bf16 v[40:43], v[124:127], a[120:123], v[40:43]
    ds_read_b128 v[112:115], v14 offset:2048
    v_mfma_f32_16x16x32_bf16 v[76:79], v[124:127], a[124:127], v[76:79]
    s_waitcnt lgkmcnt(6)
    v_mfma_f32_16x16x32_bf16 v[44:47], v[224:227], a[120:123], v[44:47]
    ds_read_b128 v[116:119], v14 offset:3072
    v_mfma_f32_16x16x32_bf16 v[80:83], v[224:227], a[124:127], v[80:83]
    v_mfma_f32_16x16x32_bf16 v[48:51], v[228:231], a[120:123], v[48:51]
    ds_read_b128 v[120:123], v14 offset:4096
    s_add_u32 s80, s77, 147
    s_lshl_b32 s80, s80, 17
    v_mfma_f32_16x16x32_bf16 v[84:87], v[228:231], a[124:127], v[84:87]
    buffer_load_dwordx4 a[56:59], v18, s[12:15], s80 offen offset:0 sc1
    v_mfma_f32_16x16x32_bf16 v[52:55], v[232:235], a[120:123], v[52:55]
    ds_read_b128 v[124:127], v14 offset:5120
    v_mfma_f32_16x16x32_bf16 v[88:91], v[232:235], a[124:127], v[88:91]
    s_waitcnt lgkmcnt(6)
    v_mfma_f32_16x16x32_bf16 v[56:59], v[236:239], a[120:123], v[56:59]
    ds_read_b128 v[224:227], v14 offset:6144
    v_mfma_f32_16x16x32_bf16 v[92:95], v[236:239], a[124:127], v[92:95]
    buffer_load_dwordx4 a[60:63], v18, s[12:15], s80 offen offset:1024 sc1
    v_mfma_f32_16x16x32_bf16 v[60:63], v[240:243], a[120:123], v[60:63]
    ds_read_b128 v[228:231], v14 offset:7168
    v_mfma_f32_16x16x32_bf16 v[96:99], v[240:243], a[124:127], v[96:99]
    v_mfma_f32_16x16x32_bf16 v[64:67], v[244:247], a[120:123], v[64:67]
    ds_read_b128 v[232:235], v14 offset:8192
    v_mfma_f32_16x16x32_bf16 v[100:103], v[244:247], a[124:127], v[100:103]
    s_waitcnt vmcnt(19)
    s_barrier
    s_waitcnt lgkmcnt(6)
    v_mfma_f32_16x16x32_bf16 v[32:35], v[104:107], a[0:3], v[32:35]
    ds_read_b128 v[236:239], v14 offset:9216
    s_add_u32 s80, s77, 148
    s_lshl_b32 s80, s80, 17
    s_cmp_eq_u32 s78, 5
    s_cselect_b32 s80, s80, 21233664
    v_mfma_f32_16x16x32_bf16 v[68:71], v[104:107], a[4:7], v[68:71]
    buffer_load_dwordx4 a[64:67], v18, s[12:15], s80 offen offset:0 sc1
    v_mfma_f32_16x16x32_bf16 v[36:39], v[108:111], a[0:3], v[36:39]
    ds_read_b128 v[240:243], v14 offset:10240
    v_mfma_f32_16x16x32_bf16 v[72:75], v[108:111], a[4:7], v[72:75]
    v_mfma_f32_16x16x32_bf16 v[40:43], v[112:115], a[0:3], v[40:43]
    ds_read_b128 v[244:247], v14 offset:11264
    v_mfma_f32_16x16x32_bf16 v[76:79], v[112:115], a[4:7], v[76:79]
    s_waitcnt lgkmcnt(6)
    v_mfma_f32_16x16x32_bf16 v[44:47], v[116:119], a[0:3], v[44:47]
    ds_read_b128 v[104:107], v14 offset:12288
    v_mfma_f32_16x16x32_bf16 v[80:83], v[116:119], a[4:7], v[80:83]
    v_mfma_f32_16x16x32_bf16 v[48:51], v[120:123], a[0:3], v[48:51]
    ds_read_b128 v[108:111], v14 offset:13312
    v_mfma_f32_16x16x32_bf16 v[84:87], v[120:123], a[4:7], v[84:87]
    v_mfma_f32_16x16x32_bf16 v[52:55], v[124:127], a[0:3], v[52:55]
    ds_read_b128 v[112:115], v14 offset:14336
    v_mfma_f32_16x16x32_bf16 v[88:91], v[124:127], a[4:7], v[88:91]
    s_waitcnt lgkmcnt(6)
    v_mfma_f32_16x16x32_bf16 v[56:59], v[224:227], a[0:3], v[56:59]
    ds_read_b128 v[116:119], v14 offset:15360
    v_mfma_f32_16x16x32_bf16 v[92:95], v[224:227], a[4:7], v[92:95]
    v_mfma_f32_16x16x32_bf16 v[60:63], v[228:231], a[0:3], v[60:63]
    ds_read_b128 v[120:123], v14 offset:16384
    v_mfma_f32_16x16x32_bf16 v[96:99], v[228:231], a[4:7], v[96:99]
    v_mfma_f32_16x16x32_bf16 v[64:67], v[232:235], a[0:3], v[64:67]
    ds_read_b128 v[124:127], v14 offset:17408
    v_mfma_f32_16x16x32_bf16 v[100:103], v[232:235], a[4:7], v[100:103]
    s_waitcnt lgkmcnt(6)
    v_mfma_f32_16x16x32_bf16 v[32:35], v[236:239], a[8:11], v[32:35]
    ds_read_b128 v[224:227], v14 offset:18432
    v_mfma_f32_16x16x32_bf16 v[68:71], v[236:239], a[12:15], v[68:71]
    v_mfma_f32_16x16x32_bf16 v[36:39], v[240:243], a[8:11], v[36:39]
    ds_read_b128 v[228:231], v14 offset:19456
    v_mfma_f32_16x16x32_bf16 v[72:75], v[240:243], a[12:15], v[72:75]
    v_mfma_f32_16x16x32_bf16 v[40:43], v[244:247], a[8:11], v[40:43]
    ds_read_b128 v[232:235], v14 offset:20480
    v_mfma_f32_16x16x32_bf16 v[76:79], v[244:247], a[12:15], v[76:79]
    s_waitcnt lgkmcnt(6)
    v_mfma_f32_16x16x32_bf16 v[44:47], v[104:107], a[8:11], v[44:47]
    ds_read_b128 v[236:239], v14 offset:21504
    v_mfma_f32_16x16x32_bf16 v[80:83], v[104:107], a[12:15], v[80:83]
    v_mfma_f32_16x16x32_bf16 v[48:51], v[108:111], a[8:11], v[48:51]
    ds_read_b128 v[240:243], v14 offset:22528
    v_mfma_f32_16x16x32_bf16 v[84:87], v[108:111], a[12:15], v[84:87]
    v_mfma_f32_16x16x32_bf16 v[52:55], v[112:115], a[8:11], v[52:55]
    ds_read_b128 v[244:247], v14 offset:23552
    v_mfma_f32_16x16x32_bf16 v[88:91], v[112:115], a[12:15], v[88:91]
    s_waitcnt lgkmcnt(6)
    v_mfma_f32_16x16x32_bf16 v[56:59], v[116:119], a[8:11], v[56:59]
    ds_read_b128 v[104:107], v14 offset:24576
    v_mfma_f32_16x16x32_bf16 v[92:95], v[116:119], a[12:15], v[92:95]
    v_mfma_f32_16x16x32_bf16 v[60:63], v[120:123], a[8:11], v[60:63]
    ds_read_b128 v[108:111], v14 offset:25600
    v_mfma_f32_16x16x32_bf16 v[96:99], v[120:123], a[12:15], v[96:99]
    v_mfma_f32_16x16x32_bf16 v[64:67], v[124:127], a[8:11], v[64:67]
    ds_read_b128 v[112:115], v14 offset:26624
    v_mfma_f32_16x16x32_bf16 v[100:103], v[124:127], a[12:15], v[100:103]
    s_waitcnt lgkmcnt(6)
    v_mfma_f32_16x16x32_bf16 v[32:35], v[224:227], a[16:19], v[32:35]
    ds_read_b128 v[116:119], v14 offset:27648
    v_mfma_f32_16x16x32_bf16 v[68:71], v[224:227], a[20:23], v[68:71]
    buffer_load_dwordx4 a[68:71], v18, s[12:15], s80 offen offset:1024 sc1
    v_mfma_f32_16x16x32_bf16 v[36:39], v[228:231], a[16:19], v[36:39]
    ds_read_b128 v[120:123], v14 offset:28672
    v_mfma_f32_16x16x32_bf16 v[72:75], v[228:231], a[20:23], v[72:75]
    v_mfma_f32_16x16x32_bf16 v[40:43], v[232:235], a[16:19], v[40:43]
    ds_read_b128 v[124:127], v14 offset:29696
    v_mfma_f32_16x16x32_bf16 v[76:79], v[232:235], a[20:23], v[76:79]
    s_waitcnt lgkmcnt(6)
    v_mfma_f32_16x16x32_bf16 v[44:47], v[236:239], a[16:19], v[44:47]
    ds_read_b128 v[224:227], v14 offset:30720
    v_mfma_f32_16x16x32_bf16 v[80:83], v[236:239], a[20:23], v[80:83]
    v_mfma_f32_16x16x32_bf16 v[48:51], v[240:243], a[16:19], v[48:51]
    ds_read_b128 v[228:231], v14 offset:31744
    v_mfma_f32_16x16x32_bf16 v[84:87], v[240:243], a[20:23], v[84:87]
    v_mfma_f32_16x16x32_bf16 v[52:55], v[244:247], a[16:19], v[52:55]
    ds_read_b128 v[232:235], v14 offset:32768
    v_mfma_f32_16x16x32_bf16 v[88:91], v[244:247], a[20:23], v[88:91]
    s_waitcnt lgkmcnt(6)
    v_mfma_f32_16x16x32_bf16 v[56:59], v[104:107], a[16:19], v[56:59]
    ds_read_b128 v[236:239], v14 offset:33792
    v_mfma_f32_16x16x32_bf16 v[92:95], v[104:107], a[20:23], v[92:95]
    v_mfma_f32_16x16x32_bf16 v[60:63], v[108:111], a[16:19], v[60:63]
    ds_read_b128 v[240:243], v14 offset:34816
    v_mfma_f32_16x16x32_bf16 v[96:99], v[108:111], a[20:23], v[96:99]
    v_mfma_f32_16x16x32_bf16 v[64:67], v[112:115], a[16:19], v[64:67]
    ds_read_b128 v[244:247], v14 offset:35840
    v_mfma_f32_16x16x32_bf16 v[100:103], v[112:115], a[20:23], v[100:103]
    s_waitcnt lgkmcnt(6)
    v_mfma_f32_16x16x32_bf16 v[32:35], v[116:119], a[24:27], v[32:35]
    ds_read_b128 v[104:107], v15 offset:0
    v_mfma_f32_16x16x32_bf16 v[68:71], v[116:119], a[28:31], v[68:71]
    v_mfma_f32_16x16x32_bf16 v[36:39], v[120:123], a[24:27], v[36:39]
    ds_read_b128 v[108:111], v15 offset:1024
    v_mfma_f32_16x16x32_bf16 v[72:75], v[120:123], a[28:31], v[72:75]
    v_mfma_f32_16x16x32_bf16 v[40:43], v[124:127], a[24:27], v[40:43]
    ds_read_b128 v[112:115], v15 offset:2048
    v_mfma_f32_16x16x32_bf16 v[76:79], v[124:127], a[28:31], v[76:79]
    s_waitcnt lgkmcnt(6)
    v_mfma_f32_16x16x32_bf16 v[44:47], v[224:227], a[24:27], v[44:47]
    ds_read_b128 v[116:119], v15 offset:3072
    v_mfma_f32_16x16x32_bf16 v[80:83], v[224:227], a[28:31], v[80:83]
    v_mfma_f32_16x16x32_bf16 v[48:51], v[228:231], a[24:27], v[48:51]
    ds_read_b128 v[120:123], v15 offset:4096
    v_mfma_f32_16x16x32_bf16 v[84:87], v[228:231], a[28:31], v[84:87]
    v_mfma_f32_16x16x32_bf16 v[52:55], v[232:235], a[24:27], v[52:55]
    ds_read_b128 v[124:127], v15 offset:5120
    v_mfma_f32_16x16x32_bf16 v[88:91], v[232:235], a[28:31], v[88:91]
    s_waitcnt lgkmcnt(6)
    v_mfma_f32_16x16x32_bf16 v[56:59], v[236:239], a[24:27], v[56:59]
    ds_read_b128 v[224:227], v15 offset:6144
    v_mfma_f32_16x16x32_bf16 v[92:95], v[236:239], a[28:31], v[92:95]
    v_mfma_f32_16x16x32_bf16 v[60:63], v[240:243], a[24:27], v[60:63]
    ds_read_b128 v[228:231], v15 offset:7168
    v_mfma_f32_16x16x32_bf16 v[96:99], v[240:243], a[28:31], v[96:99]
    v_mfma_f32_16x16x32_bf16 v[64:67], v[244:247], a[24:27], v[64:67]
    ds_read_b128 v[232:235], v15 offset:8192
    v_mfma_f32_16x16x32_bf16 v[100:103], v[244:247], a[28:31], v[100:103]
    s_waitcnt vmcnt(19)
    s_nop 4
    v_sub_f32 v20, 1.0, v20
    v_sub_f32 v21, 1.0, v21
    v_mul_f32 v32, v32, v20
    v_mul_f32 v33, v33, v20
    v_mul_f32 v34, v34, v20
    v_mul_f32 v35, v35, v20
    v_mul_f32 v36, v36, v20
    v_mul_f32 v37, v37, v20
    v_mul_f32 v38, v38, v20
    v_mul_f32 v39, v39, v20
    v_mul_f32 v40, v40, v20
    v_mul_f32 v41, v41, v20
    v_mul_f32 v42, v42, v20
    v_mul_f32 v43, v43, v20
    v_mul_f32 v44, v44, v20
    v_mul_f32 v45, v45, v20
    v_mul_f32 v46, v46, v20
    v_mul_f32 v47, v47, v20
    v_mul_f32 v48, v48, v20
    v_mul_f32 v49, v49, v20
    v_mul_f32 v50, v50, v20
    v_mul_f32 v51, v51, v20
    v_mul_f32 v52, v52, v20
    v_mul_f32 v53, v53, v20
    v_mul_f32 v54, v54, v20
    v_mul_f32 v55, v55, v20
    v_mul_f32 v56, v56, v20
    v_mul_f32 v57, v57, v20
    v_mul_f32 v58, v58, v20
    v_mul_f32 v59, v59, v20
    v_mul_f32 v60, v60, v20
    v_mul_f32 v61, v61, v20
    v_mul_f32 v62, v62, v20
    v_mul_f32 v63, v63, v20
    v_mul_f32 v64, v64, v20
    v_mul_f32 v65, v65, v20
    v_mul_f32 v66, v66, v20
    v_mul_f32 v67, v67, v20
    v_mul_f32 v68, v68, v21
    v_mul_f32 v69, v69, v21
    v_mul_f32 v70, v70, v21
    v_mul_f32 v71, v71, v21
    v_mul_f32 v72, v72, v21
    v_mul_f32 v73, v73, v21
    v_mul_f32 v74, v74, v21
    v_mul_f32 v75, v75, v21
    v_mul_f32 v76, v76, v21
    v_mul_f32 v77, v77, v21
    v_mul_f32 v78, v78, v21
    v_mul_f32 v79, v79, v21
    v_mul_f32 v80, v80, v21
    v_mul_f32 v81, v81, v21
    v_mul_f32 v82, v82, v21
    v_mul_f32 v83, v83, v21
    v_mul_f32 v84, v84, v21
    v_mul_f32 v85, v85, v21
    v_mul_f32 v86, v86, v21
    v_mul_f32 v87, v87, v21
    v_mul_f32 v88, v88, v21
    v_mul_f32 v89, v89, v21
    v_mul_f32 v90, v90, v21
    v_mul_f32 v91, v91, v21
    v_mul_f32 v92, v92, v21
    v_mul_f32 v93, v93, v21
    v_mul_f32 v94, v94, v21
    v_mul_f32 v95, v95, v21
    v_mul_f32 v96, v96, v21
    v_mul_f32 v97, v97, v21
    v_mul_f32 v98, v98, v21
    v_mul_f32 v99, v99, v21
    v_mul_f32 v100, v100, v21
    v_mul_f32 v101, v101, v21
    v_mul_f32 v102, v102, v21
    v_mul_f32 v103, v103, v21
    s_nop 1
    s_waitcnt vmcnt(2)
    s_barrier
    s_waitcnt lgkmcnt(6)
    v_mfma_f32_16x16x32_bf16 v[32:35], v[104:107], a[32:35], v[32:35]
    ds_read_b128 v[236:239], v15 offset:9216
    v_mfma_f32_16x16x32_bf16 v[68:71], v[104:107], a[36:39], v[68:71]
    v_mfma_f32_16x16x32_bf16 v[36:39], v[108:111], a[32:35], v[36:39]
    ds_read_b128 v[240:243], v15 offset:10240
    v_mfma_f32_16x16x32_bf16 v[72:75], v[108:111], a[36:39], v[72:75]
    v_mfma_f32_16x16x32_bf16 v[40:43], v[112:115], a[32:35], v[40:43]
    ds_read_b128 v[244:247], v15 offset:11264
    v_mfma_f32_16x16x32_bf16 v[76:79], v[112:115], a[36:39], v[76:79]
    s_waitcnt lgkmcnt(6)
    v_mfma_f32_16x16x32_bf16 v[44:47], v[116:119], a[32:35], v[44:47]
    ds_read_b128 v[104:107], v15 offset:12288
    v_mfma_f32_16x16x32_bf16 v[80:83], v[116:119], a[36:39], v[80:83]
    v_mfma_f32_16x16x32_bf16 v[48:51], v[120:123], a[32:35], v[48:51]
    ds_read_b128 v[108:111], v15 offset:13312
    v_mfma_f32_16x16x32_bf16 v[84:87], v[120:123], a[36:39], v[84:87]
    v_mfma_f32_16x16x32_bf16 v[52:55], v[124:127], a[32:35], v[52:55]
    ds_read_b128 v[112:115], v15 offset:14336
    v_mfma_f32_16x16x32_bf16 v[88:91], v[124:127], a[36:39], v[88:91]
    s_waitcnt lgkmcnt(6)
    v_mfma_f32_16x16x32_bf16 v[56:59], v[224:227], a[32:35], v[56:59]
    ds_read_b128 v[116:119], v15 offset:15360
    v_mfma_f32_16x16x32_bf16 v[92:95], v[224:227], a[36:39], v[92:95]
    v_mfma_f32_16x16x32_bf16 v[60:63], v[228:231], a[32:35], v[60:63]
    ds_read_b128 v[120:123], v15 offset:16384
    v_mfma_f32_16x16x32_bf16 v[96:99], v[228:231], a[36:39], v[96:99]
    v_mfma_f32_16x16x32_bf16 v[64:67], v[232:235], a[32:35], v[64:67]
    ds_read_b128 v[124:127], v15 offset:17408
    v_mfma_f32_16x16x32_bf16 v[100:103], v[232:235], a[36:39], v[100:103]
    s_waitcnt lgkmcnt(6)
    v_mfma_f32_16x16x32_bf16 v[32:35], v[236:239], a[40:43], v[32:35]
    ds_read_b128 v[224:227], v15 offset:18432
    v_mfma_f32_16x16x32_bf16 v[68:71], v[236:239], a[44:47], v[68:71]
    v_mfma_f32_16x16x32_bf16 v[36:39], v[240:243], a[40:43], v[36:39]
    ds_read_b128 v[228:231], v15 offset:19456
    v_mfma_f32_16x16x32_bf16 v[72:75], v[240:243], a[44:47], v[72:75]
    v_mfma_f32_16x16x32_bf16 v[40:43], v[244:247], a[40:43], v[40:43]
    ds_read_b128 v[232:235], v15 offset:20480
    v_mfma_f32_16x16x32_bf16 v[76:79], v[244:247], a[44:47], v[76:79]
    s_waitcnt lgkmcnt(6)
    v_mfma_f32_16x16x32_bf16 v[44:47], v[104:107], a[40:43], v[44:47]
    ds_read_b128 v[236:239], v15 offset:21504
    v_mfma_f32_16x16x32_bf16 v[80:83], v[104:107], a[44:47], v[80:83]
    v_mfma_f32_16x16x32_bf16 v[48:51], v[108:111], a[40:43], v[48:51]
    ds_read_b128 v[240:243], v15 offset:22528
    v_mfma_f32_16x16x32_bf16 v[84:87], v[108:111], a[44:47], v[84:87]
    v_mfma_f32_16x16x32_bf16 v[52:55], v[112:115], a[40:43], v[52:55]
    ds_read_b128 v[244:247], v15 offset:23552
    v_mfma_f32_16x16x32_bf16 v[88:91], v[112:115], a[44:47], v[88:91]
    s_waitcnt lgkmcnt(6)
    v_mfma_f32_16x16x32_bf16 v[56:59], v[116:119], a[40:43], v[56:59]
    ds_read_b128 v[104:107], v15 offset:24576
    v_mfma_f32_16x16x32_bf16 v[92:95], v[116:119], a[44:47], v[92:95]
    v_mfma_f32_16x16x32_bf16 v[60:63], v[120:123], a[40:43], v[60:63]
    ds_read_b128 v[108:111], v15 offset:25600
    v_mfma_f32_16x16x32_bf16 v[96:99], v[120:123], a[44:47], v[96:99]
    v_mfma_f32_16x16x32_bf16 v[64:67], v[124:127], a[40:43], v[64:67]
    ds_read_b128 v[112:115], v15 offset:26624
    v_mfma_f32_16x16x32_bf16 v[100:103], v[124:127], a[44:47], v[100:103]
    s_waitcnt lgkmcnt(6)
    v_mfma_f32_16x16x32_bf16 v[32:35], v[224:227], a[48:51], v[32:35]
    ds_read_b128 v[116:119], v15 offset:27648
    v_mfma_f32_16x16x32_bf16 v[68:71], v[224:227], a[52:55], v[68:71]
    v_mfma_f32_16x16x32_bf16 v[36:39], v[228:231], a[48:51], v[36:39]
    ds_read_b128 v[120:123], v15 offset:28672
    v_mfma_f32_16x16x32_bf16 v[72:75], v[228:231], a[52:55], v[72:75]
    v_mfma_f32_16x16x32_bf16 v[40:43], v[232:235], a[48:51], v[40:43]
    ds_read_b128 v[124:127], v15 offset:29696
    v_mfma_f32_16x16x32_bf16 v[76:79], v[232:235], a[52:55], v[76:79]
    s_waitcnt lgkmcnt(6)
    v_mfma_f32_16x16x32_bf16 v[44:47], v[236:239], a[48:51], v[44:47]
    ds_read_b128 v[224:227], v15 offset:30720
    v_mfma_f32_16x16x32_bf16 v[80:83], v[236:239], a[52:55], v[80:83]
    v_mfma_f32_16x16x32_bf16 v[48:51], v[240:243], a[48:51], v[48:51]
    ds_read_b128 v[228:231], v15 offset:31744
    v_mfma_f32_16x16x32_bf16 v[84:87], v[240:243], a[52:55], v[84:87]
    v_mfma_f32_16x16x32_bf16 v[52:55], v[244:247], a[48:51], v[52:55]
    ds_read_b128 v[232:235], v15 offset:32768
    v_mfma_f32_16x16x32_bf16 v[88:91], v[244:247], a[52:55], v[88:91]
    s_waitcnt lgkmcnt(6)
    v_mfma_f32_16x16x32_bf16 v[56:59], v[104:107], a[48:51], v[56:59]
    ds_read_b128 v[236:239], v15 offset:33792
    v_mfma_f32_16x16x32_bf16 v[92:95], v[104:107], a[52:55], v[92:95]
    v_mfma_f32_16x16x32_bf16 v[60:63], v[108:111], a[48:51], v[60:63]
    ds_read_b128 v[240:243], v15 offset:34816
    v_mfma_f32_16x16x32_bf16 v[96:99], v[108:111], a[52:55], v[96:99]
    v_mfma_f32_16x16x32_bf16 v[64:67], v[112:115], a[48:51], v[64:67]
    ds_read_b128 v[244:247], v15 offset:35840
    v_mfma_f32_16x16x32_bf16 v[100:103], v[112:115], a[52:55], v[100:103]
    s_waitcnt lgkmcnt(6)
    v_mfma_f32_16x16x32_bf16 v[32:35], v[116:119], a[56:59], v[32:35]
    ds_read_b128 v[104:107], v16 offset:0
    v_mfma_f32_16x16x32_bf16 v[68:71], v[116:119], a[60:63], v[68:71]
    v_mfma_f32_16x16x32_bf16 v[36:39], v[120:123], a[56:59], v[36:39]
    ds_read_b128 v[108:111], v16 offset:1024
    v_mfma_f32_16x16x32_bf16 v[72:75], v[120:123], a[60:63], v[72:75]
    v_mfma_f32_16x16x32_bf16 v[40:43], v[124:127], a[56:59], v[40:43]
    ds_read_b128 v[112:115], v16 offset:2048
    v_mfma_f32_16x16x32_bf16 v[76:79], v[124:127], a[60:63], v[76:79]
    s_waitcnt lgkmcnt(6)
    v_mfma_f32_16x16x32_bf16 v[44:47], v[224:227], a[56:59], v[44:47]
    ds_read_b128 v[116:119], v16 offset:3072
    v_mfma_f32_16x16x32_bf16 v[80:83], v[224:227], a[60:63], v[80:83]
    v_mfma_f32_16x16x32_bf16 v[48:51], v[228:231], a[56:59], v[48:51]
    ds_read_b128 v[120:123], v16 offset:4096
    v_mfma_f32_16x16x32_bf16 v[84:87], v[228:231], a[60:63], v[84:87]
    v_mfma_f32_16x16x32_bf16 v[52:55], v[232:235], a[56:59], v[52:55]
    ds_read_b128 v[124:127], v16 offset:5120
    v_mfma_f32_16x16x32_bf16 v[88:91], v[232:235], a[60:63], v[88:91]
    s_waitcnt lgkmcnt(6)
    v_mfma_f32_16x16x32_bf16 v[56:59], v[236:239], a[56:59], v[56:59]
    ds_read_b128 v[224:227], v16 offset:6144
    v_mfma_f32_16x16x32_bf16 v[92:95], v[236:239], a[60:63], v[92:95]
    v_mfma_f32_16x16x32_bf16 v[60:63], v[240:243], a[56:59], v[60:63]
    ds_read_b128 v[228:231], v16 offset:7168
    v_mfma_f32_16x16x32_bf16 v[96:99], v[240:243], a[60:63], v[96:99]
    v_mfma_f32_16x16x32_bf16 v[64:67], v[244:247], a[56:59], v[64:67]
    ds_read_b128 v[232:235], v16 offset:8192
    v_mfma_f32_16x16x32_bf16 v[100:103], v[244:247], a[60:63], v[100:103]
    s_waitcnt vmcnt(0)
    s_barrier
    s_waitcnt lgkmcnt(6)
    v_mfma_f32_16x16x32_bf16 v[32:35], v[104:107], a[64:67], v[32:35]
    v_mfma_f32_16x16x32_bf16 v[68:71], v[104:107], a[68:71], v[68:71]
    v_mfma_f32_16x16x32_bf16 v[36:39], v[108:111], a[64:67], v[36:39]
    v_mfma_f32_16x16x32_bf16 v[72:75], v[108:111], a[68:71], v[72:75]
    v_mfma_f32_16x16x32_bf16 v[40:43], v[112:115], a[64:67], v[40:43]
    v_mfma_f32_16x16x32_bf16 v[76:79], v[112:115], a[68:71], v[76:79]
    s_waitcnt lgkmcnt(3)
    v_mfma_f32_16x16x32_bf16 v[44:47], v[116:119], a[64:67], v[44:47]
    v_mfma_f32_16x16x32_bf16 v[80:83], v[116:119], a[68:71], v[80:83]
    v_mfma_f32_16x16x32_bf16 v[48:51], v[120:123], a[64:67], v[48:51]
    v_mfma_f32_16x16x32_bf16 v[84:87], v[120:123], a[68:71], v[84:87]
    v_mfma_f32_16x16x32_bf16 v[52:55], v[124:127], a[64:67], v[52:55]
    v_mfma_f32_16x16x32_bf16 v[88:91], v[124:127], a[68:71], v[88:91]
    s_waitcnt lgkmcnt(0)
    v_mfma_f32_16x16x32_bf16 v[56:59], v[224:227], a[64:67], v[56:59]
    v_mfma_f32_16x16x32_bf16 v[92:95], v[224:227], a[68:71], v[92:95]
    v_mfma_f32_16x16x32_bf16 v[60:63], v[228:231], a[64:67], v[60:63]
    v_mfma_f32_16x16x32_bf16 v[96:99], v[228:231], a[68:71], v[96:99]
    v_mfma_f32_16x16x32_bf16 v[64:67], v[232:235], a[64:67], v[64:67]
    v_mfma_f32_16x16x32_bf16 v[100:103], v[232:235], a[68:71], v[100:103]
    s_nop 7
    s_mul_i32 s27, s70, 12288
    s_cmp_eq_u32 s70, 0
    s_cbranch_scc1 m_x0
    s_cmp_eq_u32 s70, 1
    s_cbranch_scc1 m_x1
    s_cmp_eq_u32 s70, 2
    s_cbranch_scc1 m_x2
    s_branch m_x3
m_x0:
    v_cvt_pk_bf16_f32 v128, v52, v53
    v_cvt_pk_bf16_f32 v129, v54, v55
    v_cvt_pk_bf16_f32 v130, v56, v57
    v_cvt_pk_bf16_f32 v131, v58, v59
    s_add_u32 s28, s27, 3072
    buffer_store_dwordx4 v[128:131], v22, s[52:55], s28 offen sc1
    v_cvt_pk_bf16_f32 v132, v60, v61
    v_cvt_pk_bf16_f32 v133, v62, v63
    v_cvt_pk_bf16_f32 v134, v64, v65
    v_cvt_pk_bf16_f32 v135, v66, v67
    s_add_u32 s28, s27, 4096
    buffer_store_dwordx4 v[132:135], v22, s[52:55], s28 offen sc1
    v_cvt_pk_bf16_f32 v136, v68, v69
    v_cvt_pk_bf16_f32 v137, v70, v71
    s_add_u32 s28, s27, 5120
    buffer_store_dwordx4 v[136:139], v22, s[52:55], s28 offen sc1
    v_cvt_pk_bf16_f32 v140, v72, v73
    v_cvt_pk_bf16_f32 v141, v74, v75
    v_cvt_pk_bf16_f32 v142, v76, v77
    v_cvt_pk_bf16_f32 v143, v78, v79
    s_add_u32 s28, s27, 6144
    buffer_store_dwordx4 v[140:143], v22, s[52:55], s28 offen sc1
    v_cvt_pk_bf16_f32 v144, v80, v81
    v_cvt_pk_bf16_f32 v145, v82, v83
    v_cvt_pk_bf16_f32 v146, v84, v85
    v_cvt_pk_bf16_f32 v147, v86, v87
    s_add_u32 s28, s27, 7168
    buffer_store_dwordx4 v[144:147], v22, s[52:55], s28 offen sc1
    v_cvt_pk_bf16_f32 v148, v88, v89
    v_cvt_pk_bf16_f32 v149, v90, v91
    v_cvt_pk_bf16_f32 v150, v92, v93
    v_cvt_pk_bf16_f32 v151, v94, v95
    s_add_u32 s28, s27, 9216
    buffer_store_dwordx4 v[148:151], v22, s[52:55], s28 offen sc1
    v_cvt_pk_bf16_f32 v152, v96, v97
    v_cvt_pk_bf16_f32 v153, v98, v99
    v_cvt_pk_bf16_f32 v154, v100, v101
    v_cvt_pk_bf16_f32 v155, v102, v103
    s_add_u32 s28, s27, 10240
    buffer_store_dwordx4 v[152:155], v22, s[52:55], s28 offen sc1
    s_waitcnt vmcnt(0)
    s_barrier
    s_cmp_lg_u32 s26, 0
    s_cbranch_scc1 m_go0

    v_mov_b32 v248, s74
    v_mov_b32 v249, 1
    s_mov_b64 exec, 1
    global_atomic_add v248, v249, s[30:31]

m_poll0:
    global_load_dword v250, v248, s[30:31] sc1
    s_waitcnt vmcnt(0)
    v_readfirstlane_b32 s28, v250
    s_cmp_ge_u32 s28, 4
    s_cbranch_scc1 m_pd0
    s_sleep 1
    s_add_u32 s101, s101, 1
    s_cmp_ge_u32 s101, 4194304
    s_cbranch_scc1 m_pd0
    s_branch m_poll0

m_pd0:
    s_mov_b64 exec, -1
m_go0:
    s_barrier
    s_mov_b32 s28, 12288
    buffer_load_dwordx4 v[128:131], v22, s[52:55], s28 offen sc1
    s_mov_b32 s28, 24576
    buffer_load_dwordx4 v[132:135], v22, s[52:55], s28 offen sc1
    s_mov_b32 s28, 36864
    buffer_load_dwordx4 v[136:139], v22, s[52:55], s28 offen sc1
    s_mov_b32 s28, 13312
    buffer_load_dwordx4 v[140:143], v22, s[52:55], s28 offen sc1
    s_mov_b32 s28, 25600
    buffer_load_dwordx4 v[144:147], v22, s[52:55], s28 offen sc1
    s_mov_b32 s28, 37888
    buffer_load_dwordx4 v[148:151], v22, s[52:55], s28 offen sc1
    s_mov_b32 s28, 14336
    buffer_load_dwordx4 v[152:155], v22, s[52:55], s28 offen sc1
    s_mov_b32 s28, 26624
    buffer_load_dwordx4 v[156:159], v22, s[52:55], s28 offen sc1
    s_mov_b32 s28, 38912
    buffer_load_dwordx4 v[160:163], v22, s[52:55], s28 offen sc1
    s_waitcnt vmcnt(6)
    v_lshlrev_b32 v248, 16, v128
    v_and_b32 v249, 0xffff0000, v128
    v_lshlrev_b32 v250, 16, v129
    v_and_b32 v251, 0xffff0000, v129
    v_add_f32 v32, v32, v248
    v_add_f32 v33, v33, v249
    v_add_f32 v34, v34, v250
    v_add_f32 v35, v35, v251
    v_lshlrev_b32 v248, 16, v132
    v_and_b32 v249, 0xffff0000, v132
    v_lshlrev_b32 v250, 16, v133
    v_and_b32 v251, 0xffff0000, v133
    v_add_f32 v32, v32, v248
    v_add_f32 v33, v33, v249
    v_add_f32 v34, v34, v250
    v_add_f32 v35, v35, v251
    v_lshlrev_b32 v248, 16, v136
    v_and_b32 v249, 0xffff0000, v136
    v_lshlrev_b32 v250, 16, v137
    v_and_b32 v251, 0xffff0000, v137
    v_add_f32 v32, v32, v248
    v_add_f32 v33, v33, v249
    v_add_f32 v34, v34, v250
    v_add_f32 v35, v35, v251
    v_lshlrev_b32 v248, 16, v130
    v_and_b32 v249, 0xffff0000, v130
    v_lshlrev_b32 v250, 16, v131
    v_and_b32 v251, 0xffff0000, v131
    v_add_f32 v36, v36, v248
    v_add_f32 v37, v37, v249
    v_add_f32 v38, v38, v250
    v_add_f32 v39, v39, v251
    v_lshlrev_b32 v248, 16, v134
    v_and_b32 v249, 0xffff0000, v134
    v_lshlrev_b32 v250, 16, v135
    v_and_b32 v251, 0xffff0000, v135
    v_add_f32 v36, v36, v248
    v_add_f32 v37, v37, v249
    v_add_f32 v38, v38, v250
    v_add_f32 v39, v39, v251
    v_lshlrev_b32 v248, 16, v138
    v_and_b32 v249, 0xffff0000, v138
    v_lshlrev_b32 v250, 16, v139
    v_and_b32 v251, 0xffff0000, v139
    v_add_f32 v36, v36, v248
    v_add_f32 v37, v37, v249
    v_add_f32 v38, v38, v250
    v_add_f32 v39, v39, v251
    v_cvt_pk_bf16_f32 v164, v32, v33
    v_cvt_pk_bf16_f32 v165, v34, v35
    v_cvt_pk_bf16_f32 v166, v36, v37
    v_cvt_pk_bf16_f32 v167, v38, v39
    s_mov_b32 s28, 0
    s_nop 0
    v_permlane16_swap_b32 v164, v166
    v_permlane16_swap_b32 v165, v167
    buffer_store_dwordx4 v[164:167], v25, s[36:39], s28 offen nt
    s_waitcnt vmcnt(3)
    v_lshlrev_b32 v248, 16, v140
    v_and_b32 v249, 0xffff0000, v140
    v_lshlrev_b32 v250, 16, v141
    v_and_b32 v251, 0xffff0000, v141
    v_add_f32 v40, v40, v248
    v_add_f32 v41, v41, v249
    v_add_f32 v42, v42, v250
    v_add_f32 v43, v43, v251
    v_lshlrev_b32 v248, 16, v144
    v_and_b32 v249, 0xffff0000, v144
    v_lshlrev_b32 v250, 16, v145
    v_and_b32 v251, 0xffff0000, v145
    v_add_f32 v40, v40, v248
    v_add_f32 v41, v41, v249
    v_add_f32 v42, v42, v250
    v_add_f32 v43, v43, v251
    v_lshlrev_b32 v248, 16, v148
    v_and_b32 v249, 0xffff0000, v148
    v_lshlrev_b32 v250, 16, v149
    v_and_b32 v251, 0xffff0000, v149
    v_add_f32 v40, v40, v248
    v_add_f32 v41, v41, v249
    v_add_f32 v42, v42, v250
    v_add_f32 v43, v43, v251
    v_lshlrev_b32 v248, 16, v142
    v_and_b32 v249, 0xffff0000, v142
    v_lshlrev_b32 v250, 16, v143
    v_and_b32 v251, 0xffff0000, v143
    v_add_f32 v44, v44, v248
    v_add_f32 v45, v45, v249
    v_add_f32 v46, v46, v250
    v_add_f32 v47, v47, v251
    v_lshlrev_b32 v248, 16, v146
    v_and_b32 v249, 0xffff0000, v146
    v_lshlrev_b32 v250, 16, v147
    v_and_b32 v251, 0xffff0000, v147
    v_add_f32 v44, v44, v248
    v_add_f32 v45, v45, v249
    v_add_f32 v46, v46, v250
    v_add_f32 v47, v47, v251
    v_lshlrev_b32 v248, 16, v150
    v_and_b32 v249, 0xffff0000, v150
    v_lshlrev_b32 v250, 16, v151
    v_and_b32 v251, 0xffff0000, v151
    v_add_f32 v44, v44, v248
    v_add_f32 v45, v45, v249
    v_add_f32 v46, v46, v250
    v_add_f32 v47, v47, v251
    v_cvt_pk_bf16_f32 v168, v40, v41
    v_cvt_pk_bf16_f32 v169, v42, v43
    v_cvt_pk_bf16_f32 v170, v44, v45
    v_cvt_pk_bf16_f32 v171, v46, v47
    s_mov_b32 s28, 64
    s_nop 0
    v_permlane16_swap_b32 v168, v170
    v_permlane16_swap_b32 v169, v171
    buffer_store_dwordx4 v[168:171], v25, s[36:39], s28 offen nt
    s_waitcnt vmcnt(0)
    v_lshlrev_b32 v248, 16, v152
    v_and_b32 v249, 0xffff0000, v152
    v_lshlrev_b32 v250, 16, v153
    v_and_b32 v251, 0xffff0000, v153
    v_add_f32 v48, v48, v248
    v_add_f32 v49, v49, v249
    v_add_f32 v50, v50, v250
    v_add_f32 v51, v51, v251
    v_lshlrev_b32 v248, 16, v156
    v_and_b32 v249, 0xffff0000, v156
    v_lshlrev_b32 v250, 16, v157
    v_and_b32 v251, 0xffff0000, v157
    v_add_f32 v48, v48, v248
    v_add_f32 v49, v49, v249
    v_add_f32 v50, v50, v250
    v_add_f32 v51, v51, v251
    v_lshlrev_b32 v248, 16, v160
    v_and_b32 v249, 0xffff0000, v160
    v_lshlrev_b32 v250, 16, v161
    v_and_b32 v251, 0xffff0000, v161
    v_add_f32 v48, v48, v248
    v_add_f32 v49, v49, v249
    v_add_f32 v50, v50, v250
    v_add_f32 v51, v51, v251
    v_cvt_pk_bf16_f32 v48, v48, v49
    v_cvt_pk_bf16_f32 v49, v50, v51
    s_mov_b32 s28, 128
    buffer_store_dwordx2 v[48:49], v26, s[36:39], s28 offen nt
    s_branch m_fin
m_x1:
    v_cvt_pk_bf16_f32 v128, v32, v33
    v_cvt_pk_bf16_f32 v129, v34, v35
    v_cvt_pk_bf16_f32 v130, v36, v37
    v_cvt_pk_bf16_f32 v131, v38, v39
    s_add_u32 s28, s27, 0
    buffer_store_dwordx4 v[128:131], v22, s[52:55], s28 offen sc1
    v_cvt_pk_bf16_f32 v132, v40, v41
    v_cvt_pk_bf16_f32 v133, v42, v43
    v_cvt_pk_bf16_f32 v134, v44, v45
    v_cvt_pk_bf16_f32 v135, v46, v47
    s_add_u32 s28, s27, 1024
    buffer_store_dwordx4 v[132:135], v22, s[52:55], s28 offen sc1
    v_cvt_pk_bf16_f32 v136, v48, v49
    v_cvt_pk_bf16_f32 v137, v50, v51
    s_add_u32 s28, s27, 2048
    buffer_store_dwordx4 v[136:139], v22, s[52:55], s28 offen sc1
    v_cvt_pk_bf16_f32 v140, v72, v73
    v_cvt_pk_bf16_f32 v141, v74, v75
    v_cvt_pk_bf16_f32 v142, v76, v77
    v_cvt_pk_bf16_f32 v143, v78, v79
    s_add_u32 s28, s27, 6144
    buffer_store_dwordx4 v[140:143], v22, s[52:55], s28 offen sc1
    v_cvt_pk_bf16_f32 v144, v80, v81
    v_cvt_pk_bf16_f32 v145, v82, v83
    v_cvt_pk_bf16_f32 v146, v84, v85
    v_cvt_pk_bf16_f32 v147, v86, v87
    s_add_u32 s28, s27, 7168
    buffer_store_dwordx4 v[144:147], v22, s[52:55], s28 offen sc1
    v_cvt_pk_bf16_f32 v148, v88, v89
    v_cvt_pk_bf16_f32 v149, v90, v91
    v_cvt_pk_bf16_f32 v150, v92, v93
    v_cvt_pk_bf16_f32 v151, v94, v95
    s_add_u32 s28, s27, 9216
    buffer_store_dwordx4 v[148:151], v22, s[52:55], s28 offen sc1
    v_cvt_pk_bf16_f32 v152, v96, v97
    v_cvt_pk_bf16_f32 v153, v98, v99
    v_cvt_pk_bf16_f32 v154, v100, v101
    v_cvt_pk_bf16_f32 v155, v102, v103
    s_add_u32 s28, s27, 10240
    buffer_store_dwordx4 v[152:155], v22, s[52:55], s28 offen sc1
    s_waitcnt vmcnt(0)
    s_barrier
    s_cmp_lg_u32 s26, 0
    s_cbranch_scc1 m_go1

    v_mov_b32 v248, s74
    v_mov_b32 v249, 1
    s_mov_b64 exec, 1
    global_atomic_add v248, v249, s[30:31]

m_poll1:
    global_load_dword v250, v248, s[30:31] sc1
    s_waitcnt vmcnt(0)
    v_readfirstlane_b32 s28, v250
    s_cmp_ge_u32 s28, 4
    s_cbranch_scc1 m_pd1
    s_sleep 1
    s_add_u32 s101, s101, 1
    s_cmp_ge_u32 s101, 4194304
    s_cbranch_scc1 m_pd1
    s_branch m_poll1

m_pd1:
    s_mov_b64 exec, -1
m_go1:
    s_barrier
    s_mov_b32 s28, 3072
    buffer_load_dwordx4 v[128:131], v22, s[52:55], s28 offen sc1
    s_mov_b32 s28, 27648
    buffer_load_dwordx4 v[132:135], v22, s[52:55], s28 offen sc1
    s_mov_b32 s28, 39936
    buffer_load_dwordx4 v[136:139], v22, s[52:55], s28 offen sc1
    s_mov_b32 s28, 4096
    buffer_load_dwordx4 v[140:143], v22, s[52:55], s28 offen sc1
    s_mov_b32 s28, 28672
    buffer_load_dwordx4 v[144:147], v22, s[52:55], s28 offen sc1
    s_mov_b32 s28, 40960
    buffer_load_dwordx4 v[148:151], v22, s[52:55], s28 offen sc1
    s_mov_b32 s28, 5120
    buffer_load_dwordx4 v[152:155], v22, s[52:55], s28 offen sc1
    s_mov_b32 s28, 29696
    buffer_load_dwordx4 v[156:159], v22, s[52:55], s28 offen sc1
    s_mov_b32 s28, 41984
    buffer_load_dwordx4 v[160:163], v22, s[52:55], s28 offen sc1
    s_waitcnt vmcnt(6)
    v_lshlrev_b32 v248, 16, v128
    v_and_b32 v249, 0xffff0000, v128
    v_lshlrev_b32 v250, 16, v129
    v_and_b32 v251, 0xffff0000, v129
    v_add_f32 v52, v52, v248
    v_add_f32 v53, v53, v249
    v_add_f32 v54, v54, v250
    v_add_f32 v55, v55, v251
    v_lshlrev_b32 v248, 16, v132
    v_and_b32 v249, 0xffff0000, v132
    v_lshlrev_b32 v250, 16, v133
    v_and_b32 v251, 0xffff0000, v133
    v_add_f32 v52, v52, v248
    v_add_f32 v53, v53, v249
    v_add_f32 v54, v54, v250
    v_add_f32 v55, v55, v251
    v_lshlrev_b32 v248, 16, v136
    v_and_b32 v249, 0xffff0000, v136
    v_lshlrev_b32 v250, 16, v137
    v_and_b32 v251, 0xffff0000, v137
    v_add_f32 v52, v52, v248
    v_add_f32 v53, v53, v249
    v_add_f32 v54, v54, v250
    v_add_f32 v55, v55, v251
    v_lshlrev_b32 v248, 16, v130
    v_and_b32 v249, 0xffff0000, v130
    v_lshlrev_b32 v250, 16, v131
    v_and_b32 v251, 0xffff0000, v131
    v_add_f32 v56, v56, v248
    v_add_f32 v57, v57, v249
    v_add_f32 v58, v58, v250
    v_add_f32 v59, v59, v251
    v_lshlrev_b32 v248, 16, v134
    v_and_b32 v249, 0xffff0000, v134
    v_lshlrev_b32 v250, 16, v135
    v_and_b32 v251, 0xffff0000, v135
    v_add_f32 v56, v56, v248
    v_add_f32 v57, v57, v249
    v_add_f32 v58, v58, v250
    v_add_f32 v59, v59, v251
    v_lshlrev_b32 v248, 16, v138
    v_and_b32 v249, 0xffff0000, v138
    v_lshlrev_b32 v250, 16, v139
    v_and_b32 v251, 0xffff0000, v139
    v_add_f32 v56, v56, v248
    v_add_f32 v57, v57, v249
    v_add_f32 v58, v58, v250
    v_add_f32 v59, v59, v251
    v_cvt_pk_bf16_f32 v164, v52, v53
    v_cvt_pk_bf16_f32 v165, v54, v55
    v_cvt_pk_bf16_f32 v166, v56, v57
    v_cvt_pk_bf16_f32 v167, v58, v59
    s_mov_b32 s28, 160
    s_nop 0
    v_permlane16_swap_b32 v164, v166
    v_permlane16_swap_b32 v165, v167
    buffer_store_dwordx4 v[164:167], v25, s[36:39], s28 offen nt
    s_waitcnt vmcnt(3)
    v_lshlrev_b32 v248, 16, v140
    v_and_b32 v249, 0xffff0000, v140
    v_lshlrev_b32 v250, 16, v141
    v_and_b32 v251, 0xffff0000, v141
    v_add_f32 v60, v60, v248
    v_add_f32 v61, v61, v249
    v_add_f32 v62, v62, v250
    v_add_f32 v63, v63, v251
    v_lshlrev_b32 v248, 16, v144
    v_and_b32 v249, 0xffff0000, v144
    v_lshlrev_b32 v250, 16, v145
    v_and_b32 v251, 0xffff0000, v145
    v_add_f32 v60, v60, v248
    v_add_f32 v61, v61, v249
    v_add_f32 v62, v62, v250
    v_add_f32 v63, v63, v251
    v_lshlrev_b32 v248, 16, v148
    v_and_b32 v249, 0xffff0000, v148
    v_lshlrev_b32 v250, 16, v149
    v_and_b32 v251, 0xffff0000, v149
    v_add_f32 v60, v60, v248
    v_add_f32 v61, v61, v249
    v_add_f32 v62, v62, v250
    v_add_f32 v63, v63, v251
    v_lshlrev_b32 v248, 16, v142
    v_and_b32 v249, 0xffff0000, v142
    v_lshlrev_b32 v250, 16, v143
    v_and_b32 v251, 0xffff0000, v143
    v_add_f32 v64, v64, v248
    v_add_f32 v65, v65, v249
    v_add_f32 v66, v66, v250
    v_add_f32 v67, v67, v251
    v_lshlrev_b32 v248, 16, v146
    v_and_b32 v249, 0xffff0000, v146
    v_lshlrev_b32 v250, 16, v147
    v_and_b32 v251, 0xffff0000, v147
    v_add_f32 v64, v64, v248
    v_add_f32 v65, v65, v249
    v_add_f32 v66, v66, v250
    v_add_f32 v67, v67, v251
    v_lshlrev_b32 v248, 16, v150
    v_and_b32 v249, 0xffff0000, v150
    v_lshlrev_b32 v250, 16, v151
    v_and_b32 v251, 0xffff0000, v151
    v_add_f32 v64, v64, v248
    v_add_f32 v65, v65, v249
    v_add_f32 v66, v66, v250
    v_add_f32 v67, v67, v251
    v_cvt_pk_bf16_f32 v168, v60, v61
    v_cvt_pk_bf16_f32 v169, v62, v63
    v_cvt_pk_bf16_f32 v170, v64, v65
    v_cvt_pk_bf16_f32 v171, v66, v67
    s_mov_b32 s28, 224
    s_nop 0
    v_permlane16_swap_b32 v168, v170
    v_permlane16_swap_b32 v169, v171
    buffer_store_dwordx4 v[168:171], v25, s[36:39], s28 offen nt
    s_waitcnt vmcnt(0)
    v_lshlrev_b32 v248, 16, v152
    v_and_b32 v249, 0xffff0000, v152
    v_lshlrev_b32 v250, 16, v153
    v_and_b32 v251, 0xffff0000, v153
    v_add_f32 v68, v68, v248
    v_add_f32 v69, v69, v249
    v_add_f32 v70, v70, v250
    v_add_f32 v71, v71, v251
    v_lshlrev_b32 v248, 16, v156
    v_and_b32 v249, 0xffff0000, v156
    v_lshlrev_b32 v250, 16, v157
    v_and_b32 v251, 0xffff0000, v157
    v_add_f32 v68, v68, v248
    v_add_f32 v69, v69, v249
    v_add_f32 v70, v70, v250
    v_add_f32 v71, v71, v251
    v_lshlrev_b32 v248, 16, v160
    v_and_b32 v249, 0xffff0000, v160
    v_lshlrev_b32 v250, 16, v161
    v_and_b32 v251, 0xffff0000, v161
    v_add_f32 v68, v68, v248
    v_add_f32 v69, v69, v249
    v_add_f32 v70, v70, v250
    v_add_f32 v71, v71, v251
    v_cvt_pk_bf16_f32 v68, v68, v69
    v_cvt_pk_bf16_f32 v69, v70, v71
    s_mov_b32 s28, 18432
    buffer_store_dwordx2 v[68:69], v26, s[36:39], s28 offen nt
    s_branch m_fin
m_x2:
    v_cvt_pk_bf16_f32 v128, v32, v33
    v_cvt_pk_bf16_f32 v129, v34, v35
    v_cvt_pk_bf16_f32 v130, v36, v37
    v_cvt_pk_bf16_f32 v131, v38, v39
    s_add_u32 s28, s27, 0
    buffer_store_dwordx4 v[128:131], v22, s[52:55], s28 offen sc1
    v_cvt_pk_bf16_f32 v132, v40, v41
    v_cvt_pk_bf16_f32 v133, v42, v43
    v_cvt_pk_bf16_f32 v134, v44, v45
    v_cvt_pk_bf16_f32 v135, v46, v47
    s_add_u32 s28, s27, 1024
    buffer_store_dwordx4 v[132:135], v22, s[52:55], s28 offen sc1
    v_cvt_pk_bf16_f32 v136, v48, v49
    v_cvt_pk_bf16_f32 v137, v50, v51
    s_add_u32 s28, s27, 2048
    buffer_store_dwordx4 v[136:139], v22, s[52:55], s28 offen sc1
    v_cvt_pk_bf16_f32 v140, v52, v53
    v_cvt_pk_bf16_f32 v141, v54, v55
    v_cvt_pk_bf16_f32 v142, v56, v57
    v_cvt_pk_bf16_f32 v143, v58, v59
    s_add_u32 s28, s27, 3072
    buffer_store_dwordx4 v[140:143], v22, s[52:55], s28 offen sc1
    v_cvt_pk_bf16_f32 v144, v60, v61
    v_cvt_pk_bf16_f32 v145, v62, v63
    v_cvt_pk_bf16_f32 v146, v64, v65
    v_cvt_pk_bf16_f32 v147, v66, v67
    s_add_u32 s28, s27, 4096
    buffer_store_dwordx4 v[144:147], v22, s[52:55], s28 offen sc1
    v_cvt_pk_bf16_f32 v148, v68, v69
    v_cvt_pk_bf16_f32 v149, v70, v71
    s_add_u32 s28, s27, 5120
    buffer_store_dwordx4 v[148:151], v22, s[52:55], s28 offen sc1
    v_cvt_pk_bf16_f32 v152, v88, v89
    v_cvt_pk_bf16_f32 v153, v90, v91
    v_cvt_pk_bf16_f32 v154, v92, v93
    v_cvt_pk_bf16_f32 v155, v94, v95
    s_add_u32 s28, s27, 9216
    buffer_store_dwordx4 v[152:155], v22, s[52:55], s28 offen sc1
    v_cvt_pk_bf16_f32 v156, v96, v97
    v_cvt_pk_bf16_f32 v157, v98, v99
    v_cvt_pk_bf16_f32 v158, v100, v101
    v_cvt_pk_bf16_f32 v159, v102, v103
    s_add_u32 s28, s27, 10240
    buffer_store_dwordx4 v[156:159], v22, s[52:55], s28 offen sc1
    s_waitcnt vmcnt(0)
    s_barrier
    s_cmp_lg_u32 s26, 0
    s_cbranch_scc1 m_go2

    v_mov_b32 v248, s74
    v_mov_b32 v249, 1
    s_mov_b64 exec, 1
    global_atomic_add v248, v249, s[30:31]

m_poll2:
    global_load_dword v250, v248, s[30:31] sc1
    s_waitcnt vmcnt(0)
    v_readfirstlane_b32 s28, v250
    s_cmp_ge_u32 s28, 4
    s_cbranch_scc1 m_pd2
    s_sleep 1
    s_add_u32 s101, s101, 1
    s_cmp_ge_u32 s101, 4194304
    s_cbranch_scc1 m_pd2
    s_branch m_poll2

m_pd2:
    s_mov_b64 exec, -1
m_go2:
    s_barrier
    s_mov_b32 s28, 6144
    buffer_load_dwordx4 v[128:131], v22, s[52:55], s28 offen sc1
    s_mov_b32 s28, 18432
    buffer_load_dwordx4 v[132:135], v22, s[52:55], s28 offen sc1
    s_mov_b32 s28, 43008
    buffer_load_dwordx4 v[136:139], v22, s[52:55], s28 offen sc1
    s_mov_b32 s28, 7168
    buffer_load_dwordx4 v[140:143], v22, s[52:55], s28 offen sc1
    s_mov_b32 s28, 19456
    buffer_load_dwordx4 v[144:147], v22, s[52:55], s28 offen sc1
    s_mov_b32 s28, 44032
    buffer_load_dwordx4 v[148:151], v22, s[52:55], s28 offen sc1
    s_waitcnt vmcnt(3)
    v_lshlrev_b32 v248, 16, v128
    v_and_b32 v249, 0xffff0000, v128
    v_lshlrev_b32 v250, 16, v129
    v_and_b32 v251, 0xffff0000, v129
    v_add_f32 v72, v72, v248
    v_add_f32 v73, v73, v249
    v_add_f32 v74, v74, v250
    v_add_f32 v75, v75, v251
    v_lshlrev_b32 v248, 16, v132
    v_and_b32 v249, 0xffff0000, v132
    v_lshlrev_b32 v250, 16, v133
    v_and_b32 v251, 0xffff0000, v133
    v_add_f32 v72, v72, v248
    v_add_f32 v73, v73, v249
    v_add_f32 v74, v74, v250
    v_add_f32 v75, v75, v251
    v_lshlrev_b32 v248, 16, v136
    v_and_b32 v249, 0xffff0000, v136
    v_lshlrev_b32 v250, 16, v137
    v_and_b32 v251, 0xffff0000, v137
    v_add_f32 v72, v72, v248
    v_add_f32 v73, v73, v249
    v_add_f32 v74, v74, v250
    v_add_f32 v75, v75, v251
    v_lshlrev_b32 v248, 16, v130
    v_and_b32 v249, 0xffff0000, v130
    v_lshlrev_b32 v250, 16, v131
    v_and_b32 v251, 0xffff0000, v131
    v_add_f32 v76, v76, v248
    v_add_f32 v77, v77, v249
    v_add_f32 v78, v78, v250
    v_add_f32 v79, v79, v251
    v_lshlrev_b32 v248, 16, v134
    v_and_b32 v249, 0xffff0000, v134
    v_lshlrev_b32 v250, 16, v135
    v_and_b32 v251, 0xffff0000, v135
    v_add_f32 v76, v76, v248
    v_add_f32 v77, v77, v249
    v_add_f32 v78, v78, v250
    v_add_f32 v79, v79, v251
    v_lshlrev_b32 v248, 16, v138
    v_and_b32 v249, 0xffff0000, v138
    v_lshlrev_b32 v250, 16, v139
    v_and_b32 v251, 0xffff0000, v139
    v_add_f32 v76, v76, v248
    v_add_f32 v77, v77, v249
    v_add_f32 v78, v78, v250
    v_add_f32 v79, v79, v251
    v_cvt_pk_bf16_f32 v164, v72, v73
    v_cvt_pk_bf16_f32 v165, v74, v75
    v_cvt_pk_bf16_f32 v166, v76, v77
    v_cvt_pk_bf16_f32 v167, v78, v79
    s_mov_b32 s28, 18464
    s_nop 0
    v_permlane16_swap_b32 v164, v166
    v_permlane16_swap_b32 v165, v167
    buffer_store_dwordx4 v[164:167], v25, s[36:39], s28 offen nt
    s_waitcnt vmcnt(0)
    v_lshlrev_b32 v248, 16, v140
    v_and_b32 v249, 0xffff0000, v140
    v_lshlrev_b32 v250, 16, v141
    v_and_b32 v251, 0xffff0000, v141
    v_add_f32 v80, v80, v248
    v_add_f32 v81, v81, v249
    v_add_f32 v82, v82, v250
    v_add_f32 v83, v83, v251
    v_lshlrev_b32 v248, 16, v144
    v_and_b32 v249, 0xffff0000, v144
    v_lshlrev_b32 v250, 16, v145
    v_and_b32 v251, 0xffff0000, v145
    v_add_f32 v80, v80, v248
    v_add_f32 v81, v81, v249
    v_add_f32 v82, v82, v250
    v_add_f32 v83, v83, v251
    v_lshlrev_b32 v248, 16, v148
    v_and_b32 v249, 0xffff0000, v148
    v_lshlrev_b32 v250, 16, v149
    v_and_b32 v251, 0xffff0000, v149
    v_add_f32 v80, v80, v248
    v_add_f32 v81, v81, v249
    v_add_f32 v82, v82, v250
    v_add_f32 v83, v83, v251
    v_lshlrev_b32 v248, 16, v142
    v_and_b32 v249, 0xffff0000, v142
    v_lshlrev_b32 v250, 16, v143
    v_and_b32 v251, 0xffff0000, v143
    v_add_f32 v84, v84, v248
    v_add_f32 v85, v85, v249
    v_add_f32 v86, v86, v250
    v_add_f32 v87, v87, v251
    v_lshlrev_b32 v248, 16, v146
    v_and_b32 v249, 0xffff0000, v146
    v_lshlrev_b32 v250, 16, v147
    v_and_b32 v251, 0xffff0000, v147
    v_add_f32 v84, v84, v248
    v_add_f32 v85, v85, v249
    v_add_f32 v86, v86, v250
    v_add_f32 v87, v87, v251
    v_lshlrev_b32 v248, 16, v150
    v_and_b32 v249, 0xffff0000, v150
    v_lshlrev_b32 v250, 16, v151
    v_and_b32 v251, 0xffff0000, v151
    v_add_f32 v84, v84, v248
    v_add_f32 v85, v85, v249
    v_add_f32 v86, v86, v250
    v_add_f32 v87, v87, v251
    v_cvt_pk_bf16_f32 v168, v80, v81
    v_cvt_pk_bf16_f32 v169, v82, v83
    v_cvt_pk_bf16_f32 v170, v84, v85
    v_cvt_pk_bf16_f32 v171, v86, v87
    s_mov_b32 s28, 18528
    s_nop 0
    v_permlane16_swap_b32 v168, v170
    v_permlane16_swap_b32 v169, v171
    buffer_store_dwordx4 v[168:171], v25, s[36:39], s28 offen nt
    s_branch m_fin
m_x3:
    v_cvt_pk_bf16_f32 v128, v32, v33
    v_cvt_pk_bf16_f32 v129, v34, v35
    v_cvt_pk_bf16_f32 v130, v36, v37
    v_cvt_pk_bf16_f32 v131, v38, v39
    s_add_u32 s28, s27, 0
    buffer_store_dwordx4 v[128:131], v22, s[52:55], s28 offen sc1
    v_cvt_pk_bf16_f32 v132, v40, v41
    v_cvt_pk_bf16_f32 v133, v42, v43
    v_cvt_pk_bf16_f32 v134, v44, v45
    v_cvt_pk_bf16_f32 v135, v46, v47
    s_add_u32 s28, s27, 1024
    buffer_store_dwordx4 v[132:135], v22, s[52:55], s28 offen sc1
    v_cvt_pk_bf16_f32 v136, v48, v49
    v_cvt_pk_bf16_f32 v137, v50, v51
    s_add_u32 s28, s27, 2048
    buffer_store_dwordx4 v[136:139], v22, s[52:55], s28 offen sc1
    v_cvt_pk_bf16_f32 v140, v52, v53
    v_cvt_pk_bf16_f32 v141, v54, v55
    v_cvt_pk_bf16_f32 v142, v56, v57
    v_cvt_pk_bf16_f32 v143, v58, v59
    s_add_u32 s28, s27, 3072
    buffer_store_dwordx4 v[140:143], v22, s[52:55], s28 offen sc1
    v_cvt_pk_bf16_f32 v144, v60, v61
    v_cvt_pk_bf16_f32 v145, v62, v63
    v_cvt_pk_bf16_f32 v146, v64, v65
    v_cvt_pk_bf16_f32 v147, v66, v67
    s_add_u32 s28, s27, 4096
    buffer_store_dwordx4 v[144:147], v22, s[52:55], s28 offen sc1
    v_cvt_pk_bf16_f32 v148, v68, v69
    v_cvt_pk_bf16_f32 v149, v70, v71
    s_add_u32 s28, s27, 5120
    buffer_store_dwordx4 v[148:151], v22, s[52:55], s28 offen sc1
    v_cvt_pk_bf16_f32 v152, v72, v73
    v_cvt_pk_bf16_f32 v153, v74, v75
    v_cvt_pk_bf16_f32 v154, v76, v77
    v_cvt_pk_bf16_f32 v155, v78, v79
    s_add_u32 s28, s27, 6144
    buffer_store_dwordx4 v[152:155], v22, s[52:55], s28 offen sc1
    v_cvt_pk_bf16_f32 v156, v80, v81
    v_cvt_pk_bf16_f32 v157, v82, v83
    v_cvt_pk_bf16_f32 v158, v84, v85
    v_cvt_pk_bf16_f32 v159, v86, v87
    s_add_u32 s28, s27, 7168
    buffer_store_dwordx4 v[156:159], v22, s[52:55], s28 offen sc1
    s_waitcnt vmcnt(0)
    s_barrier
    s_cmp_lg_u32 s26, 0
    s_cbranch_scc1 m_go3

    v_mov_b32 v248, s74
    v_mov_b32 v249, 1
    s_mov_b64 exec, 1
    global_atomic_add v248, v249, s[30:31]

m_poll3:
    global_load_dword v250, v248, s[30:31] sc1
    s_waitcnt vmcnt(0)
    v_readfirstlane_b32 s28, v250
    s_cmp_ge_u32 s28, 4
    s_cbranch_scc1 m_pd3
    s_sleep 1
    s_add_u32 s101, s101, 1
    s_cmp_ge_u32 s101, 4194304
    s_cbranch_scc1 m_pd3
    s_branch m_poll3

m_pd3:
    s_mov_b64 exec, -1
m_go3:
    s_barrier
    s_mov_b32 s28, 9216
    buffer_load_dwordx4 v[128:131], v22, s[52:55], s28 offen sc1
    s_mov_b32 s28, 21504
    buffer_load_dwordx4 v[132:135], v22, s[52:55], s28 offen sc1
    s_mov_b32 s28, 33792
    buffer_load_dwordx4 v[136:139], v22, s[52:55], s28 offen sc1
    s_mov_b32 s28, 10240
    buffer_load_dwordx4 v[140:143], v22, s[52:55], s28 offen sc1
    s_mov_b32 s28, 22528
    buffer_load_dwordx4 v[144:147], v22, s[52:55], s28 offen sc1
    s_mov_b32 s28, 34816
    buffer_load_dwordx4 v[148:151], v22, s[52:55], s28 offen sc1
    s_waitcnt vmcnt(3)
    v_lshlrev_b32 v248, 16, v128
    v_and_b32 v249, 0xffff0000, v128
    v_lshlrev_b32 v250, 16, v129
    v_and_b32 v251, 0xffff0000, v129
    v_add_f32 v88, v88, v248
    v_add_f32 v89, v89, v249
    v_add_f32 v90, v90, v250
    v_add_f32 v91, v91, v251
    v_lshlrev_b32 v248, 16, v132
    v_and_b32 v249, 0xffff0000, v132
    v_lshlrev_b32 v250, 16, v133
    v_and_b32 v251, 0xffff0000, v133
    v_add_f32 v88, v88, v248
    v_add_f32 v89, v89, v249
    v_add_f32 v90, v90, v250
    v_add_f32 v91, v91, v251
    v_lshlrev_b32 v248, 16, v136
    v_and_b32 v249, 0xffff0000, v136
    v_lshlrev_b32 v250, 16, v137
    v_and_b32 v251, 0xffff0000, v137
    v_add_f32 v88, v88, v248
    v_add_f32 v89, v89, v249
    v_add_f32 v90, v90, v250
    v_add_f32 v91, v91, v251
    v_lshlrev_b32 v248, 16, v130
    v_and_b32 v249, 0xffff0000, v130
    v_lshlrev_b32 v250, 16, v131
    v_and_b32 v251, 0xffff0000, v131
    v_add_f32 v92, v92, v248
    v_add_f32 v93, v93, v249
    v_add_f32 v94, v94, v250
    v_add_f32 v95, v95, v251
    v_lshlrev_b32 v248, 16, v134
    v_and_b32 v249, 0xffff0000, v134
    v_lshlrev_b32 v250, 16, v135
    v_and_b32 v251, 0xffff0000, v135
    v_add_f32 v92, v92, v248
    v_add_f32 v93, v93, v249
    v_add_f32 v94, v94, v250
    v_add_f32 v95, v95, v251
    v_lshlrev_b32 v248, 16, v138
    v_and_b32 v249, 0xffff0000, v138
    v_lshlrev_b32 v250, 16, v139
    v_and_b32 v251, 0xffff0000, v139
    v_add_f32 v92, v92, v248
    v_add_f32 v93, v93, v249
    v_add_f32 v94, v94, v250
    v_add_f32 v95, v95, v251
    v_cvt_pk_bf16_f32 v164, v88, v89
    v_cvt_pk_bf16_f32 v165, v90, v91
    v_cvt_pk_bf16_f32 v166, v92, v93
    v_cvt_pk_bf16_f32 v167, v94, v95
    s_mov_b32 s28, 18592
    s_nop 0
    v_permlane16_swap_b32 v164, v166
    v_permlane16_swap_b32 v165, v167
    buffer_store_dwordx4 v[164:167], v25, s[36:39], s28 offen nt
    s_waitcnt vmcnt(0)
    v_lshlrev_b32 v248, 16, v140
    v_and_b32 v249, 0xffff0000, v140
    v_lshlrev_b32 v250, 16, v141
    v_and_b32 v251, 0xffff0000, v141
    v_add_f32 v96, v96, v248
    v_add_f32 v97, v97, v249
    v_add_f32 v98, v98, v250
    v_add_f32 v99, v99, v251
    v_lshlrev_b32 v248, 16, v144
    v_and_b32 v249, 0xffff0000, v144
    v_lshlrev_b32 v250, 16, v145
    v_and_b32 v251, 0xffff0000, v145
    v_add_f32 v96, v96, v248
    v_add_f32 v97, v97, v249
    v_add_f32 v98, v98, v250
    v_add_f32 v99, v99, v251
    v_lshlrev_b32 v248, 16, v148
    v_and_b32 v249, 0xffff0000, v148
    v_lshlrev_b32 v250, 16, v149
    v_and_b32 v251, 0xffff0000, v149
    v_add_f32 v96, v96, v248
    v_add_f32 v97, v97, v249
    v_add_f32 v98, v98, v250
    v_add_f32 v99, v99, v251
    v_lshlrev_b32 v248, 16, v142
    v_and_b32 v249, 0xffff0000, v142
    v_lshlrev_b32 v250, 16, v143
    v_and_b32 v251, 0xffff0000, v143
    v_add_f32 v100, v100, v248
    v_add_f32 v101, v101, v249
    v_add_f32 v102, v102, v250
    v_add_f32 v103, v103, v251
    v_lshlrev_b32 v248, 16, v146
    v_and_b32 v249, 0xffff0000, v146
    v_lshlrev_b32 v250, 16, v147
    v_and_b32 v251, 0xffff0000, v147
    v_add_f32 v100, v100, v248
    v_add_f32 v101, v101, v249
    v_add_f32 v102, v102, v250
    v_add_f32 v103, v103, v251
    v_lshlrev_b32 v248, 16, v150
    v_and_b32 v249, 0xffff0000, v150
    v_lshlrev_b32 v250, 16, v151
    v_and_b32 v251, 0xffff0000, v151
    v_add_f32 v100, v100, v248
    v_add_f32 v101, v101, v249
    v_add_f32 v102, v102, v250
    v_add_f32 v103, v103, v251
    v_cvt_pk_bf16_f32 v168, v96, v97
    v_cvt_pk_bf16_f32 v169, v98, v99
    v_cvt_pk_bf16_f32 v170, v100, v101
    v_cvt_pk_bf16_f32 v171, v102, v103
    s_mov_b32 s28, 18656
    s_nop 0
    v_permlane16_swap_b32 v168, v170
    v_permlane16_swap_b32 v169, v171
    buffer_store_dwordx4 v[168:171], v25, s[36:39], s28 offen nt
    s_branch m_fin
m_fin:
    s_endpgm
m_code_end:
.section .rodata,"a"
.p2align 6
.amdhsa_kernel gated_mix__linear_attn_block__swiglu_ffn__prompt_kernel
  .amdhsa_next_free_vgpr 512
  .amdhsa_next_free_sgpr 102
  .amdhsa_accum_offset 256
  .amdhsa_group_segment_fixed_size 0
  .amdhsa_kernarg_size 88
  .amdhsa_user_sgpr_count 2
  .amdhsa_user_sgpr_kernarg_segment_ptr 1
  .amdhsa_system_sgpr_workgroup_id_x 1
.end_amdhsa_kernel
.text
```
